```python
import torch

def _softmax(x, axis=-1):
    return torch.softmax(x, dim=axis)

def _gelu(x):
    return torch.nn.functional.gelu(x, approximate='tanh')

def _silu(x):
    return torch.nn.functional.silu(x)

def _sigmoid(x):
    return torch.sigmoid(x)

def _layernorm(x, axis=-1, eps=1e-05):
    m = x.mean(dim=axis, keepdim=True)
    v = x.var(dim=axis, keepdim=True, unbiased=False)
    return (x - m) / torch.sqrt(v + eps)

def _scatter_add(tgt, idx, src, axis=0):
    return tgt.clone().index_add_(axis, idx, src)

def _segment_sum(src, seg, n):
    out = torch.zeros((n,) + src.shape[1:], dtype=src.dtype)
    return out.index_add_(0, seg, src)

def _pad(x, pw):
    flat = tuple((v for pair in reversed(pw) for v in pair))
    return torch.nn.functional.pad(x, flat)
kernel_name = 'parallel_sum__memory_aug_recurrent_mem_tr__dense_activation_gelu__prompt'

def setup_inputs():

    _w = lambda a: (lambda t: t.to(torch.bfloat16) if t.is_floating_point() else t)(torch.as_tensor(a))

    def _A_setup():
        B, S, Dm = (1, 2048, 576)
        H, Dh = (32, 128)
        M, seg = (8, 32)
        seg = min(seg, S)
        S = S // seg * seg
        return {'x': _w((lambda *s: torch.randn(*s, dtype=torch.bfloat16) * 0.05)(B, S, Dm)), 'mem0': _w((lambda *s: torch.randn(*s, dtype=torch.bfloat16) * 0.2)(B, M, Dm)), 'Wq': _w((lambda *s: torch.randn(*s, dtype=torch.bfloat16) * 1.6)(Dm, H, Dh) * Dm ** (-0.5)), 'Wk': _w((lambda *s: torch.randn(*s, dtype=torch.bfloat16) * 1.6)(Dm, H, Dh) * Dm ** (-0.5)), 'Wv': _w((lambda *s: torch.randn(*s, dtype=torch.bfloat16) * 0.2)(Dm, H, Dh) * Dm ** (-0.5)), 'Wo': _w((lambda *s: torch.randn(*s, dtype=torch.bfloat16) * 0.2)(H, Dh, Dm) * (H * Dh) ** (-0.5)), 'seg_len': seg}
    _A_in = _A_setup()

    def _B_setup():
        B, S, D, F = (1, 2048, 576, 4608)
        return {'x': _w((lambda *s: torch.randn(*s, dtype=torch.bfloat16) * 0.05)(B, S, D)), 'w1': _w((lambda *s: torch.randn(*s, dtype=torch.bfloat16) * 0.8)(D, F) * D ** (-0.5)), 'b1': _w((lambda *s: torch.randn(*s, dtype=torch.bfloat16) * 12.8)(F) * 0.01), 'w2': _w((lambda *s: torch.randn(*s, dtype=torch.bfloat16) * 0.2)(F, D) * F ** (-0.5)), 'b2': _w((lambda *s: torch.randn(*s, dtype=torch.bfloat16) * 3.2)(D) * 0.01)}
    _B_in = _B_setup()
    return {'A_x': _A_in['x'], 'A_mem0': _A_in['mem0'], 'A_Wq': _A_in['Wq'], 'A_Wk': _A_in['Wk'], 'A_Wv': _A_in['Wv'], 'A_Wo': _A_in['Wo'], 'A_seg_len': _A_in['seg_len'], 'B_x': _B_in['x'], 'B_w1': _B_in['w1'], 'B_b1': _B_in['b1'], 'B_w2': _B_in['w2'], 'B_b2': _B_in['b2']}

def reference(A_x, A_mem0, A_Wq, A_Wk, A_Wv, A_Wo, A_seg_len, B_x, B_w1, B_b1, B_w2, B_b2):

    def _A_ref(x, mem0, Wq, Wk, Wv, Wo, seg_len):
        B, S, Dm = x.shape
        H, Dh = (Wq.shape[1], Wq.shape[2])
        M = mem0.shape[1]
        scale = Dh ** (-0.5)
        n_seg = S // seg_len
        L = M + seg_len
        idx = torch.arange(L)
        mask = (idx[:, None] < M) | (idx[:, None] >= idx[None, :])
        mem = mem0
        outs = []
        for s in range(n_seg):
            xs = x[:, s * seg_len:(s + 1) * seg_len, :].clone()
            h = torch.concatenate([mem, xs], axis=1)
            q = torch.einsum('btd,dhe->bhte', h, Wq)
            k = torch.einsum('btd,dhe->bhte', h, Wk)
            v = torch.einsum('btd,dhe->bhte', h, Wv)
            scores = torch.einsum('bhqe,bhke->bhqk', q, k) * scale
            scores = torch.where(mask[None, None], scores, -1000000000.0)
            p = _softmax(scores, axis=-1)
            o = torch.einsum('bhqk,bhke->bhqe', p, v)
            o = torch.einsum('bhte,hed->btd', o, Wo)
            mem = o[:, :M, :].clone()
            outs.append(o[:, M:, :])
        return torch.concatenate(outs, axis=1)

    def _B_ref(x, w1, b1, w2, b2):
        h = torch.einsum('bsd,df->bsf', x, w1) + b1
        h = _gelu(h)
        return torch.einsum('bsf,fd->bsd', h, w2) + b2
    x = A_x
    xn = _layernorm(x, axis=-1)
    return x + _A_ref(xn, A_mem0, A_Wq, A_Wk, A_Wv, A_Wo, A_seg_len) + _B_ref(xn, B_w1, B_b1, B_w2, B_b2)
```

```asm
; @launch grid=(256,1,1) block=(256,1,1) lds=163840
.amdgcn_target "amdgcn-amd-amdhsa--gfx950"
.text
.globl parallel_sum__memory_aug_recurrent_mem_tr__dense_activation_gelu__prompt_kernel
.p2align 8
.type parallel_sum__memory_aug_recurrent_mem_tr__dense_activation_gelu__prompt_kernel,@function
parallel_sum__memory_aug_recurrent_mem_tr__dense_activation_gelu__prompt_kernel:
  s_cmp_ge_u32 s2, 256
  s_cbranch_scc1 L_exit
  s_load_dwordx2 s[12:13], s[0:1], 104
  s_load_dwordx2 s[4:5], s[0:1], 112
  s_load_dwordx2 s[8:9], s[0:1], 40
  s_mov_b32 s6, 268435456
  s_mov_b32 s7, 0x00020000
  s_mov_b32 s14, 256
  s_mov_b32 s15, 0x00020000
  s_waitcnt lgkmcnt(0)
  s_and_b32 s5, s5, 0xffff
  s_and_b32 s13, s13, 0xffff
  v_lshrrev_b32 v1, 6, v0
  s_nop 0
  v_readfirstlane_b32 s17, v1
  s_getreg_b32 s98, hwreg(HW_REG_XCC_ID)
  s_and_b32 s98, s98, 15
  s_cmp_lg_u32 s17, 0
  s_cbranch_scc1 L_role_wait
  s_mov_b64 exec, 1
  v_mov_b32 v1, 1
  s_cmp_lg_u32 s98, 0
  s_cbranch_scc1 L_role_glob
  buffer_atomic_add v1, off, s[12:15], 0 offset:0 sc0 sc1
  s_waitcnt vmcnt(0)
  v_readfirstlane_b32 s97, v1
  s_cmp_lt_u32 s97, 32
  s_cbranch_scc1 L_role_done
L_role_glob:
  v_mov_b32 v1, 1
  buffer_atomic_add v1, off, s[12:15], 0 offset:4 sc0 sc1
  s_waitcnt vmcnt(0)
  v_readfirstlane_b32 s97, v1
  s_add_u32 s97, s97, 32
  s_cmp_lt_u32 s97, 256
  s_cbranch_scc1 L_role_done
  v_mov_b32 v1, 1
  buffer_atomic_add v1, off, s[12:15], 0 offset:0 sc0 sc1
  s_waitcnt vmcnt(0)
  v_readfirstlane_b32 s97, v1
  v_mov_b32 v1, 1
  buffer_atomic_or v1, off, s[12:15], 0 offset:8 sc1
  s_waitcnt vmcnt(0)
L_role_done:
  v_mov_b32 v1, s97
  v_mov_b32 v2, 0
  ds_write_b32 v2, v1
  s_waitcnt lgkmcnt(0)
  s_mov_b64 exec, -1
L_role_wait:
  s_barrier
  v_mov_b32 v2, 0
  ds_read_b32 v1, v2
  s_waitcnt lgkmcnt(0)
  v_readfirstlane_b32 s97, v1
  s_barrier
  s_cmp_lt_u32 s97, 32
  s_cbranch_scc1 L_chain
  s_sub_u32 s96, s97, 32
  s_cmp_lt_u32 s96, 64
  s_cbranch_scc1 L_r_ln
  s_cmp_lt_u32 s96, 160
  s_cbranch_scc1 L_r_qkv
  s_sub_u32 s96, s96, 160
  s_load_dwordx2 s[8:9], s[0:1], 64
  s_waitcnt lgkmcnt(0)
  s_and_b32 s9, s9, 0xffff
  s_mov_b32 s10, 5308416
  s_mov_b32 s11, 0x00020000
  s_load_dwordx2 s[32:33], s[0:1], 80
  s_waitcnt lgkmcnt(0)
  s_and_b32 s33, s33, 0xffff
  s_mov_b32 s34, 5308416
  s_mov_b32 s35, 0x00020000
  s_lshr_b32 s18, s96, 2
  s_and_b32 s19, s96, 3
  s_lshl_b32 s20, s18, 2
  s_add_u32 s20, s20, s17
  v_and_b32 v9, 63, v0
  v_lshlrev_b32 v1, 4, v9
  v_lshrrev_b32 v10, 2, v9
  v_mul_u32_u24 v10, 9216, v10
  v_and_b32 v11, 3, v9
  v_lshl_add_u32 v2, v11, 4, v10
  s_mul_i32 s24, s19, 2304
  s_mul_i32 s21, s17, 1327104
  s_add_u32 s24, s24, s21
  s_mul_i32 s25, s19, 1327104
  s_mul_i32 s27, s17, 9216
  s_add_u32 s25, s25, s27
  v_lshrrev_b32 v10, 5, v9
  v_bfe_u32 v11, v9, 2, 2
  v_lshl_add_u32 v12, v10, 3, v11
  v_lshlrev_b32 v12, 6, v12
  v_bfe_u32 v13, v9, 4, 1
  v_lshlrev_b32 v13, 5, v13
  v_and_b32 v14, 3, v9
  v_lshl_add_u32 v13, v14, 3, v13
  v_add_u32 v3, v12, v13
  v_add_u32 v7, 73728, v3
  v_lshl_add_u32 v12, v10, 2, v11
  v_mul_u32_u24 v12, 1152, v12
  v_add_u32 v12, v12, v13
  v_add_u32 v4, 36864, v12
  v_add_u32 v208, 73728, v4
  v_lshlrev_b32 v12, 4, v10
  v_add_u32 v6, 147456, v12
  v_lshlrev_b32 v12, 8, v10
  v_and_b32 v13, 15, v9
  v_lshl_add_u32 v12, v13, 4, v12
  v_bfe_u32 v13, v9, 4, 1
  v_lshl_add_u32 v5, v13, 3, v12
  s_mov_b32 s28, 0xc0135761
  s_mov_b32 s29, 0xbdd2d3e8
  s_add_u32 s23, s24, 0
  s_add_u32 m0, s27, 0
  s_nop 0
  buffer_load_dwordx4 v2, s[8:11], s23 offen lds
  s_add_u32 s23, s24, 147456
  s_add_u32 m0, s27, 1024
  s_nop 0
  buffer_load_dwordx4 v2, s[8:11], s23 offen lds
  s_add_u32 s23, s24, 294912
  s_add_u32 m0, s27, 2048
  s_nop 0
  buffer_load_dwordx4 v2, s[8:11], s23 offen lds
  s_add_u32 s23, s24, 442368
  s_add_u32 m0, s27, 3072
  s_nop 0
  buffer_load_dwordx4 v2, s[8:11], s23 offen lds
  s_add_u32 s23, s24, 589824
  s_add_u32 m0, s27, 4096
  s_nop 0
  buffer_load_dwordx4 v2, s[8:11], s23 offen lds
  s_add_u32 s23, s24, 737280
  s_add_u32 m0, s27, 5120
  s_nop 0
  buffer_load_dwordx4 v2, s[8:11], s23 offen lds
  s_add_u32 s23, s24, 884736
  s_add_u32 m0, s27, 6144
  s_nop 0
  buffer_load_dwordx4 v2, s[8:11], s23 offen lds
  s_add_u32 s23, s24, 1032192
  s_add_u32 m0, s27, 7168
  s_nop 0
  buffer_load_dwordx4 v2, s[8:11], s23 offen lds
  s_add_u32 s23, s24, 1179648
  s_add_u32 m0, s27, 8192
  s_nop 0
  buffer_load_dwordx4 v2, s[8:11], s23 offen lds
  s_add_u32 s23, s25, 0
  s_add_u32 m0, s27, 36864
  s_nop 0
  buffer_load_dwordx4 v1, s[32:35], s23 offen lds
  s_add_u32 s23, s25, 1024
  s_add_u32 m0, s27, 37888
  s_nop 0
  buffer_load_dwordx4 v1, s[32:35], s23 offen lds
  s_add_u32 s23, s25, 2048
  s_add_u32 m0, s27, 38912
  s_nop 0
  buffer_load_dwordx4 v1, s[32:35], s23 offen lds
  s_add_u32 s23, s25, 3072
  s_add_u32 m0, s27, 39936
  s_nop 0
  buffer_load_dwordx4 v1, s[32:35], s23 offen lds
  s_add_u32 s23, s25, 4096
  s_add_u32 m0, s27, 40960
  s_nop 0
  buffer_load_dwordx4 v1, s[32:35], s23 offen lds
  s_add_u32 s23, s25, 5120
  s_add_u32 m0, s27, 41984
  s_nop 0
  buffer_load_dwordx4 v1, s[32:35], s23 offen lds
  s_add_u32 s23, s25, 6144
  s_add_u32 m0, s27, 43008
  s_nop 0
  buffer_load_dwordx4 v1, s[32:35], s23 offen lds
  s_add_u32 s23, s25, 7168
  s_add_u32 m0, s27, 44032
  s_nop 0
  buffer_load_dwordx4 v1, s[32:35], s23 offen lds
  s_add_u32 s23, s25, 8192
  s_add_u32 m0, s27, 45056
  s_nop 0
  buffer_load_dwordx4 v1, s[32:35], s23 offen lds
  s_add_u32 s24, s24, 64
  s_add_u32 s25, s25, 36864
  s_load_dwordx2 s[36:37], s[0:1], 72
  s_waitcnt lgkmcnt(0)
  s_and_b32 s37, s37, 0xffff
  s_mov_b32 s38, 9216
  s_mov_b32 s39, 0x00020000
  s_mul_i32 s21, s19, 2304
  v_lshlrev_b32 v10, 3, v0
  buffer_load_dwordx2 v[12:13], v10, s[36:39], s21 offen
  v_lshlrev_b32 v11, 4, v0
  v_add_u32 v11, 147456, v11
  s_add_u32 s22, s21, 2048
  v_cmp_gt_u32 vcc, 32, v0
  s_and_saveexec_b64 s[40:41], vcc
  s_cbranch_execz L_ffn_b1
  buffer_load_dwordx2 v[14:15], v10, s[36:39], s22 offen
  s_waitcnt vmcnt(0)
  v_lshlrev_b32 v16, 16, v14
  v_and_b32 v17, 0xffff0000, v14
  v_lshlrev_b32 v18, 16, v15
  v_and_b32 v19, 0xffff0000, v15
  ds_write_b128 v11, v[16:19] offset:4096
L_ffn_b1:
  s_mov_b64 exec, s[40:41]
  s_waitcnt vmcnt(0)
  v_lshlrev_b32 v16, 16, v12
  v_and_b32 v17, 0xffff0000, v12
  v_lshlrev_b32 v18, 16, v13
  v_and_b32 v19, 0xffff0000, v13
  ds_write_b128 v11, v[16:19]
  s_add_u32 s95, s96, 160
  s_lshl_b32 s95, s95, 8
  s_add_u32 s95, s95, 0
  s_cmp_lg_u32 s17, 0
  s_cbranch_scc1 L_wl_2
  s_mov_b32 s94, 0
L_wl_1:
  buffer_load_dword v16, off, s[12:15], 0 offset:128 sc1
  s_waitcnt vmcnt(0)
  v_readfirstlane_b32 s92, v16
  s_cmp_ge_u32 s92, 64
  s_cbranch_scc1 L_wl_2
  s_add_u32 s94, s94, 1
  s_cmp_lt_u32 s94, 400000
  s_cbranch_scc1 L_wl_1
  s_branch L_fail
L_wl_2:
  s_barrier
  s_mul_i32 s21, s20, 36864
  s_add_u32 s21, s21, 1048576
  s_add_u32 s22, s21, 0
  buffer_load_dwordx4 v[64:67], v1, s[4:7], s22 offen
  s_add_u32 s22, s21, 1024
  buffer_load_dwordx4 v[68:71], v1, s[4:7], s22 offen
  s_add_u32 s22, s21, 2048
  buffer_load_dwordx4 v[72:75], v1, s[4:7], s22 offen
  s_add_u32 s22, s21, 3072
  buffer_load_dwordx4 v[76:79], v1, s[4:7], s22 offen
  s_add_u32 s22, s21, 4096
  buffer_load_dwordx4 v[80:83], v1, s[4:7], s22 offen
  s_add_u32 s22, s21, 5120
  buffer_load_dwordx4 v[84:87], v1, s[4:7], s22 offen
  s_add_u32 s22, s21, 6144
  buffer_load_dwordx4 v[88:91], v1, s[4:7], s22 offen
  s_add_u32 s22, s21, 7168
  buffer_load_dwordx4 v[92:95], v1, s[4:7], s22 offen
  s_add_u32 s22, s21, 8192
  buffer_load_dwordx4 v[96:99], v1, s[4:7], s22 offen
  s_add_u32 s22, s21, 9216
  buffer_load_dwordx4 v[100:103], v1, s[4:7], s22 offen
  s_add_u32 s22, s21, 10240
  buffer_load_dwordx4 v[104:107], v1, s[4:7], s22 offen
  s_add_u32 s22, s21, 11264
  buffer_load_dwordx4 v[108:111], v1, s[4:7], s22 offen
  s_add_u32 s22, s21, 12288
  buffer_load_dwordx4 v[112:115], v1, s[4:7], s22 offen
  s_add_u32 s22, s21, 13312
  buffer_load_dwordx4 v[116:119], v1, s[4:7], s22 offen
  s_add_u32 s22, s21, 14336
  buffer_load_dwordx4 v[120:123], v1, s[4:7], s22 offen
  s_add_u32 s22, s21, 15360
  buffer_load_dwordx4 v[124:127], v1, s[4:7], s22 offen
  s_add_u32 s22, s21, 16384
  buffer_load_dwordx4 v[128:131], v1, s[4:7], s22 offen
  s_add_u32 s22, s21, 17408
  buffer_load_dwordx4 v[132:135], v1, s[4:7], s22 offen
  s_add_u32 s22, s21, 18432
  buffer_load_dwordx4 v[136:139], v1, s[4:7], s22 offen
  s_add_u32 s22, s21, 19456
  buffer_load_dwordx4 v[140:143], v1, s[4:7], s22 offen
  s_add_u32 s22, s21, 20480
  buffer_load_dwordx4 v[144:147], v1, s[4:7], s22 offen
  s_add_u32 s22, s21, 21504
  buffer_load_dwordx4 v[148:151], v1, s[4:7], s22 offen
  s_add_u32 s22, s21, 22528
  buffer_load_dwordx4 v[152:155], v1, s[4:7], s22 offen
  s_add_u32 s22, s21, 23552
  buffer_load_dwordx4 v[156:159], v1, s[4:7], s22 offen
  s_add_u32 s22, s21, 24576
  buffer_load_dwordx4 v[160:163], v1, s[4:7], s22 offen
  s_add_u32 s22, s21, 25600
  buffer_load_dwordx4 v[164:167], v1, s[4:7], s22 offen
  s_add_u32 s22, s21, 26624
  buffer_load_dwordx4 v[168:171], v1, s[4:7], s22 offen
  s_add_u32 s22, s21, 27648
  buffer_load_dwordx4 v[172:175], v1, s[4:7], s22 offen
  s_add_u32 s22, s21, 28672
  buffer_load_dwordx4 v[176:179], v1, s[4:7], s22 offen
  s_add_u32 s22, s21, 29696
  buffer_load_dwordx4 v[180:183], v1, s[4:7], s22 offen
  s_add_u32 s22, s21, 30720
  buffer_load_dwordx4 v[184:187], v1, s[4:7], s22 offen
  s_add_u32 s22, s21, 31744
  buffer_load_dwordx4 v[188:191], v1, s[4:7], s22 offen
  s_add_u32 s22, s21, 32768
  buffer_load_dwordx4 v[192:195], v1, s[4:7], s22 offen
  s_add_u32 s22, s21, 33792
  buffer_load_dwordx4 v[196:199], v1, s[4:7], s22 offen
  s_add_u32 s22, s21, 34816
  buffer_load_dwordx4 v[200:203], v1, s[4:7], s22 offen
  s_add_u32 s22, s21, 35840
  buffer_load_dwordx4 v[204:207], v1, s[4:7], s22 offen
  v_accvgpr_write_b32 a0, 0
  v_accvgpr_write_b32 a1, 0
  v_accvgpr_write_b32 a2, 0
  v_accvgpr_write_b32 a3, 0
  v_accvgpr_write_b32 a4, 0
  v_accvgpr_write_b32 a5, 0
  v_accvgpr_write_b32 a6, 0
  v_accvgpr_write_b32 a7, 0
  v_accvgpr_write_b32 a8, 0
  v_accvgpr_write_b32 a9, 0
  v_accvgpr_write_b32 a10, 0
  v_accvgpr_write_b32 a11, 0
  v_accvgpr_write_b32 a12, 0
  v_accvgpr_write_b32 a13, 0
  v_accvgpr_write_b32 a14, 0
  v_accvgpr_write_b32 a15, 0
  v_accvgpr_write_b32 a16, 0
  v_accvgpr_write_b32 a17, 0
  v_accvgpr_write_b32 a18, 0
  v_accvgpr_write_b32 a19, 0
  v_accvgpr_write_b32 a20, 0
  v_accvgpr_write_b32 a21, 0
  v_accvgpr_write_b32 a22, 0
  v_accvgpr_write_b32 a23, 0
  v_accvgpr_write_b32 a24, 0
  v_accvgpr_write_b32 a25, 0
  v_accvgpr_write_b32 a26, 0
  v_accvgpr_write_b32 a27, 0
  v_accvgpr_write_b32 a28, 0
  v_accvgpr_write_b32 a29, 0
  v_accvgpr_write_b32 a30, 0
  v_accvgpr_write_b32 a31, 0
  v_accvgpr_write_b32 a32, 0
  v_accvgpr_write_b32 a33, 0
  v_accvgpr_write_b32 a34, 0
  v_accvgpr_write_b32 a35, 0
  v_accvgpr_write_b32 a36, 0
  v_accvgpr_write_b32 a37, 0
  v_accvgpr_write_b32 a38, 0
  v_accvgpr_write_b32 a39, 0
  v_accvgpr_write_b32 a40, 0
  v_accvgpr_write_b32 a41, 0
  v_accvgpr_write_b32 a42, 0
  v_accvgpr_write_b32 a43, 0
  v_accvgpr_write_b32 a44, 0
  v_accvgpr_write_b32 a45, 0
  v_accvgpr_write_b32 a46, 0
  v_accvgpr_write_b32 a47, 0
  v_accvgpr_write_b32 a48, 0
  v_accvgpr_write_b32 a49, 0
  v_accvgpr_write_b32 a50, 0
  v_accvgpr_write_b32 a51, 0
  v_accvgpr_write_b32 a52, 0
  v_accvgpr_write_b32 a53, 0
  v_accvgpr_write_b32 a54, 0
  v_accvgpr_write_b32 a55, 0
  v_accvgpr_write_b32 a56, 0
  v_accvgpr_write_b32 a57, 0
  v_accvgpr_write_b32 a58, 0
  v_accvgpr_write_b32 a59, 0
  v_accvgpr_write_b32 a60, 0
  v_accvgpr_write_b32 a61, 0
  v_accvgpr_write_b32 a62, 0
  v_accvgpr_write_b32 a63, 0
  v_accvgpr_write_b32 a64, 0
  v_accvgpr_write_b32 a65, 0
  v_accvgpr_write_b32 a66, 0
  v_accvgpr_write_b32 a67, 0
  v_accvgpr_write_b32 a68, 0
  v_accvgpr_write_b32 a69, 0
  v_accvgpr_write_b32 a70, 0
  v_accvgpr_write_b32 a71, 0
  v_accvgpr_write_b32 a72, 0
  v_accvgpr_write_b32 a73, 0
  v_accvgpr_write_b32 a74, 0
  v_accvgpr_write_b32 a75, 0
  v_accvgpr_write_b32 a76, 0
  v_accvgpr_write_b32 a77, 0
  v_accvgpr_write_b32 a78, 0
  v_accvgpr_write_b32 a79, 0
  v_accvgpr_write_b32 a80, 0
  v_accvgpr_write_b32 a81, 0
  v_accvgpr_write_b32 a82, 0
  v_accvgpr_write_b32 a83, 0
  v_accvgpr_write_b32 a84, 0
  v_accvgpr_write_b32 a85, 0
  v_accvgpr_write_b32 a86, 0
  v_accvgpr_write_b32 a87, 0
  v_accvgpr_write_b32 a88, 0
  v_accvgpr_write_b32 a89, 0
  v_accvgpr_write_b32 a90, 0
  v_accvgpr_write_b32 a91, 0
  v_accvgpr_write_b32 a92, 0
  v_accvgpr_write_b32 a93, 0
  v_accvgpr_write_b32 a94, 0
  v_accvgpr_write_b32 a95, 0
  v_accvgpr_write_b32 a96, 0
  v_accvgpr_write_b32 a97, 0
  v_accvgpr_write_b32 a98, 0
  v_accvgpr_write_b32 a99, 0
  v_accvgpr_write_b32 a100, 0
  v_accvgpr_write_b32 a101, 0
  v_accvgpr_write_b32 a102, 0
  v_accvgpr_write_b32 a103, 0
  v_accvgpr_write_b32 a104, 0
  v_accvgpr_write_b32 a105, 0
  v_accvgpr_write_b32 a106, 0
  v_accvgpr_write_b32 a107, 0
  v_accvgpr_write_b32 a108, 0
  v_accvgpr_write_b32 a109, 0
  v_accvgpr_write_b32 a110, 0
  v_accvgpr_write_b32 a111, 0
  v_accvgpr_write_b32 a112, 0
  v_accvgpr_write_b32 a113, 0
  v_accvgpr_write_b32 a114, 0
  v_accvgpr_write_b32 a115, 0
  v_accvgpr_write_b32 a116, 0
  v_accvgpr_write_b32 a117, 0
  v_accvgpr_write_b32 a118, 0
  v_accvgpr_write_b32 a119, 0
  v_accvgpr_write_b32 a120, 0
  v_accvgpr_write_b32 a121, 0
  v_accvgpr_write_b32 a122, 0
  v_accvgpr_write_b32 a123, 0
  v_accvgpr_write_b32 a124, 0
  v_accvgpr_write_b32 a125, 0
  v_accvgpr_write_b32 a126, 0
  v_accvgpr_write_b32 a127, 0
  v_accvgpr_write_b32 a128, 0
  v_accvgpr_write_b32 a129, 0
  v_accvgpr_write_b32 a130, 0
  v_accvgpr_write_b32 a131, 0
  v_accvgpr_write_b32 a132, 0
  v_accvgpr_write_b32 a133, 0
  v_accvgpr_write_b32 a134, 0
  v_accvgpr_write_b32 a135, 0
  v_accvgpr_write_b32 a136, 0
  v_accvgpr_write_b32 a137, 0
  v_accvgpr_write_b32 a138, 0
  v_accvgpr_write_b32 a139, 0
  v_accvgpr_write_b32 a140, 0
  v_accvgpr_write_b32 a141, 0
  v_accvgpr_write_b32 a142, 0
  v_accvgpr_write_b32 a143, 0
  v_accvgpr_write_b32 a144, 0
  v_accvgpr_write_b32 a145, 0
  v_accvgpr_write_b32 a146, 0
  v_accvgpr_write_b32 a147, 0
  v_accvgpr_write_b32 a148, 0
  v_accvgpr_write_b32 a149, 0
  v_accvgpr_write_b32 a150, 0
  v_accvgpr_write_b32 a151, 0
  v_accvgpr_write_b32 a152, 0
  v_accvgpr_write_b32 a153, 0
  v_accvgpr_write_b32 a154, 0
  v_accvgpr_write_b32 a155, 0
  v_accvgpr_write_b32 a156, 0
  v_accvgpr_write_b32 a157, 0
  v_accvgpr_write_b32 a158, 0
  v_accvgpr_write_b32 a159, 0
  v_accvgpr_write_b32 a160, 0
  v_accvgpr_write_b32 a161, 0
  v_accvgpr_write_b32 a162, 0
  v_accvgpr_write_b32 a163, 0
  v_accvgpr_write_b32 a164, 0
  v_accvgpr_write_b32 a165, 0
  v_accvgpr_write_b32 a166, 0
  v_accvgpr_write_b32 a167, 0
  v_accvgpr_write_b32 a168, 0
  v_accvgpr_write_b32 a169, 0
  v_accvgpr_write_b32 a170, 0
  v_accvgpr_write_b32 a171, 0
  v_accvgpr_write_b32 a172, 0
  v_accvgpr_write_b32 a173, 0
  v_accvgpr_write_b32 a174, 0
  v_accvgpr_write_b32 a175, 0
  v_accvgpr_write_b32 a176, 0
  v_accvgpr_write_b32 a177, 0
  v_accvgpr_write_b32 a178, 0
  v_accvgpr_write_b32 a179, 0
  v_accvgpr_write_b32 a180, 0
  v_accvgpr_write_b32 a181, 0
  v_accvgpr_write_b32 a182, 0
  v_accvgpr_write_b32 a183, 0
  v_accvgpr_write_b32 a184, 0
  v_accvgpr_write_b32 a185, 0
  v_accvgpr_write_b32 a186, 0
  v_accvgpr_write_b32 a187, 0
  v_accvgpr_write_b32 a188, 0
  v_accvgpr_write_b32 a189, 0
  v_accvgpr_write_b32 a190, 0
  v_accvgpr_write_b32 a191, 0
  v_accvgpr_write_b32 a192, 0
  v_accvgpr_write_b32 a193, 0
  v_accvgpr_write_b32 a194, 0
  v_accvgpr_write_b32 a195, 0
  v_accvgpr_write_b32 a196, 0
  v_accvgpr_write_b32 a197, 0
  v_accvgpr_write_b32 a198, 0
  v_accvgpr_write_b32 a199, 0
  v_accvgpr_write_b32 a200, 0
  v_accvgpr_write_b32 a201, 0
  v_accvgpr_write_b32 a202, 0
  v_accvgpr_write_b32 a203, 0
  v_accvgpr_write_b32 a204, 0
  v_accvgpr_write_b32 a205, 0
  v_accvgpr_write_b32 a206, 0
  v_accvgpr_write_b32 a207, 0
  v_accvgpr_write_b32 a208, 0
  v_accvgpr_write_b32 a209, 0
  v_accvgpr_write_b32 a210, 0
  v_accvgpr_write_b32 a211, 0
  v_accvgpr_write_b32 a212, 0
  v_accvgpr_write_b32 a213, 0
  v_accvgpr_write_b32 a214, 0
  v_accvgpr_write_b32 a215, 0
  v_accvgpr_write_b32 a216, 0
  v_accvgpr_write_b32 a217, 0
  v_accvgpr_write_b32 a218, 0
  v_accvgpr_write_b32 a219, 0
  v_accvgpr_write_b32 a220, 0
  v_accvgpr_write_b32 a221, 0
  v_accvgpr_write_b32 a222, 0
  v_accvgpr_write_b32 a223, 0
  v_accvgpr_write_b32 a224, 0
  v_accvgpr_write_b32 a225, 0
  v_accvgpr_write_b32 a226, 0
  v_accvgpr_write_b32 a227, 0
  v_accvgpr_write_b32 a228, 0
  v_accvgpr_write_b32 a229, 0
  v_accvgpr_write_b32 a230, 0
  v_accvgpr_write_b32 a231, 0
  v_accvgpr_write_b32 a232, 0
  v_accvgpr_write_b32 a233, 0
  v_accvgpr_write_b32 a234, 0
  v_accvgpr_write_b32 a235, 0
  v_accvgpr_write_b32 a236, 0
  v_accvgpr_write_b32 a237, 0
  v_accvgpr_write_b32 a238, 0
  v_accvgpr_write_b32 a239, 0
  v_accvgpr_write_b32 a240, 0
  v_accvgpr_write_b32 a241, 0
  v_accvgpr_write_b32 a242, 0
  v_accvgpr_write_b32 a243, 0
  v_accvgpr_write_b32 a244, 0
  v_accvgpr_write_b32 a245, 0
  v_accvgpr_write_b32 a246, 0
  v_accvgpr_write_b32 a247, 0
  v_accvgpr_write_b32 a248, 0
  v_accvgpr_write_b32 a249, 0
  v_accvgpr_write_b32 a250, 0
  v_accvgpr_write_b32 a251, 0
  v_accvgpr_write_b32 a252, 0
  v_accvgpr_write_b32 a253, 0
  v_accvgpr_write_b32 a254, 0
  v_accvgpr_write_b32 a255, 0
  v_mov_b32 v224, 0
  v_mov_b32 v225, 0
  v_mov_b32 v226, 0
  v_mov_b32 v227, 0
  v_mov_b32 v228, 0
  v_mov_b32 v229, 0
  v_mov_b32 v230, 0
  v_mov_b32 v231, 0
  v_mov_b32 v232, 0
  v_mov_b32 v233, 0
  v_mov_b32 v234, 0
  v_mov_b32 v235, 0
  v_mov_b32 v236, 0
  v_mov_b32 v237, 0
  v_mov_b32 v238, 0
  v_mov_b32 v239, 0
  v_mov_b32 v240, 0
  v_mov_b32 v241, 0
  v_mov_b32 v242, 0
  v_mov_b32 v243, 0
  v_mov_b32 v244, 0
  v_mov_b32 v245, 0
  v_mov_b32 v246, 0
  v_mov_b32 v247, 0
  v_mov_b32 v248, 0
  v_mov_b32 v249, 0
  v_mov_b32 v250, 0
  v_mov_b32 v251, 0
  v_mov_b32 v252, 0
  v_mov_b32 v253, 0
  v_mov_b32 v254, 0
  v_mov_b32 v255, 0
  s_mov_b32 s26, 0
  s_waitcnt lgkmcnt(0)
  v_mov_b32 v218, s28
L_ffn_loop:
  s_waitcnt vmcnt(0)
  s_barrier
  s_cmp_ge_u32 s26, 35
  s_cbranch_scc1 L_fnd_3
  s_add_u32 s23, s24, 0
  s_add_u32 m0, s27, 73728
  s_nop 0
  buffer_load_dwordx4 v2, s[8:11], s23 offen lds
  s_add_u32 s23, s24, 147456
  s_add_u32 m0, s27, 74752
  s_nop 0
  buffer_load_dwordx4 v2, s[8:11], s23 offen lds
  s_add_u32 s23, s24, 294912
  s_add_u32 m0, s27, 75776
  s_nop 0
  buffer_load_dwordx4 v2, s[8:11], s23 offen lds
  s_add_u32 s23, s24, 442368
  s_add_u32 m0, s27, 76800
  s_nop 0
  buffer_load_dwordx4 v2, s[8:11], s23 offen lds
  s_add_u32 s23, s24, 589824
  s_add_u32 m0, s27, 77824
  s_nop 0
  buffer_load_dwordx4 v2, s[8:11], s23 offen lds
  s_add_u32 s23, s24, 737280
  s_add_u32 m0, s27, 78848
  s_nop 0
  buffer_load_dwordx4 v2, s[8:11], s23 offen lds
  s_add_u32 s23, s24, 884736
  s_add_u32 m0, s27, 79872
  s_nop 0
  buffer_load_dwordx4 v2, s[8:11], s23 offen lds
  s_add_u32 s23, s24, 1032192
  s_add_u32 m0, s27, 80896
  s_nop 0
  buffer_load_dwordx4 v2, s[8:11], s23 offen lds
  s_add_u32 s23, s24, 1179648
  s_add_u32 m0, s27, 81920
  s_nop 0
  buffer_load_dwordx4 v2, s[8:11], s23 offen lds
  s_add_u32 s23, s25, 0
  s_add_u32 m0, s27, 110592
  s_nop 0
  buffer_load_dwordx4 v1, s[32:35], s23 offen lds
  s_add_u32 s23, s25, 1024
  s_add_u32 m0, s27, 111616
  s_nop 0
  buffer_load_dwordx4 v1, s[32:35], s23 offen lds
  s_add_u32 s23, s25, 2048
  s_add_u32 m0, s27, 112640
  s_nop 0
  buffer_load_dwordx4 v1, s[32:35], s23 offen lds
  s_add_u32 s23, s25, 3072
  s_add_u32 m0, s27, 113664
  s_nop 0
  buffer_load_dwordx4 v1, s[32:35], s23 offen lds
  s_add_u32 s23, s25, 4096
  s_add_u32 m0, s27, 114688
  s_nop 0
  buffer_load_dwordx4 v1, s[32:35], s23 offen lds
  s_add_u32 s23, s25, 5120
  s_add_u32 m0, s27, 115712
  s_nop 0
  buffer_load_dwordx4 v1, s[32:35], s23 offen lds
  s_add_u32 s23, s25, 6144
  s_add_u32 m0, s27, 116736
  s_nop 0
  buffer_load_dwordx4 v1, s[32:35], s23 offen lds
  s_add_u32 s23, s25, 7168
  s_add_u32 m0, s27, 117760
  s_nop 0
  buffer_load_dwordx4 v1, s[32:35], s23 offen lds
  s_add_u32 s23, s25, 8192
  s_add_u32 m0, s27, 118784
  s_nop 0
  buffer_load_dwordx4 v1, s[32:35], s23 offen lds
  s_add_u32 s24, s24, 64
  s_add_u32 s25, s25, 36864
L_fnd_3:
  ds_read_b128 v[40:43], v6 offset:0
  ds_read_b128 v[44:47], v6 offset:32
  ds_read_b128 v[48:51], v6 offset:64
  ds_read_b128 v[52:55], v6 offset:96
  v_add_u32 v6, 128, v6
  ds_read_b64_tr_b16 v[8:9], v3 offset:0
  ds_read_b64_tr_b16 v[10:11], v3 offset:256
  ds_read_b64_tr_b16 v[12:13], v3 offset:1024
  ds_read_b64_tr_b16 v[14:15], v3 offset:1280
  ds_read_b64_tr_b16 v[16:17], v3 offset:2048
  ds_read_b64_tr_b16 v[18:19], v3 offset:2304
  ds_read_b64_tr_b16 v[20:21], v3 offset:3072
  ds_read_b64_tr_b16 v[22:23], v3 offset:3328
  ds_read_b64_tr_b16 v[24:25], v3 offset:4096
  ds_read_b64_tr_b16 v[26:27], v3 offset:4352
  s_waitcnt lgkmcnt(8)
  v_mfma_f32_32x32x16_bf16 v[40:55], v[8:11], v[64:67], v[40:55]
  ds_read_b64_tr_b16 v[28:29], v3 offset:5120
  ds_read_b64_tr_b16 v[30:31], v3 offset:5376
  s_waitcnt lgkmcnt(8)
  v_mfma_f32_32x32x16_bf16 v[40:55], v[12:15], v[68:71], v[40:55]
  ds_read_b64_tr_b16 v[32:33], v3 offset:6144
  ds_read_b64_tr_b16 v[34:35], v3 offset:6400
  s_waitcnt lgkmcnt(8)
  v_mfma_f32_32x32x16_bf16 v[40:55], v[16:19], v[72:75], v[40:55]
  ds_read_b64_tr_b16 v[36:37], v3 offset:7168
  ds_read_b64_tr_b16 v[38:39], v3 offset:7424
  s_waitcnt lgkmcnt(8)
  v_mfma_f32_32x32x16_bf16 v[40:55], v[20:23], v[76:79], v[40:55]
  ds_read_b64_tr_b16 v[8:9], v3 offset:8192
  ds_read_b64_tr_b16 v[10:11], v3 offset:8448
  s_waitcnt lgkmcnt(8)
  v_mfma_f32_32x32x16_bf16 v[40:55], v[24:27], v[80:83], v[40:55]
  ds_read_b64_tr_b16 v[12:13], v3 offset:9216
  ds_read_b64_tr_b16 v[14:15], v3 offset:9472
  s_waitcnt lgkmcnt(8)
  v_mfma_f32_32x32x16_bf16 v[40:55], v[28:31], v[84:87], v[40:55]
  ds_read_b64_tr_b16 v[16:17], v3 offset:10240
  ds_read_b64_tr_b16 v[18:19], v3 offset:10496
  s_waitcnt lgkmcnt(8)
  v_mfma_f32_32x32x16_bf16 v[40:55], v[32:35], v[88:91], v[40:55]
  ds_read_b64_tr_b16 v[20:21], v3 offset:11264
  ds_read_b64_tr_b16 v[22:23], v3 offset:11520
  s_waitcnt lgkmcnt(8)
  v_mfma_f32_32x32x16_bf16 v[40:55], v[36:39], v[92:95], v[40:55]
  ds_read_b64_tr_b16 v[24:25], v3 offset:12288
  ds_read_b64_tr_b16 v[26:27], v3 offset:12544
  s_waitcnt lgkmcnt(8)
  v_mfma_f32_32x32x16_bf16 v[40:55], v[8:11], v[96:99], v[40:55]
  ds_read_b64_tr_b16 v[28:29], v3 offset:13312
  ds_read_b64_tr_b16 v[30:31], v3 offset:13568
  s_waitcnt lgkmcnt(8)
  v_mfma_f32_32x32x16_bf16 v[40:55], v[12:15], v[100:103], v[40:55]
  ds_read_b64_tr_b16 v[32:33], v3 offset:14336
  ds_read_b64_tr_b16 v[34:35], v3 offset:14592
  s_waitcnt lgkmcnt(8)
  v_mfma_f32_32x32x16_bf16 v[40:55], v[16:19], v[104:107], v[40:55]
  ds_read_b64_tr_b16 v[36:37], v3 offset:15360
  ds_read_b64_tr_b16 v[38:39], v3 offset:15616
  s_waitcnt lgkmcnt(8)
  v_mfma_f32_32x32x16_bf16 v[40:55], v[20:23], v[108:111], v[40:55]
  ds_read_b64_tr_b16 v[8:9], v3 offset:16384
  ds_read_b64_tr_b16 v[10:11], v3 offset:16640
  s_waitcnt lgkmcnt(8)
  v_mfma_f32_32x32x16_bf16 v[40:55], v[24:27], v[112:115], v[40:55]
  ds_read_b64_tr_b16 v[12:13], v3 offset:17408
  ds_read_b64_tr_b16 v[14:15], v3 offset:17664
  s_waitcnt lgkmcnt(8)
  v_mfma_f32_32x32x16_bf16 v[40:55], v[28:31], v[116:119], v[40:55]
  ds_read_b64_tr_b16 v[16:17], v3 offset:18432
  ds_read_b64_tr_b16 v[18:19], v3 offset:18688
  s_waitcnt lgkmcnt(8)
  v_mfma_f32_32x32x16_bf16 v[40:55], v[32:35], v[120:123], v[40:55]
  ds_read_b64_tr_b16 v[20:21], v3 offset:19456
  ds_read_b64_tr_b16 v[22:23], v3 offset:19712
  s_waitcnt lgkmcnt(8)
  v_mfma_f32_32x32x16_bf16 v[40:55], v[36:39], v[124:127], v[40:55]
  ds_read_b64_tr_b16 v[24:25], v3 offset:20480
  ds_read_b64_tr_b16 v[26:27], v3 offset:20736
  s_waitcnt lgkmcnt(8)
  v_mfma_f32_32x32x16_bf16 v[40:55], v[8:11], v[128:131], v[40:55]
  ds_read_b64_tr_b16 v[28:29], v3 offset:21504
  ds_read_b64_tr_b16 v[30:31], v3 offset:21760
  s_waitcnt lgkmcnt(8)
  v_mfma_f32_32x32x16_bf16 v[40:55], v[12:15], v[132:135], v[40:55]
  ds_read_b64_tr_b16 v[32:33], v3 offset:22528
  ds_read_b64_tr_b16 v[34:35], v3 offset:22784
  s_waitcnt lgkmcnt(8)
  v_mfma_f32_32x32x16_bf16 v[40:55], v[16:19], v[136:139], v[40:55]
  ds_read_b64_tr_b16 v[36:37], v3 offset:23552
  ds_read_b64_tr_b16 v[38:39], v3 offset:23808
  s_waitcnt lgkmcnt(8)
  v_mfma_f32_32x32x16_bf16 v[40:55], v[20:23], v[140:143], v[40:55]
  ds_read_b64_tr_b16 v[8:9], v3 offset:24576
  ds_read_b64_tr_b16 v[10:11], v3 offset:24832
  s_waitcnt lgkmcnt(8)
  v_mfma_f32_32x32x16_bf16 v[40:55], v[24:27], v[144:147], v[40:55]
  ds_read_b64_tr_b16 v[12:13], v3 offset:25600
  ds_read_b64_tr_b16 v[14:15], v3 offset:25856
  s_waitcnt lgkmcnt(8)
  v_mfma_f32_32x32x16_bf16 v[40:55], v[28:31], v[148:151], v[40:55]
  ds_read_b64_tr_b16 v[16:17], v3 offset:26624
  ds_read_b64_tr_b16 v[18:19], v3 offset:26880
  s_waitcnt lgkmcnt(8)
  v_mfma_f32_32x32x16_bf16 v[40:55], v[32:35], v[152:155], v[40:55]
  ds_read_b64_tr_b16 v[20:21], v3 offset:27648
  ds_read_b64_tr_b16 v[22:23], v3 offset:27904
  s_waitcnt lgkmcnt(8)
  v_mfma_f32_32x32x16_bf16 v[40:55], v[36:39], v[156:159], v[40:55]
  ds_read_b64_tr_b16 v[24:25], v3 offset:28672
  ds_read_b64_tr_b16 v[26:27], v3 offset:28928
  s_waitcnt lgkmcnt(8)
  v_mfma_f32_32x32x16_bf16 v[40:55], v[8:11], v[160:163], v[40:55]
  ds_read_b64_tr_b16 v[28:29], v3 offset:29696
  ds_read_b64_tr_b16 v[30:31], v3 offset:29952
  s_waitcnt lgkmcnt(8)
  v_mfma_f32_32x32x16_bf16 v[40:55], v[12:15], v[164:167], v[40:55]
  ds_read_b64_tr_b16 v[32:33], v3 offset:30720
  ds_read_b64_tr_b16 v[34:35], v3 offset:30976
  s_waitcnt lgkmcnt(8)
  v_mfma_f32_32x32x16_bf16 v[40:55], v[16:19], v[168:171], v[40:55]
  ds_read_b64_tr_b16 v[36:37], v3 offset:31744
  ds_read_b64_tr_b16 v[38:39], v3 offset:32000
  s_waitcnt lgkmcnt(8)
  v_mfma_f32_32x32x16_bf16 v[40:55], v[20:23], v[172:175], v[40:55]
  ds_read_b64_tr_b16 v[8:9], v3 offset:32768
  ds_read_b64_tr_b16 v[10:11], v3 offset:33024
  s_waitcnt lgkmcnt(8)
  v_mfma_f32_32x32x16_bf16 v[40:55], v[24:27], v[176:179], v[40:55]
  ds_read_b64_tr_b16 v[12:13], v3 offset:33792
  ds_read_b64_tr_b16 v[14:15], v3 offset:34048
  s_waitcnt lgkmcnt(8)
  v_mfma_f32_32x32x16_bf16 v[40:55], v[28:31], v[180:183], v[40:55]
  ds_read_b64_tr_b16 v[16:17], v3 offset:34816
  ds_read_b64_tr_b16 v[18:19], v3 offset:35072
  s_waitcnt lgkmcnt(8)
  v_mfma_f32_32x32x16_bf16 v[40:55], v[32:35], v[184:187], v[40:55]
  ds_read_b64_tr_b16 v[20:21], v3 offset:35840
  ds_read_b64_tr_b16 v[22:23], v3 offset:36096
  s_waitcnt lgkmcnt(8)
  v_mfma_f32_32x32x16_bf16 v[40:55], v[36:39], v[188:191], v[40:55]
  ds_read_b64_tr_b16 v[24:25], v4 offset:0
  ds_read_b64_tr_b16 v[26:27], v4 offset:9216
  s_waitcnt lgkmcnt(8)
  v_mfma_f32_32x32x16_bf16 v[40:55], v[8:11], v[192:195], v[40:55]
  ds_read_b64_tr_b16 v[28:29], v4 offset:64
  ds_read_b64_tr_b16 v[30:31], v4 offset:9280
  s_waitcnt lgkmcnt(8)
  v_mfma_f32_32x32x16_bf16 v[40:55], v[12:15], v[196:199], v[40:55]
  ds_read_b64_tr_b16 v[32:33], v4 offset:128
  ds_read_b64_tr_b16 v[34:35], v4 offset:9344
  s_waitcnt lgkmcnt(8)
  v_mfma_f32_32x32x16_bf16 v[40:55], v[16:19], v[200:203], v[40:55]
  ds_read_b64_tr_b16 v[36:37], v4 offset:192
  ds_read_b64_tr_b16 v[38:39], v4 offset:9408
  s_waitcnt lgkmcnt(8)
  v_mfma_f32_32x32x16_bf16 v[40:55], v[20:23], v[204:207], v[40:55]
  ds_read_b64_tr_b16 v[8:9], v4 offset:256
  ds_read_b64_tr_b16 v[10:11], v4 offset:9472
  s_nop 9
  v_mul_f32 v210, v40, v40
  v_mul_f32 v211, v41, v41
  v_mul_f32 v212, v42, v42
  v_mul_f32 v213, v43, v43
  v_fma_f32 v210, v210, s29, v218
  v_fma_f32 v211, v211, s29, v218
  v_fma_f32 v212, v212, s29, v218
  v_fma_f32 v213, v213, s29, v218
  v_mul_f32 v210, v210, v40
  v_mul_f32 v211, v211, v41
  v_mul_f32 v212, v212, v42
  v_mul_f32 v213, v213, v43
  v_exp_f32 v210, v210
  v_exp_f32 v211, v211
  v_exp_f32 v212, v212
  v_exp_f32 v213, v213
  v_add_f32 v210, 1.0, v210
  v_add_f32 v211, 1.0, v211
  v_add_f32 v212, 1.0, v212
  v_add_f32 v213, 1.0, v213
  v_rcp_f32 v210, v210
  v_rcp_f32 v211, v211
  v_rcp_f32 v212, v212
  v_rcp_f32 v213, v213
  v_mul_f32 v40, v40, v210
  v_mul_f32 v41, v41, v211
  v_mul_f32 v42, v42, v212
  v_mul_f32 v43, v43, v213
  v_cvt_pk_bf16_f32 v56, v40, v41
  v_cvt_pk_bf16_f32 v57, v42, v43
  v_mul_f32 v214, v44, v44
  v_mul_f32 v215, v45, v45
  v_mul_f32 v216, v46, v46
  v_mul_f32 v217, v47, v47
  v_fma_f32 v214, v214, s29, v218
  v_fma_f32 v215, v215, s29, v218
  v_fma_f32 v216, v216, s29, v218
  v_fma_f32 v217, v217, s29, v218
  v_mul_f32 v214, v214, v44
  v_mul_f32 v215, v215, v45
  v_mul_f32 v216, v216, v46
  v_mul_f32 v217, v217, v47
  v_exp_f32 v214, v214
  v_exp_f32 v215, v215
  v_exp_f32 v216, v216
  v_exp_f32 v217, v217
  v_add_f32 v214, 1.0, v214
  v_add_f32 v215, 1.0, v215
  v_add_f32 v216, 1.0, v216
  v_add_f32 v217, 1.0, v217
  v_rcp_f32 v214, v214
  v_rcp_f32 v215, v215
  v_rcp_f32 v216, v216
  v_rcp_f32 v217, v217
  v_mul_f32 v44, v44, v214
  v_mul_f32 v45, v45, v215
  v_mul_f32 v46, v46, v216
  v_mul_f32 v47, v47, v217
  v_cvt_pk_bf16_f32 v58, v44, v45
  v_cvt_pk_bf16_f32 v59, v46, v47
  v_mul_f32 v210, v48, v48
  v_mul_f32 v211, v49, v49
  v_mul_f32 v212, v50, v50
  v_mul_f32 v213, v51, v51
  v_fma_f32 v210, v210, s29, v218
  v_fma_f32 v211, v211, s29, v218
  v_fma_f32 v212, v212, s29, v218
  v_fma_f32 v213, v213, s29, v218
  v_mul_f32 v210, v210, v48
  v_mul_f32 v211, v211, v49
  v_mul_f32 v212, v212, v50
  v_mul_f32 v213, v213, v51
  v_exp_f32 v210, v210
  v_exp_f32 v211, v211
  v_exp_f32 v212, v212
  v_exp_f32 v213, v213
  v_add_f32 v210, 1.0, v210
  v_add_f32 v211, 1.0, v211
  v_add_f32 v212, 1.0, v212
  v_add_f32 v213, 1.0, v213
  v_rcp_f32 v210, v210
  v_rcp_f32 v211, v211
  v_rcp_f32 v212, v212
  v_rcp_f32 v213, v213
  v_mul_f32 v48, v48, v210
  v_mul_f32 v49, v49, v211
  v_mul_f32 v50, v50, v212
  v_mul_f32 v51, v51, v213
  v_cvt_pk_bf16_f32 v60, v48, v49
  v_cvt_pk_bf16_f32 v61, v50, v51
  v_mul_f32 v214, v52, v52
  v_mul_f32 v215, v53, v53
  v_mul_f32 v216, v54, v54
  v_mul_f32 v217, v55, v55
  v_fma_f32 v214, v214, s29, v218
  v_fma_f32 v215, v215, s29, v218
  v_fma_f32 v216, v216, s29, v218
  v_fma_f32 v217, v217, s29, v218
  v_mul_f32 v214, v214, v52
  v_mul_f32 v215, v215, v53
  v_mul_f32 v216, v216, v54
  v_mul_f32 v217, v217, v55
  v_exp_f32 v214, v214
  v_exp_f32 v215, v215
  v_exp_f32 v216, v216
  v_exp_f32 v217, v217
  v_add_f32 v214, 1.0, v214
  v_add_f32 v215, 1.0, v215
  v_add_f32 v216, 1.0, v216
  v_add_f32 v217, 1.0, v217
  v_rcp_f32 v214, v214
  v_rcp_f32 v215, v215
  v_rcp_f32 v216, v216
  v_rcp_f32 v217, v217
  v_mul_f32 v52, v52, v214
  v_mul_f32 v53, v53, v215
  v_mul_f32 v54, v54, v216
  v_mul_f32 v55, v55, v217
  v_cvt_pk_bf16_f32 v62, v52, v53
  v_cvt_pk_bf16_f32 v63, v54, v55
  s_waitcnt lgkmcnt(8)
  v_mfma_f32_32x32x16_bf16 a[0:15], v[24:27], v[56:59], a[0:15]
  ds_read_b64_tr_b16 v[12:13], v4 offset:320
  ds_read_b64_tr_b16 v[14:15], v4 offset:9536
  s_waitcnt lgkmcnt(8)
  v_mfma_f32_32x32x16_bf16 a[16:31], v[28:31], v[56:59], a[16:31]
  ds_read_b64_tr_b16 v[16:17], v4 offset:384
  ds_read_b64_tr_b16 v[18:19], v4 offset:9600
  s_waitcnt lgkmcnt(8)
  v_mfma_f32_32x32x16_bf16 a[32:47], v[32:35], v[56:59], a[32:47]
  ds_read_b64_tr_b16 v[20:21], v4 offset:448
  ds_read_b64_tr_b16 v[22:23], v4 offset:9664
  s_waitcnt lgkmcnt(8)
  v_mfma_f32_32x32x16_bf16 a[48:63], v[36:39], v[56:59], a[48:63]
  ds_read_b64_tr_b16 v[24:25], v4 offset:512
  ds_read_b64_tr_b16 v[26:27], v4 offset:9728
  s_waitcnt lgkmcnt(8)
  v_mfma_f32_32x32x16_bf16 a[64:79], v[8:11], v[56:59], a[64:79]
  ds_read_b64_tr_b16 v[28:29], v4 offset:576
  ds_read_b64_tr_b16 v[30:31], v4 offset:9792
  s_waitcnt lgkmcnt(8)
  v_mfma_f32_32x32x16_bf16 a[80:95], v[12:15], v[56:59], a[80:95]
  ds_read_b64_tr_b16 v[32:33], v4 offset:640
  ds_read_b64_tr_b16 v[34:35], v4 offset:9856
  s_waitcnt lgkmcnt(8)
  v_mfma_f32_32x32x16_bf16 a[96:111], v[16:19], v[56:59], a[96:111]
  ds_read_b64_tr_b16 v[36:37], v4 offset:704
  ds_read_b64_tr_b16 v[38:39], v4 offset:9920
  s_waitcnt lgkmcnt(8)
  v_mfma_f32_32x32x16_bf16 a[112:127], v[20:23], v[56:59], a[112:127]
  ds_read_b64_tr_b16 v[8:9], v4 offset:768
  ds_read_b64_tr_b16 v[10:11], v4 offset:9984
  s_waitcnt lgkmcnt(8)
  v_mfma_f32_32x32x16_bf16 a[128:143], v[24:27], v[56:59], a[128:143]
  ds_read_b64_tr_b16 v[12:13], v4 offset:832
  ds_read_b64_tr_b16 v[14:15], v4 offset:10048
  s_waitcnt lgkmcnt(8)
  v_mfma_f32_32x32x16_bf16 a[144:159], v[28:31], v[56:59], a[144:159]
  ds_read_b64_tr_b16 v[16:17], v4 offset:896
  ds_read_b64_tr_b16 v[18:19], v4 offset:10112
  s_waitcnt lgkmcnt(8)
  v_mfma_f32_32x32x16_bf16 a[160:175], v[32:35], v[56:59], a[160:175]
  ds_read_b64_tr_b16 v[20:21], v4 offset:960
  ds_read_b64_tr_b16 v[22:23], v4 offset:10176
  s_waitcnt lgkmcnt(8)
  v_mfma_f32_32x32x16_bf16 a[176:191], v[36:39], v[56:59], a[176:191]
  ds_read_b64_tr_b16 v[24:25], v4 offset:1024
  ds_read_b64_tr_b16 v[26:27], v4 offset:10240
  s_waitcnt lgkmcnt(8)
  v_mfma_f32_32x32x16_bf16 a[192:207], v[8:11], v[56:59], a[192:207]
  ds_read_b64_tr_b16 v[28:29], v4 offset:1088
  ds_read_b64_tr_b16 v[30:31], v4 offset:10304
  s_waitcnt lgkmcnt(8)
  v_mfma_f32_32x32x16_bf16 a[208:223], v[12:15], v[56:59], a[208:223]
  ds_read_b64_tr_b16 v[32:33], v4 offset:18432
  ds_read_b64_tr_b16 v[34:35], v4 offset:27648
  s_waitcnt lgkmcnt(8)
  v_mfma_f32_32x32x16_bf16 a[224:239], v[16:19], v[56:59], a[224:239]
  ds_read_b64_tr_b16 v[36:37], v4 offset:18496
  ds_read_b64_tr_b16 v[38:39], v4 offset:27712
  s_waitcnt lgkmcnt(8)
  v_mfma_f32_32x32x16_bf16 a[240:255], v[20:23], v[56:59], a[240:255]
  ds_read_b64_tr_b16 v[8:9], v4 offset:18560
  ds_read_b64_tr_b16 v[10:11], v4 offset:27776
  s_waitcnt lgkmcnt(8)
  v_mfma_f32_32x32x16_bf16 v[224:239], v[24:27], v[56:59], v[224:239]
  ds_read_b64_tr_b16 v[12:13], v4 offset:18624
  ds_read_b64_tr_b16 v[14:15], v4 offset:27840
  s_waitcnt lgkmcnt(8)
  v_mfma_f32_32x32x16_bf16 v[240:255], v[28:31], v[56:59], v[240:255]
  ds_read_b64_tr_b16 v[16:17], v4 offset:18688
  ds_read_b64_tr_b16 v[18:19], v4 offset:27904
  s_waitcnt lgkmcnt(8)
  v_mfma_f32_32x32x16_bf16 a[0:15], v[32:35], v[60:63], a[0:15]
  ds_read_b64_tr_b16 v[20:21], v4 offset:18752
  ds_read_b64_tr_b16 v[22:23], v4 offset:27968
  s_waitcnt lgkmcnt(8)
  v_mfma_f32_32x32x16_bf16 a[16:31], v[36:39], v[60:63], a[16:31]
  ds_read_b64_tr_b16 v[24:25], v4 offset:18816
  ds_read_b64_tr_b16 v[26:27], v4 offset:28032
  s_waitcnt lgkmcnt(8)
  v_mfma_f32_32x32x16_bf16 a[32:47], v[8:11], v[60:63], a[32:47]
  ds_read_b64_tr_b16 v[28:29], v4 offset:18880
  ds_read_b64_tr_b16 v[30:31], v4 offset:28096
  s_waitcnt lgkmcnt(8)
  v_mfma_f32_32x32x16_bf16 a[48:63], v[12:15], v[60:63], a[48:63]
  ds_read_b64_tr_b16 v[32:33], v4 offset:18944
  ds_read_b64_tr_b16 v[34:35], v4 offset:28160
  s_waitcnt lgkmcnt(8)
  v_mfma_f32_32x32x16_bf16 a[64:79], v[16:19], v[60:63], a[64:79]
  ds_read_b64_tr_b16 v[36:37], v4 offset:19008
  ds_read_b64_tr_b16 v[38:39], v4 offset:28224
  s_waitcnt lgkmcnt(8)
  v_mfma_f32_32x32x16_bf16 a[80:95], v[20:23], v[60:63], a[80:95]
  ds_read_b64_tr_b16 v[8:9], v4 offset:19072
  ds_read_b64_tr_b16 v[10:11], v4 offset:28288
  s_waitcnt lgkmcnt(8)
  v_mfma_f32_32x32x16_bf16 a[96:111], v[24:27], v[60:63], a[96:111]
  ds_read_b64_tr_b16 v[12:13], v4 offset:19136
  ds_read_b64_tr_b16 v[14:15], v4 offset:28352
  s_waitcnt lgkmcnt(8)
  v_mfma_f32_32x32x16_bf16 a[112:127], v[28:31], v[60:63], a[112:127]
  ds_read_b64_tr_b16 v[16:17], v4 offset:19200
  ds_read_b64_tr_b16 v[18:19], v4 offset:28416
  s_waitcnt lgkmcnt(8)
  v_mfma_f32_32x32x16_bf16 a[128:143], v[32:35], v[60:63], a[128:143]
  ds_read_b64_tr_b16 v[20:21], v4 offset:19264
  ds_read_b64_tr_b16 v[22:23], v4 offset:28480
  s_waitcnt lgkmcnt(8)
  v_mfma_f32_32x32x16_bf16 a[144:159], v[36:39], v[60:63], a[144:159]
  ds_read_b64_tr_b16 v[24:25], v4 offset:19328
  ds_read_b64_tr_b16 v[26:27], v4 offset:28544
  s_waitcnt lgkmcnt(8)
  v_mfma_f32_32x32x16_bf16 a[160:175], v[8:11], v[60:63], a[160:175]
  ds_read_b64_tr_b16 v[28:29], v4 offset:19392
  ds_read_b64_tr_b16 v[30:31], v4 offset:28608
  s_waitcnt lgkmcnt(8)
  v_mfma_f32_32x32x16_bf16 a[176:191], v[12:15], v[60:63], a[176:191]
  ds_read_b64_tr_b16 v[32:33], v4 offset:19456
  ds_read_b64_tr_b16 v[34:35], v4 offset:28672
  s_waitcnt lgkmcnt(8)
  v_mfma_f32_32x32x16_bf16 a[192:207], v[16:19], v[60:63], a[192:207]
  ds_read_b64_tr_b16 v[36:37], v4 offset:19520
  ds_read_b64_tr_b16 v[38:39], v4 offset:28736
  s_waitcnt lgkmcnt(8)
  v_mfma_f32_32x32x16_bf16 a[208:223], v[20:23], v[60:63], a[208:223]
  s_waitcnt lgkmcnt(6)
  v_mfma_f32_32x32x16_bf16 a[224:239], v[24:27], v[60:63], a[224:239]
  s_waitcnt lgkmcnt(4)
  v_mfma_f32_32x32x16_bf16 a[240:255], v[28:31], v[60:63], a[240:255]
  s_waitcnt lgkmcnt(2)
  v_mfma_f32_32x32x16_bf16 v[224:239], v[32:35], v[60:63], v[224:239]
  s_waitcnt lgkmcnt(0)
  v_mfma_f32_32x32x16_bf16 v[240:255], v[36:39], v[60:63], v[240:255]
  s_add_u32 s26, s26, 1
  s_waitcnt vmcnt(0)
  s_barrier
  s_cmp_ge_u32 s26, 35
  s_cbranch_scc1 L_fnd_4
  s_add_u32 s23, s24, 0
  s_add_u32 m0, s27, 0
  s_nop 0
  buffer_load_dwordx4 v2, s[8:11], s23 offen lds
  s_add_u32 s23, s24, 147456
  s_add_u32 m0, s27, 1024
  s_nop 0
  buffer_load_dwordx4 v2, s[8:11], s23 offen lds
  s_add_u32 s23, s24, 294912
  s_add_u32 m0, s27, 2048
  s_nop 0
  buffer_load_dwordx4 v2, s[8:11], s23 offen lds
  s_add_u32 s23, s24, 442368
  s_add_u32 m0, s27, 3072
  s_nop 0
  buffer_load_dwordx4 v2, s[8:11], s23 offen lds
  s_add_u32 s23, s24, 589824
  s_add_u32 m0, s27, 4096
  s_nop 0
  buffer_load_dwordx4 v2, s[8:11], s23 offen lds
  s_add_u32 s23, s24, 737280
  s_add_u32 m0, s27, 5120
  s_nop 0
  buffer_load_dwordx4 v2, s[8:11], s23 offen lds
  s_add_u32 s23, s24, 884736
  s_add_u32 m0, s27, 6144
  s_nop 0
  buffer_load_dwordx4 v2, s[8:11], s23 offen lds
  s_add_u32 s23, s24, 1032192
  s_add_u32 m0, s27, 7168
  s_nop 0
  buffer_load_dwordx4 v2, s[8:11], s23 offen lds
  s_add_u32 s23, s24, 1179648
  s_add_u32 m0, s27, 8192
  s_nop 0
  buffer_load_dwordx4 v2, s[8:11], s23 offen lds
  s_add_u32 s23, s25, 0
  s_add_u32 m0, s27, 36864
  s_nop 0
  buffer_load_dwordx4 v1, s[32:35], s23 offen lds
  s_add_u32 s23, s25, 1024
  s_add_u32 m0, s27, 37888
  s_nop 0
  buffer_load_dwordx4 v1, s[32:35], s23 offen lds
  s_add_u32 s23, s25, 2048
  s_add_u32 m0, s27, 38912
  s_nop 0
  buffer_load_dwordx4 v1, s[32:35], s23 offen lds
  s_add_u32 s23, s25, 3072
  s_add_u32 m0, s27, 39936
  s_nop 0
  buffer_load_dwordx4 v1, s[32:35], s23 offen lds
  s_add_u32 s23, s25, 4096
  s_add_u32 m0, s27, 40960
  s_nop 0
  buffer_load_dwordx4 v1, s[32:35], s23 offen lds
  s_add_u32 s23, s25, 5120
  s_add_u32 m0, s27, 41984
  s_nop 0
  buffer_load_dwordx4 v1, s[32:35], s23 offen lds
  s_add_u32 s23, s25, 6144
  s_add_u32 m0, s27, 43008
  s_nop 0
  buffer_load_dwordx4 v1, s[32:35], s23 offen lds
  s_add_u32 s23, s25, 7168
  s_add_u32 m0, s27, 44032
  s_nop 0
  buffer_load_dwordx4 v1, s[32:35], s23 offen lds
  s_add_u32 s23, s25, 8192
  s_add_u32 m0, s27, 45056
  s_nop 0
  buffer_load_dwordx4 v1, s[32:35], s23 offen lds
  s_add_u32 s24, s24, 64
  s_add_u32 s25, s25, 36864
L_fnd_4:
  ds_read_b128 v[40:43], v6 offset:0
  ds_read_b128 v[44:47], v6 offset:32
  ds_read_b128 v[48:51], v6 offset:64
  ds_read_b128 v[52:55], v6 offset:96
  v_add_u32 v6, 128, v6
  ds_read_b64_tr_b16 v[8:9], v7 offset:0
  ds_read_b64_tr_b16 v[10:11], v7 offset:256
  ds_read_b64_tr_b16 v[12:13], v7 offset:1024
  ds_read_b64_tr_b16 v[14:15], v7 offset:1280
  ds_read_b64_tr_b16 v[16:17], v7 offset:2048
  ds_read_b64_tr_b16 v[18:19], v7 offset:2304
  ds_read_b64_tr_b16 v[20:21], v7 offset:3072
  ds_read_b64_tr_b16 v[22:23], v7 offset:3328
  ds_read_b64_tr_b16 v[24:25], v7 offset:4096
  ds_read_b64_tr_b16 v[26:27], v7 offset:4352
  s_waitcnt lgkmcnt(8)
  v_mfma_f32_32x32x16_bf16 v[40:55], v[8:11], v[64:67], v[40:55]
  ds_read_b64_tr_b16 v[28:29], v7 offset:5120
  ds_read_b64_tr_b16 v[30:31], v7 offset:5376
  s_waitcnt lgkmcnt(8)
  v_mfma_f32_32x32x16_bf16 v[40:55], v[12:15], v[68:71], v[40:55]
  ds_read_b64_tr_b16 v[32:33], v7 offset:6144
  ds_read_b64_tr_b16 v[34:35], v7 offset:6400
  s_waitcnt lgkmcnt(8)
  v_mfma_f32_32x32x16_bf16 v[40:55], v[16:19], v[72:75], v[40:55]
  ds_read_b64_tr_b16 v[36:37], v7 offset:7168
  ds_read_b64_tr_b16 v[38:39], v7 offset:7424
  s_waitcnt lgkmcnt(8)
  v_mfma_f32_32x32x16_bf16 v[40:55], v[20:23], v[76:79], v[40:55]
  ds_read_b64_tr_b16 v[8:9], v7 offset:8192
  ds_read_b64_tr_b16 v[10:11], v7 offset:8448
  s_waitcnt lgkmcnt(8)
  v_mfma_f32_32x32x16_bf16 v[40:55], v[24:27], v[80:83], v[40:55]
  ds_read_b64_tr_b16 v[12:13], v7 offset:9216
  ds_read_b64_tr_b16 v[14:15], v7 offset:9472
  s_waitcnt lgkmcnt(8)
  v_mfma_f32_32x32x16_bf16 v[40:55], v[28:31], v[84:87], v[40:55]
  ds_read_b64_tr_b16 v[16:17], v7 offset:10240
  ds_read_b64_tr_b16 v[18:19], v7 offset:10496
  s_waitcnt lgkmcnt(8)
  v_mfma_f32_32x32x16_bf16 v[40:55], v[32:35], v[88:91], v[40:55]
  ds_read_b64_tr_b16 v[20:21], v7 offset:11264
  ds_read_b64_tr_b16 v[22:23], v7 offset:11520
  s_waitcnt lgkmcnt(8)
  v_mfma_f32_32x32x16_bf16 v[40:55], v[36:39], v[92:95], v[40:55]
  ds_read_b64_tr_b16 v[24:25], v7 offset:12288
  ds_read_b64_tr_b16 v[26:27], v7 offset:12544
  s_waitcnt lgkmcnt(8)
  v_mfma_f32_32x32x16_bf16 v[40:55], v[8:11], v[96:99], v[40:55]
  ds_read_b64_tr_b16 v[28:29], v7 offset:13312
  ds_read_b64_tr_b16 v[30:31], v7 offset:13568
  s_waitcnt lgkmcnt(8)
  v_mfma_f32_32x32x16_bf16 v[40:55], v[12:15], v[100:103], v[40:55]
  ds_read_b64_tr_b16 v[32:33], v7 offset:14336
  ds_read_b64_tr_b16 v[34:35], v7 offset:14592
  s_waitcnt lgkmcnt(8)
  v_mfma_f32_32x32x16_bf16 v[40:55], v[16:19], v[104:107], v[40:55]
  ds_read_b64_tr_b16 v[36:37], v7 offset:15360
  ds_read_b64_tr_b16 v[38:39], v7 offset:15616
  s_waitcnt lgkmcnt(8)
  v_mfma_f32_32x32x16_bf16 v[40:55], v[20:23], v[108:111], v[40:55]
  ds_read_b64_tr_b16 v[8:9], v7 offset:16384
  ds_read_b64_tr_b16 v[10:11], v7 offset:16640
  s_waitcnt lgkmcnt(8)
  v_mfma_f32_32x32x16_bf16 v[40:55], v[24:27], v[112:115], v[40:55]
  ds_read_b64_tr_b16 v[12:13], v7 offset:17408
  ds_read_b64_tr_b16 v[14:15], v7 offset:17664
  s_waitcnt lgkmcnt(8)
  v_mfma_f32_32x32x16_bf16 v[40:55], v[28:31], v[116:119], v[40:55]
  ds_read_b64_tr_b16 v[16:17], v7 offset:18432
  ds_read_b64_tr_b16 v[18:19], v7 offset:18688
  s_waitcnt lgkmcnt(8)
  v_mfma_f32_32x32x16_bf16 v[40:55], v[32:35], v[120:123], v[40:55]
  ds_read_b64_tr_b16 v[20:21], v7 offset:19456
  ds_read_b64_tr_b16 v[22:23], v7 offset:19712
  s_waitcnt lgkmcnt(8)
  v_mfma_f32_32x32x16_bf16 v[40:55], v[36:39], v[124:127], v[40:55]
  ds_read_b64_tr_b16 v[24:25], v7 offset:20480
  ds_read_b64_tr_b16 v[26:27], v7 offset:20736
  s_waitcnt lgkmcnt(8)
  v_mfma_f32_32x32x16_bf16 v[40:55], v[8:11], v[128:131], v[40:55]
  ds_read_b64_tr_b16 v[28:29], v7 offset:21504
  ds_read_b64_tr_b16 v[30:31], v7 offset:21760
  s_waitcnt lgkmcnt(8)
  v_mfma_f32_32x32x16_bf16 v[40:55], v[12:15], v[132:135], v[40:55]
  ds_read_b64_tr_b16 v[32:33], v7 offset:22528
  ds_read_b64_tr_b16 v[34:35], v7 offset:22784
  s_waitcnt lgkmcnt(8)
  v_mfma_f32_32x32x16_bf16 v[40:55], v[16:19], v[136:139], v[40:55]
  ds_read_b64_tr_b16 v[36:37], v7 offset:23552
  ds_read_b64_tr_b16 v[38:39], v7 offset:23808
  s_waitcnt lgkmcnt(8)
  v_mfma_f32_32x32x16_bf16 v[40:55], v[20:23], v[140:143], v[40:55]
  ds_read_b64_tr_b16 v[8:9], v7 offset:24576
  ds_read_b64_tr_b16 v[10:11], v7 offset:24832
  s_waitcnt lgkmcnt(8)
  v_mfma_f32_32x32x16_bf16 v[40:55], v[24:27], v[144:147], v[40:55]
  ds_read_b64_tr_b16 v[12:13], v7 offset:25600
  ds_read_b64_tr_b16 v[14:15], v7 offset:25856
  s_waitcnt lgkmcnt(8)
  v_mfma_f32_32x32x16_bf16 v[40:55], v[28:31], v[148:151], v[40:55]
  ds_read_b64_tr_b16 v[16:17], v7 offset:26624
  ds_read_b64_tr_b16 v[18:19], v7 offset:26880
  s_waitcnt lgkmcnt(8)
  v_mfma_f32_32x32x16_bf16 v[40:55], v[32:35], v[152:155], v[40:55]
  ds_read_b64_tr_b16 v[20:21], v7 offset:27648
  ds_read_b64_tr_b16 v[22:23], v7 offset:27904
  s_waitcnt lgkmcnt(8)
  v_mfma_f32_32x32x16_bf16 v[40:55], v[36:39], v[156:159], v[40:55]
  ds_read_b64_tr_b16 v[24:25], v7 offset:28672
  ds_read_b64_tr_b16 v[26:27], v7 offset:28928
  s_waitcnt lgkmcnt(8)
  v_mfma_f32_32x32x16_bf16 v[40:55], v[8:11], v[160:163], v[40:55]
  ds_read_b64_tr_b16 v[28:29], v7 offset:29696
  ds_read_b64_tr_b16 v[30:31], v7 offset:29952
  s_waitcnt lgkmcnt(8)
  v_mfma_f32_32x32x16_bf16 v[40:55], v[12:15], v[164:167], v[40:55]
  ds_read_b64_tr_b16 v[32:33], v7 offset:30720
  ds_read_b64_tr_b16 v[34:35], v7 offset:30976
  s_waitcnt lgkmcnt(8)
  v_mfma_f32_32x32x16_bf16 v[40:55], v[16:19], v[168:171], v[40:55]
  ds_read_b64_tr_b16 v[36:37], v7 offset:31744
  ds_read_b64_tr_b16 v[38:39], v7 offset:32000
  s_waitcnt lgkmcnt(8)
  v_mfma_f32_32x32x16_bf16 v[40:55], v[20:23], v[172:175], v[40:55]
  ds_read_b64_tr_b16 v[8:9], v7 offset:32768
  ds_read_b64_tr_b16 v[10:11], v7 offset:33024
  s_waitcnt lgkmcnt(8)
  v_mfma_f32_32x32x16_bf16 v[40:55], v[24:27], v[176:179], v[40:55]
  ds_read_b64_tr_b16 v[12:13], v7 offset:33792
  ds_read_b64_tr_b16 v[14:15], v7 offset:34048
  s_waitcnt lgkmcnt(8)
  v_mfma_f32_32x32x16_bf16 v[40:55], v[28:31], v[180:183], v[40:55]
  ds_read_b64_tr_b16 v[16:17], v7 offset:34816
  ds_read_b64_tr_b16 v[18:19], v7 offset:35072
  s_waitcnt lgkmcnt(8)
  v_mfma_f32_32x32x16_bf16 v[40:55], v[32:35], v[184:187], v[40:55]
  ds_read_b64_tr_b16 v[20:21], v7 offset:35840
  ds_read_b64_tr_b16 v[22:23], v7 offset:36096
  s_waitcnt lgkmcnt(8)
  v_mfma_f32_32x32x16_bf16 v[40:55], v[36:39], v[188:191], v[40:55]
  ds_read_b64_tr_b16 v[24:25], v208 offset:0
  ds_read_b64_tr_b16 v[26:27], v208 offset:9216
  s_waitcnt lgkmcnt(8)
  v_mfma_f32_32x32x16_bf16 v[40:55], v[8:11], v[192:195], v[40:55]
  ds_read_b64_tr_b16 v[28:29], v208 offset:64
  ds_read_b64_tr_b16 v[30:31], v208 offset:9280
  s_waitcnt lgkmcnt(8)
  v_mfma_f32_32x32x16_bf16 v[40:55], v[12:15], v[196:199], v[40:55]
  ds_read_b64_tr_b16 v[32:33], v208 offset:128
  ds_read_b64_tr_b16 v[34:35], v208 offset:9344
  s_waitcnt lgkmcnt(8)
  v_mfma_f32_32x32x16_bf16 v[40:55], v[16:19], v[200:203], v[40:55]
  ds_read_b64_tr_b16 v[36:37], v208 offset:192
  ds_read_b64_tr_b16 v[38:39], v208 offset:9408
  s_waitcnt lgkmcnt(8)
  v_mfma_f32_32x32x16_bf16 v[40:55], v[20:23], v[204:207], v[40:55]
  ds_read_b64_tr_b16 v[8:9], v208 offset:256
  ds_read_b64_tr_b16 v[10:11], v208 offset:9472
  s_nop 9
  v_mul_f32 v210, v40, v40
  v_mul_f32 v211, v41, v41
  v_mul_f32 v212, v42, v42
  v_mul_f32 v213, v43, v43
  v_fma_f32 v210, v210, s29, v218
  v_fma_f32 v211, v211, s29, v218
  v_fma_f32 v212, v212, s29, v218
  v_fma_f32 v213, v213, s29, v218
  v_mul_f32 v210, v210, v40
  v_mul_f32 v211, v211, v41
  v_mul_f32 v212, v212, v42
  v_mul_f32 v213, v213, v43
  v_exp_f32 v210, v210
  v_exp_f32 v211, v211
  v_exp_f32 v212, v212
  v_exp_f32 v213, v213
  v_add_f32 v210, 1.0, v210
  v_add_f32 v211, 1.0, v211
  v_add_f32 v212, 1.0, v212
  v_add_f32 v213, 1.0, v213
  v_rcp_f32 v210, v210
  v_rcp_f32 v211, v211
  v_rcp_f32 v212, v212
  v_rcp_f32 v213, v213
  v_mul_f32 v40, v40, v210
  v_mul_f32 v41, v41, v211
  v_mul_f32 v42, v42, v212
  v_mul_f32 v43, v43, v213
  v_cvt_pk_bf16_f32 v56, v40, v41
  v_cvt_pk_bf16_f32 v57, v42, v43
  v_mul_f32 v214, v44, v44
  v_mul_f32 v215, v45, v45
  v_mul_f32 v216, v46, v46
  v_mul_f32 v217, v47, v47
  v_fma_f32 v214, v214, s29, v218
  v_fma_f32 v215, v215, s29, v218
  v_fma_f32 v216, v216, s29, v218
  v_fma_f32 v217, v217, s29, v218
  v_mul_f32 v214, v214, v44
  v_mul_f32 v215, v215, v45
  v_mul_f32 v216, v216, v46
  v_mul_f32 v217, v217, v47
  v_exp_f32 v214, v214
  v_exp_f32 v215, v215
  v_exp_f32 v216, v216
  v_exp_f32 v217, v217
  v_add_f32 v214, 1.0, v214
  v_add_f32 v215, 1.0, v215
  v_add_f32 v216, 1.0, v216
  v_add_f32 v217, 1.0, v217
  v_rcp_f32 v214, v214
  v_rcp_f32 v215, v215
  v_rcp_f32 v216, v216
  v_rcp_f32 v217, v217
  v_mul_f32 v44, v44, v214
  v_mul_f32 v45, v45, v215
  v_mul_f32 v46, v46, v216
  v_mul_f32 v47, v47, v217
  v_cvt_pk_bf16_f32 v58, v44, v45
  v_cvt_pk_bf16_f32 v59, v46, v47
  v_mul_f32 v210, v48, v48
  v_mul_f32 v211, v49, v49
  v_mul_f32 v212, v50, v50
  v_mul_f32 v213, v51, v51
  v_fma_f32 v210, v210, s29, v218
  v_fma_f32 v211, v211, s29, v218
  v_fma_f32 v212, v212, s29, v218
  v_fma_f32 v213, v213, s29, v218
  v_mul_f32 v210, v210, v48
  v_mul_f32 v211, v211, v49
  v_mul_f32 v212, v212, v50
  v_mul_f32 v213, v213, v51
  v_exp_f32 v210, v210
  v_exp_f32 v211, v211
  v_exp_f32 v212, v212
  v_exp_f32 v213, v213
  v_add_f32 v210, 1.0, v210
  v_add_f32 v211, 1.0, v211
  v_add_f32 v212, 1.0, v212
  v_add_f32 v213, 1.0, v213
  v_rcp_f32 v210, v210
  v_rcp_f32 v211, v211
  v_rcp_f32 v212, v212
  v_rcp_f32 v213, v213
  v_mul_f32 v48, v48, v210
  v_mul_f32 v49, v49, v211
  v_mul_f32 v50, v50, v212
  v_mul_f32 v51, v51, v213
  v_cvt_pk_bf16_f32 v60, v48, v49
  v_cvt_pk_bf16_f32 v61, v50, v51
  v_mul_f32 v214, v52, v52
  v_mul_f32 v215, v53, v53
  v_mul_f32 v216, v54, v54
  v_mul_f32 v217, v55, v55
  v_fma_f32 v214, v214, s29, v218
  v_fma_f32 v215, v215, s29, v218
  v_fma_f32 v216, v216, s29, v218
  v_fma_f32 v217, v217, s29, v218
  v_mul_f32 v214, v214, v52
  v_mul_f32 v215, v215, v53
  v_mul_f32 v216, v216, v54
  v_mul_f32 v217, v217, v55
  v_exp_f32 v214, v214
  v_exp_f32 v215, v215
  v_exp_f32 v216, v216
  v_exp_f32 v217, v217
  v_add_f32 v214, 1.0, v214
  v_add_f32 v215, 1.0, v215
  v_add_f32 v216, 1.0, v216
  v_add_f32 v217, 1.0, v217
  v_rcp_f32 v214, v214
  v_rcp_f32 v215, v215
  v_rcp_f32 v216, v216
  v_rcp_f32 v217, v217
  v_mul_f32 v52, v52, v214
  v_mul_f32 v53, v53, v215
  v_mul_f32 v54, v54, v216
  v_mul_f32 v55, v55, v217
  v_cvt_pk_bf16_f32 v62, v52, v53
  v_cvt_pk_bf16_f32 v63, v54, v55
  s_waitcnt lgkmcnt(8)
  v_mfma_f32_32x32x16_bf16 a[0:15], v[24:27], v[56:59], a[0:15]
  ds_read_b64_tr_b16 v[12:13], v208 offset:320
  ds_read_b64_tr_b16 v[14:15], v208 offset:9536
  s_waitcnt lgkmcnt(8)
  v_mfma_f32_32x32x16_bf16 a[16:31], v[28:31], v[56:59], a[16:31]
  ds_read_b64_tr_b16 v[16:17], v208 offset:384
  ds_read_b64_tr_b16 v[18:19], v208 offset:9600
  s_waitcnt lgkmcnt(8)
  v_mfma_f32_32x32x16_bf16 a[32:47], v[32:35], v[56:59], a[32:47]
  ds_read_b64_tr_b16 v[20:21], v208 offset:448
  ds_read_b64_tr_b16 v[22:23], v208 offset:9664
  s_waitcnt lgkmcnt(8)
  v_mfma_f32_32x32x16_bf16 a[48:63], v[36:39], v[56:59], a[48:63]
  ds_read_b64_tr_b16 v[24:25], v208 offset:512
  ds_read_b64_tr_b16 v[26:27], v208 offset:9728
  s_waitcnt lgkmcnt(8)
  v_mfma_f32_32x32x16_bf16 a[64:79], v[8:11], v[56:59], a[64:79]
  ds_read_b64_tr_b16 v[28:29], v208 offset:576
  ds_read_b64_tr_b16 v[30:31], v208 offset:9792
  s_waitcnt lgkmcnt(8)
  v_mfma_f32_32x32x16_bf16 a[80:95], v[12:15], v[56:59], a[80:95]
  ds_read_b64_tr_b16 v[32:33], v208 offset:640
  ds_read_b64_tr_b16 v[34:35], v208 offset:9856
  s_waitcnt lgkmcnt(8)
  v_mfma_f32_32x32x16_bf16 a[96:111], v[16:19], v[56:59], a[96:111]
  ds_read_b64_tr_b16 v[36:37], v208 offset:704
  ds_read_b64_tr_b16 v[38:39], v208 offset:9920
  s_waitcnt lgkmcnt(8)
  v_mfma_f32_32x32x16_bf16 a[112:127], v[20:23], v[56:59], a[112:127]
  ds_read_b64_tr_b16 v[8:9], v208 offset:768
  ds_read_b64_tr_b16 v[10:11], v208 offset:9984
  s_waitcnt lgkmcnt(8)
  v_mfma_f32_32x32x16_bf16 a[128:143], v[24:27], v[56:59], a[128:143]
  ds_read_b64_tr_b16 v[12:13], v208 offset:832
  ds_read_b64_tr_b16 v[14:15], v208 offset:10048
  s_waitcnt lgkmcnt(8)
  v_mfma_f32_32x32x16_bf16 a[144:159], v[28:31], v[56:59], a[144:159]
  ds_read_b64_tr_b16 v[16:17], v208 offset:896
  ds_read_b64_tr_b16 v[18:19], v208 offset:10112
  s_waitcnt lgkmcnt(8)
  v_mfma_f32_32x32x16_bf16 a[160:175], v[32:35], v[56:59], a[160:175]
  ds_read_b64_tr_b16 v[20:21], v208 offset:960
  ds_read_b64_tr_b16 v[22:23], v208 offset:10176
  s_waitcnt lgkmcnt(8)
  v_mfma_f32_32x32x16_bf16 a[176:191], v[36:39], v[56:59], a[176:191]
  ds_read_b64_tr_b16 v[24:25], v208 offset:1024
  ds_read_b64_tr_b16 v[26:27], v208 offset:10240
  s_waitcnt lgkmcnt(8)
  v_mfma_f32_32x32x16_bf16 a[192:207], v[8:11], v[56:59], a[192:207]
  ds_read_b64_tr_b16 v[28:29], v208 offset:1088
  ds_read_b64_tr_b16 v[30:31], v208 offset:10304
  s_waitcnt lgkmcnt(8)
  v_mfma_f32_32x32x16_bf16 a[208:223], v[12:15], v[56:59], a[208:223]
  ds_read_b64_tr_b16 v[32:33], v208 offset:18432
  ds_read_b64_tr_b16 v[34:35], v208 offset:27648
  s_waitcnt lgkmcnt(8)
  v_mfma_f32_32x32x16_bf16 a[224:239], v[16:19], v[56:59], a[224:239]
  ds_read_b64_tr_b16 v[36:37], v208 offset:18496
  ds_read_b64_tr_b16 v[38:39], v208 offset:27712
  s_waitcnt lgkmcnt(8)
  v_mfma_f32_32x32x16_bf16 a[240:255], v[20:23], v[56:59], a[240:255]
  ds_read_b64_tr_b16 v[8:9], v208 offset:18560
  ds_read_b64_tr_b16 v[10:11], v208 offset:27776
  s_waitcnt lgkmcnt(8)
  v_mfma_f32_32x32x16_bf16 v[224:239], v[24:27], v[56:59], v[224:239]
  ds_read_b64_tr_b16 v[12:13], v208 offset:18624
  ds_read_b64_tr_b16 v[14:15], v208 offset:27840
  s_waitcnt lgkmcnt(8)
  v_mfma_f32_32x32x16_bf16 v[240:255], v[28:31], v[56:59], v[240:255]
  ds_read_b64_tr_b16 v[16:17], v208 offset:18688
  ds_read_b64_tr_b16 v[18:19], v208 offset:27904
  s_waitcnt lgkmcnt(8)
  v_mfma_f32_32x32x16_bf16 a[0:15], v[32:35], v[60:63], a[0:15]
  ds_read_b64_tr_b16 v[20:21], v208 offset:18752
  ds_read_b64_tr_b16 v[22:23], v208 offset:27968
  s_waitcnt lgkmcnt(8)
  v_mfma_f32_32x32x16_bf16 a[16:31], v[36:39], v[60:63], a[16:31]
  ds_read_b64_tr_b16 v[24:25], v208 offset:18816
  ds_read_b64_tr_b16 v[26:27], v208 offset:28032
  s_waitcnt lgkmcnt(8)
  v_mfma_f32_32x32x16_bf16 a[32:47], v[8:11], v[60:63], a[32:47]
  ds_read_b64_tr_b16 v[28:29], v208 offset:18880
  ds_read_b64_tr_b16 v[30:31], v208 offset:28096
  s_waitcnt lgkmcnt(8)
  v_mfma_f32_32x32x16_bf16 a[48:63], v[12:15], v[60:63], a[48:63]
  ds_read_b64_tr_b16 v[32:33], v208 offset:18944
  ds_read_b64_tr_b16 v[34:35], v208 offset:28160
  s_waitcnt lgkmcnt(8)
  v_mfma_f32_32x32x16_bf16 a[64:79], v[16:19], v[60:63], a[64:79]
  ds_read_b64_tr_b16 v[36:37], v208 offset:19008
  ds_read_b64_tr_b16 v[38:39], v208 offset:28224
  s_waitcnt lgkmcnt(8)
  v_mfma_f32_32x32x16_bf16 a[80:95], v[20:23], v[60:63], a[80:95]
  ds_read_b64_tr_b16 v[8:9], v208 offset:19072
  ds_read_b64_tr_b16 v[10:11], v208 offset:28288
  s_waitcnt lgkmcnt(8)
  v_mfma_f32_32x32x16_bf16 a[96:111], v[24:27], v[60:63], a[96:111]
  ds_read_b64_tr_b16 v[12:13], v208 offset:19136
  ds_read_b64_tr_b16 v[14:15], v208 offset:28352
  s_waitcnt lgkmcnt(8)
  v_mfma_f32_32x32x16_bf16 a[112:127], v[28:31], v[60:63], a[112:127]
  ds_read_b64_tr_b16 v[16:17], v208 offset:19200
  ds_read_b64_tr_b16 v[18:19], v208 offset:28416
  s_waitcnt lgkmcnt(8)
  v_mfma_f32_32x32x16_bf16 a[128:143], v[32:35], v[60:63], a[128:143]
  ds_read_b64_tr_b16 v[20:21], v208 offset:19264
  ds_read_b64_tr_b16 v[22:23], v208 offset:28480
  s_waitcnt lgkmcnt(8)
  v_mfma_f32_32x32x16_bf16 a[144:159], v[36:39], v[60:63], a[144:159]
  ds_read_b64_tr_b16 v[24:25], v208 offset:19328
  ds_read_b64_tr_b16 v[26:27], v208 offset:28544
  s_waitcnt lgkmcnt(8)
  v_mfma_f32_32x32x16_bf16 a[160:175], v[8:11], v[60:63], a[160:175]
  ds_read_b64_tr_b16 v[28:29], v208 offset:19392
  ds_read_b64_tr_b16 v[30:31], v208 offset:28608
  s_waitcnt lgkmcnt(8)
  v_mfma_f32_32x32x16_bf16 a[176:191], v[12:15], v[60:63], a[176:191]
  ds_read_b64_tr_b16 v[32:33], v208 offset:19456
  ds_read_b64_tr_b16 v[34:35], v208 offset:28672
  s_waitcnt lgkmcnt(8)
  v_mfma_f32_32x32x16_bf16 a[192:207], v[16:19], v[60:63], a[192:207]
  ds_read_b64_tr_b16 v[36:37], v208 offset:19520
  ds_read_b64_tr_b16 v[38:39], v208 offset:28736
  s_waitcnt lgkmcnt(8)
  v_mfma_f32_32x32x16_bf16 a[208:223], v[20:23], v[60:63], a[208:223]
  s_waitcnt lgkmcnt(6)
  v_mfma_f32_32x32x16_bf16 a[224:239], v[24:27], v[60:63], a[224:239]
  s_waitcnt lgkmcnt(4)
  v_mfma_f32_32x32x16_bf16 a[240:255], v[28:31], v[60:63], a[240:255]
  s_waitcnt lgkmcnt(2)
  v_mfma_f32_32x32x16_bf16 v[224:239], v[32:35], v[60:63], v[224:239]
  s_waitcnt lgkmcnt(0)
  v_mfma_f32_32x32x16_bf16 v[240:255], v[36:39], v[60:63], v[240:255]
  s_add_u32 s26, s26, 1
  s_cmp_lt_u32 s26, 36
  s_cbranch_scc1 L_ffn_loop
  s_lshl_b32 s21, s20, 2
  s_add_u32 s21, s21, s19
  s_mul_i32 s21, s21, 36864
  s_add_u32 s21, s21, 109051904
  v_accvgpr_read_b32 v8, a0
  v_accvgpr_read_b32 v9, a1
  v_accvgpr_read_b32 v10, a2
  v_accvgpr_read_b32 v11, a3
  v_cvt_pk_bf16_f32 v12, v8, v9
  v_cvt_pk_bf16_f32 v13, v10, v11
  s_add_u32 s22, s21, 0
  buffer_store_dwordx2 v[12:13], v5, s[4:7], s22 offen sc1
  v_accvgpr_read_b32 v16, a4
  v_accvgpr_read_b32 v17, a5
  v_accvgpr_read_b32 v18, a6
  v_accvgpr_read_b32 v19, a7
  v_cvt_pk_bf16_f32 v20, v16, v17
  v_cvt_pk_bf16_f32 v21, v18, v19
  s_add_u32 s22, s21, 512
  buffer_store_dwordx2 v[20:21], v5, s[4:7], s22 offen sc1
  v_accvgpr_read_b32 v24, a8
  v_accvgpr_read_b32 v25, a9
  v_accvgpr_read_b32 v26, a10
  v_accvgpr_read_b32 v27, a11
  v_cvt_pk_bf16_f32 v28, v24, v25
  v_cvt_pk_bf16_f32 v29, v26, v27
  s_add_u32 s22, s21, 1024
  buffer_store_dwordx2 v[28:29], v5, s[4:7], s22 offen sc1
  v_accvgpr_read_b32 v32, a12
  v_accvgpr_read_b32 v33, a13
  v_accvgpr_read_b32 v34, a14
  v_accvgpr_read_b32 v35, a15
  v_cvt_pk_bf16_f32 v36, v32, v33
  v_cvt_pk_bf16_f32 v37, v34, v35
  s_add_u32 s22, s21, 1536
  buffer_store_dwordx2 v[36:37], v5, s[4:7], s22 offen sc1
  v_accvgpr_read_b32 v8, a16
  v_accvgpr_read_b32 v9, a17
  v_accvgpr_read_b32 v10, a18
  v_accvgpr_read_b32 v11, a19
  v_cvt_pk_bf16_f32 v12, v8, v9
  v_cvt_pk_bf16_f32 v13, v10, v11
  s_add_u32 s22, s21, 2048
  buffer_store_dwordx2 v[12:13], v5, s[4:7], s22 offen sc1
  v_accvgpr_read_b32 v16, a20
  v_accvgpr_read_b32 v17, a21
  v_accvgpr_read_b32 v18, a22
  v_accvgpr_read_b32 v19, a23
  v_cvt_pk_bf16_f32 v20, v16, v17
  v_cvt_pk_bf16_f32 v21, v18, v19
  s_add_u32 s22, s21, 2560
  buffer_store_dwordx2 v[20:21], v5, s[4:7], s22 offen sc1
  v_accvgpr_read_b32 v24, a24
  v_accvgpr_read_b32 v25, a25
  v_accvgpr_read_b32 v26, a26
  v_accvgpr_read_b32 v27, a27
  v_cvt_pk_bf16_f32 v28, v24, v25
  v_cvt_pk_bf16_f32 v29, v26, v27
  s_add_u32 s22, s21, 3072
  buffer_store_dwordx2 v[28:29], v5, s[4:7], s22 offen sc1
  v_accvgpr_read_b32 v32, a28
  v_accvgpr_read_b32 v33, a29
  v_accvgpr_read_b32 v34, a30
  v_accvgpr_read_b32 v35, a31
  v_cvt_pk_bf16_f32 v36, v32, v33
  v_cvt_pk_bf16_f32 v37, v34, v35
  s_add_u32 s22, s21, 3584
  buffer_store_dwordx2 v[36:37], v5, s[4:7], s22 offen sc1
  v_accvgpr_read_b32 v8, a32
  v_accvgpr_read_b32 v9, a33
  v_accvgpr_read_b32 v10, a34
  v_accvgpr_read_b32 v11, a35
  v_cvt_pk_bf16_f32 v12, v8, v9
  v_cvt_pk_bf16_f32 v13, v10, v11
  s_add_u32 s22, s21, 4096
  buffer_store_dwordx2 v[12:13], v5, s[4:7], s22 offen sc1
  v_accvgpr_read_b32 v16, a36
  v_accvgpr_read_b32 v17, a37
  v_accvgpr_read_b32 v18, a38
  v_accvgpr_read_b32 v19, a39
  v_cvt_pk_bf16_f32 v20, v16, v17
  v_cvt_pk_bf16_f32 v21, v18, v19
  s_add_u32 s22, s21, 4608
  buffer_store_dwordx2 v[20:21], v5, s[4:7], s22 offen sc1
  v_accvgpr_read_b32 v24, a40
  v_accvgpr_read_b32 v25, a41
  v_accvgpr_read_b32 v26, a42
  v_accvgpr_read_b32 v27, a43
  v_cvt_pk_bf16_f32 v28, v24, v25
  v_cvt_pk_bf16_f32 v29, v26, v27
  s_add_u32 s22, s21, 5120
  buffer_store_dwordx2 v[28:29], v5, s[4:7], s22 offen sc1
  v_accvgpr_read_b32 v32, a44
  v_accvgpr_read_b32 v33, a45
  v_accvgpr_read_b32 v34, a46
  v_accvgpr_read_b32 v35, a47
  v_cvt_pk_bf16_f32 v36, v32, v33
  v_cvt_pk_bf16_f32 v37, v34, v35
  s_add_u32 s22, s21, 5632
  buffer_store_dwordx2 v[36:37], v5, s[4:7], s22 offen sc1
  v_accvgpr_read_b32 v8, a48
  v_accvgpr_read_b32 v9, a49
  v_accvgpr_read_b32 v10, a50
  v_accvgpr_read_b32 v11, a51
  v_cvt_pk_bf16_f32 v12, v8, v9
  v_cvt_pk_bf16_f32 v13, v10, v11
  s_add_u32 s22, s21, 6144
  buffer_store_dwordx2 v[12:13], v5, s[4:7], s22 offen sc1
  v_accvgpr_read_b32 v16, a52
  v_accvgpr_read_b32 v17, a53
  v_accvgpr_read_b32 v18, a54
  v_accvgpr_read_b32 v19, a55
  v_cvt_pk_bf16_f32 v20, v16, v17
  v_cvt_pk_bf16_f32 v21, v18, v19
  s_add_u32 s22, s21, 6656
  buffer_store_dwordx2 v[20:21], v5, s[4:7], s22 offen sc1
  v_accvgpr_read_b32 v24, a56
  v_accvgpr_read_b32 v25, a57
  v_accvgpr_read_b32 v26, a58
  v_accvgpr_read_b32 v27, a59
  v_cvt_pk_bf16_f32 v28, v24, v25
  v_cvt_pk_bf16_f32 v29, v26, v27
  s_add_u32 s22, s21, 7168
  buffer_store_dwordx2 v[28:29], v5, s[4:7], s22 offen sc1
  v_accvgpr_read_b32 v32, a60
  v_accvgpr_read_b32 v33, a61
  v_accvgpr_read_b32 v34, a62
  v_accvgpr_read_b32 v35, a63
  v_cvt_pk_bf16_f32 v36, v32, v33
  v_cvt_pk_bf16_f32 v37, v34, v35
  s_add_u32 s22, s21, 7680
  buffer_store_dwordx2 v[36:37], v5, s[4:7], s22 offen sc1
  v_accvgpr_read_b32 v8, a64
  v_accvgpr_read_b32 v9, a65
  v_accvgpr_read_b32 v10, a66
  v_accvgpr_read_b32 v11, a67
  v_cvt_pk_bf16_f32 v12, v8, v9
  v_cvt_pk_bf16_f32 v13, v10, v11
  s_add_u32 s22, s21, 8192
  buffer_store_dwordx2 v[12:13], v5, s[4:7], s22 offen sc1
  v_accvgpr_read_b32 v16, a68
  v_accvgpr_read_b32 v17, a69
  v_accvgpr_read_b32 v18, a70
  v_accvgpr_read_b32 v19, a71
  v_cvt_pk_bf16_f32 v20, v16, v17
  v_cvt_pk_bf16_f32 v21, v18, v19
  s_add_u32 s22, s21, 8704
  buffer_store_dwordx2 v[20:21], v5, s[4:7], s22 offen sc1
  v_accvgpr_read_b32 v24, a72
  v_accvgpr_read_b32 v25, a73
  v_accvgpr_read_b32 v26, a74
  v_accvgpr_read_b32 v27, a75
  v_cvt_pk_bf16_f32 v28, v24, v25
  v_cvt_pk_bf16_f32 v29, v26, v27
  s_add_u32 s22, s21, 9216
  buffer_store_dwordx2 v[28:29], v5, s[4:7], s22 offen sc1
  v_accvgpr_read_b32 v32, a76
  v_accvgpr_read_b32 v33, a77
  v_accvgpr_read_b32 v34, a78
  v_accvgpr_read_b32 v35, a79
  v_cvt_pk_bf16_f32 v36, v32, v33
  v_cvt_pk_bf16_f32 v37, v34, v35
  s_add_u32 s22, s21, 9728
  buffer_store_dwordx2 v[36:37], v5, s[4:7], s22 offen sc1
  v_accvgpr_read_b32 v8, a80
  v_accvgpr_read_b32 v9, a81
  v_accvgpr_read_b32 v10, a82
  v_accvgpr_read_b32 v11, a83
  v_cvt_pk_bf16_f32 v12, v8, v9
  v_cvt_pk_bf16_f32 v13, v10, v11
  s_add_u32 s22, s21, 10240
  buffer_store_dwordx2 v[12:13], v5, s[4:7], s22 offen sc1
  v_accvgpr_read_b32 v16, a84
  v_accvgpr_read_b32 v17, a85
  v_accvgpr_read_b32 v18, a86
  v_accvgpr_read_b32 v19, a87
  v_cvt_pk_bf16_f32 v20, v16, v17
  v_cvt_pk_bf16_f32 v21, v18, v19
  s_add_u32 s22, s21, 10752
  buffer_store_dwordx2 v[20:21], v5, s[4:7], s22 offen sc1
  v_accvgpr_read_b32 v24, a88
  v_accvgpr_read_b32 v25, a89
  v_accvgpr_read_b32 v26, a90
  v_accvgpr_read_b32 v27, a91
  v_cvt_pk_bf16_f32 v28, v24, v25
  v_cvt_pk_bf16_f32 v29, v26, v27
  s_add_u32 s22, s21, 11264
  buffer_store_dwordx2 v[28:29], v5, s[4:7], s22 offen sc1
  v_accvgpr_read_b32 v32, a92
  v_accvgpr_read_b32 v33, a93
  v_accvgpr_read_b32 v34, a94
  v_accvgpr_read_b32 v35, a95
  v_cvt_pk_bf16_f32 v36, v32, v33
  v_cvt_pk_bf16_f32 v37, v34, v35
  s_add_u32 s22, s21, 11776
  buffer_store_dwordx2 v[36:37], v5, s[4:7], s22 offen sc1
  v_accvgpr_read_b32 v8, a96
  v_accvgpr_read_b32 v9, a97
  v_accvgpr_read_b32 v10, a98
  v_accvgpr_read_b32 v11, a99
  v_cvt_pk_bf16_f32 v12, v8, v9
  v_cvt_pk_bf16_f32 v13, v10, v11
  s_add_u32 s22, s21, 12288
  buffer_store_dwordx2 v[12:13], v5, s[4:7], s22 offen sc1
  v_accvgpr_read_b32 v16, a100
  v_accvgpr_read_b32 v17, a101
  v_accvgpr_read_b32 v18, a102
  v_accvgpr_read_b32 v19, a103
  v_cvt_pk_bf16_f32 v20, v16, v17
  v_cvt_pk_bf16_f32 v21, v18, v19
  s_add_u32 s22, s21, 12800
  buffer_store_dwordx2 v[20:21], v5, s[4:7], s22 offen sc1
  v_accvgpr_read_b32 v24, a104
  v_accvgpr_read_b32 v25, a105
  v_accvgpr_read_b32 v26, a106
  v_accvgpr_read_b32 v27, a107
  v_cvt_pk_bf16_f32 v28, v24, v25
  v_cvt_pk_bf16_f32 v29, v26, v27
  s_add_u32 s22, s21, 13312
  buffer_store_dwordx2 v[28:29], v5, s[4:7], s22 offen sc1
  v_accvgpr_read_b32 v32, a108
  v_accvgpr_read_b32 v33, a109
  v_accvgpr_read_b32 v34, a110
  v_accvgpr_read_b32 v35, a111
  v_cvt_pk_bf16_f32 v36, v32, v33
  v_cvt_pk_bf16_f32 v37, v34, v35
  s_add_u32 s22, s21, 13824
  buffer_store_dwordx2 v[36:37], v5, s[4:7], s22 offen sc1
  v_accvgpr_read_b32 v8, a112
  v_accvgpr_read_b32 v9, a113
  v_accvgpr_read_b32 v10, a114
  v_accvgpr_read_b32 v11, a115
  v_cvt_pk_bf16_f32 v12, v8, v9
  v_cvt_pk_bf16_f32 v13, v10, v11
  s_add_u32 s22, s21, 14336
  buffer_store_dwordx2 v[12:13], v5, s[4:7], s22 offen sc1
  v_accvgpr_read_b32 v16, a116
  v_accvgpr_read_b32 v17, a117
  v_accvgpr_read_b32 v18, a118
  v_accvgpr_read_b32 v19, a119
  v_cvt_pk_bf16_f32 v20, v16, v17
  v_cvt_pk_bf16_f32 v21, v18, v19
  s_add_u32 s22, s21, 14848
  buffer_store_dwordx2 v[20:21], v5, s[4:7], s22 offen sc1
  v_accvgpr_read_b32 v24, a120
  v_accvgpr_read_b32 v25, a121
  v_accvgpr_read_b32 v26, a122
  v_accvgpr_read_b32 v27, a123
  v_cvt_pk_bf16_f32 v28, v24, v25
  v_cvt_pk_bf16_f32 v29, v26, v27
  s_add_u32 s22, s21, 15360
  buffer_store_dwordx2 v[28:29], v5, s[4:7], s22 offen sc1
  v_accvgpr_read_b32 v32, a124
  v_accvgpr_read_b32 v33, a125
  v_accvgpr_read_b32 v34, a126
  v_accvgpr_read_b32 v35, a127
  v_cvt_pk_bf16_f32 v36, v32, v33
  v_cvt_pk_bf16_f32 v37, v34, v35
  s_add_u32 s22, s21, 15872
  buffer_store_dwordx2 v[36:37], v5, s[4:7], s22 offen sc1
  v_accvgpr_read_b32 v8, a128
  v_accvgpr_read_b32 v9, a129
  v_accvgpr_read_b32 v10, a130
  v_accvgpr_read_b32 v11, a131
  v_cvt_pk_bf16_f32 v12, v8, v9
  v_cvt_pk_bf16_f32 v13, v10, v11
  s_add_u32 s22, s21, 16384
  buffer_store_dwordx2 v[12:13], v5, s[4:7], s22 offen sc1
  v_accvgpr_read_b32 v16, a132
  v_accvgpr_read_b32 v17, a133
  v_accvgpr_read_b32 v18, a134
  v_accvgpr_read_b32 v19, a135
  v_cvt_pk_bf16_f32 v20, v16, v17
  v_cvt_pk_bf16_f32 v21, v18, v19
  s_add_u32 s22, s21, 16896
  buffer_store_dwordx2 v[20:21], v5, s[4:7], s22 offen sc1
  v_accvgpr_read_b32 v24, a136
  v_accvgpr_read_b32 v25, a137
  v_accvgpr_read_b32 v26, a138
  v_accvgpr_read_b32 v27, a139
  v_cvt_pk_bf16_f32 v28, v24, v25
  v_cvt_pk_bf16_f32 v29, v26, v27
  s_add_u32 s22, s21, 17408
  buffer_store_dwordx2 v[28:29], v5, s[4:7], s22 offen sc1
  v_accvgpr_read_b32 v32, a140
  v_accvgpr_read_b32 v33, a141
  v_accvgpr_read_b32 v34, a142
  v_accvgpr_read_b32 v35, a143
  v_cvt_pk_bf16_f32 v36, v32, v33
  v_cvt_pk_bf16_f32 v37, v34, v35
  s_add_u32 s22, s21, 17920
  buffer_store_dwordx2 v[36:37], v5, s[4:7], s22 offen sc1
  v_accvgpr_read_b32 v8, a144
  v_accvgpr_read_b32 v9, a145
  v_accvgpr_read_b32 v10, a146
  v_accvgpr_read_b32 v11, a147
  v_cvt_pk_bf16_f32 v12, v8, v9
  v_cvt_pk_bf16_f32 v13, v10, v11
  s_add_u32 s22, s21, 18432
  buffer_store_dwordx2 v[12:13], v5, s[4:7], s22 offen sc1
  v_accvgpr_read_b32 v16, a148
  v_accvgpr_read_b32 v17, a149
  v_accvgpr_read_b32 v18, a150
  v_accvgpr_read_b32 v19, a151
  v_cvt_pk_bf16_f32 v20, v16, v17
  v_cvt_pk_bf16_f32 v21, v18, v19
  s_add_u32 s22, s21, 18944
  buffer_store_dwordx2 v[20:21], v5, s[4:7], s22 offen sc1
  v_accvgpr_read_b32 v24, a152
  v_accvgpr_read_b32 v25, a153
  v_accvgpr_read_b32 v26, a154
  v_accvgpr_read_b32 v27, a155
  v_cvt_pk_bf16_f32 v28, v24, v25
  v_cvt_pk_bf16_f32 v29, v26, v27
  s_add_u32 s22, s21, 19456
  buffer_store_dwordx2 v[28:29], v5, s[4:7], s22 offen sc1
  v_accvgpr_read_b32 v32, a156
  v_accvgpr_read_b32 v33, a157
  v_accvgpr_read_b32 v34, a158
  v_accvgpr_read_b32 v35, a159
  v_cvt_pk_bf16_f32 v36, v32, v33
  v_cvt_pk_bf16_f32 v37, v34, v35
  s_add_u32 s22, s21, 19968
  buffer_store_dwordx2 v[36:37], v5, s[4:7], s22 offen sc1
  v_accvgpr_read_b32 v8, a160
  v_accvgpr_read_b32 v9, a161
  v_accvgpr_read_b32 v10, a162
  v_accvgpr_read_b32 v11, a163
  v_cvt_pk_bf16_f32 v12, v8, v9
  v_cvt_pk_bf16_f32 v13, v10, v11
  s_add_u32 s22, s21, 20480
  buffer_store_dwordx2 v[12:13], v5, s[4:7], s22 offen sc1
  v_accvgpr_read_b32 v16, a164
  v_accvgpr_read_b32 v17, a165
  v_accvgpr_read_b32 v18, a166
  v_accvgpr_read_b32 v19, a167
  v_cvt_pk_bf16_f32 v20, v16, v17
  v_cvt_pk_bf16_f32 v21, v18, v19
  s_add_u32 s22, s21, 20992
  buffer_store_dwordx2 v[20:21], v5, s[4:7], s22 offen sc1
  v_accvgpr_read_b32 v24, a168
  v_accvgpr_read_b32 v25, a169
  v_accvgpr_read_b32 v26, a170
  v_accvgpr_read_b32 v27, a171
  v_cvt_pk_bf16_f32 v28, v24, v25
  v_cvt_pk_bf16_f32 v29, v26, v27
  s_add_u32 s22, s21, 21504
  buffer_store_dwordx2 v[28:29], v5, s[4:7], s22 offen sc1
  v_accvgpr_read_b32 v32, a172
  v_accvgpr_read_b32 v33, a173
  v_accvgpr_read_b32 v34, a174
  v_accvgpr_read_b32 v35, a175
  v_cvt_pk_bf16_f32 v36, v32, v33
  v_cvt_pk_bf16_f32 v37, v34, v35
  s_add_u32 s22, s21, 22016
  buffer_store_dwordx2 v[36:37], v5, s[4:7], s22 offen sc1
  v_accvgpr_read_b32 v8, a176
  v_accvgpr_read_b32 v9, a177
  v_accvgpr_read_b32 v10, a178
  v_accvgpr_read_b32 v11, a179
  v_cvt_pk_bf16_f32 v12, v8, v9
  v_cvt_pk_bf16_f32 v13, v10, v11
  s_add_u32 s22, s21, 22528
  buffer_store_dwordx2 v[12:13], v5, s[4:7], s22 offen sc1
  v_accvgpr_read_b32 v16, a180
  v_accvgpr_read_b32 v17, a181
  v_accvgpr_read_b32 v18, a182
  v_accvgpr_read_b32 v19, a183
  v_cvt_pk_bf16_f32 v20, v16, v17
  v_cvt_pk_bf16_f32 v21, v18, v19
  s_add_u32 s22, s21, 23040
  buffer_store_dwordx2 v[20:21], v5, s[4:7], s22 offen sc1
  v_accvgpr_read_b32 v24, a184
  v_accvgpr_read_b32 v25, a185
  v_accvgpr_read_b32 v26, a186
  v_accvgpr_read_b32 v27, a187
  v_cvt_pk_bf16_f32 v28, v24, v25
  v_cvt_pk_bf16_f32 v29, v26, v27
  s_add_u32 s22, s21, 23552
  buffer_store_dwordx2 v[28:29], v5, s[4:7], s22 offen sc1
  v_accvgpr_read_b32 v32, a188
  v_accvgpr_read_b32 v33, a189
  v_accvgpr_read_b32 v34, a190
  v_accvgpr_read_b32 v35, a191
  v_cvt_pk_bf16_f32 v36, v32, v33
  v_cvt_pk_bf16_f32 v37, v34, v35
  s_add_u32 s22, s21, 24064
  buffer_store_dwordx2 v[36:37], v5, s[4:7], s22 offen sc1
  v_accvgpr_read_b32 v8, a192
  v_accvgpr_read_b32 v9, a193
  v_accvgpr_read_b32 v10, a194
  v_accvgpr_read_b32 v11, a195
  v_cvt_pk_bf16_f32 v12, v8, v9
  v_cvt_pk_bf16_f32 v13, v10, v11
  s_add_u32 s22, s21, 24576
  buffer_store_dwordx2 v[12:13], v5, s[4:7], s22 offen sc1
  v_accvgpr_read_b32 v16, a196
  v_accvgpr_read_b32 v17, a197
  v_accvgpr_read_b32 v18, a198
  v_accvgpr_read_b32 v19, a199
  v_cvt_pk_bf16_f32 v20, v16, v17
  v_cvt_pk_bf16_f32 v21, v18, v19
  s_add_u32 s22, s21, 25088
  buffer_store_dwordx2 v[20:21], v5, s[4:7], s22 offen sc1
  v_accvgpr_read_b32 v24, a200
  v_accvgpr_read_b32 v25, a201
  v_accvgpr_read_b32 v26, a202
  v_accvgpr_read_b32 v27, a203
  v_cvt_pk_bf16_f32 v28, v24, v25
  v_cvt_pk_bf16_f32 v29, v26, v27
  s_add_u32 s22, s21, 25600
  buffer_store_dwordx2 v[28:29], v5, s[4:7], s22 offen sc1
  v_accvgpr_read_b32 v32, a204
  v_accvgpr_read_b32 v33, a205
  v_accvgpr_read_b32 v34, a206
  v_accvgpr_read_b32 v35, a207
  v_cvt_pk_bf16_f32 v36, v32, v33
  v_cvt_pk_bf16_f32 v37, v34, v35
  s_add_u32 s22, s21, 26112
  buffer_store_dwordx2 v[36:37], v5, s[4:7], s22 offen sc1
  v_accvgpr_read_b32 v8, a208
  v_accvgpr_read_b32 v9, a209
  v_accvgpr_read_b32 v10, a210
  v_accvgpr_read_b32 v11, a211
  v_cvt_pk_bf16_f32 v12, v8, v9
  v_cvt_pk_bf16_f32 v13, v10, v11
  s_add_u32 s22, s21, 26624
  buffer_store_dwordx2 v[12:13], v5, s[4:7], s22 offen sc1
  v_accvgpr_read_b32 v16, a212
  v_accvgpr_read_b32 v17, a213
  v_accvgpr_read_b32 v18, a214
  v_accvgpr_read_b32 v19, a215
  v_cvt_pk_bf16_f32 v20, v16, v17
  v_cvt_pk_bf16_f32 v21, v18, v19
  s_add_u32 s22, s21, 27136
  buffer_store_dwordx2 v[20:21], v5, s[4:7], s22 offen sc1
  v_accvgpr_read_b32 v24, a216
  v_accvgpr_read_b32 v25, a217
  v_accvgpr_read_b32 v26, a218
  v_accvgpr_read_b32 v27, a219
  v_cvt_pk_bf16_f32 v28, v24, v25
  v_cvt_pk_bf16_f32 v29, v26, v27
  s_add_u32 s22, s21, 27648
  buffer_store_dwordx2 v[28:29], v5, s[4:7], s22 offen sc1
  v_accvgpr_read_b32 v32, a220
  v_accvgpr_read_b32 v33, a221
  v_accvgpr_read_b32 v34, a222
  v_accvgpr_read_b32 v35, a223
  v_cvt_pk_bf16_f32 v36, v32, v33
  v_cvt_pk_bf16_f32 v37, v34, v35
  s_add_u32 s22, s21, 28160
  buffer_store_dwordx2 v[36:37], v5, s[4:7], s22 offen sc1
  v_accvgpr_read_b32 v8, a224
  v_accvgpr_read_b32 v9, a225
  v_accvgpr_read_b32 v10, a226
  v_accvgpr_read_b32 v11, a227
  v_cvt_pk_bf16_f32 v12, v8, v9
  v_cvt_pk_bf16_f32 v13, v10, v11
  s_add_u32 s22, s21, 28672
  buffer_store_dwordx2 v[12:13], v5, s[4:7], s22 offen sc1
  v_accvgpr_read_b32 v16, a228
  v_accvgpr_read_b32 v17, a229
  v_accvgpr_read_b32 v18, a230
  v_accvgpr_read_b32 v19, a231
  v_cvt_pk_bf16_f32 v20, v16, v17
  v_cvt_pk_bf16_f32 v21, v18, v19
  s_add_u32 s22, s21, 29184
  buffer_store_dwordx2 v[20:21], v5, s[4:7], s22 offen sc1
  v_accvgpr_read_b32 v24, a232
  v_accvgpr_read_b32 v25, a233
  v_accvgpr_read_b32 v26, a234
  v_accvgpr_read_b32 v27, a235
  v_cvt_pk_bf16_f32 v28, v24, v25
  v_cvt_pk_bf16_f32 v29, v26, v27
  s_add_u32 s22, s21, 29696
  buffer_store_dwordx2 v[28:29], v5, s[4:7], s22 offen sc1
  v_accvgpr_read_b32 v32, a236
  v_accvgpr_read_b32 v33, a237
  v_accvgpr_read_b32 v34, a238
  v_accvgpr_read_b32 v35, a239
  v_cvt_pk_bf16_f32 v36, v32, v33
  v_cvt_pk_bf16_f32 v37, v34, v35
  s_add_u32 s22, s21, 30208
  buffer_store_dwordx2 v[36:37], v5, s[4:7], s22 offen sc1
  v_accvgpr_read_b32 v8, a240
  v_accvgpr_read_b32 v9, a241
  v_accvgpr_read_b32 v10, a242
  v_accvgpr_read_b32 v11, a243
  v_cvt_pk_bf16_f32 v12, v8, v9
  v_cvt_pk_bf16_f32 v13, v10, v11
  s_add_u32 s22, s21, 30720
  buffer_store_dwordx2 v[12:13], v5, s[4:7], s22 offen sc1
  v_accvgpr_read_b32 v16, a244
  v_accvgpr_read_b32 v17, a245
  v_accvgpr_read_b32 v18, a246
  v_accvgpr_read_b32 v19, a247
  v_cvt_pk_bf16_f32 v20, v16, v17
  v_cvt_pk_bf16_f32 v21, v18, v19
  s_add_u32 s22, s21, 31232
  buffer_store_dwordx2 v[20:21], v5, s[4:7], s22 offen sc1
  v_accvgpr_read_b32 v24, a248
  v_accvgpr_read_b32 v25, a249
  v_accvgpr_read_b32 v26, a250
  v_accvgpr_read_b32 v27, a251
  v_cvt_pk_bf16_f32 v28, v24, v25
  v_cvt_pk_bf16_f32 v29, v26, v27
  s_add_u32 s22, s21, 31744
  buffer_store_dwordx2 v[28:29], v5, s[4:7], s22 offen sc1
  v_accvgpr_read_b32 v32, a252
  v_accvgpr_read_b32 v33, a253
  v_accvgpr_read_b32 v34, a254
  v_accvgpr_read_b32 v35, a255
  v_cvt_pk_bf16_f32 v36, v32, v33
  v_cvt_pk_bf16_f32 v37, v34, v35
  s_add_u32 s22, s21, 32256
  buffer_store_dwordx2 v[36:37], v5, s[4:7], s22 offen sc1
  v_cvt_pk_bf16_f32 v12, v224, v225
  v_cvt_pk_bf16_f32 v13, v226, v227
  s_add_u32 s22, s21, 32768
  buffer_store_dwordx2 v[12:13], v5, s[4:7], s22 offen sc1
  v_cvt_pk_bf16_f32 v20, v228, v229
  v_cvt_pk_bf16_f32 v21, v230, v231
  s_add_u32 s22, s21, 33280
  buffer_store_dwordx2 v[20:21], v5, s[4:7], s22 offen sc1
  v_cvt_pk_bf16_f32 v28, v232, v233
  v_cvt_pk_bf16_f32 v29, v234, v235
  s_add_u32 s22, s21, 33792
  buffer_store_dwordx2 v[28:29], v5, s[4:7], s22 offen sc1
  v_cvt_pk_bf16_f32 v36, v236, v237
  v_cvt_pk_bf16_f32 v37, v238, v239
  s_add_u32 s22, s21, 34304
  buffer_store_dwordx2 v[36:37], v5, s[4:7], s22 offen sc1
  v_cvt_pk_bf16_f32 v12, v240, v241
  v_cvt_pk_bf16_f32 v13, v242, v243
  s_add_u32 s22, s21, 34816
  buffer_store_dwordx2 v[12:13], v5, s[4:7], s22 offen sc1
  v_cvt_pk_bf16_f32 v20, v244, v245
  v_cvt_pk_bf16_f32 v21, v246, v247
  s_add_u32 s22, s21, 35328
  buffer_store_dwordx2 v[20:21], v5, s[4:7], s22 offen sc1
  v_cvt_pk_bf16_f32 v28, v248, v249
  v_cvt_pk_bf16_f32 v29, v250, v251
  s_add_u32 s22, s21, 35840
  buffer_store_dwordx2 v[28:29], v5, s[4:7], s22 offen sc1
  v_cvt_pk_bf16_f32 v36, v252, v253
  v_cvt_pk_bf16_f32 v37, v254, v255
  s_add_u32 s22, s21, 36352
  buffer_store_dwordx2 v[36:37], v5, s[4:7], s22 offen sc1
  s_waitcnt vmcnt(0)
  s_barrier
  s_cmp_lg_u32 s17, 0
  s_cbranch_scc1 L_fs_5
  v_mov_b32 v16, 1
  s_mov_b64 exec, 1
  buffer_store_dword v16, off, s[4:7], s95 sc1
  s_mov_b64 exec, -1
L_fs_5:
  s_branch L_r_ffn_end
L_r_ffn_end:
  s_branch L_final
L_r_qkv:
  s_sub_u32 s96, s96, 64
  s_cmp_ge_u32 s96, 48
  s_cselect_b32 s18, 1, 0
  s_mul_i32 s24, s18, 48
  s_sub_u32 s24, s96, s24
  s_lshr_b32 s19, s24, 4
  s_and_b32 s20, s24, 15
  v_and_b32 v5, 63, v0
  v_lshlrev_b32 v1, 4, v5
  v_add_u32 v2, 36864, v1
  s_mov_b32 s24, 24
  s_cmp_eq_u32 s19, 1
  s_cselect_b32 s24, 32, s24
  s_cmp_eq_u32 s19, 2
  s_cselect_b32 s24, 16, s24
  s_load_dwordx2 s[8:9], s[0:1], s24
  s_waitcnt lgkmcnt(0)
  s_and_b32 s9, s9, 0xffff
  s_mov_b32 s10, 4718592
  s_mov_b32 s11, 0x00020000
  v_lshrrev_b32 v6, 3, v5
  v_lshlrev_b32 v6, 13, v6
  v_and_b32 v7, 7, v5
  v_lshl_add_u32 v6, v7, 4, v6
  s_lshl_b32 s24, s20, 1
  s_lshr_b32 s25, s17, 1
  s_add_u32 s24, s24, s25
  s_lshl_b32 s22, s24, 2
  s_lshl_b32 s24, s24, 8
  s_and_b32 s25, s17, 1
  s_lshl_b32 s26, s25, 1
  s_add_u32 s22, s22, s26
  s_lshl_b32 s25, s25, 7
  s_add_u32 s24, s24, s25
  s_mul_i32 s25, s17, 36864
  v_lshrrev_b32 v7, 5, v5
  v_lshlrev_b32 v7, 3, v7
  v_bfe_u32 v8, v5, 2, 2
  v_add_u32 v7, v7, v8
  v_lshlrev_b32 v7, 7, v7
  v_bfe_u32 v8, v5, 4, 1
  v_lshl_add_u32 v7, v8, 5, v7
  v_and_b32 v8, 3, v5
  v_lshl_add_u32 v7, v8, 3, v7
  v_add_u32 v7, s25, v7
  s_add_u32 s26, s24, 0
  s_add_u32 m0, s25, 0
  s_nop 0
  buffer_load_dwordx4 v6, s[8:11], s26 offen lds
  s_add_u32 s26, s24, 65536
  s_add_u32 m0, s25, 1024
  s_nop 0
  buffer_load_dwordx4 v6, s[8:11], s26 offen lds
  s_add_u32 s26, s24, 131072
  s_add_u32 m0, s25, 2048
  s_nop 0
  buffer_load_dwordx4 v6, s[8:11], s26 offen lds
  s_add_u32 s26, s24, 196608
  s_add_u32 m0, s25, 3072
  s_nop 0
  buffer_load_dwordx4 v6, s[8:11], s26 offen lds
  s_add_u32 s26, s24, 262144
  s_add_u32 m0, s25, 4096
  s_nop 0
  buffer_load_dwordx4 v6, s[8:11], s26 offen lds
  s_add_u32 s26, s24, 327680
  s_add_u32 m0, s25, 5120
  s_nop 0
  buffer_load_dwordx4 v6, s[8:11], s26 offen lds
  s_add_u32 s26, s24, 393216
  s_add_u32 m0, s25, 6144
  s_nop 0
  buffer_load_dwordx4 v6, s[8:11], s26 offen lds
  s_add_u32 s26, s24, 458752
  s_add_u32 m0, s25, 7168
  s_nop 0
  buffer_load_dwordx4 v6, s[8:11], s26 offen lds
  s_add_u32 s26, s24, 524288
  s_add_u32 m0, s25, 8192
  s_nop 0
  buffer_load_dwordx4 v6, s[8:11], s26 offen lds
  s_add_u32 s26, s24, 589824
  s_add_u32 m0, s25, 9216
  s_nop 0
  buffer_load_dwordx4 v6, s[8:11], s26 offen lds
  s_add_u32 s26, s24, 655360
  s_add_u32 m0, s25, 10240
  s_nop 0
  buffer_load_dwordx4 v6, s[8:11], s26 offen lds
  s_add_u32 s26, s24, 720896
  s_add_u32 m0, s25, 11264
  s_nop 0
  buffer_load_dwordx4 v6, s[8:11], s26 offen lds
  s_add_u32 s26, s24, 786432
  s_add_u32 m0, s25, 12288
  s_nop 0
  buffer_load_dwordx4 v6, s[8:11], s26 offen lds
  s_add_u32 s26, s24, 851968
  s_add_u32 m0, s25, 13312
  s_nop 0
  buffer_load_dwordx4 v6, s[8:11], s26 offen lds
  s_add_u32 s26, s24, 917504
  s_add_u32 m0, s25, 14336
  s_nop 0
  buffer_load_dwordx4 v6, s[8:11], s26 offen lds
  s_add_u32 s26, s24, 983040
  s_add_u32 m0, s25, 15360
  s_nop 0
  buffer_load_dwordx4 v6, s[8:11], s26 offen lds
  s_add_u32 s26, s24, 1048576
  s_add_u32 m0, s25, 16384
  s_nop 0
  buffer_load_dwordx4 v6, s[8:11], s26 offen lds
  s_add_u32 s26, s24, 1114112
  s_add_u32 m0, s25, 17408
  s_nop 0
  buffer_load_dwordx4 v6, s[8:11], s26 offen lds
  s_add_u32 s26, s24, 1179648
  s_add_u32 m0, s25, 18432
  s_nop 0
  buffer_load_dwordx4 v6, s[8:11], s26 offen lds
  s_add_u32 s26, s24, 1245184
  s_add_u32 m0, s25, 19456
  s_nop 0
  buffer_load_dwordx4 v6, s[8:11], s26 offen lds
  s_add_u32 s26, s24, 1310720
  s_add_u32 m0, s25, 20480
  s_nop 0
  buffer_load_dwordx4 v6, s[8:11], s26 offen lds
  s_add_u32 s26, s24, 1376256
  s_add_u32 m0, s25, 21504
  s_nop 0
  buffer_load_dwordx4 v6, s[8:11], s26 offen lds
  s_add_u32 s26, s24, 1441792
  s_add_u32 m0, s25, 22528
  s_nop 0
  buffer_load_dwordx4 v6, s[8:11], s26 offen lds
  s_add_u32 s26, s24, 1507328
  s_add_u32 m0, s25, 23552
  s_nop 0
  buffer_load_dwordx4 v6, s[8:11], s26 offen lds
  s_add_u32 s26, s24, 1572864
  s_add_u32 m0, s25, 24576
  s_nop 0
  buffer_load_dwordx4 v6, s[8:11], s26 offen lds
  s_add_u32 s26, s24, 1638400
  s_add_u32 m0, s25, 25600
  s_nop 0
  buffer_load_dwordx4 v6, s[8:11], s26 offen lds
  s_add_u32 s26, s24, 1703936
  s_add_u32 m0, s25, 26624
  s_nop 0
  buffer_load_dwordx4 v6, s[8:11], s26 offen lds
  s_add_u32 s26, s24, 1769472
  s_add_u32 m0, s25, 27648
  s_nop 0
  buffer_load_dwordx4 v6, s[8:11], s26 offen lds
  s_add_u32 s26, s24, 1835008
  s_add_u32 m0, s25, 28672
  s_nop 0
  buffer_load_dwordx4 v6, s[8:11], s26 offen lds
  s_add_u32 s26, s24, 1900544
  s_add_u32 m0, s25, 29696
  s_nop 0
  buffer_load_dwordx4 v6, s[8:11], s26 offen lds
  s_add_u32 s26, s24, 1966080
  s_add_u32 m0, s25, 30720
  s_nop 0
  buffer_load_dwordx4 v6, s[8:11], s26 offen lds
  s_add_u32 s26, s24, 2031616
  s_add_u32 m0, s25, 31744
  s_nop 0
  buffer_load_dwordx4 v6, s[8:11], s26 offen lds
  s_add_u32 s26, s24, 2097152
  s_add_u32 m0, s25, 32768
  s_nop 0
  buffer_load_dwordx4 v6, s[8:11], s26 offen lds
  s_add_u32 s26, s24, 2162688
  s_add_u32 m0, s25, 33792
  s_nop 0
  buffer_load_dwordx4 v6, s[8:11], s26 offen lds
  s_add_u32 s26, s24, 2228224
  s_add_u32 m0, s25, 34816
  s_nop 0
  buffer_load_dwordx4 v6, s[8:11], s26 offen lds
  s_add_u32 s26, s24, 2293760
  s_add_u32 m0, s25, 35840
  s_nop 0
  buffer_load_dwordx4 v6, s[8:11], s26 offen lds
  s_waitcnt vmcnt(34)
  ds_read_b64_tr_b16 a[0:1], v7 offset:0
  ds_read_b64_tr_b16 a[2:3], v7 offset:512
  ds_read_b64_tr_b16 a[144:145], v7 offset:64
  ds_read_b64_tr_b16 a[146:147], v7 offset:576
  s_waitcnt vmcnt(32)
  ds_read_b64_tr_b16 a[4:5], v7 offset:2048
  ds_read_b64_tr_b16 a[6:7], v7 offset:2560
  ds_read_b64_tr_b16 a[148:149], v7 offset:2112
  ds_read_b64_tr_b16 a[150:151], v7 offset:2624
  s_waitcnt vmcnt(30)
  ds_read_b64_tr_b16 a[8:9], v7 offset:4096
  ds_read_b64_tr_b16 a[10:11], v7 offset:4608
  ds_read_b64_tr_b16 a[152:153], v7 offset:4160
  ds_read_b64_tr_b16 a[154:155], v7 offset:4672
  s_waitcnt vmcnt(28)
  ds_read_b64_tr_b16 a[12:13], v7 offset:6144
  ds_read_b64_tr_b16 a[14:15], v7 offset:6656
  ds_read_b64_tr_b16 a[156:157], v7 offset:6208
  ds_read_b64_tr_b16 a[158:159], v7 offset:6720
  s_waitcnt vmcnt(26)
  ds_read_b64_tr_b16 a[16:17], v7 offset:8192
  ds_read_b64_tr_b16 a[18:19], v7 offset:8704
  ds_read_b64_tr_b16 a[160:161], v7 offset:8256
  ds_read_b64_tr_b16 a[162:163], v7 offset:8768
  s_waitcnt vmcnt(24)
  ds_read_b64_tr_b16 a[20:21], v7 offset:10240
  ds_read_b64_tr_b16 a[22:23], v7 offset:10752
  ds_read_b64_tr_b16 a[164:165], v7 offset:10304
  ds_read_b64_tr_b16 a[166:167], v7 offset:10816
  s_waitcnt vmcnt(22)
  ds_read_b64_tr_b16 a[24:25], v7 offset:12288
  ds_read_b64_tr_b16 a[26:27], v7 offset:12800
  ds_read_b64_tr_b16 a[168:169], v7 offset:12352
  ds_read_b64_tr_b16 a[170:171], v7 offset:12864
  s_waitcnt vmcnt(20)
  ds_read_b64_tr_b16 a[28:29], v7 offset:14336
  ds_read_b64_tr_b16 a[30:31], v7 offset:14848
  ds_read_b64_tr_b16 a[172:173], v7 offset:14400
  ds_read_b64_tr_b16 a[174:175], v7 offset:14912
  s_waitcnt vmcnt(18)
  ds_read_b64_tr_b16 a[32:33], v7 offset:16384
  ds_read_b64_tr_b16 a[34:35], v7 offset:16896
  ds_read_b64_tr_b16 a[176:177], v7 offset:16448
  ds_read_b64_tr_b16 a[178:179], v7 offset:16960
  s_waitcnt vmcnt(16)
  ds_read_b64_tr_b16 a[36:37], v7 offset:18432
  ds_read_b64_tr_b16 a[38:39], v7 offset:18944
  ds_read_b64_tr_b16 a[180:181], v7 offset:18496
  ds_read_b64_tr_b16 a[182:183], v7 offset:19008
  s_waitcnt vmcnt(14)
  ds_read_b64_tr_b16 a[40:41], v7 offset:20480
  ds_read_b64_tr_b16 a[42:43], v7 offset:20992
  ds_read_b64_tr_b16 a[184:185], v7 offset:20544
  ds_read_b64_tr_b16 a[186:187], v7 offset:21056
  s_waitcnt vmcnt(12)
  ds_read_b64_tr_b16 a[44:45], v7 offset:22528
  ds_read_b64_tr_b16 a[46:47], v7 offset:23040
  ds_read_b64_tr_b16 a[188:189], v7 offset:22592
  ds_read_b64_tr_b16 a[190:191], v7 offset:23104
  s_waitcnt vmcnt(10)
  ds_read_b64_tr_b16 a[48:49], v7 offset:24576
  ds_read_b64_tr_b16 a[50:51], v7 offset:25088
  ds_read_b64_tr_b16 a[192:193], v7 offset:24640
  ds_read_b64_tr_b16 a[194:195], v7 offset:25152
  s_waitcnt vmcnt(8)
  ds_read_b64_tr_b16 a[52:53], v7 offset:26624
  ds_read_b64_tr_b16 a[54:55], v7 offset:27136
  ds_read_b64_tr_b16 a[196:197], v7 offset:26688
  ds_read_b64_tr_b16 a[198:199], v7 offset:27200
  s_waitcnt vmcnt(6)
  ds_read_b64_tr_b16 a[56:57], v7 offset:28672
  ds_read_b64_tr_b16 a[58:59], v7 offset:29184
  ds_read_b64_tr_b16 a[200:201], v7 offset:28736
  ds_read_b64_tr_b16 a[202:203], v7 offset:29248
  s_waitcnt vmcnt(4)
  ds_read_b64_tr_b16 a[60:61], v7 offset:30720
  ds_read_b64_tr_b16 a[62:63], v7 offset:31232
  ds_read_b64_tr_b16 a[204:205], v7 offset:30784
  ds_read_b64_tr_b16 a[206:207], v7 offset:31296
  s_waitcnt vmcnt(2)
  ds_read_b64_tr_b16 a[64:65], v7 offset:32768
  ds_read_b64_tr_b16 a[66:67], v7 offset:33280
  ds_read_b64_tr_b16 a[208:209], v7 offset:32832
  ds_read_b64_tr_b16 a[210:211], v7 offset:33344
  s_waitcnt vmcnt(0)
  ds_read_b64_tr_b16 a[68:69], v7 offset:34816
  ds_read_b64_tr_b16 a[70:71], v7 offset:35328
  ds_read_b64_tr_b16 a[212:213], v7 offset:34880
  ds_read_b64_tr_b16 a[214:215], v7 offset:35392
  s_waitcnt lgkmcnt(0)
  s_add_u32 s26, s24, 2359296
  s_add_u32 m0, s25, 0
  s_nop 0
  buffer_load_dwordx4 v6, s[8:11], s26 offen lds
  s_add_u32 s26, s24, 2424832
  s_add_u32 m0, s25, 1024
  s_nop 0
  buffer_load_dwordx4 v6, s[8:11], s26 offen lds
  s_add_u32 s26, s24, 2490368
  s_add_u32 m0, s25, 2048
  s_nop 0
  buffer_load_dwordx4 v6, s[8:11], s26 offen lds
  s_add_u32 s26, s24, 2555904
  s_add_u32 m0, s25, 3072
  s_nop 0
  buffer_load_dwordx4 v6, s[8:11], s26 offen lds
  s_add_u32 s26, s24, 2621440
  s_add_u32 m0, s25, 4096
  s_nop 0
  buffer_load_dwordx4 v6, s[8:11], s26 offen lds
  s_add_u32 s26, s24, 2686976
  s_add_u32 m0, s25, 5120
  s_nop 0
  buffer_load_dwordx4 v6, s[8:11], s26 offen lds
  s_add_u32 s26, s24, 2752512
  s_add_u32 m0, s25, 6144
  s_nop 0
  buffer_load_dwordx4 v6, s[8:11], s26 offen lds
  s_add_u32 s26, s24, 2818048
  s_add_u32 m0, s25, 7168
  s_nop 0
  buffer_load_dwordx4 v6, s[8:11], s26 offen lds
  s_add_u32 s26, s24, 2883584
  s_add_u32 m0, s25, 8192
  s_nop 0
  buffer_load_dwordx4 v6, s[8:11], s26 offen lds
  s_add_u32 s26, s24, 2949120
  s_add_u32 m0, s25, 9216
  s_nop 0
  buffer_load_dwordx4 v6, s[8:11], s26 offen lds
  s_add_u32 s26, s24, 3014656
  s_add_u32 m0, s25, 10240
  s_nop 0
  buffer_load_dwordx4 v6, s[8:11], s26 offen lds
  s_add_u32 s26, s24, 3080192
  s_add_u32 m0, s25, 11264
  s_nop 0
  buffer_load_dwordx4 v6, s[8:11], s26 offen lds
  s_add_u32 s26, s24, 3145728
  s_add_u32 m0, s25, 12288
  s_nop 0
  buffer_load_dwordx4 v6, s[8:11], s26 offen lds
  s_add_u32 s26, s24, 3211264
  s_add_u32 m0, s25, 13312
  s_nop 0
  buffer_load_dwordx4 v6, s[8:11], s26 offen lds
  s_add_u32 s26, s24, 3276800
  s_add_u32 m0, s25, 14336
  s_nop 0
  buffer_load_dwordx4 v6, s[8:11], s26 offen lds
  s_add_u32 s26, s24, 3342336
  s_add_u32 m0, s25, 15360
  s_nop 0
  buffer_load_dwordx4 v6, s[8:11], s26 offen lds
  s_add_u32 s26, s24, 3407872
  s_add_u32 m0, s25, 16384
  s_nop 0
  buffer_load_dwordx4 v6, s[8:11], s26 offen lds
  s_add_u32 s26, s24, 3473408
  s_add_u32 m0, s25, 17408
  s_nop 0
  buffer_load_dwordx4 v6, s[8:11], s26 offen lds
  s_add_u32 s26, s24, 3538944
  s_add_u32 m0, s25, 18432
  s_nop 0
  buffer_load_dwordx4 v6, s[8:11], s26 offen lds
  s_add_u32 s26, s24, 3604480
  s_add_u32 m0, s25, 19456
  s_nop 0
  buffer_load_dwordx4 v6, s[8:11], s26 offen lds
  s_add_u32 s26, s24, 3670016
  s_add_u32 m0, s25, 20480
  s_nop 0
  buffer_load_dwordx4 v6, s[8:11], s26 offen lds
  s_add_u32 s26, s24, 3735552
  s_add_u32 m0, s25, 21504
  s_nop 0
  buffer_load_dwordx4 v6, s[8:11], s26 offen lds
  s_add_u32 s26, s24, 3801088
  s_add_u32 m0, s25, 22528
  s_nop 0
  buffer_load_dwordx4 v6, s[8:11], s26 offen lds
  s_add_u32 s26, s24, 3866624
  s_add_u32 m0, s25, 23552
  s_nop 0
  buffer_load_dwordx4 v6, s[8:11], s26 offen lds
  s_add_u32 s26, s24, 3932160
  s_add_u32 m0, s25, 24576
  s_nop 0
  buffer_load_dwordx4 v6, s[8:11], s26 offen lds
  s_add_u32 s26, s24, 3997696
  s_add_u32 m0, s25, 25600
  s_nop 0
  buffer_load_dwordx4 v6, s[8:11], s26 offen lds
  s_add_u32 s26, s24, 4063232
  s_add_u32 m0, s25, 26624
  s_nop 0
  buffer_load_dwordx4 v6, s[8:11], s26 offen lds
  s_add_u32 s26, s24, 4128768
  s_add_u32 m0, s25, 27648
  s_nop 0
  buffer_load_dwordx4 v6, s[8:11], s26 offen lds
  s_add_u32 s26, s24, 4194304
  s_add_u32 m0, s25, 28672
  s_nop 0
  buffer_load_dwordx4 v6, s[8:11], s26 offen lds
  s_add_u32 s26, s24, 4259840
  s_add_u32 m0, s25, 29696
  s_nop 0
  buffer_load_dwordx4 v6, s[8:11], s26 offen lds
  s_add_u32 s26, s24, 4325376
  s_add_u32 m0, s25, 30720
  s_nop 0
  buffer_load_dwordx4 v6, s[8:11], s26 offen lds
  s_add_u32 s26, s24, 4390912
  s_add_u32 m0, s25, 31744
  s_nop 0
  buffer_load_dwordx4 v6, s[8:11], s26 offen lds
  s_add_u32 s26, s24, 4456448
  s_add_u32 m0, s25, 32768
  s_nop 0
  buffer_load_dwordx4 v6, s[8:11], s26 offen lds
  s_add_u32 s26, s24, 4521984
  s_add_u32 m0, s25, 33792
  s_nop 0
  buffer_load_dwordx4 v6, s[8:11], s26 offen lds
  s_add_u32 s26, s24, 4587520
  s_add_u32 m0, s25, 34816
  s_nop 0
  buffer_load_dwordx4 v6, s[8:11], s26 offen lds
  s_add_u32 s26, s24, 4653056
  s_add_u32 m0, s25, 35840
  s_nop 0
  buffer_load_dwordx4 v6, s[8:11], s26 offen lds
  s_waitcnt vmcnt(34)
  ds_read_b64_tr_b16 a[72:73], v7 offset:0
  ds_read_b64_tr_b16 a[74:75], v7 offset:512
  ds_read_b64_tr_b16 a[216:217], v7 offset:64
  ds_read_b64_tr_b16 a[218:219], v7 offset:576
  s_waitcnt vmcnt(32)
  ds_read_b64_tr_b16 a[76:77], v7 offset:2048
  ds_read_b64_tr_b16 a[78:79], v7 offset:2560
  ds_read_b64_tr_b16 a[220:221], v7 offset:2112
  ds_read_b64_tr_b16 a[222:223], v7 offset:2624
  s_waitcnt vmcnt(30)
  ds_read_b64_tr_b16 a[80:81], v7 offset:4096
  ds_read_b64_tr_b16 a[82:83], v7 offset:4608
  ds_read_b64_tr_b16 a[224:225], v7 offset:4160
  ds_read_b64_tr_b16 a[226:227], v7 offset:4672
  s_waitcnt vmcnt(28)
  ds_read_b64_tr_b16 a[84:85], v7 offset:6144
  ds_read_b64_tr_b16 a[86:87], v7 offset:6656
  ds_read_b64_tr_b16 a[228:229], v7 offset:6208
  ds_read_b64_tr_b16 a[230:231], v7 offset:6720
  s_waitcnt vmcnt(26)
  ds_read_b64_tr_b16 a[88:89], v7 offset:8192
  ds_read_b64_tr_b16 a[90:91], v7 offset:8704
  ds_read_b64_tr_b16 a[232:233], v7 offset:8256
  ds_read_b64_tr_b16 a[234:235], v7 offset:8768
  s_waitcnt vmcnt(24)
  ds_read_b64_tr_b16 a[92:93], v7 offset:10240
  ds_read_b64_tr_b16 a[94:95], v7 offset:10752
  ds_read_b64_tr_b16 a[236:237], v7 offset:10304
  ds_read_b64_tr_b16 a[238:239], v7 offset:10816
  s_waitcnt vmcnt(22)
  ds_read_b64_tr_b16 a[96:97], v7 offset:12288
  ds_read_b64_tr_b16 a[98:99], v7 offset:12800
  ds_read_b64_tr_b16 a[240:241], v7 offset:12352
  ds_read_b64_tr_b16 a[242:243], v7 offset:12864
  s_waitcnt vmcnt(20)
  ds_read_b64_tr_b16 a[100:101], v7 offset:14336
  ds_read_b64_tr_b16 a[102:103], v7 offset:14848
  ds_read_b64_tr_b16 a[244:245], v7 offset:14400
  ds_read_b64_tr_b16 a[246:247], v7 offset:14912
  s_waitcnt vmcnt(18)
  ds_read_b64_tr_b16 a[104:105], v7 offset:16384
  ds_read_b64_tr_b16 a[106:107], v7 offset:16896
  ds_read_b64_tr_b16 a[248:249], v7 offset:16448
  ds_read_b64_tr_b16 a[250:251], v7 offset:16960
  s_waitcnt vmcnt(16)
  ds_read_b64_tr_b16 a[108:109], v7 offset:18432
  ds_read_b64_tr_b16 a[110:111], v7 offset:18944
  ds_read_b64_tr_b16 a[252:253], v7 offset:18496
  ds_read_b64_tr_b16 a[254:255], v7 offset:19008
  s_waitcnt vmcnt(14)
  ds_read_b64_tr_b16 a[112:113], v7 offset:20480
  ds_read_b64_tr_b16 a[114:115], v7 offset:20992
  ds_read_b64_tr_b16 v[224:225], v7 offset:20544
  ds_read_b64_tr_b16 v[226:227], v7 offset:21056
  s_waitcnt vmcnt(12)
  ds_read_b64_tr_b16 a[116:117], v7 offset:22528
  ds_read_b64_tr_b16 a[118:119], v7 offset:23040
  ds_read_b64_tr_b16 v[228:229], v7 offset:22592
  ds_read_b64_tr_b16 v[230:231], v7 offset:23104
  s_waitcnt vmcnt(10)
  ds_read_b64_tr_b16 a[120:121], v7 offset:24576
  ds_read_b64_tr_b16 a[122:123], v7 offset:25088
  ds_read_b64_tr_b16 v[232:233], v7 offset:24640
  ds_read_b64_tr_b16 v[234:235], v7 offset:25152
  s_waitcnt vmcnt(8)
  ds_read_b64_tr_b16 a[124:125], v7 offset:26624
  ds_read_b64_tr_b16 a[126:127], v7 offset:27136
  ds_read_b64_tr_b16 v[236:237], v7 offset:26688
  ds_read_b64_tr_b16 v[238:239], v7 offset:27200
  s_waitcnt vmcnt(6)
  ds_read_b64_tr_b16 a[128:129], v7 offset:28672
  ds_read_b64_tr_b16 a[130:131], v7 offset:29184
  ds_read_b64_tr_b16 v[240:241], v7 offset:28736
  ds_read_b64_tr_b16 v[242:243], v7 offset:29248
  s_waitcnt vmcnt(4)
  ds_read_b64_tr_b16 a[132:133], v7 offset:30720
  ds_read_b64_tr_b16 a[134:135], v7 offset:31232
  ds_read_b64_tr_b16 v[244:245], v7 offset:30784
  ds_read_b64_tr_b16 v[246:247], v7 offset:31296
  s_waitcnt vmcnt(2)
  ds_read_b64_tr_b16 a[136:137], v7 offset:32768
  ds_read_b64_tr_b16 a[138:139], v7 offset:33280
  ds_read_b64_tr_b16 v[248:249], v7 offset:32832
  ds_read_b64_tr_b16 v[250:251], v7 offset:33344
  s_waitcnt vmcnt(0)
  ds_read_b64_tr_b16 a[140:141], v7 offset:34816
  ds_read_b64_tr_b16 a[142:143], v7 offset:35328
  ds_read_b64_tr_b16 v[252:253], v7 offset:34880
  ds_read_b64_tr_b16 v[254:255], v7 offset:35392
  s_waitcnt lgkmcnt(0)
  s_lshl_b32 s22, s22, 11
  s_mov_b32 s24, 4194304
  s_cmp_eq_u32 s19, 1
  s_cselect_b32 s24, 20971520, s24
  s_cmp_eq_u32 s19, 2
  s_cselect_b32 s24, 37748736, s24
  s_add_u32 s22, s22, s24
  s_lshl_b32 s24, s18, 18
  s_add_u32 s22, s22, s24
  v_bfe_u32 v6, v5, 4, 1
  v_lshlrev_b32 v6, 10, v6
  v_lshrrev_b32 v7, 5, v5
  v_lshl_add_u32 v6, v7, 8, v6
  v_and_b32 v7, 15, v5
  v_lshl_add_u32 v3, v7, 4, v6
  s_mul_i32 s23, s18, 36864
  s_mul_i32 s24, s17, 9216
  s_add_u32 s23, s23, s24
  s_add_u32 s23, s23, 1048576
  s_mov_b32 s21, 0
  s_barrier
  s_add_u32 s95, s96, 32
  s_lshl_b32 s95, s95, 8
  s_add_u32 s95, s95, 0
  s_cmp_lg_u32 s17, 0
  s_cbranch_scc1 L_wl_7
  s_mov_b32 s94, 0
L_wl_6:
  buffer_load_dword v4, off, s[12:15], 0 offset:128 sc1
  s_waitcnt vmcnt(0)
  v_readfirstlane_b32 s92, v4
  s_cmp_ge_u32 s92, 64
  s_cbranch_scc1 L_wl_7
  s_add_u32 s94, s94, 1
  s_cmp_lt_u32 s94, 400000
  s_cbranch_scc1 L_wl_6
  s_branch L_fail
L_wl_7:
  s_barrier
  s_cmp_eq_u32 s19, 1
  s_cbranch_scc1 L_qkv_v
  s_add_u32 s26, s23, 0
  s_mul_i32 s24, s17, 9216
  s_add_u32 m0, s24, 0
  s_nop 0
  buffer_load_dwordx4 v1, s[4:7], s26 offen lds
  s_add_u32 s26, s23, 1024
  s_mul_i32 s24, s17, 9216
  s_add_u32 m0, s24, 1024
  s_nop 0
  buffer_load_dwordx4 v1, s[4:7], s26 offen lds
  s_add_u32 s26, s23, 2048
  s_mul_i32 s24, s17, 9216
  s_add_u32 m0, s24, 2048
  s_nop 0
  buffer_load_dwordx4 v1, s[4:7], s26 offen lds
  s_add_u32 s26, s23, 3072
  s_mul_i32 s24, s17, 9216
  s_add_u32 m0, s24, 3072
  s_nop 0
  buffer_load_dwordx4 v1, s[4:7], s26 offen lds
  s_add_u32 s26, s23, 4096
  s_mul_i32 s24, s17, 9216
  s_add_u32 m0, s24, 4096
  s_nop 0
  buffer_load_dwordx4 v1, s[4:7], s26 offen lds
  s_add_u32 s26, s23, 5120
  s_mul_i32 s24, s17, 9216
  s_add_u32 m0, s24, 5120
  s_nop 0
  buffer_load_dwordx4 v1, s[4:7], s26 offen lds
  s_add_u32 s26, s23, 6144
  s_mul_i32 s24, s17, 9216
  s_add_u32 m0, s24, 6144
  s_nop 0
  buffer_load_dwordx4 v1, s[4:7], s26 offen lds
  s_add_u32 s26, s23, 7168
  s_mul_i32 s24, s17, 9216
  s_add_u32 m0, s24, 7168
  s_nop 0
  buffer_load_dwordx4 v1, s[4:7], s26 offen lds
  s_add_u32 s26, s23, 8192
  s_mul_i32 s24, s17, 9216
  s_add_u32 m0, s24, 8192
  s_nop 0
  buffer_load_dwordx4 v1, s[4:7], s26 offen lds
  s_add_u32 s23, s23, 73728
  s_waitcnt vmcnt(0)
  s_barrier
  s_sub_u32 s92, s21, 1
  s_max_i32 s92, s92, 0
  s_cmp_lg_u32 s17, 0
  s_cbranch_scc1 L_fs_8
  v_mov_b32 v4, s92
  s_mov_b64 exec, 1
  buffer_store_dword v4, off, s[4:7], s95 sc1
  s_mov_b64 exec, -1
L_fs_8:
  s_cmp_ge_u32 s21, 31
  s_cbranch_scc1 L_qnd_9
  s_add_u32 s26, s23, 0
  s_mul_i32 s24, s17, 9216
  s_add_u32 m0, s24, 36864
  s_nop 0
  buffer_load_dwordx4 v1, s[4:7], s26 offen lds
  s_add_u32 s26, s23, 1024
  s_mul_i32 s24, s17, 9216
  s_add_u32 m0, s24, 37888
  s_nop 0
  buffer_load_dwordx4 v1, s[4:7], s26 offen lds
  s_add_u32 s26, s23, 2048
  s_mul_i32 s24, s17, 9216
  s_add_u32 m0, s24, 38912
  s_nop 0
  buffer_load_dwordx4 v1, s[4:7], s26 offen lds
  s_add_u32 s26, s23, 3072
  s_mul_i32 s24, s17, 9216
  s_add_u32 m0, s24, 39936
  s_nop 0
  buffer_load_dwordx4 v1, s[4:7], s26 offen lds
  s_add_u32 s26, s23, 4096
  s_mul_i32 s24, s17, 9216
  s_add_u32 m0, s24, 40960
  s_nop 0
  buffer_load_dwordx4 v1, s[4:7], s26 offen lds
  s_add_u32 s26, s23, 5120
  s_mul_i32 s24, s17, 9216
  s_add_u32 m0, s24, 41984
  s_nop 0
  buffer_load_dwordx4 v1, s[4:7], s26 offen lds
  s_add_u32 s26, s23, 6144
  s_mul_i32 s24, s17, 9216
  s_add_u32 m0, s24, 43008
  s_nop 0
  buffer_load_dwordx4 v1, s[4:7], s26 offen lds
  s_add_u32 s26, s23, 7168
  s_mul_i32 s24, s17, 9216
  s_add_u32 m0, s24, 44032
  s_nop 0
  buffer_load_dwordx4 v1, s[4:7], s26 offen lds
  s_add_u32 s26, s23, 8192
  s_mul_i32 s24, s17, 9216
  s_add_u32 m0, s24, 45056
  s_nop 0
  buffer_load_dwordx4 v1, s[4:7], s26 offen lds
  s_add_u32 s23, s23, 73728
L_qnd_9:
  ds_read_b128 v[8:11], v1 offset:0
  ds_read_b128 v[12:15], v1 offset:1024
  ds_read_b128 v[16:19], v1 offset:2048
  ds_read_b128 v[20:23], v1 offset:3072
  ds_read_b128 v[24:27], v1 offset:4096
  s_waitcnt lgkmcnt(4)
  v_mfma_f32_32x32x16_bf16 v[40:55], a[0:3], v[8:11], 0
  v_mfma_f32_32x32x16_bf16 v[56:71], a[144:147], v[8:11], 0
  ds_read_b128 v[28:31], v1 offset:5120
  s_waitcnt lgkmcnt(4)
  v_mfma_f32_32x32x16_bf16 v[40:55], a[4:7], v[12:15], v[40:55]
  v_mfma_f32_32x32x16_bf16 v[56:71], a[148:151], v[12:15], v[56:71]
  ds_read_b128 v[32:35], v1 offset:6144
  s_waitcnt lgkmcnt(4)
  v_mfma_f32_32x32x16_bf16 v[40:55], a[8:11], v[16:19], v[40:55]
  v_mfma_f32_32x32x16_bf16 v[56:71], a[152:155], v[16:19], v[56:71]
  ds_read_b128 v[36:39], v1 offset:7168
  s_waitcnt lgkmcnt(4)
  v_mfma_f32_32x32x16_bf16 v[40:55], a[12:15], v[20:23], v[40:55]
  v_mfma_f32_32x32x16_bf16 v[56:71], a[156:159], v[20:23], v[56:71]
  ds_read_b128 v[8:11], v1 offset:8192
  s_waitcnt lgkmcnt(4)
  v_mfma_f32_32x32x16_bf16 v[40:55], a[16:19], v[24:27], v[40:55]
  v_mfma_f32_32x32x16_bf16 v[56:71], a[160:163], v[24:27], v[56:71]
  ds_read_b128 v[12:15], v1 offset:9216
  s_waitcnt lgkmcnt(4)
  v_mfma_f32_32x32x16_bf16 v[40:55], a[20:23], v[28:31], v[40:55]
  v_mfma_f32_32x32x16_bf16 v[56:71], a[164:167], v[28:31], v[56:71]
  ds_read_b128 v[16:19], v1 offset:10240
  s_waitcnt lgkmcnt(4)
  v_mfma_f32_32x32x16_bf16 v[40:55], a[24:27], v[32:35], v[40:55]
  v_mfma_f32_32x32x16_bf16 v[56:71], a[168:171], v[32:35], v[56:71]
  ds_read_b128 v[20:23], v1 offset:11264
  s_waitcnt lgkmcnt(4)
  v_mfma_f32_32x32x16_bf16 v[40:55], a[28:31], v[36:39], v[40:55]
  v_mfma_f32_32x32x16_bf16 v[56:71], a[172:175], v[36:39], v[56:71]
  ds_read_b128 v[24:27], v1 offset:12288
  s_waitcnt lgkmcnt(4)
  v_mfma_f32_32x32x16_bf16 v[40:55], a[32:35], v[8:11], v[40:55]
  v_mfma_f32_32x32x16_bf16 v[56:71], a[176:179], v[8:11], v[56:71]
  ds_read_b128 v[28:31], v1 offset:13312
  s_waitcnt lgkmcnt(4)
  v_mfma_f32_32x32x16_bf16 v[40:55], a[36:39], v[12:15], v[40:55]
  v_mfma_f32_32x32x16_bf16 v[56:71], a[180:183], v[12:15], v[56:71]
  ds_read_b128 v[32:35], v1 offset:14336
  s_waitcnt lgkmcnt(4)
  v_mfma_f32_32x32x16_bf16 v[40:55], a[40:43], v[16:19], v[40:55]
  v_mfma_f32_32x32x16_bf16 v[56:71], a[184:187], v[16:19], v[56:71]
  ds_read_b128 v[36:39], v1 offset:15360
  s_waitcnt lgkmcnt(4)
  v_mfma_f32_32x32x16_bf16 v[40:55], a[44:47], v[20:23], v[40:55]
  v_mfma_f32_32x32x16_bf16 v[56:71], a[188:191], v[20:23], v[56:71]
  ds_read_b128 v[8:11], v1 offset:16384
  s_waitcnt lgkmcnt(4)
  v_mfma_f32_32x32x16_bf16 v[40:55], a[48:51], v[24:27], v[40:55]
  v_mfma_f32_32x32x16_bf16 v[56:71], a[192:195], v[24:27], v[56:71]
  ds_read_b128 v[12:15], v1 offset:17408
  s_waitcnt lgkmcnt(4)
  v_mfma_f32_32x32x16_bf16 v[40:55], a[52:55], v[28:31], v[40:55]
  v_mfma_f32_32x32x16_bf16 v[56:71], a[196:199], v[28:31], v[56:71]
  ds_read_b128 v[16:19], v1 offset:18432
  s_waitcnt lgkmcnt(4)
  v_mfma_f32_32x32x16_bf16 v[40:55], a[56:59], v[32:35], v[40:55]
  v_mfma_f32_32x32x16_bf16 v[56:71], a[200:203], v[32:35], v[56:71]
  ds_read_b128 v[20:23], v1 offset:19456
  s_waitcnt lgkmcnt(4)
  v_mfma_f32_32x32x16_bf16 v[40:55], a[60:63], v[36:39], v[40:55]
  v_mfma_f32_32x32x16_bf16 v[56:71], a[204:207], v[36:39], v[56:71]
  ds_read_b128 v[24:27], v1 offset:20480
  s_waitcnt lgkmcnt(4)
  v_mfma_f32_32x32x16_bf16 v[40:55], a[64:67], v[8:11], v[40:55]
  v_mfma_f32_32x32x16_bf16 v[56:71], a[208:211], v[8:11], v[56:71]
  ds_read_b128 v[28:31], v1 offset:21504
  s_waitcnt lgkmcnt(4)
  v_mfma_f32_32x32x16_bf16 v[40:55], a[68:71], v[12:15], v[40:55]
  v_mfma_f32_32x32x16_bf16 v[56:71], a[212:215], v[12:15], v[56:71]
  ds_read_b128 v[32:35], v1 offset:22528
  s_waitcnt lgkmcnt(4)
  v_mfma_f32_32x32x16_bf16 v[40:55], a[72:75], v[16:19], v[40:55]
  v_mfma_f32_32x32x16_bf16 v[56:71], a[216:219], v[16:19], v[56:71]
  ds_read_b128 v[36:39], v1 offset:23552
  s_waitcnt lgkmcnt(4)
  v_mfma_f32_32x32x16_bf16 v[40:55], a[76:79], v[20:23], v[40:55]
  v_mfma_f32_32x32x16_bf16 v[56:71], a[220:223], v[20:23], v[56:71]
  ds_read_b128 v[8:11], v1 offset:24576
  s_waitcnt lgkmcnt(4)
  v_mfma_f32_32x32x16_bf16 v[40:55], a[80:83], v[24:27], v[40:55]
  v_mfma_f32_32x32x16_bf16 v[56:71], a[224:227], v[24:27], v[56:71]
  ds_read_b128 v[12:15], v1 offset:25600
  s_waitcnt lgkmcnt(4)
  v_mfma_f32_32x32x16_bf16 v[40:55], a[84:87], v[28:31], v[40:55]
  v_mfma_f32_32x32x16_bf16 v[56:71], a[228:231], v[28:31], v[56:71]
  ds_read_b128 v[16:19], v1 offset:26624
  s_waitcnt lgkmcnt(4)
  v_mfma_f32_32x32x16_bf16 v[40:55], a[88:91], v[32:35], v[40:55]
  v_mfma_f32_32x32x16_bf16 v[56:71], a[232:235], v[32:35], v[56:71]
  ds_read_b128 v[20:23], v1 offset:27648
  s_waitcnt lgkmcnt(4)
  v_mfma_f32_32x32x16_bf16 v[40:55], a[92:95], v[36:39], v[40:55]
  v_mfma_f32_32x32x16_bf16 v[56:71], a[236:239], v[36:39], v[56:71]
  ds_read_b128 v[24:27], v1 offset:28672
  s_waitcnt lgkmcnt(4)
  v_mfma_f32_32x32x16_bf16 v[40:55], a[96:99], v[8:11], v[40:55]
  v_mfma_f32_32x32x16_bf16 v[56:71], a[240:243], v[8:11], v[56:71]
  ds_read_b128 v[28:31], v1 offset:29696
  s_waitcnt lgkmcnt(4)
  v_mfma_f32_32x32x16_bf16 v[40:55], a[100:103], v[12:15], v[40:55]
  v_mfma_f32_32x32x16_bf16 v[56:71], a[244:247], v[12:15], v[56:71]
  ds_read_b128 v[32:35], v1 offset:30720
  s_waitcnt lgkmcnt(4)
  v_mfma_f32_32x32x16_bf16 v[40:55], a[104:107], v[16:19], v[40:55]
  v_mfma_f32_32x32x16_bf16 v[56:71], a[248:251], v[16:19], v[56:71]
  ds_read_b128 v[36:39], v1 offset:31744
  s_waitcnt lgkmcnt(4)
  v_mfma_f32_32x32x16_bf16 v[40:55], a[108:111], v[20:23], v[40:55]
  v_mfma_f32_32x32x16_bf16 v[56:71], a[252:255], v[20:23], v[56:71]
  ds_read_b128 v[8:11], v1 offset:32768
  s_waitcnt lgkmcnt(4)
  v_mfma_f32_32x32x16_bf16 v[40:55], a[112:115], v[24:27], v[40:55]
  v_mfma_f32_32x32x16_bf16 v[56:71], v[224:227], v[24:27], v[56:71]
  ds_read_b128 v[12:15], v1 offset:33792
  s_waitcnt lgkmcnt(4)
  v_mfma_f32_32x32x16_bf16 v[40:55], a[116:119], v[28:31], v[40:55]
  v_mfma_f32_32x32x16_bf16 v[56:71], v[228:231], v[28:31], v[56:71]
  ds_read_b128 v[16:19], v1 offset:34816
  s_waitcnt lgkmcnt(4)
  v_mfma_f32_32x32x16_bf16 v[40:55], a[120:123], v[32:35], v[40:55]
  v_mfma_f32_32x32x16_bf16 v[56:71], v[232:235], v[32:35], v[56:71]
  ds_read_b128 v[20:23], v1 offset:35840
  s_waitcnt lgkmcnt(4)
  v_mfma_f32_32x32x16_bf16 v[40:55], a[124:127], v[36:39], v[40:55]
  v_mfma_f32_32x32x16_bf16 v[56:71], v[236:239], v[36:39], v[56:71]
  s_waitcnt lgkmcnt(3)
  v_mfma_f32_32x32x16_bf16 v[40:55], a[128:131], v[8:11], v[40:55]
  v_mfma_f32_32x32x16_bf16 v[56:71], v[240:243], v[8:11], v[56:71]
  s_waitcnt lgkmcnt(2)
  v_mfma_f32_32x32x16_bf16 v[40:55], a[132:135], v[12:15], v[40:55]
  v_mfma_f32_32x32x16_bf16 v[56:71], v[244:247], v[12:15], v[56:71]
  s_waitcnt lgkmcnt(1)
  v_mfma_f32_32x32x16_bf16 v[40:55], a[136:139], v[16:19], v[40:55]
  v_mfma_f32_32x32x16_bf16 v[56:71], v[248:251], v[16:19], v[56:71]
  s_waitcnt lgkmcnt(0)
  v_mfma_f32_32x32x16_bf16 v[40:55], a[140:143], v[20:23], v[40:55]
  v_mfma_f32_32x32x16_bf16 v[56:71], v[252:255], v[20:23], v[56:71]
  s_nop 3
  v_cvt_pk_bf16_f32 v72, v40, v41
  v_cvt_pk_bf16_f32 v73, v42, v43
  v_cvt_pk_bf16_f32 v74, v48, v49
  v_cvt_pk_bf16_f32 v75, v50, v51
  s_add_u32 s26, s22, 0
  buffer_store_dwordx4 v[72:75], v3, s[4:7], s26 offen sc1
  v_cvt_pk_bf16_f32 v76, v44, v45
  v_cvt_pk_bf16_f32 v77, v46, v47
  v_cvt_pk_bf16_f32 v78, v52, v53
  v_cvt_pk_bf16_f32 v79, v54, v55
  s_add_u32 s26, s22, 512
  buffer_store_dwordx4 v[76:79], v3, s[4:7], s26 offen sc1
  v_cvt_pk_bf16_f32 v80, v56, v57
  v_cvt_pk_bf16_f32 v81, v58, v59
  v_cvt_pk_bf16_f32 v82, v64, v65
  v_cvt_pk_bf16_f32 v83, v66, v67
  s_add_u32 s26, s22, 2048
  buffer_store_dwordx4 v[80:83], v3, s[4:7], s26 offen sc1
  v_cvt_pk_bf16_f32 v84, v60, v61
  v_cvt_pk_bf16_f32 v85, v62, v63
  v_cvt_pk_bf16_f32 v86, v68, v69
  v_cvt_pk_bf16_f32 v87, v70, v71
  s_add_u32 s26, s22, 2560
  buffer_store_dwordx4 v[84:87], v3, s[4:7], s26 offen sc1
  s_add_u32 s22, s22, 524288
  s_add_u32 s21, s21, 1
L_qloop_k:
  s_waitcnt vmcnt(4)
  s_barrier
  s_sub_u32 s92, s21, 1
  s_max_i32 s92, s92, 0
  s_cmp_lg_u32 s17, 0
  s_cbranch_scc1 L_fs_10
  v_mov_b32 v4, s92
  s_mov_b64 exec, 1
  buffer_store_dword v4, off, s[4:7], s95 sc1
  s_mov_b64 exec, -1
L_fs_10:
  s_cmp_ge_u32 s21, 31
  s_cbranch_scc1 L_qnd_11
  s_add_u32 s26, s23, 0
  s_mul_i32 s24, s17, 9216
  s_add_u32 m0, s24, 0
  s_nop 0
  buffer_load_dwordx4 v1, s[4:7], s26 offen lds
  s_add_u32 s26, s23, 1024
  s_mul_i32 s24, s17, 9216
  s_add_u32 m0, s24, 1024
  s_nop 0
  buffer_load_dwordx4 v1, s[4:7], s26 offen lds
  s_add_u32 s26, s23, 2048
  s_mul_i32 s24, s17, 9216
  s_add_u32 m0, s24, 2048
  s_nop 0
  buffer_load_dwordx4 v1, s[4:7], s26 offen lds
  s_add_u32 s26, s23, 3072
  s_mul_i32 s24, s17, 9216
  s_add_u32 m0, s24, 3072
  s_nop 0
  buffer_load_dwordx4 v1, s[4:7], s26 offen lds
  s_add_u32 s26, s23, 4096
  s_mul_i32 s24, s17, 9216
  s_add_u32 m0, s24, 4096
  s_nop 0
  buffer_load_dwordx4 v1, s[4:7], s26 offen lds
  s_add_u32 s26, s23, 5120
  s_mul_i32 s24, s17, 9216
  s_add_u32 m0, s24, 5120
  s_nop 0
  buffer_load_dwordx4 v1, s[4:7], s26 offen lds
  s_add_u32 s26, s23, 6144
  s_mul_i32 s24, s17, 9216
  s_add_u32 m0, s24, 6144
  s_nop 0
  buffer_load_dwordx4 v1, s[4:7], s26 offen lds
  s_add_u32 s26, s23, 7168
  s_mul_i32 s24, s17, 9216
  s_add_u32 m0, s24, 7168
  s_nop 0
  buffer_load_dwordx4 v1, s[4:7], s26 offen lds
  s_add_u32 s26, s23, 8192
  s_mul_i32 s24, s17, 9216
  s_add_u32 m0, s24, 8192
  s_nop 0
  buffer_load_dwordx4 v1, s[4:7], s26 offen lds
  s_add_u32 s23, s23, 73728
L_qnd_11:
  ds_read_b128 v[8:11], v2 offset:0
  ds_read_b128 v[12:15], v2 offset:1024
  ds_read_b128 v[16:19], v2 offset:2048
  ds_read_b128 v[20:23], v2 offset:3072
  ds_read_b128 v[24:27], v2 offset:4096
  s_waitcnt lgkmcnt(4)
  v_mfma_f32_32x32x16_bf16 v[40:55], a[0:3], v[8:11], 0
  v_mfma_f32_32x32x16_bf16 v[56:71], a[144:147], v[8:11], 0
  ds_read_b128 v[28:31], v2 offset:5120
  s_waitcnt lgkmcnt(4)
  v_mfma_f32_32x32x16_bf16 v[40:55], a[4:7], v[12:15], v[40:55]
  v_mfma_f32_32x32x16_bf16 v[56:71], a[148:151], v[12:15], v[56:71]
  ds_read_b128 v[32:35], v2 offset:6144
  s_waitcnt lgkmcnt(4)
  v_mfma_f32_32x32x16_bf16 v[40:55], a[8:11], v[16:19], v[40:55]
  v_mfma_f32_32x32x16_bf16 v[56:71], a[152:155], v[16:19], v[56:71]
  ds_read_b128 v[36:39], v2 offset:7168
  s_waitcnt lgkmcnt(4)
  v_mfma_f32_32x32x16_bf16 v[40:55], a[12:15], v[20:23], v[40:55]
  v_mfma_f32_32x32x16_bf16 v[56:71], a[156:159], v[20:23], v[56:71]
  ds_read_b128 v[8:11], v2 offset:8192
  s_waitcnt lgkmcnt(4)
  v_mfma_f32_32x32x16_bf16 v[40:55], a[16:19], v[24:27], v[40:55]
  v_mfma_f32_32x32x16_bf16 v[56:71], a[160:163], v[24:27], v[56:71]
  ds_read_b128 v[12:15], v2 offset:9216
  s_waitcnt lgkmcnt(4)
  v_mfma_f32_32x32x16_bf16 v[40:55], a[20:23], v[28:31], v[40:55]
  v_mfma_f32_32x32x16_bf16 v[56:71], a[164:167], v[28:31], v[56:71]
  ds_read_b128 v[16:19], v2 offset:10240
  s_waitcnt lgkmcnt(4)
  v_mfma_f32_32x32x16_bf16 v[40:55], a[24:27], v[32:35], v[40:55]
  v_mfma_f32_32x32x16_bf16 v[56:71], a[168:171], v[32:35], v[56:71]
  ds_read_b128 v[20:23], v2 offset:11264
  s_waitcnt lgkmcnt(4)
  v_mfma_f32_32x32x16_bf16 v[40:55], a[28:31], v[36:39], v[40:55]
  v_mfma_f32_32x32x16_bf16 v[56:71], a[172:175], v[36:39], v[56:71]
  ds_read_b128 v[24:27], v2 offset:12288
  s_waitcnt lgkmcnt(4)
  v_mfma_f32_32x32x16_bf16 v[40:55], a[32:35], v[8:11], v[40:55]
  v_mfma_f32_32x32x16_bf16 v[56:71], a[176:179], v[8:11], v[56:71]
  ds_read_b128 v[28:31], v2 offset:13312
  s_waitcnt lgkmcnt(4)
  v_mfma_f32_32x32x16_bf16 v[40:55], a[36:39], v[12:15], v[40:55]
  v_mfma_f32_32x32x16_bf16 v[56:71], a[180:183], v[12:15], v[56:71]
  ds_read_b128 v[32:35], v2 offset:14336
  s_waitcnt lgkmcnt(4)
  v_mfma_f32_32x32x16_bf16 v[40:55], a[40:43], v[16:19], v[40:55]
  v_mfma_f32_32x32x16_bf16 v[56:71], a[184:187], v[16:19], v[56:71]
  ds_read_b128 v[36:39], v2 offset:15360
  s_waitcnt lgkmcnt(4)
  v_mfma_f32_32x32x16_bf16 v[40:55], a[44:47], v[20:23], v[40:55]
  v_mfma_f32_32x32x16_bf16 v[56:71], a[188:191], v[20:23], v[56:71]
  ds_read_b128 v[8:11], v2 offset:16384
  s_waitcnt lgkmcnt(4)
  v_mfma_f32_32x32x16_bf16 v[40:55], a[48:51], v[24:27], v[40:55]
  v_mfma_f32_32x32x16_bf16 v[56:71], a[192:195], v[24:27], v[56:71]
  ds_read_b128 v[12:15], v2 offset:17408
  s_waitcnt lgkmcnt(4)
  v_mfma_f32_32x32x16_bf16 v[40:55], a[52:55], v[28:31], v[40:55]
  v_mfma_f32_32x32x16_bf16 v[56:71], a[196:199], v[28:31], v[56:71]
  ds_read_b128 v[16:19], v2 offset:18432
  s_waitcnt lgkmcnt(4)
  v_mfma_f32_32x32x16_bf16 v[40:55], a[56:59], v[32:35], v[40:55]
  v_mfma_f32_32x32x16_bf16 v[56:71], a[200:203], v[32:35], v[56:71]
  ds_read_b128 v[20:23], v2 offset:19456
  s_waitcnt lgkmcnt(4)
  v_mfma_f32_32x32x16_bf16 v[40:55], a[60:63], v[36:39], v[40:55]
  v_mfma_f32_32x32x16_bf16 v[56:71], a[204:207], v[36:39], v[56:71]
  ds_read_b128 v[24:27], v2 offset:20480
  s_waitcnt lgkmcnt(4)
  v_mfma_f32_32x32x16_bf16 v[40:55], a[64:67], v[8:11], v[40:55]
  v_mfma_f32_32x32x16_bf16 v[56:71], a[208:211], v[8:11], v[56:71]
  ds_read_b128 v[28:31], v2 offset:21504
  s_waitcnt lgkmcnt(4)
  v_mfma_f32_32x32x16_bf16 v[40:55], a[68:71], v[12:15], v[40:55]
  v_mfma_f32_32x32x16_bf16 v[56:71], a[212:215], v[12:15], v[56:71]
  ds_read_b128 v[32:35], v2 offset:22528
  s_waitcnt lgkmcnt(4)
  v_mfma_f32_32x32x16_bf16 v[40:55], a[72:75], v[16:19], v[40:55]
  v_mfma_f32_32x32x16_bf16 v[56:71], a[216:219], v[16:19], v[56:71]
  ds_read_b128 v[36:39], v2 offset:23552
  s_waitcnt lgkmcnt(4)
  v_mfma_f32_32x32x16_bf16 v[40:55], a[76:79], v[20:23], v[40:55]
  v_mfma_f32_32x32x16_bf16 v[56:71], a[220:223], v[20:23], v[56:71]
  ds_read_b128 v[8:11], v2 offset:24576
  s_waitcnt lgkmcnt(4)
  v_mfma_f32_32x32x16_bf16 v[40:55], a[80:83], v[24:27], v[40:55]
  v_mfma_f32_32x32x16_bf16 v[56:71], a[224:227], v[24:27], v[56:71]
  ds_read_b128 v[12:15], v2 offset:25600
  s_waitcnt lgkmcnt(4)
  v_mfma_f32_32x32x16_bf16 v[40:55], a[84:87], v[28:31], v[40:55]
  v_mfma_f32_32x32x16_bf16 v[56:71], a[228:231], v[28:31], v[56:71]
  ds_read_b128 v[16:19], v2 offset:26624
  s_waitcnt lgkmcnt(4)
  v_mfma_f32_32x32x16_bf16 v[40:55], a[88:91], v[32:35], v[40:55]
  v_mfma_f32_32x32x16_bf16 v[56:71], a[232:235], v[32:35], v[56:71]
  ds_read_b128 v[20:23], v2 offset:27648
  s_waitcnt lgkmcnt(4)
  v_mfma_f32_32x32x16_bf16 v[40:55], a[92:95], v[36:39], v[40:55]
  v_mfma_f32_32x32x16_bf16 v[56:71], a[236:239], v[36:39], v[56:71]
  ds_read_b128 v[24:27], v2 offset:28672
  s_waitcnt lgkmcnt(4)
  v_mfma_f32_32x32x16_bf16 v[40:55], a[96:99], v[8:11], v[40:55]
  v_mfma_f32_32x32x16_bf16 v[56:71], a[240:243], v[8:11], v[56:71]
  ds_read_b128 v[28:31], v2 offset:29696
  s_waitcnt lgkmcnt(4)
  v_mfma_f32_32x32x16_bf16 v[40:55], a[100:103], v[12:15], v[40:55]
  v_mfma_f32_32x32x16_bf16 v[56:71], a[244:247], v[12:15], v[56:71]
  ds_read_b128 v[32:35], v2 offset:30720
  s_waitcnt lgkmcnt(4)
  v_mfma_f32_32x32x16_bf16 v[40:55], a[104:107], v[16:19], v[40:55]
  v_mfma_f32_32x32x16_bf16 v[56:71], a[248:251], v[16:19], v[56:71]
  ds_read_b128 v[36:39], v2 offset:31744
  s_waitcnt lgkmcnt(4)
  v_mfma_f32_32x32x16_bf16 v[40:55], a[108:111], v[20:23], v[40:55]
  v_mfma_f32_32x32x16_bf16 v[56:71], a[252:255], v[20:23], v[56:71]
  ds_read_b128 v[8:11], v2 offset:32768
  s_waitcnt lgkmcnt(4)
  v_mfma_f32_32x32x16_bf16 v[40:55], a[112:115], v[24:27], v[40:55]
  v_mfma_f32_32x32x16_bf16 v[56:71], v[224:227], v[24:27], v[56:71]
  ds_read_b128 v[12:15], v2 offset:33792
  s_waitcnt lgkmcnt(4)
  v_mfma_f32_32x32x16_bf16 v[40:55], a[116:119], v[28:31], v[40:55]
  v_mfma_f32_32x32x16_bf16 v[56:71], v[228:231], v[28:31], v[56:71]
  ds_read_b128 v[16:19], v2 offset:34816
  s_waitcnt lgkmcnt(4)
  v_mfma_f32_32x32x16_bf16 v[40:55], a[120:123], v[32:35], v[40:55]
  v_mfma_f32_32x32x16_bf16 v[56:71], v[232:235], v[32:35], v[56:71]
  ds_read_b128 v[20:23], v2 offset:35840
  s_waitcnt lgkmcnt(4)
  v_mfma_f32_32x32x16_bf16 v[40:55], a[124:127], v[36:39], v[40:55]
  v_mfma_f32_32x32x16_bf16 v[56:71], v[236:239], v[36:39], v[56:71]
  s_waitcnt lgkmcnt(3)
  v_mfma_f32_32x32x16_bf16 v[40:55], a[128:131], v[8:11], v[40:55]
  v_mfma_f32_32x32x16_bf16 v[56:71], v[240:243], v[8:11], v[56:71]
  s_waitcnt lgkmcnt(2)
  v_mfma_f32_32x32x16_bf16 v[40:55], a[132:135], v[12:15], v[40:55]
  v_mfma_f32_32x32x16_bf16 v[56:71], v[244:247], v[12:15], v[56:71]
  s_waitcnt lgkmcnt(1)
  v_mfma_f32_32x32x16_bf16 v[40:55], a[136:139], v[16:19], v[40:55]
  v_mfma_f32_32x32x16_bf16 v[56:71], v[248:251], v[16:19], v[56:71]
  s_waitcnt lgkmcnt(0)
  v_mfma_f32_32x32x16_bf16 v[40:55], a[140:143], v[20:23], v[40:55]
  v_mfma_f32_32x32x16_bf16 v[56:71], v[252:255], v[20:23], v[56:71]
  s_nop 3
  v_cvt_pk_bf16_f32 v72, v40, v41
  v_cvt_pk_bf16_f32 v73, v42, v43
  v_cvt_pk_bf16_f32 v74, v48, v49
  v_cvt_pk_bf16_f32 v75, v50, v51
  s_add_u32 s26, s22, 0
  buffer_store_dwordx4 v[72:75], v3, s[4:7], s26 offen sc1
  v_cvt_pk_bf16_f32 v76, v44, v45
  v_cvt_pk_bf16_f32 v77, v46, v47
  v_cvt_pk_bf16_f32 v78, v52, v53
  v_cvt_pk_bf16_f32 v79, v54, v55
  s_add_u32 s26, s22, 512
  buffer_store_dwordx4 v[76:79], v3, s[4:7], s26 offen sc1
  v_cvt_pk_bf16_f32 v80, v56, v57
  v_cvt_pk_bf16_f32 v81, v58, v59
  v_cvt_pk_bf16_f32 v82, v64, v65
  v_cvt_pk_bf16_f32 v83, v66, v67
  s_add_u32 s26, s22, 2048
  buffer_store_dwordx4 v[80:83], v3, s[4:7], s26 offen sc1
  v_cvt_pk_bf16_f32 v84, v60, v61
  v_cvt_pk_bf16_f32 v85, v62, v63
  v_cvt_pk_bf16_f32 v86, v68, v69
  v_cvt_pk_bf16_f32 v87, v70, v71
  s_add_u32 s26, s22, 2560
  buffer_store_dwordx4 v[84:87], v3, s[4:7], s26 offen sc1
  s_add_u32 s22, s22, 524288
  s_add_u32 s21, s21, 1
  s_cmp_ge_u32 s21, 32
  s_cbranch_scc1 L_qdone_k
  s_waitcnt vmcnt(4)
  s_barrier
  s_sub_u32 s92, s21, 1
  s_max_i32 s92, s92, 0
  s_cmp_lg_u32 s17, 0
  s_cbranch_scc1 L_fs_12
  v_mov_b32 v4, s92
  s_mov_b64 exec, 1
  buffer_store_dword v4, off, s[4:7], s95 sc1
  s_mov_b64 exec, -1
L_fs_12:
  s_cmp_ge_u32 s21, 31
  s_cbranch_scc1 L_qnd_13
  s_add_u32 s26, s23, 0
  s_mul_i32 s24, s17, 9216
  s_add_u32 m0, s24, 36864
  s_nop 0
  buffer_load_dwordx4 v1, s[4:7], s26 offen lds
  s_add_u32 s26, s23, 1024
  s_mul_i32 s24, s17, 9216
  s_add_u32 m0, s24, 37888
  s_nop 0
  buffer_load_dwordx4 v1, s[4:7], s26 offen lds
  s_add_u32 s26, s23, 2048
  s_mul_i32 s24, s17, 9216
  s_add_u32 m0, s24, 38912
  s_nop 0
  buffer_load_dwordx4 v1, s[4:7], s26 offen lds
  s_add_u32 s26, s23, 3072
  s_mul_i32 s24, s17, 9216
  s_add_u32 m0, s24, 39936
  s_nop 0
  buffer_load_dwordx4 v1, s[4:7], s26 offen lds
  s_add_u32 s26, s23, 4096
  s_mul_i32 s24, s17, 9216
  s_add_u32 m0, s24, 40960
  s_nop 0
  buffer_load_dwordx4 v1, s[4:7], s26 offen lds
  s_add_u32 s26, s23, 5120
  s_mul_i32 s24, s17, 9216
  s_add_u32 m0, s24, 41984
  s_nop 0
  buffer_load_dwordx4 v1, s[4:7], s26 offen lds
  s_add_u32 s26, s23, 6144
  s_mul_i32 s24, s17, 9216
  s_add_u32 m0, s24, 43008
  s_nop 0
  buffer_load_dwordx4 v1, s[4:7], s26 offen lds
  s_add_u32 s26, s23, 7168
  s_mul_i32 s24, s17, 9216
  s_add_u32 m0, s24, 44032
  s_nop 0
  buffer_load_dwordx4 v1, s[4:7], s26 offen lds
  s_add_u32 s26, s23, 8192
  s_mul_i32 s24, s17, 9216
  s_add_u32 m0, s24, 45056
  s_nop 0
  buffer_load_dwordx4 v1, s[4:7], s26 offen lds
  s_add_u32 s23, s23, 73728
L_qnd_13:
  ds_read_b128 v[8:11], v1 offset:0
  ds_read_b128 v[12:15], v1 offset:1024
  ds_read_b128 v[16:19], v1 offset:2048
  ds_read_b128 v[20:23], v1 offset:3072
  ds_read_b128 v[24:27], v1 offset:4096
  s_waitcnt lgkmcnt(4)
  v_mfma_f32_32x32x16_bf16 v[40:55], a[0:3], v[8:11], 0
  v_mfma_f32_32x32x16_bf16 v[56:71], a[144:147], v[8:11], 0
  ds_read_b128 v[28:31], v1 offset:5120
  s_waitcnt lgkmcnt(4)
  v_mfma_f32_32x32x16_bf16 v[40:55], a[4:7], v[12:15], v[40:55]
  v_mfma_f32_32x32x16_bf16 v[56:71], a[148:151], v[12:15], v[56:71]
  ds_read_b128 v[32:35], v1 offset:6144
  s_waitcnt lgkmcnt(4)
  v_mfma_f32_32x32x16_bf16 v[40:55], a[8:11], v[16:19], v[40:55]
  v_mfma_f32_32x32x16_bf16 v[56:71], a[152:155], v[16:19], v[56:71]
  ds_read_b128 v[36:39], v1 offset:7168
  s_waitcnt lgkmcnt(4)
  v_mfma_f32_32x32x16_bf16 v[40:55], a[12:15], v[20:23], v[40:55]
  v_mfma_f32_32x32x16_bf16 v[56:71], a[156:159], v[20:23], v[56:71]
  ds_read_b128 v[8:11], v1 offset:8192
  s_waitcnt lgkmcnt(4)
  v_mfma_f32_32x32x16_bf16 v[40:55], a[16:19], v[24:27], v[40:55]
  v_mfma_f32_32x32x16_bf16 v[56:71], a[160:163], v[24:27], v[56:71]
  ds_read_b128 v[12:15], v1 offset:9216
  s_waitcnt lgkmcnt(4)
  v_mfma_f32_32x32x16_bf16 v[40:55], a[20:23], v[28:31], v[40:55]
  v_mfma_f32_32x32x16_bf16 v[56:71], a[164:167], v[28:31], v[56:71]
  ds_read_b128 v[16:19], v1 offset:10240
  s_waitcnt lgkmcnt(4)
  v_mfma_f32_32x32x16_bf16 v[40:55], a[24:27], v[32:35], v[40:55]
  v_mfma_f32_32x32x16_bf16 v[56:71], a[168:171], v[32:35], v[56:71]
  ds_read_b128 v[20:23], v1 offset:11264
  s_waitcnt lgkmcnt(4)
  v_mfma_f32_32x32x16_bf16 v[40:55], a[28:31], v[36:39], v[40:55]
  v_mfma_f32_32x32x16_bf16 v[56:71], a[172:175], v[36:39], v[56:71]
  ds_read_b128 v[24:27], v1 offset:12288
  s_waitcnt lgkmcnt(4)
  v_mfma_f32_32x32x16_bf16 v[40:55], a[32:35], v[8:11], v[40:55]
  v_mfma_f32_32x32x16_bf16 v[56:71], a[176:179], v[8:11], v[56:71]
  ds_read_b128 v[28:31], v1 offset:13312
  s_waitcnt lgkmcnt(4)
  v_mfma_f32_32x32x16_bf16 v[40:55], a[36:39], v[12:15], v[40:55]
  v_mfma_f32_32x32x16_bf16 v[56:71], a[180:183], v[12:15], v[56:71]
  ds_read_b128 v[32:35], v1 offset:14336
  s_waitcnt lgkmcnt(4)
  v_mfma_f32_32x32x16_bf16 v[40:55], a[40:43], v[16:19], v[40:55]
  v_mfma_f32_32x32x16_bf16 v[56:71], a[184:187], v[16:19], v[56:71]
  ds_read_b128 v[36:39], v1 offset:15360
  s_waitcnt lgkmcnt(4)
  v_mfma_f32_32x32x16_bf16 v[40:55], a[44:47], v[20:23], v[40:55]
  v_mfma_f32_32x32x16_bf16 v[56:71], a[188:191], v[20:23], v[56:71]
  ds_read_b128 v[8:11], v1 offset:16384
  s_waitcnt lgkmcnt(4)
  v_mfma_f32_32x32x16_bf16 v[40:55], a[48:51], v[24:27], v[40:55]
  v_mfma_f32_32x32x16_bf16 v[56:71], a[192:195], v[24:27], v[56:71]
  ds_read_b128 v[12:15], v1 offset:17408
  s_waitcnt lgkmcnt(4)
  v_mfma_f32_32x32x16_bf16 v[40:55], a[52:55], v[28:31], v[40:55]
  v_mfma_f32_32x32x16_bf16 v[56:71], a[196:199], v[28:31], v[56:71]
  ds_read_b128 v[16:19], v1 offset:18432
  s_waitcnt lgkmcnt(4)
  v_mfma_f32_32x32x16_bf16 v[40:55], a[56:59], v[32:35], v[40:55]
  v_mfma_f32_32x32x16_bf16 v[56:71], a[200:203], v[32:35], v[56:71]
  ds_read_b128 v[20:23], v1 offset:19456
  s_waitcnt lgkmcnt(4)
  v_mfma_f32_32x32x16_bf16 v[40:55], a[60:63], v[36:39], v[40:55]
  v_mfma_f32_32x32x16_bf16 v[56:71], a[204:207], v[36:39], v[56:71]
  ds_read_b128 v[24:27], v1 offset:20480
  s_waitcnt lgkmcnt(4)
  v_mfma_f32_32x32x16_bf16 v[40:55], a[64:67], v[8:11], v[40:55]
  v_mfma_f32_32x32x16_bf16 v[56:71], a[208:211], v[8:11], v[56:71]
  ds_read_b128 v[28:31], v1 offset:21504
  s_waitcnt lgkmcnt(4)
  v_mfma_f32_32x32x16_bf16 v[40:55], a[68:71], v[12:15], v[40:55]
  v_mfma_f32_32x32x16_bf16 v[56:71], a[212:215], v[12:15], v[56:71]
  ds_read_b128 v[32:35], v1 offset:22528
  s_waitcnt lgkmcnt(4)
  v_mfma_f32_32x32x16_bf16 v[40:55], a[72:75], v[16:19], v[40:55]
  v_mfma_f32_32x32x16_bf16 v[56:71], a[216:219], v[16:19], v[56:71]
  ds_read_b128 v[36:39], v1 offset:23552
  s_waitcnt lgkmcnt(4)
  v_mfma_f32_32x32x16_bf16 v[40:55], a[76:79], v[20:23], v[40:55]
  v_mfma_f32_32x32x16_bf16 v[56:71], a[220:223], v[20:23], v[56:71]
  ds_read_b128 v[8:11], v1 offset:24576
  s_waitcnt lgkmcnt(4)
  v_mfma_f32_32x32x16_bf16 v[40:55], a[80:83], v[24:27], v[40:55]
  v_mfma_f32_32x32x16_bf16 v[56:71], a[224:227], v[24:27], v[56:71]
  ds_read_b128 v[12:15], v1 offset:25600
  s_waitcnt lgkmcnt(4)
  v_mfma_f32_32x32x16_bf16 v[40:55], a[84:87], v[28:31], v[40:55]
  v_mfma_f32_32x32x16_bf16 v[56:71], a[228:231], v[28:31], v[56:71]
  ds_read_b128 v[16:19], v1 offset:26624
  s_waitcnt lgkmcnt(4)
  v_mfma_f32_32x32x16_bf16 v[40:55], a[88:91], v[32:35], v[40:55]
  v_mfma_f32_32x32x16_bf16 v[56:71], a[232:235], v[32:35], v[56:71]
  ds_read_b128 v[20:23], v1 offset:27648
  s_waitcnt lgkmcnt(4)
  v_mfma_f32_32x32x16_bf16 v[40:55], a[92:95], v[36:39], v[40:55]
  v_mfma_f32_32x32x16_bf16 v[56:71], a[236:239], v[36:39], v[56:71]
  ds_read_b128 v[24:27], v1 offset:28672
  s_waitcnt lgkmcnt(4)
  v_mfma_f32_32x32x16_bf16 v[40:55], a[96:99], v[8:11], v[40:55]
  v_mfma_f32_32x32x16_bf16 v[56:71], a[240:243], v[8:11], v[56:71]
  ds_read_b128 v[28:31], v1 offset:29696
  s_waitcnt lgkmcnt(4)
  v_mfma_f32_32x32x16_bf16 v[40:55], a[100:103], v[12:15], v[40:55]
  v_mfma_f32_32x32x16_bf16 v[56:71], a[244:247], v[12:15], v[56:71]
  ds_read_b128 v[32:35], v1 offset:30720
  s_waitcnt lgkmcnt(4)
  v_mfma_f32_32x32x16_bf16 v[40:55], a[104:107], v[16:19], v[40:55]
  v_mfma_f32_32x32x16_bf16 v[56:71], a[248:251], v[16:19], v[56:71]
  ds_read_b128 v[36:39], v1 offset:31744
  s_waitcnt lgkmcnt(4)
  v_mfma_f32_32x32x16_bf16 v[40:55], a[108:111], v[20:23], v[40:55]
  v_mfma_f32_32x32x16_bf16 v[56:71], a[252:255], v[20:23], v[56:71]
  ds_read_b128 v[8:11], v1 offset:32768
  s_waitcnt lgkmcnt(4)
  v_mfma_f32_32x32x16_bf16 v[40:55], a[112:115], v[24:27], v[40:55]
  v_mfma_f32_32x32x16_bf16 v[56:71], v[224:227], v[24:27], v[56:71]
  ds_read_b128 v[12:15], v1 offset:33792
  s_waitcnt lgkmcnt(4)
  v_mfma_f32_32x32x16_bf16 v[40:55], a[116:119], v[28:31], v[40:55]
  v_mfma_f32_32x32x16_bf16 v[56:71], v[228:231], v[28:31], v[56:71]
  ds_read_b128 v[16:19], v1 offset:34816
  s_waitcnt lgkmcnt(4)
  v_mfma_f32_32x32x16_bf16 v[40:55], a[120:123], v[32:35], v[40:55]
  v_mfma_f32_32x32x16_bf16 v[56:71], v[232:235], v[32:35], v[56:71]
  ds_read_b128 v[20:23], v1 offset:35840
  s_waitcnt lgkmcnt(4)
  v_mfma_f32_32x32x16_bf16 v[40:55], a[124:127], v[36:39], v[40:55]
  v_mfma_f32_32x32x16_bf16 v[56:71], v[236:239], v[36:39], v[56:71]
  s_waitcnt lgkmcnt(3)
  v_mfma_f32_32x32x16_bf16 v[40:55], a[128:131], v[8:11], v[40:55]
  v_mfma_f32_32x32x16_bf16 v[56:71], v[240:243], v[8:11], v[56:71]
  s_waitcnt lgkmcnt(2)
  v_mfma_f32_32x32x16_bf16 v[40:55], a[132:135], v[12:15], v[40:55]
  v_mfma_f32_32x32x16_bf16 v[56:71], v[244:247], v[12:15], v[56:71]
  s_waitcnt lgkmcnt(1)
  v_mfma_f32_32x32x16_bf16 v[40:55], a[136:139], v[16:19], v[40:55]
  v_mfma_f32_32x32x16_bf16 v[56:71], v[248:251], v[16:19], v[56:71]
  s_waitcnt lgkmcnt(0)
  v_mfma_f32_32x32x16_bf16 v[40:55], a[140:143], v[20:23], v[40:55]
  v_mfma_f32_32x32x16_bf16 v[56:71], v[252:255], v[20:23], v[56:71]
  s_nop 3
  v_cvt_pk_bf16_f32 v72, v40, v41
  v_cvt_pk_bf16_f32 v73, v42, v43
  v_cvt_pk_bf16_f32 v74, v48, v49
  v_cvt_pk_bf16_f32 v75, v50, v51
  s_add_u32 s26, s22, 0
  buffer_store_dwordx4 v[72:75], v3, s[4:7], s26 offen sc1
  v_cvt_pk_bf16_f32 v76, v44, v45
  v_cvt_pk_bf16_f32 v77, v46, v47
  v_cvt_pk_bf16_f32 v78, v52, v53
  v_cvt_pk_bf16_f32 v79, v54, v55
  s_add_u32 s26, s22, 512
  buffer_store_dwordx4 v[76:79], v3, s[4:7], s26 offen sc1
  v_cvt_pk_bf16_f32 v80, v56, v57
  v_cvt_pk_bf16_f32 v81, v58, v59
  v_cvt_pk_bf16_f32 v82, v64, v65
  v_cvt_pk_bf16_f32 v83, v66, v67
  s_add_u32 s26, s22, 2048
  buffer_store_dwordx4 v[80:83], v3, s[4:7], s26 offen sc1
  v_cvt_pk_bf16_f32 v84, v60, v61
  v_cvt_pk_bf16_f32 v85, v62, v63
  v_cvt_pk_bf16_f32 v86, v68, v69
  v_cvt_pk_bf16_f32 v87, v70, v71
  s_add_u32 s26, s22, 2560
  buffer_store_dwordx4 v[84:87], v3, s[4:7], s26 offen sc1
  s_add_u32 s22, s22, 524288
  s_add_u32 s21, s21, 1
  s_branch L_qloop_k
L_qdone_k:
  s_waitcnt vmcnt(0)
  s_branch L_qkv_end
L_qkv_v:
  s_add_u32 s26, s23, 0
  s_mul_i32 s24, s17, 9216
  s_add_u32 m0, s24, 0
  s_nop 0
  buffer_load_dwordx4 v1, s[4:7], s26 offen lds
  s_add_u32 s26, s23, 1024
  s_mul_i32 s24, s17, 9216
  s_add_u32 m0, s24, 1024
  s_nop 0
  buffer_load_dwordx4 v1, s[4:7], s26 offen lds
  s_add_u32 s26, s23, 2048
  s_mul_i32 s24, s17, 9216
  s_add_u32 m0, s24, 2048
  s_nop 0
  buffer_load_dwordx4 v1, s[4:7], s26 offen lds
  s_add_u32 s26, s23, 3072
  s_mul_i32 s24, s17, 9216
  s_add_u32 m0, s24, 3072
  s_nop 0
  buffer_load_dwordx4 v1, s[4:7], s26 offen lds
  s_add_u32 s26, s23, 4096
  s_mul_i32 s24, s17, 9216
  s_add_u32 m0, s24, 4096
  s_nop 0
  buffer_load_dwordx4 v1, s[4:7], s26 offen lds
  s_add_u32 s26, s23, 5120
  s_mul_i32 s24, s17, 9216
  s_add_u32 m0, s24, 5120
  s_nop 0
  buffer_load_dwordx4 v1, s[4:7], s26 offen lds
  s_add_u32 s26, s23, 6144
  s_mul_i32 s24, s17, 9216
  s_add_u32 m0, s24, 6144
  s_nop 0
  buffer_load_dwordx4 v1, s[4:7], s26 offen lds
  s_add_u32 s26, s23, 7168
  s_mul_i32 s24, s17, 9216
  s_add_u32 m0, s24, 7168
  s_nop 0
  buffer_load_dwordx4 v1, s[4:7], s26 offen lds
  s_add_u32 s26, s23, 8192
  s_mul_i32 s24, s17, 9216
  s_add_u32 m0, s24, 8192
  s_nop 0
  buffer_load_dwordx4 v1, s[4:7], s26 offen lds
  s_add_u32 s23, s23, 73728
  s_waitcnt vmcnt(0)
  s_barrier
  s_sub_u32 s92, s21, 1
  s_max_i32 s92, s92, 0
  s_cmp_lg_u32 s17, 0
  s_cbranch_scc1 L_fs_14
  v_mov_b32 v4, s92
  s_mov_b64 exec, 1
  buffer_store_dword v4, off, s[4:7], s95 sc1
  s_mov_b64 exec, -1
L_fs_14:
  s_cmp_ge_u32 s21, 31
  s_cbranch_scc1 L_qnd_15
  s_add_u32 s26, s23, 0
  s_mul_i32 s24, s17, 9216
  s_add_u32 m0, s24, 36864
  s_nop 0
  buffer_load_dwordx4 v1, s[4:7], s26 offen lds
  s_add_u32 s26, s23, 1024
  s_mul_i32 s24, s17, 9216
  s_add_u32 m0, s24, 37888
  s_nop 0
  buffer_load_dwordx4 v1, s[4:7], s26 offen lds
  s_add_u32 s26, s23, 2048
  s_mul_i32 s24, s17, 9216
  s_add_u32 m0, s24, 38912
  s_nop 0
  buffer_load_dwordx4 v1, s[4:7], s26 offen lds
  s_add_u32 s26, s23, 3072
  s_mul_i32 s24, s17, 9216
  s_add_u32 m0, s24, 39936
  s_nop 0
  buffer_load_dwordx4 v1, s[4:7], s26 offen lds
  s_add_u32 s26, s23, 4096
  s_mul_i32 s24, s17, 9216
  s_add_u32 m0, s24, 40960
  s_nop 0
  buffer_load_dwordx4 v1, s[4:7], s26 offen lds
  s_add_u32 s26, s23, 5120
  s_mul_i32 s24, s17, 9216
  s_add_u32 m0, s24, 41984
  s_nop 0
  buffer_load_dwordx4 v1, s[4:7], s26 offen lds
  s_add_u32 s26, s23, 6144
  s_mul_i32 s24, s17, 9216
  s_add_u32 m0, s24, 43008
  s_nop 0
  buffer_load_dwordx4 v1, s[4:7], s26 offen lds
  s_add_u32 s26, s23, 7168
  s_mul_i32 s24, s17, 9216
  s_add_u32 m0, s24, 44032
  s_nop 0
  buffer_load_dwordx4 v1, s[4:7], s26 offen lds
  s_add_u32 s26, s23, 8192
  s_mul_i32 s24, s17, 9216
  s_add_u32 m0, s24, 45056
  s_nop 0
  buffer_load_dwordx4 v1, s[4:7], s26 offen lds
  s_add_u32 s23, s23, 73728
L_qnd_15:
  ds_read_b128 v[8:11], v1 offset:0
  ds_read_b128 v[12:15], v1 offset:1024
  ds_read_b128 v[16:19], v1 offset:2048
  ds_read_b128 v[20:23], v1 offset:3072
  ds_read_b128 v[24:27], v1 offset:4096
  s_waitcnt lgkmcnt(4)
  v_mfma_f32_32x32x16_bf16 v[40:55], v[8:11], a[0:3], 0
  v_mfma_f32_32x32x16_bf16 v[56:71], v[8:11], a[144:147], 0
  ds_read_b128 v[28:31], v1 offset:5120
  s_waitcnt lgkmcnt(4)
  v_mfma_f32_32x32x16_bf16 v[40:55], v[12:15], a[4:7], v[40:55]
  v_mfma_f32_32x32x16_bf16 v[56:71], v[12:15], a[148:151], v[56:71]
  ds_read_b128 v[32:35], v1 offset:6144
  s_waitcnt lgkmcnt(4)
  v_mfma_f32_32x32x16_bf16 v[40:55], v[16:19], a[8:11], v[40:55]
  v_mfma_f32_32x32x16_bf16 v[56:71], v[16:19], a[152:155], v[56:71]
  ds_read_b128 v[36:39], v1 offset:7168
  s_waitcnt lgkmcnt(4)
  v_mfma_f32_32x32x16_bf16 v[40:55], v[20:23], a[12:15], v[40:55]
  v_mfma_f32_32x32x16_bf16 v[56:71], v[20:23], a[156:159], v[56:71]
  ds_read_b128 v[8:11], v1 offset:8192
  s_waitcnt lgkmcnt(4)
  v_mfma_f32_32x32x16_bf16 v[40:55], v[24:27], a[16:19], v[40:55]
  v_mfma_f32_32x32x16_bf16 v[56:71], v[24:27], a[160:163], v[56:71]
  ds_read_b128 v[12:15], v1 offset:9216
  s_waitcnt lgkmcnt(4)
  v_mfma_f32_32x32x16_bf16 v[40:55], v[28:31], a[20:23], v[40:55]
  v_mfma_f32_32x32x16_bf16 v[56:71], v[28:31], a[164:167], v[56:71]
  ds_read_b128 v[16:19], v1 offset:10240
  s_waitcnt lgkmcnt(4)
  v_mfma_f32_32x32x16_bf16 v[40:55], v[32:35], a[24:27], v[40:55]
  v_mfma_f32_32x32x16_bf16 v[56:71], v[32:35], a[168:171], v[56:71]
  ds_read_b128 v[20:23], v1 offset:11264
  s_waitcnt lgkmcnt(4)
  v_mfma_f32_32x32x16_bf16 v[40:55], v[36:39], a[28:31], v[40:55]
  v_mfma_f32_32x32x16_bf16 v[56:71], v[36:39], a[172:175], v[56:71]
  ds_read_b128 v[24:27], v1 offset:12288
  s_waitcnt lgkmcnt(4)
  v_mfma_f32_32x32x16_bf16 v[40:55], v[8:11], a[32:35], v[40:55]
  v_mfma_f32_32x32x16_bf16 v[56:71], v[8:11], a[176:179], v[56:71]
  ds_read_b128 v[28:31], v1 offset:13312
  s_waitcnt lgkmcnt(4)
  v_mfma_f32_32x32x16_bf16 v[40:55], v[12:15], a[36:39], v[40:55]
  v_mfma_f32_32x32x16_bf16 v[56:71], v[12:15], a[180:183], v[56:71]
  ds_read_b128 v[32:35], v1 offset:14336
  s_waitcnt lgkmcnt(4)
  v_mfma_f32_32x32x16_bf16 v[40:55], v[16:19], a[40:43], v[40:55]
  v_mfma_f32_32x32x16_bf16 v[56:71], v[16:19], a[184:187], v[56:71]
  ds_read_b128 v[36:39], v1 offset:15360
  s_waitcnt lgkmcnt(4)
  v_mfma_f32_32x32x16_bf16 v[40:55], v[20:23], a[44:47], v[40:55]
  v_mfma_f32_32x32x16_bf16 v[56:71], v[20:23], a[188:191], v[56:71]
  ds_read_b128 v[8:11], v1 offset:16384
  s_waitcnt lgkmcnt(4)
  v_mfma_f32_32x32x16_bf16 v[40:55], v[24:27], a[48:51], v[40:55]
  v_mfma_f32_32x32x16_bf16 v[56:71], v[24:27], a[192:195], v[56:71]
  ds_read_b128 v[12:15], v1 offset:17408
  s_waitcnt lgkmcnt(4)
  v_mfma_f32_32x32x16_bf16 v[40:55], v[28:31], a[52:55], v[40:55]
  v_mfma_f32_32x32x16_bf16 v[56:71], v[28:31], a[196:199], v[56:71]
  ds_read_b128 v[16:19], v1 offset:18432
  s_waitcnt lgkmcnt(4)
  v_mfma_f32_32x32x16_bf16 v[40:55], v[32:35], a[56:59], v[40:55]
  v_mfma_f32_32x32x16_bf16 v[56:71], v[32:35], a[200:203], v[56:71]
  ds_read_b128 v[20:23], v1 offset:19456
  s_waitcnt lgkmcnt(4)
  v_mfma_f32_32x32x16_bf16 v[40:55], v[36:39], a[60:63], v[40:55]
  v_mfma_f32_32x32x16_bf16 v[56:71], v[36:39], a[204:207], v[56:71]
  ds_read_b128 v[24:27], v1 offset:20480
  s_waitcnt lgkmcnt(4)
  v_mfma_f32_32x32x16_bf16 v[40:55], v[8:11], a[64:67], v[40:55]
  v_mfma_f32_32x32x16_bf16 v[56:71], v[8:11], a[208:211], v[56:71]
  ds_read_b128 v[28:31], v1 offset:21504
  s_waitcnt lgkmcnt(4)
  v_mfma_f32_32x32x16_bf16 v[40:55], v[12:15], a[68:71], v[40:55]
  v_mfma_f32_32x32x16_bf16 v[56:71], v[12:15], a[212:215], v[56:71]
  ds_read_b128 v[32:35], v1 offset:22528
  s_waitcnt lgkmcnt(4)
  v_mfma_f32_32x32x16_bf16 v[40:55], v[16:19], a[72:75], v[40:55]
  v_mfma_f32_32x32x16_bf16 v[56:71], v[16:19], a[216:219], v[56:71]
  ds_read_b128 v[36:39], v1 offset:23552
  s_waitcnt lgkmcnt(4)
  v_mfma_f32_32x32x16_bf16 v[40:55], v[20:23], a[76:79], v[40:55]
  v_mfma_f32_32x32x16_bf16 v[56:71], v[20:23], a[220:223], v[56:71]
  ds_read_b128 v[8:11], v1 offset:24576
  s_waitcnt lgkmcnt(4)
  v_mfma_f32_32x32x16_bf16 v[40:55], v[24:27], a[80:83], v[40:55]
  v_mfma_f32_32x32x16_bf16 v[56:71], v[24:27], a[224:227], v[56:71]
  ds_read_b128 v[12:15], v1 offset:25600
  s_waitcnt lgkmcnt(4)
  v_mfma_f32_32x32x16_bf16 v[40:55], v[28:31], a[84:87], v[40:55]
  v_mfma_f32_32x32x16_bf16 v[56:71], v[28:31], a[228:231], v[56:71]
  ds_read_b128 v[16:19], v1 offset:26624
  s_waitcnt lgkmcnt(4)
  v_mfma_f32_32x32x16_bf16 v[40:55], v[32:35], a[88:91], v[40:55]
  v_mfma_f32_32x32x16_bf16 v[56:71], v[32:35], a[232:235], v[56:71]
  ds_read_b128 v[20:23], v1 offset:27648
  s_waitcnt lgkmcnt(4)
  v_mfma_f32_32x32x16_bf16 v[40:55], v[36:39], a[92:95], v[40:55]
  v_mfma_f32_32x32x16_bf16 v[56:71], v[36:39], a[236:239], v[56:71]
  ds_read_b128 v[24:27], v1 offset:28672
  s_waitcnt lgkmcnt(4)
  v_mfma_f32_32x32x16_bf16 v[40:55], v[8:11], a[96:99], v[40:55]
  v_mfma_f32_32x32x16_bf16 v[56:71], v[8:11], a[240:243], v[56:71]
  ds_read_b128 v[28:31], v1 offset:29696
  s_waitcnt lgkmcnt(4)
  v_mfma_f32_32x32x16_bf16 v[40:55], v[12:15], a[100:103], v[40:55]
  v_mfma_f32_32x32x16_bf16 v[56:71], v[12:15], a[244:247], v[56:71]
  ds_read_b128 v[32:35], v1 offset:30720
  s_waitcnt lgkmcnt(4)
  v_mfma_f32_32x32x16_bf16 v[40:55], v[16:19], a[104:107], v[40:55]
  v_mfma_f32_32x32x16_bf16 v[56:71], v[16:19], a[248:251], v[56:71]
  ds_read_b128 v[36:39], v1 offset:31744
  s_waitcnt lgkmcnt(4)
  v_mfma_f32_32x32x16_bf16 v[40:55], v[20:23], a[108:111], v[40:55]
  v_mfma_f32_32x32x16_bf16 v[56:71], v[20:23], a[252:255], v[56:71]
  ds_read_b128 v[8:11], v1 offset:32768
  s_waitcnt lgkmcnt(4)
  v_mfma_f32_32x32x16_bf16 v[40:55], v[24:27], a[112:115], v[40:55]
  v_mfma_f32_32x32x16_bf16 v[56:71], v[24:27], v[224:227], v[56:71]
  ds_read_b128 v[12:15], v1 offset:33792
  s_waitcnt lgkmcnt(4)
  v_mfma_f32_32x32x16_bf16 v[40:55], v[28:31], a[116:119], v[40:55]
  v_mfma_f32_32x32x16_bf16 v[56:71], v[28:31], v[228:231], v[56:71]
  ds_read_b128 v[16:19], v1 offset:34816
  s_waitcnt lgkmcnt(4)
  v_mfma_f32_32x32x16_bf16 v[40:55], v[32:35], a[120:123], v[40:55]
  v_mfma_f32_32x32x16_bf16 v[56:71], v[32:35], v[232:235], v[56:71]
  ds_read_b128 v[20:23], v1 offset:35840
  s_waitcnt lgkmcnt(4)
  v_mfma_f32_32x32x16_bf16 v[40:55], v[36:39], a[124:127], v[40:55]
  v_mfma_f32_32x32x16_bf16 v[56:71], v[36:39], v[236:239], v[56:71]
  s_waitcnt lgkmcnt(3)
  v_mfma_f32_32x32x16_bf16 v[40:55], v[8:11], a[128:131], v[40:55]
  v_mfma_f32_32x32x16_bf16 v[56:71], v[8:11], v[240:243], v[56:71]
  s_waitcnt lgkmcnt(2)
  v_mfma_f32_32x32x16_bf16 v[40:55], v[12:15], a[132:135], v[40:55]
  v_mfma_f32_32x32x16_bf16 v[56:71], v[12:15], v[244:247], v[56:71]
  s_waitcnt lgkmcnt(1)
  v_mfma_f32_32x32x16_bf16 v[40:55], v[16:19], a[136:139], v[40:55]
  v_mfma_f32_32x32x16_bf16 v[56:71], v[16:19], v[248:251], v[56:71]
  s_waitcnt lgkmcnt(0)
  v_mfma_f32_32x32x16_bf16 v[40:55], v[20:23], a[140:143], v[40:55]
  v_mfma_f32_32x32x16_bf16 v[56:71], v[20:23], v[252:255], v[56:71]
  s_nop 3
  v_cvt_pk_bf16_f32 v72, v40, v41
  v_cvt_pk_bf16_f32 v73, v42, v43
  v_cvt_pk_bf16_f32 v74, v48, v49
  v_cvt_pk_bf16_f32 v75, v50, v51
  s_add_u32 s26, s22, 0
  buffer_store_dwordx4 v[72:75], v3, s[4:7], s26 offen sc1
  v_cvt_pk_bf16_f32 v76, v44, v45
  v_cvt_pk_bf16_f32 v77, v46, v47
  v_cvt_pk_bf16_f32 v78, v52, v53
  v_cvt_pk_bf16_f32 v79, v54, v55
  s_add_u32 s26, s22, 512
  buffer_store_dwordx4 v[76:79], v3, s[4:7], s26 offen sc1
  v_cvt_pk_bf16_f32 v80, v56, v57
  v_cvt_pk_bf16_f32 v81, v58, v59
  v_cvt_pk_bf16_f32 v82, v64, v65
  v_cvt_pk_bf16_f32 v83, v66, v67
  s_add_u32 s26, s22, 2048
  buffer_store_dwordx4 v[80:83], v3, s[4:7], s26 offen sc1
  v_cvt_pk_bf16_f32 v84, v60, v61
  v_cvt_pk_bf16_f32 v85, v62, v63
  v_cvt_pk_bf16_f32 v86, v68, v69
  v_cvt_pk_bf16_f32 v87, v70, v71
  s_add_u32 s26, s22, 2560
  buffer_store_dwordx4 v[84:87], v3, s[4:7], s26 offen sc1
  s_add_u32 s22, s22, 524288
  s_add_u32 s21, s21, 1
L_qloop_v:
  s_waitcnt vmcnt(4)
  s_barrier
  s_sub_u32 s92, s21, 1
  s_max_i32 s92, s92, 0
  s_cmp_lg_u32 s17, 0
  s_cbranch_scc1 L_fs_16
  v_mov_b32 v4, s92
  s_mov_b64 exec, 1
  buffer_store_dword v4, off, s[4:7], s95 sc1
  s_mov_b64 exec, -1
L_fs_16:
  s_cmp_ge_u32 s21, 31
  s_cbranch_scc1 L_qnd_17
  s_add_u32 s26, s23, 0
  s_mul_i32 s24, s17, 9216
  s_add_u32 m0, s24, 0
  s_nop 0
  buffer_load_dwordx4 v1, s[4:7], s26 offen lds
  s_add_u32 s26, s23, 1024
  s_mul_i32 s24, s17, 9216
  s_add_u32 m0, s24, 1024
  s_nop 0
  buffer_load_dwordx4 v1, s[4:7], s26 offen lds
  s_add_u32 s26, s23, 2048
  s_mul_i32 s24, s17, 9216
  s_add_u32 m0, s24, 2048
  s_nop 0
  buffer_load_dwordx4 v1, s[4:7], s26 offen lds
  s_add_u32 s26, s23, 3072
  s_mul_i32 s24, s17, 9216
  s_add_u32 m0, s24, 3072
  s_nop 0
  buffer_load_dwordx4 v1, s[4:7], s26 offen lds
  s_add_u32 s26, s23, 4096
  s_mul_i32 s24, s17, 9216
  s_add_u32 m0, s24, 4096
  s_nop 0
  buffer_load_dwordx4 v1, s[4:7], s26 offen lds
  s_add_u32 s26, s23, 5120
  s_mul_i32 s24, s17, 9216
  s_add_u32 m0, s24, 5120
  s_nop 0
  buffer_load_dwordx4 v1, s[4:7], s26 offen lds
  s_add_u32 s26, s23, 6144
  s_mul_i32 s24, s17, 9216
  s_add_u32 m0, s24, 6144
  s_nop 0
  buffer_load_dwordx4 v1, s[4:7], s26 offen lds
  s_add_u32 s26, s23, 7168
  s_mul_i32 s24, s17, 9216
  s_add_u32 m0, s24, 7168
  s_nop 0
  buffer_load_dwordx4 v1, s[4:7], s26 offen lds
  s_add_u32 s26, s23, 8192
  s_mul_i32 s24, s17, 9216
  s_add_u32 m0, s24, 8192
  s_nop 0
  buffer_load_dwordx4 v1, s[4:7], s26 offen lds
  s_add_u32 s23, s23, 73728
L_qnd_17:
  ds_read_b128 v[8:11], v2 offset:0
  ds_read_b128 v[12:15], v2 offset:1024
  ds_read_b128 v[16:19], v2 offset:2048
  ds_read_b128 v[20:23], v2 offset:3072
  ds_read_b128 v[24:27], v2 offset:4096
  s_waitcnt lgkmcnt(4)
  v_mfma_f32_32x32x16_bf16 v[40:55], v[8:11], a[0:3], 0
  v_mfma_f32_32x32x16_bf16 v[56:71], v[8:11], a[144:147], 0
  ds_read_b128 v[28:31], v2 offset:5120
  s_waitcnt lgkmcnt(4)
  v_mfma_f32_32x32x16_bf16 v[40:55], v[12:15], a[4:7], v[40:55]
  v_mfma_f32_32x32x16_bf16 v[56:71], v[12:15], a[148:151], v[56:71]
  ds_read_b128 v[32:35], v2 offset:6144
  s_waitcnt lgkmcnt(4)
  v_mfma_f32_32x32x16_bf16 v[40:55], v[16:19], a[8:11], v[40:55]
  v_mfma_f32_32x32x16_bf16 v[56:71], v[16:19], a[152:155], v[56:71]
  ds_read_b128 v[36:39], v2 offset:7168
  s_waitcnt lgkmcnt(4)
  v_mfma_f32_32x32x16_bf16 v[40:55], v[20:23], a[12:15], v[40:55]
  v_mfma_f32_32x32x16_bf16 v[56:71], v[20:23], a[156:159], v[56:71]
  ds_read_b128 v[8:11], v2 offset:8192
  s_waitcnt lgkmcnt(4)
  v_mfma_f32_32x32x16_bf16 v[40:55], v[24:27], a[16:19], v[40:55]
  v_mfma_f32_32x32x16_bf16 v[56:71], v[24:27], a[160:163], v[56:71]
  ds_read_b128 v[12:15], v2 offset:9216
  s_waitcnt lgkmcnt(4)
  v_mfma_f32_32x32x16_bf16 v[40:55], v[28:31], a[20:23], v[40:55]
  v_mfma_f32_32x32x16_bf16 v[56:71], v[28:31], a[164:167], v[56:71]
  ds_read_b128 v[16:19], v2 offset:10240
  s_waitcnt lgkmcnt(4)
  v_mfma_f32_32x32x16_bf16 v[40:55], v[32:35], a[24:27], v[40:55]
  v_mfma_f32_32x32x16_bf16 v[56:71], v[32:35], a[168:171], v[56:71]
  ds_read_b128 v[20:23], v2 offset:11264
  s_waitcnt lgkmcnt(4)
  v_mfma_f32_32x32x16_bf16 v[40:55], v[36:39], a[28:31], v[40:55]
  v_mfma_f32_32x32x16_bf16 v[56:71], v[36:39], a[172:175], v[56:71]
  ds_read_b128 v[24:27], v2 offset:12288
  s_waitcnt lgkmcnt(4)
  v_mfma_f32_32x32x16_bf16 v[40:55], v[8:11], a[32:35], v[40:55]
  v_mfma_f32_32x32x16_bf16 v[56:71], v[8:11], a[176:179], v[56:71]
  ds_read_b128 v[28:31], v2 offset:13312
  s_waitcnt lgkmcnt(4)
  v_mfma_f32_32x32x16_bf16 v[40:55], v[12:15], a[36:39], v[40:55]
  v_mfma_f32_32x32x16_bf16 v[56:71], v[12:15], a[180:183], v[56:71]
  ds_read_b128 v[32:35], v2 offset:14336
  s_waitcnt lgkmcnt(4)
  v_mfma_f32_32x32x16_bf16 v[40:55], v[16:19], a[40:43], v[40:55]
  v_mfma_f32_32x32x16_bf16 v[56:71], v[16:19], a[184:187], v[56:71]
  ds_read_b128 v[36:39], v2 offset:15360
  s_waitcnt lgkmcnt(4)
  v_mfma_f32_32x32x16_bf16 v[40:55], v[20:23], a[44:47], v[40:55]
  v_mfma_f32_32x32x16_bf16 v[56:71], v[20:23], a[188:191], v[56:71]
  ds_read_b128 v[8:11], v2 offset:16384
  s_waitcnt lgkmcnt(4)
  v_mfma_f32_32x32x16_bf16 v[40:55], v[24:27], a[48:51], v[40:55]
  v_mfma_f32_32x32x16_bf16 v[56:71], v[24:27], a[192:195], v[56:71]
  ds_read_b128 v[12:15], v2 offset:17408
  s_waitcnt lgkmcnt(4)
  v_mfma_f32_32x32x16_bf16 v[40:55], v[28:31], a[52:55], v[40:55]
  v_mfma_f32_32x32x16_bf16 v[56:71], v[28:31], a[196:199], v[56:71]
  ds_read_b128 v[16:19], v2 offset:18432
  s_waitcnt lgkmcnt(4)
  v_mfma_f32_32x32x16_bf16 v[40:55], v[32:35], a[56:59], v[40:55]
  v_mfma_f32_32x32x16_bf16 v[56:71], v[32:35], a[200:203], v[56:71]
  ds_read_b128 v[20:23], v2 offset:19456
  s_waitcnt lgkmcnt(4)
  v_mfma_f32_32x32x16_bf16 v[40:55], v[36:39], a[60:63], v[40:55]
  v_mfma_f32_32x32x16_bf16 v[56:71], v[36:39], a[204:207], v[56:71]
  ds_read_b128 v[24:27], v2 offset:20480
  s_waitcnt lgkmcnt(4)
  v_mfma_f32_32x32x16_bf16 v[40:55], v[8:11], a[64:67], v[40:55]
  v_mfma_f32_32x32x16_bf16 v[56:71], v[8:11], a[208:211], v[56:71]
  ds_read_b128 v[28:31], v2 offset:21504
  s_waitcnt lgkmcnt(4)
  v_mfma_f32_32x32x16_bf16 v[40:55], v[12:15], a[68:71], v[40:55]
  v_mfma_f32_32x32x16_bf16 v[56:71], v[12:15], a[212:215], v[56:71]
  ds_read_b128 v[32:35], v2 offset:22528
  s_waitcnt lgkmcnt(4)
  v_mfma_f32_32x32x16_bf16 v[40:55], v[16:19], a[72:75], v[40:55]
  v_mfma_f32_32x32x16_bf16 v[56:71], v[16:19], a[216:219], v[56:71]
  ds_read_b128 v[36:39], v2 offset:23552
  s_waitcnt lgkmcnt(4)
  v_mfma_f32_32x32x16_bf16 v[40:55], v[20:23], a[76:79], v[40:55]
  v_mfma_f32_32x32x16_bf16 v[56:71], v[20:23], a[220:223], v[56:71]
  ds_read_b128 v[8:11], v2 offset:24576
  s_waitcnt lgkmcnt(4)
  v_mfma_f32_32x32x16_bf16 v[40:55], v[24:27], a[80:83], v[40:55]
  v_mfma_f32_32x32x16_bf16 v[56:71], v[24:27], a[224:227], v[56:71]
  ds_read_b128 v[12:15], v2 offset:25600
  s_waitcnt lgkmcnt(4)
  v_mfma_f32_32x32x16_bf16 v[40:55], v[28:31], a[84:87], v[40:55]
  v_mfma_f32_32x32x16_bf16 v[56:71], v[28:31], a[228:231], v[56:71]
  ds_read_b128 v[16:19], v2 offset:26624
  s_waitcnt lgkmcnt(4)
  v_mfma_f32_32x32x16_bf16 v[40:55], v[32:35], a[88:91], v[40:55]
  v_mfma_f32_32x32x16_bf16 v[56:71], v[32:35], a[232:235], v[56:71]
  ds_read_b128 v[20:23], v2 offset:27648
  s_waitcnt lgkmcnt(4)
  v_mfma_f32_32x32x16_bf16 v[40:55], v[36:39], a[92:95], v[40:55]
  v_mfma_f32_32x32x16_bf16 v[56:71], v[36:39], a[236:239], v[56:71]
  ds_read_b128 v[24:27], v2 offset:28672
  s_waitcnt lgkmcnt(4)
  v_mfma_f32_32x32x16_bf16 v[40:55], v[8:11], a[96:99], v[40:55]
  v_mfma_f32_32x32x16_bf16 v[56:71], v[8:11], a[240:243], v[56:71]
  ds_read_b128 v[28:31], v2 offset:29696
  s_waitcnt lgkmcnt(4)
  v_mfma_f32_32x32x16_bf16 v[40:55], v[12:15], a[100:103], v[40:55]
  v_mfma_f32_32x32x16_bf16 v[56:71], v[12:15], a[244:247], v[56:71]
  ds_read_b128 v[32:35], v2 offset:30720
  s_waitcnt lgkmcnt(4)
  v_mfma_f32_32x32x16_bf16 v[40:55], v[16:19], a[104:107], v[40:55]
  v_mfma_f32_32x32x16_bf16 v[56:71], v[16:19], a[248:251], v[56:71]
  ds_read_b128 v[36:39], v2 offset:31744
  s_waitcnt lgkmcnt(4)
  v_mfma_f32_32x32x16_bf16 v[40:55], v[20:23], a[108:111], v[40:55]
  v_mfma_f32_32x32x16_bf16 v[56:71], v[20:23], a[252:255], v[56:71]
  ds_read_b128 v[8:11], v2 offset:32768
  s_waitcnt lgkmcnt(4)
  v_mfma_f32_32x32x16_bf16 v[40:55], v[24:27], a[112:115], v[40:55]
  v_mfma_f32_32x32x16_bf16 v[56:71], v[24:27], v[224:227], v[56:71]
  ds_read_b128 v[12:15], v2 offset:33792
  s_waitcnt lgkmcnt(4)
  v_mfma_f32_32x32x16_bf16 v[40:55], v[28:31], a[116:119], v[40:55]
  v_mfma_f32_32x32x16_bf16 v[56:71], v[28:31], v[228:231], v[56:71]
  ds_read_b128 v[16:19], v2 offset:34816
  s_waitcnt lgkmcnt(4)
  v_mfma_f32_32x32x16_bf16 v[40:55], v[32:35], a[120:123], v[40:55]
  v_mfma_f32_32x32x16_bf16 v[56:71], v[32:35], v[232:235], v[56:71]
  ds_read_b128 v[20:23], v2 offset:35840
  s_waitcnt lgkmcnt(4)
  v_mfma_f32_32x32x16_bf16 v[40:55], v[36:39], a[124:127], v[40:55]
  v_mfma_f32_32x32x16_bf16 v[56:71], v[36:39], v[236:239], v[56:71]
  s_waitcnt lgkmcnt(3)
  v_mfma_f32_32x32x16_bf16 v[40:55], v[8:11], a[128:131], v[40:55]
  v_mfma_f32_32x32x16_bf16 v[56:71], v[8:11], v[240:243], v[56:71]
  s_waitcnt lgkmcnt(2)
  v_mfma_f32_32x32x16_bf16 v[40:55], v[12:15], a[132:135], v[40:55]
  v_mfma_f32_32x32x16_bf16 v[56:71], v[12:15], v[244:247], v[56:71]
  s_waitcnt lgkmcnt(1)
  v_mfma_f32_32x32x16_bf16 v[40:55], v[16:19], a[136:139], v[40:55]
  v_mfma_f32_32x32x16_bf16 v[56:71], v[16:19], v[248:251], v[56:71]
  s_waitcnt lgkmcnt(0)
  v_mfma_f32_32x32x16_bf16 v[40:55], v[20:23], a[140:143], v[40:55]
  v_mfma_f32_32x32x16_bf16 v[56:71], v[20:23], v[252:255], v[56:71]
  s_nop 3
  v_cvt_pk_bf16_f32 v72, v40, v41
  v_cvt_pk_bf16_f32 v73, v42, v43
  v_cvt_pk_bf16_f32 v74, v48, v49
  v_cvt_pk_bf16_f32 v75, v50, v51
  s_add_u32 s26, s22, 0
  buffer_store_dwordx4 v[72:75], v3, s[4:7], s26 offen sc1
  v_cvt_pk_bf16_f32 v76, v44, v45
  v_cvt_pk_bf16_f32 v77, v46, v47
  v_cvt_pk_bf16_f32 v78, v52, v53
  v_cvt_pk_bf16_f32 v79, v54, v55
  s_add_u32 s26, s22, 512
  buffer_store_dwordx4 v[76:79], v3, s[4:7], s26 offen sc1
  v_cvt_pk_bf16_f32 v80, v56, v57
  v_cvt_pk_bf16_f32 v81, v58, v59
  v_cvt_pk_bf16_f32 v82, v64, v65
  v_cvt_pk_bf16_f32 v83, v66, v67
  s_add_u32 s26, s22, 2048
  buffer_store_dwordx4 v[80:83], v3, s[4:7], s26 offen sc1
  v_cvt_pk_bf16_f32 v84, v60, v61
  v_cvt_pk_bf16_f32 v85, v62, v63
  v_cvt_pk_bf16_f32 v86, v68, v69
  v_cvt_pk_bf16_f32 v87, v70, v71
  s_add_u32 s26, s22, 2560
  buffer_store_dwordx4 v[84:87], v3, s[4:7], s26 offen sc1
  s_add_u32 s22, s22, 524288
  s_add_u32 s21, s21, 1
  s_cmp_ge_u32 s21, 32
  s_cbranch_scc1 L_qdone_v
  s_waitcnt vmcnt(4)
  s_barrier
  s_sub_u32 s92, s21, 1
  s_max_i32 s92, s92, 0
  s_cmp_lg_u32 s17, 0
  s_cbranch_scc1 L_fs_18
  v_mov_b32 v4, s92
  s_mov_b64 exec, 1
  buffer_store_dword v4, off, s[4:7], s95 sc1
  s_mov_b64 exec, -1
L_fs_18:
  s_cmp_ge_u32 s21, 31
  s_cbranch_scc1 L_qnd_19
  s_add_u32 s26, s23, 0
  s_mul_i32 s24, s17, 9216
  s_add_u32 m0, s24, 36864
  s_nop 0
  buffer_load_dwordx4 v1, s[4:7], s26 offen lds
  s_add_u32 s26, s23, 1024
  s_mul_i32 s24, s17, 9216
  s_add_u32 m0, s24, 37888
  s_nop 0
  buffer_load_dwordx4 v1, s[4:7], s26 offen lds
  s_add_u32 s26, s23, 2048
  s_mul_i32 s24, s17, 9216
  s_add_u32 m0, s24, 38912
  s_nop 0
  buffer_load_dwordx4 v1, s[4:7], s26 offen lds
  s_add_u32 s26, s23, 3072
  s_mul_i32 s24, s17, 9216
  s_add_u32 m0, s24, 39936
  s_nop 0
  buffer_load_dwordx4 v1, s[4:7], s26 offen lds
  s_add_u32 s26, s23, 4096
  s_mul_i32 s24, s17, 9216
  s_add_u32 m0, s24, 40960
  s_nop 0
  buffer_load_dwordx4 v1, s[4:7], s26 offen lds
  s_add_u32 s26, s23, 5120
  s_mul_i32 s24, s17, 9216
  s_add_u32 m0, s24, 41984
  s_nop 0
  buffer_load_dwordx4 v1, s[4:7], s26 offen lds
  s_add_u32 s26, s23, 6144
  s_mul_i32 s24, s17, 9216
  s_add_u32 m0, s24, 43008
  s_nop 0
  buffer_load_dwordx4 v1, s[4:7], s26 offen lds
  s_add_u32 s26, s23, 7168
  s_mul_i32 s24, s17, 9216
  s_add_u32 m0, s24, 44032
  s_nop 0
  buffer_load_dwordx4 v1, s[4:7], s26 offen lds
  s_add_u32 s26, s23, 8192
  s_mul_i32 s24, s17, 9216
  s_add_u32 m0, s24, 45056
  s_nop 0
  buffer_load_dwordx4 v1, s[4:7], s26 offen lds
  s_add_u32 s23, s23, 73728
L_qnd_19:
  ds_read_b128 v[8:11], v1 offset:0
  ds_read_b128 v[12:15], v1 offset:1024
  ds_read_b128 v[16:19], v1 offset:2048
  ds_read_b128 v[20:23], v1 offset:3072
  ds_read_b128 v[24:27], v1 offset:4096
  s_waitcnt lgkmcnt(4)
  v_mfma_f32_32x32x16_bf16 v[40:55], v[8:11], a[0:3], 0
  v_mfma_f32_32x32x16_bf16 v[56:71], v[8:11], a[144:147], 0
  ds_read_b128 v[28:31], v1 offset:5120
  s_waitcnt lgkmcnt(4)
  v_mfma_f32_32x32x16_bf16 v[40:55], v[12:15], a[4:7], v[40:55]
  v_mfma_f32_32x32x16_bf16 v[56:71], v[12:15], a[148:151], v[56:71]
  ds_read_b128 v[32:35], v1 offset:6144
  s_waitcnt lgkmcnt(4)
  v_mfma_f32_32x32x16_bf16 v[40:55], v[16:19], a[8:11], v[40:55]
  v_mfma_f32_32x32x16_bf16 v[56:71], v[16:19], a[152:155], v[56:71]
  ds_read_b128 v[36:39], v1 offset:7168
  s_waitcnt lgkmcnt(4)
  v_mfma_f32_32x32x16_bf16 v[40:55], v[20:23], a[12:15], v[40:55]
  v_mfma_f32_32x32x16_bf16 v[56:71], v[20:23], a[156:159], v[56:71]
  ds_read_b128 v[8:11], v1 offset:8192
  s_waitcnt lgkmcnt(4)
  v_mfma_f32_32x32x16_bf16 v[40:55], v[24:27], a[16:19], v[40:55]
  v_mfma_f32_32x32x16_bf16 v[56:71], v[24:27], a[160:163], v[56:71]
  ds_read_b128 v[12:15], v1 offset:9216
  s_waitcnt lgkmcnt(4)
  v_mfma_f32_32x32x16_bf16 v[40:55], v[28:31], a[20:23], v[40:55]
  v_mfma_f32_32x32x16_bf16 v[56:71], v[28:31], a[164:167], v[56:71]
  ds_read_b128 v[16:19], v1 offset:10240
  s_waitcnt lgkmcnt(4)
  v_mfma_f32_32x32x16_bf16 v[40:55], v[32:35], a[24:27], v[40:55]
  v_mfma_f32_32x32x16_bf16 v[56:71], v[32:35], a[168:171], v[56:71]
  ds_read_b128 v[20:23], v1 offset:11264
  s_waitcnt lgkmcnt(4)
  v_mfma_f32_32x32x16_bf16 v[40:55], v[36:39], a[28:31], v[40:55]
  v_mfma_f32_32x32x16_bf16 v[56:71], v[36:39], a[172:175], v[56:71]
  ds_read_b128 v[24:27], v1 offset:12288
  s_waitcnt lgkmcnt(4)
  v_mfma_f32_32x32x16_bf16 v[40:55], v[8:11], a[32:35], v[40:55]
  v_mfma_f32_32x32x16_bf16 v[56:71], v[8:11], a[176:179], v[56:71]
  ds_read_b128 v[28:31], v1 offset:13312
  s_waitcnt lgkmcnt(4)
  v_mfma_f32_32x32x16_bf16 v[40:55], v[12:15], a[36:39], v[40:55]
  v_mfma_f32_32x32x16_bf16 v[56:71], v[12:15], a[180:183], v[56:71]
  ds_read_b128 v[32:35], v1 offset:14336
  s_waitcnt lgkmcnt(4)
  v_mfma_f32_32x32x16_bf16 v[40:55], v[16:19], a[40:43], v[40:55]
  v_mfma_f32_32x32x16_bf16 v[56:71], v[16:19], a[184:187], v[56:71]
  ds_read_b128 v[36:39], v1 offset:15360
  s_waitcnt lgkmcnt(4)
  v_mfma_f32_32x32x16_bf16 v[40:55], v[20:23], a[44:47], v[40:55]
  v_mfma_f32_32x32x16_bf16 v[56:71], v[20:23], a[188:191], v[56:71]
  ds_read_b128 v[8:11], v1 offset:16384
  s_waitcnt lgkmcnt(4)
  v_mfma_f32_32x32x16_bf16 v[40:55], v[24:27], a[48:51], v[40:55]
  v_mfma_f32_32x32x16_bf16 v[56:71], v[24:27], a[192:195], v[56:71]
  ds_read_b128 v[12:15], v1 offset:17408
  s_waitcnt lgkmcnt(4)
  v_mfma_f32_32x32x16_bf16 v[40:55], v[28:31], a[52:55], v[40:55]
  v_mfma_f32_32x32x16_bf16 v[56:71], v[28:31], a[196:199], v[56:71]
  ds_read_b128 v[16:19], v1 offset:18432
  s_waitcnt lgkmcnt(4)
  v_mfma_f32_32x32x16_bf16 v[40:55], v[32:35], a[56:59], v[40:55]
  v_mfma_f32_32x32x16_bf16 v[56:71], v[32:35], a[200:203], v[56:71]
  ds_read_b128 v[20:23], v1 offset:19456
  s_waitcnt lgkmcnt(4)
  v_mfma_f32_32x32x16_bf16 v[40:55], v[36:39], a[60:63], v[40:55]
  v_mfma_f32_32x32x16_bf16 v[56:71], v[36:39], a[204:207], v[56:71]
  ds_read_b128 v[24:27], v1 offset:20480
  s_waitcnt lgkmcnt(4)
  v_mfma_f32_32x32x16_bf16 v[40:55], v[8:11], a[64:67], v[40:55]
  v_mfma_f32_32x32x16_bf16 v[56:71], v[8:11], a[208:211], v[56:71]
  ds_read_b128 v[28:31], v1 offset:21504
  s_waitcnt lgkmcnt(4)
  v_mfma_f32_32x32x16_bf16 v[40:55], v[12:15], a[68:71], v[40:55]
  v_mfma_f32_32x32x16_bf16 v[56:71], v[12:15], a[212:215], v[56:71]
  ds_read_b128 v[32:35], v1 offset:22528
  s_waitcnt lgkmcnt(4)
  v_mfma_f32_32x32x16_bf16 v[40:55], v[16:19], a[72:75], v[40:55]
  v_mfma_f32_32x32x16_bf16 v[56:71], v[16:19], a[216:219], v[56:71]
  ds_read_b128 v[36:39], v1 offset:23552
  s_waitcnt lgkmcnt(4)
  v_mfma_f32_32x32x16_bf16 v[40:55], v[20:23], a[76:79], v[40:55]
  v_mfma_f32_32x32x16_bf16 v[56:71], v[20:23], a[220:223], v[56:71]
  ds_read_b128 v[8:11], v1 offset:24576
  s_waitcnt lgkmcnt(4)
  v_mfma_f32_32x32x16_bf16 v[40:55], v[24:27], a[80:83], v[40:55]
  v_mfma_f32_32x32x16_bf16 v[56:71], v[24:27], a[224:227], v[56:71]
  ds_read_b128 v[12:15], v1 offset:25600
  s_waitcnt lgkmcnt(4)
  v_mfma_f32_32x32x16_bf16 v[40:55], v[28:31], a[84:87], v[40:55]
  v_mfma_f32_32x32x16_bf16 v[56:71], v[28:31], a[228:231], v[56:71]
  ds_read_b128 v[16:19], v1 offset:26624
  s_waitcnt lgkmcnt(4)
  v_mfma_f32_32x32x16_bf16 v[40:55], v[32:35], a[88:91], v[40:55]
  v_mfma_f32_32x32x16_bf16 v[56:71], v[32:35], a[232:235], v[56:71]
  ds_read_b128 v[20:23], v1 offset:27648
  s_waitcnt lgkmcnt(4)
  v_mfma_f32_32x32x16_bf16 v[40:55], v[36:39], a[92:95], v[40:55]
  v_mfma_f32_32x32x16_bf16 v[56:71], v[36:39], a[236:239], v[56:71]
  ds_read_b128 v[24:27], v1 offset:28672
  s_waitcnt lgkmcnt(4)
  v_mfma_f32_32x32x16_bf16 v[40:55], v[8:11], a[96:99], v[40:55]
  v_mfma_f32_32x32x16_bf16 v[56:71], v[8:11], a[240:243], v[56:71]
  ds_read_b128 v[28:31], v1 offset:29696
  s_waitcnt lgkmcnt(4)
  v_mfma_f32_32x32x16_bf16 v[40:55], v[12:15], a[100:103], v[40:55]
  v_mfma_f32_32x32x16_bf16 v[56:71], v[12:15], a[244:247], v[56:71]
  ds_read_b128 v[32:35], v1 offset:30720
  s_waitcnt lgkmcnt(4)
  v_mfma_f32_32x32x16_bf16 v[40:55], v[16:19], a[104:107], v[40:55]
  v_mfma_f32_32x32x16_bf16 v[56:71], v[16:19], a[248:251], v[56:71]
  ds_read_b128 v[36:39], v1 offset:31744
  s_waitcnt lgkmcnt(4)
  v_mfma_f32_32x32x16_bf16 v[40:55], v[20:23], a[108:111], v[40:55]
  v_mfma_f32_32x32x16_bf16 v[56:71], v[20:23], a[252:255], v[56:71]
  ds_read_b128 v[8:11], v1 offset:32768
  s_waitcnt lgkmcnt(4)
  v_mfma_f32_32x32x16_bf16 v[40:55], v[24:27], a[112:115], v[40:55]
  v_mfma_f32_32x32x16_bf16 v[56:71], v[24:27], v[224:227], v[56:71]
  ds_read_b128 v[12:15], v1 offset:33792
  s_waitcnt lgkmcnt(4)
  v_mfma_f32_32x32x16_bf16 v[40:55], v[28:31], a[116:119], v[40:55]
  v_mfma_f32_32x32x16_bf16 v[56:71], v[28:31], v[228:231], v[56:71]
  ds_read_b128 v[16:19], v1 offset:34816
  s_waitcnt lgkmcnt(4)
  v_mfma_f32_32x32x16_bf16 v[40:55], v[32:35], a[120:123], v[40:55]
  v_mfma_f32_32x32x16_bf16 v[56:71], v[32:35], v[232:235], v[56:71]
  ds_read_b128 v[20:23], v1 offset:35840
  s_waitcnt lgkmcnt(4)
  v_mfma_f32_32x32x16_bf16 v[40:55], v[36:39], a[124:127], v[40:55]
  v_mfma_f32_32x32x16_bf16 v[56:71], v[36:39], v[236:239], v[56:71]
  s_waitcnt lgkmcnt(3)
  v_mfma_f32_32x32x16_bf16 v[40:55], v[8:11], a[128:131], v[40:55]
  v_mfma_f32_32x32x16_bf16 v[56:71], v[8:11], v[240:243], v[56:71]
  s_waitcnt lgkmcnt(2)
  v_mfma_f32_32x32x16_bf16 v[40:55], v[12:15], a[132:135], v[40:55]
  v_mfma_f32_32x32x16_bf16 v[56:71], v[12:15], v[244:247], v[56:71]
  s_waitcnt lgkmcnt(1)
  v_mfma_f32_32x32x16_bf16 v[40:55], v[16:19], a[136:139], v[40:55]
  v_mfma_f32_32x32x16_bf16 v[56:71], v[16:19], v[248:251], v[56:71]
  s_waitcnt lgkmcnt(0)
  v_mfma_f32_32x32x16_bf16 v[40:55], v[20:23], a[140:143], v[40:55]
  v_mfma_f32_32x32x16_bf16 v[56:71], v[20:23], v[252:255], v[56:71]
  s_nop 3
  v_cvt_pk_bf16_f32 v72, v40, v41
  v_cvt_pk_bf16_f32 v73, v42, v43
  v_cvt_pk_bf16_f32 v74, v48, v49
  v_cvt_pk_bf16_f32 v75, v50, v51
  s_add_u32 s26, s22, 0
  buffer_store_dwordx4 v[72:75], v3, s[4:7], s26 offen sc1
  v_cvt_pk_bf16_f32 v76, v44, v45
  v_cvt_pk_bf16_f32 v77, v46, v47
  v_cvt_pk_bf16_f32 v78, v52, v53
  v_cvt_pk_bf16_f32 v79, v54, v55
  s_add_u32 s26, s22, 512
  buffer_store_dwordx4 v[76:79], v3, s[4:7], s26 offen sc1
  v_cvt_pk_bf16_f32 v80, v56, v57
  v_cvt_pk_bf16_f32 v81, v58, v59
  v_cvt_pk_bf16_f32 v82, v64, v65
  v_cvt_pk_bf16_f32 v83, v66, v67
  s_add_u32 s26, s22, 2048
  buffer_store_dwordx4 v[80:83], v3, s[4:7], s26 offen sc1
  v_cvt_pk_bf16_f32 v84, v60, v61
  v_cvt_pk_bf16_f32 v85, v62, v63
  v_cvt_pk_bf16_f32 v86, v68, v69
  v_cvt_pk_bf16_f32 v87, v70, v71
  s_add_u32 s26, s22, 2560
  buffer_store_dwordx4 v[84:87], v3, s[4:7], s26 offen sc1
  s_add_u32 s22, s22, 524288
  s_add_u32 s21, s21, 1
  s_branch L_qloop_v
L_qdone_v:
  s_waitcnt vmcnt(0)
L_qkv_end:
  s_barrier
  s_cmp_lg_u32 s17, 0
  s_cbranch_scc1 L_fs_20
  v_mov_b32 v4, 32
  s_mov_b64 exec, 1
  buffer_store_dword v4, off, s[4:7], s95 sc1
  s_mov_b64 exec, -1
L_fs_20:
  s_branch L_r_qkv_end
L_r_qkv_end:
  s_add_u32 s96, s96, 64
  s_branch L_final
L_r_ln:
  s_mov_b32 s30, s96
  s_load_dwordx2 s[8:9], s[0:1], 0
  s_waitcnt lgkmcnt(0)
  s_and_b32 s9, s9, 0xffff
  s_mov_b32 s10, 2359296
  s_mov_b32 s11, 0x00020000
  v_and_b32 v1, 63, v0
  v_and_b32 v2, 31, v1
  v_lshrrev_b32 v3, 5, v1
  v_mul_u32_u24 v2, 1152, v2
  v_lshl_add_u32 v2, v3, 4, v2
  s_mul_i32 s20, s17, 288
  v_add_u32 v2, s20, v2
  s_mul_i32 s21, s30, 36864
  buffer_load_dwordx4 v[8:11], v2, s[8:11], s21 offen offset:0
  buffer_load_dwordx4 v[12:15], v2, s[8:11], s21 offen offset:32
  buffer_load_dwordx4 v[16:19], v2, s[8:11], s21 offen offset:64
  buffer_load_dwordx4 v[20:23], v2, s[8:11], s21 offen offset:96
  buffer_load_dwordx4 v[24:27], v2, s[8:11], s21 offen offset:128
  buffer_load_dwordx4 v[28:31], v2, s[8:11], s21 offen offset:160
  buffer_load_dwordx4 v[32:35], v2, s[8:11], s21 offen offset:192
  buffer_load_dwordx4 v[36:39], v2, s[8:11], s21 offen offset:224
  buffer_load_dwordx4 v[40:43], v2, s[8:11], s21 offen offset:256
  v_lshlrev_b32 v4, 2, v0
  v_add_u32 v4, 0, v4
  v_lshlrev_b32 v5, 2, v1
  v_add_u32 v5, 0, v5
  v_lshlrev_b32 v6, 4, v1
  s_mul_i32 s22, s17, 9216
  s_add_u32 s21, s21, s22
  s_add_u32 s21, s21, 1048576
  s_waitcnt vmcnt(8)
  v_lshlrev_b32 v44, 16, v8
  v_and_b32 v45, 0xffff0000, v8
  v_lshlrev_b32 v46, 16, v9
  v_and_b32 v47, 0xffff0000, v9
  v_lshlrev_b32 v48, 16, v10
  v_and_b32 v49, 0xffff0000, v10
  v_lshlrev_b32 v50, 16, v11
  v_and_b32 v51, 0xffff0000, v11
  s_waitcnt vmcnt(7)
  v_lshlrev_b32 v52, 16, v12
  v_and_b32 v53, 0xffff0000, v12
  v_lshlrev_b32 v54, 16, v13
  v_and_b32 v55, 0xffff0000, v13
  v_lshlrev_b32 v56, 16, v14
  v_and_b32 v57, 0xffff0000, v14
  v_lshlrev_b32 v58, 16, v15
  v_and_b32 v59, 0xffff0000, v15
  s_waitcnt vmcnt(6)
  v_lshlrev_b32 v60, 16, v16
  v_and_b32 v61, 0xffff0000, v16
  v_lshlrev_b32 v62, 16, v17
  v_and_b32 v63, 0xffff0000, v17
  v_lshlrev_b32 v64, 16, v18
  v_and_b32 v65, 0xffff0000, v18
  v_lshlrev_b32 v66, 16, v19
  v_and_b32 v67, 0xffff0000, v19
  s_waitcnt vmcnt(5)
  v_lshlrev_b32 v68, 16, v20
  v_and_b32 v69, 0xffff0000, v20
  v_lshlrev_b32 v70, 16, v21
  v_and_b32 v71, 0xffff0000, v21
  v_lshlrev_b32 v72, 16, v22
  v_and_b32 v73, 0xffff0000, v22
  v_lshlrev_b32 v74, 16, v23
  v_and_b32 v75, 0xffff0000, v23
  s_waitcnt vmcnt(4)
  v_lshlrev_b32 v76, 16, v24
  v_and_b32 v77, 0xffff0000, v24
  v_lshlrev_b32 v78, 16, v25
  v_and_b32 v79, 0xffff0000, v25
  v_lshlrev_b32 v80, 16, v26
  v_and_b32 v81, 0xffff0000, v26
  v_lshlrev_b32 v82, 16, v27
  v_and_b32 v83, 0xffff0000, v27
  s_waitcnt vmcnt(3)
  v_lshlrev_b32 v84, 16, v28
  v_and_b32 v85, 0xffff0000, v28
  v_lshlrev_b32 v86, 16, v29
  v_and_b32 v87, 0xffff0000, v29
  v_lshlrev_b32 v88, 16, v30
  v_and_b32 v89, 0xffff0000, v30
  v_lshlrev_b32 v90, 16, v31
  v_and_b32 v91, 0xffff0000, v31
  s_waitcnt vmcnt(2)
  v_lshlrev_b32 v92, 16, v32
  v_and_b32 v93, 0xffff0000, v32
  v_lshlrev_b32 v94, 16, v33
  v_and_b32 v95, 0xffff0000, v33
  v_lshlrev_b32 v96, 16, v34
  v_and_b32 v97, 0xffff0000, v34
  v_lshlrev_b32 v98, 16, v35
  v_and_b32 v99, 0xffff0000, v35
  s_waitcnt vmcnt(1)
  v_lshlrev_b32 v100, 16, v36
  v_and_b32 v101, 0xffff0000, v36
  v_lshlrev_b32 v102, 16, v37
  v_and_b32 v103, 0xffff0000, v37
  v_lshlrev_b32 v104, 16, v38
  v_and_b32 v105, 0xffff0000, v38
  v_lshlrev_b32 v106, 16, v39
  v_and_b32 v107, 0xffff0000, v39
  s_waitcnt vmcnt(0)
  v_lshlrev_b32 v108, 16, v40
  v_and_b32 v109, 0xffff0000, v40
  v_lshlrev_b32 v110, 16, v41
  v_and_b32 v111, 0xffff0000, v41
  v_lshlrev_b32 v112, 16, v42
  v_and_b32 v113, 0xffff0000, v42
  v_lshlrev_b32 v114, 16, v43
  v_and_b32 v115, 0xffff0000, v43
  v_mov_b32 v132, -1
  v_mov_b32 v133, -1
  v_mov_b32 v134, -1
  v_mov_b32 v135, -1
  s_mul_i32 s92, s30, 12288
  s_lshl_b32 s93, s17, 10
  s_add_u32 s92, s92, s93
  s_add_u32 s92, s92, 62128128
  buffer_store_dwordx4 v[132:135], v6, s[4:7], s92 offen sc1
  s_add_u32 s92, s92, 4096
  buffer_store_dwordx4 v[132:135], v6, s[4:7], s92 offen sc1
  s_add_u32 s92, s92, 4096
  buffer_store_dwordx4 v[132:135], v6, s[4:7], s92 offen sc1
  s_add_u32 s92, s92, 8380416
  buffer_store_dwordx4 v[132:135], v6, s[4:7], s92 offen sc1
  s_add_u32 s92, s92, 4096
  buffer_store_dwordx4 v[132:135], v6, s[4:7], s92 offen sc1
  s_add_u32 s92, s92, 4096
  buffer_store_dwordx4 v[132:135], v6, s[4:7], s92 offen sc1
  s_mul_i32 s92, s30, 18432
  s_add_u32 s92, s92, s93
  s_add_u32 s92, s92, 107872256
  buffer_store_dwordx4 v[132:135], v6, s[4:7], s92 offen sc1
  s_add_u32 s92, s92, 4096
  buffer_store_dwordx4 v[132:135], v6, s[4:7], s92 offen sc1
  s_add_u32 s92, s92, 4096
  buffer_store_dwordx4 v[132:135], v6, s[4:7], s92 offen sc1
  s_add_u32 s92, s92, 4096
  buffer_store_dwordx4 v[132:135], v6, s[4:7], s92 offen sc1
  s_add_u32 s92, s92, 4096
  s_cmp_ge_u32 s17, 2
  s_cbranch_scc1 L_sn_21
  buffer_store_dwordx4 v[132:135], v6, s[4:7], s92 offen sc1
L_sn_21:
  v_add_f32 v116, v44, v48
  v_add_f32 v117, v45, v49
  v_add_f32 v118, v46, v50
  v_add_f32 v119, v47, v51
  v_add_f32 v116, v116, v52
  v_add_f32 v117, v117, v53
  v_add_f32 v118, v118, v54
  v_add_f32 v119, v119, v55
  v_add_f32 v116, v116, v56
  v_add_f32 v117, v117, v57
  v_add_f32 v118, v118, v58
  v_add_f32 v119, v119, v59
  v_add_f32 v116, v116, v60
  v_add_f32 v117, v117, v61
  v_add_f32 v118, v118, v62
  v_add_f32 v119, v119, v63
  v_add_f32 v116, v116, v64
  v_add_f32 v117, v117, v65
  v_add_f32 v118, v118, v66
  v_add_f32 v119, v119, v67
  v_add_f32 v116, v116, v68
  v_add_f32 v117, v117, v69
  v_add_f32 v118, v118, v70
  v_add_f32 v119, v119, v71
  v_add_f32 v116, v116, v72
  v_add_f32 v117, v117, v73
  v_add_f32 v118, v118, v74
  v_add_f32 v119, v119, v75
  v_add_f32 v116, v116, v76
  v_add_f32 v117, v117, v77
  v_add_f32 v118, v118, v78
  v_add_f32 v119, v119, v79
  v_add_f32 v116, v116, v80
  v_add_f32 v117, v117, v81
  v_add_f32 v118, v118, v82
  v_add_f32 v119, v119, v83
  v_add_f32 v116, v116, v84
  v_add_f32 v117, v117, v85
  v_add_f32 v118, v118, v86
  v_add_f32 v119, v119, v87
  v_add_f32 v116, v116, v88
  v_add_f32 v117, v117, v89
  v_add_f32 v118, v118, v90
  v_add_f32 v119, v119, v91
  v_add_f32 v116, v116, v92
  v_add_f32 v117, v117, v93
  v_add_f32 v118, v118, v94
  v_add_f32 v119, v119, v95
  v_add_f32 v116, v116, v96
  v_add_f32 v117, v117, v97
  v_add_f32 v118, v118, v98
  v_add_f32 v119, v119, v99
  v_add_f32 v116, v116, v100
  v_add_f32 v117, v117, v101
  v_add_f32 v118, v118, v102
  v_add_f32 v119, v119, v103
  v_add_f32 v116, v116, v104
  v_add_f32 v117, v117, v105
  v_add_f32 v118, v118, v106
  v_add_f32 v119, v119, v107
  v_add_f32 v116, v116, v108
  v_add_f32 v117, v117, v109
  v_add_f32 v118, v118, v110
  v_add_f32 v119, v119, v111
  v_add_f32 v116, v116, v112
  v_add_f32 v117, v117, v113
  v_add_f32 v118, v118, v114
  v_add_f32 v119, v119, v115
  v_add_f32 v116, v116, v117
  v_add_f32 v118, v118, v119
  v_add_f32 v116, v116, v118
  v_mov_b32 v117, v116
  s_nop 1
  v_permlane32_swap_b32 v116, v117
  v_add_f32 v116, v116, v117
  ds_write_b32 v4, v116
  s_waitcnt lgkmcnt(0)
  s_barrier
  ds_read_b32 v116, v5 offset:0
  ds_read_b32 v117, v5 offset:256
  ds_read_b32 v118, v5 offset:512
  ds_read_b32 v119, v5 offset:768
  s_waitcnt lgkmcnt(0)
  v_add_f32 v116, v116, v117
  v_add_f32 v118, v118, v119
  v_add_f32 v116, v116, v118
  v_mul_f32 v120, 0.001736111111111111, v116
  v_sub_f32 v124, v44, v120
  v_mul_f32 v116, v124, v124
  v_sub_f32 v125, v45, v120
  v_mul_f32 v117, v125, v125
  v_sub_f32 v126, v46, v120
  v_mul_f32 v118, v126, v126
  v_sub_f32 v127, v47, v120
  v_mul_f32 v119, v127, v127
  v_sub_f32 v128, v48, v120
  v_fmac_f32 v116, v128, v128
  v_sub_f32 v129, v49, v120
  v_fmac_f32 v117, v129, v129
  v_sub_f32 v130, v50, v120
  v_fmac_f32 v118, v130, v130
  v_sub_f32 v131, v51, v120
  v_fmac_f32 v119, v131, v131
  v_sub_f32 v124, v52, v120
  v_fmac_f32 v116, v124, v124
  v_sub_f32 v125, v53, v120
  v_fmac_f32 v117, v125, v125
  v_sub_f32 v126, v54, v120
  v_fmac_f32 v118, v126, v126
  v_sub_f32 v127, v55, v120
  v_fmac_f32 v119, v127, v127
  v_sub_f32 v128, v56, v120
  v_fmac_f32 v116, v128, v128
  v_sub_f32 v129, v57, v120
  v_fmac_f32 v117, v129, v129
  v_sub_f32 v130, v58, v120
  v_fmac_f32 v118, v130, v130
  v_sub_f32 v131, v59, v120
  v_fmac_f32 v119, v131, v131
  v_sub_f32 v124, v60, v120
  v_fmac_f32 v116, v124, v124
  v_sub_f32 v125, v61, v120
  v_fmac_f32 v117, v125, v125
  v_sub_f32 v126, v62, v120
  v_fmac_f32 v118, v126, v126
  v_sub_f32 v127, v63, v120
  v_fmac_f32 v119, v127, v127
  v_sub_f32 v128, v64, v120
  v_fmac_f32 v116, v128, v128
  v_sub_f32 v129, v65, v120
  v_fmac_f32 v117, v129, v129
  v_sub_f32 v130, v66, v120
  v_fmac_f32 v118, v130, v130
  v_sub_f32 v131, v67, v120
  v_fmac_f32 v119, v131, v131
  v_sub_f32 v124, v68, v120
  v_fmac_f32 v116, v124, v124
  v_sub_f32 v125, v69, v120
  v_fmac_f32 v117, v125, v125
  v_sub_f32 v126, v70, v120
  v_fmac_f32 v118, v126, v126
  v_sub_f32 v127, v71, v120
  v_fmac_f32 v119, v127, v127
  v_sub_f32 v128, v72, v120
  v_fmac_f32 v116, v128, v128
  v_sub_f32 v129, v73, v120
  v_fmac_f32 v117, v129, v129
  v_sub_f32 v130, v74, v120
  v_fmac_f32 v118, v130, v130
  v_sub_f32 v131, v75, v120
  v_fmac_f32 v119, v131, v131
  v_sub_f32 v124, v76, v120
  v_fmac_f32 v116, v124, v124
  v_sub_f32 v125, v77, v120
  v_fmac_f32 v117, v125, v125
  v_sub_f32 v126, v78, v120
  v_fmac_f32 v118, v126, v126
  v_sub_f32 v127, v79, v120
  v_fmac_f32 v119, v127, v127
  v_sub_f32 v128, v80, v120
  v_fmac_f32 v116, v128, v128
  v_sub_f32 v129, v81, v120
  v_fmac_f32 v117, v129, v129
  v_sub_f32 v130, v82, v120
  v_fmac_f32 v118, v130, v130
  v_sub_f32 v131, v83, v120
  v_fmac_f32 v119, v131, v131
  v_sub_f32 v124, v84, v120
  v_fmac_f32 v116, v124, v124
  v_sub_f32 v125, v85, v120
  v_fmac_f32 v117, v125, v125
  v_sub_f32 v126, v86, v120
  v_fmac_f32 v118, v126, v126
  v_sub_f32 v127, v87, v120
  v_fmac_f32 v119, v127, v127
  v_sub_f32 v128, v88, v120
  v_fmac_f32 v116, v128, v128
  v_sub_f32 v129, v89, v120
  v_fmac_f32 v117, v129, v129
  v_sub_f32 v130, v90, v120
  v_fmac_f32 v118, v130, v130
  v_sub_f32 v131, v91, v120
  v_fmac_f32 v119, v131, v131
  v_sub_f32 v124, v92, v120
  v_fmac_f32 v116, v124, v124
  v_sub_f32 v125, v93, v120
  v_fmac_f32 v117, v125, v125
  v_sub_f32 v126, v94, v120
  v_fmac_f32 v118, v126, v126
  v_sub_f32 v127, v95, v120
  v_fmac_f32 v119, v127, v127
  v_sub_f32 v128, v96, v120
  v_fmac_f32 v116, v128, v128
  v_sub_f32 v129, v97, v120
  v_fmac_f32 v117, v129, v129
  v_sub_f32 v130, v98, v120
  v_fmac_f32 v118, v130, v130
  v_sub_f32 v131, v99, v120
  v_fmac_f32 v119, v131, v131
  v_sub_f32 v124, v100, v120
  v_fmac_f32 v116, v124, v124
  v_sub_f32 v125, v101, v120
  v_fmac_f32 v117, v125, v125
  v_sub_f32 v126, v102, v120
  v_fmac_f32 v118, v126, v126
  v_sub_f32 v127, v103, v120
  v_fmac_f32 v119, v127, v127
  v_sub_f32 v128, v104, v120
  v_fmac_f32 v116, v128, v128
  v_sub_f32 v129, v105, v120
  v_fmac_f32 v117, v129, v129
  v_sub_f32 v130, v106, v120
  v_fmac_f32 v118, v130, v130
  v_sub_f32 v131, v107, v120
  v_fmac_f32 v119, v131, v131
  v_sub_f32 v124, v108, v120
  v_fmac_f32 v116, v124, v124
  v_sub_f32 v125, v109, v120
  v_fmac_f32 v117, v125, v125
  v_sub_f32 v126, v110, v120
  v_fmac_f32 v118, v126, v126
  v_sub_f32 v127, v111, v120
  v_fmac_f32 v119, v127, v127
  v_sub_f32 v128, v112, v120
  v_fmac_f32 v116, v128, v128
  v_sub_f32 v129, v113, v120
  v_fmac_f32 v117, v129, v129
  v_sub_f32 v130, v114, v120
  v_fmac_f32 v118, v130, v130
  v_sub_f32 v131, v115, v120
  v_fmac_f32 v119, v131, v131
  v_add_f32 v116, v116, v117
  v_add_f32 v118, v118, v119
  v_add_f32 v116, v116, v118
  v_mov_b32 v117, v116
  s_nop 1
  v_permlane32_swap_b32 v116, v117
  v_add_f32 v116, v116, v117
  ds_write_b32 v4, v116 offset:1024
  s_waitcnt lgkmcnt(0)
  s_barrier
  ds_read_b32 v116, v5 offset:1024
  ds_read_b32 v117, v5 offset:1280
  ds_read_b32 v118, v5 offset:1536
  ds_read_b32 v119, v5 offset:1792
  s_waitcnt lgkmcnt(0)
  v_add_f32 v116, v116, v117
  v_add_f32 v118, v118, v119
  v_add_f32 v116, v116, v118
  v_mul_f32 v121, 0.001736111111111111, v116
  v_cvt_pk_bf16_f32 v122, v120, v121
  v_lshlrev_b32 v120, 16, v122
  v_and_b32 v121, 0xffff0000, v122
  v_add_f32 v121, 0x3727c5ac, v121
  v_cvt_pk_bf16_f32 v122, v121, v121
  v_lshlrev_b32 v121, 16, v122
  v_sqrt_f32 v121, v121
  s_nop 0
  v_cvt_pk_bf16_f32 v122, v121, v121
  v_lshlrev_b32 v121, 16, v122
  v_rcp_f32 v121, v121
  v_sub_f32 v44, v44, v120
  v_sub_f32 v45, v45, v120
  v_cvt_pk_bf16_f32 v124, v44, v45
  v_lshlrev_b32 v44, 16, v124
  v_and_b32 v45, 0xffff0000, v124
  v_mul_f32 v44, v44, v121
  v_mul_f32 v45, v45, v121
  v_cvt_pk_bf16_f32 v8, v44, v45
  v_sub_f32 v46, v46, v120
  v_sub_f32 v47, v47, v120
  v_cvt_pk_bf16_f32 v126, v46, v47
  v_lshlrev_b32 v46, 16, v126
  v_and_b32 v47, 0xffff0000, v126
  v_mul_f32 v46, v46, v121
  v_mul_f32 v47, v47, v121
  v_cvt_pk_bf16_f32 v9, v46, v47
  v_sub_f32 v48, v48, v120
  v_sub_f32 v49, v49, v120
  v_cvt_pk_bf16_f32 v124, v48, v49
  v_lshlrev_b32 v48, 16, v124
  v_and_b32 v49, 0xffff0000, v124
  v_mul_f32 v48, v48, v121
  v_mul_f32 v49, v49, v121
  v_cvt_pk_bf16_f32 v10, v48, v49
  v_sub_f32 v50, v50, v120
  v_sub_f32 v51, v51, v120
  v_cvt_pk_bf16_f32 v126, v50, v51
  v_lshlrev_b32 v50, 16, v126
  v_and_b32 v51, 0xffff0000, v126
  v_mul_f32 v50, v50, v121
  v_mul_f32 v51, v51, v121
  v_cvt_pk_bf16_f32 v11, v50, v51
  s_add_u32 s22, s21, 0
  buffer_store_dwordx4 v[8:11], v6, s[4:7], s22 offen sc1
  v_sub_f32 v52, v52, v120
  v_sub_f32 v53, v53, v120
  v_cvt_pk_bf16_f32 v124, v52, v53
  v_lshlrev_b32 v52, 16, v124
  v_and_b32 v53, 0xffff0000, v124
  v_mul_f32 v52, v52, v121
  v_mul_f32 v53, v53, v121
  v_cvt_pk_bf16_f32 v12, v52, v53
  v_sub_f32 v54, v54, v120
  v_sub_f32 v55, v55, v120
  v_cvt_pk_bf16_f32 v126, v54, v55
  v_lshlrev_b32 v54, 16, v126
  v_and_b32 v55, 0xffff0000, v126
  v_mul_f32 v54, v54, v121
  v_mul_f32 v55, v55, v121
  v_cvt_pk_bf16_f32 v13, v54, v55
  v_sub_f32 v56, v56, v120
  v_sub_f32 v57, v57, v120
  v_cvt_pk_bf16_f32 v124, v56, v57
  v_lshlrev_b32 v56, 16, v124
  v_and_b32 v57, 0xffff0000, v124
  v_mul_f32 v56, v56, v121
  v_mul_f32 v57, v57, v121
  v_cvt_pk_bf16_f32 v14, v56, v57
  v_sub_f32 v58, v58, v120
  v_sub_f32 v59, v59, v120
  v_cvt_pk_bf16_f32 v126, v58, v59
  v_lshlrev_b32 v58, 16, v126
  v_and_b32 v59, 0xffff0000, v126
  v_mul_f32 v58, v58, v121
  v_mul_f32 v59, v59, v121
  v_cvt_pk_bf16_f32 v15, v58, v59
  s_add_u32 s22, s21, 1024
  buffer_store_dwordx4 v[12:15], v6, s[4:7], s22 offen sc1
  v_sub_f32 v60, v60, v120
  v_sub_f32 v61, v61, v120
  v_cvt_pk_bf16_f32 v124, v60, v61
  v_lshlrev_b32 v60, 16, v124
  v_and_b32 v61, 0xffff0000, v124
  v_mul_f32 v60, v60, v121
  v_mul_f32 v61, v61, v121
  v_cvt_pk_bf16_f32 v16, v60, v61
  v_sub_f32 v62, v62, v120
  v_sub_f32 v63, v63, v120
  v_cvt_pk_bf16_f32 v126, v62, v63
  v_lshlrev_b32 v62, 16, v126
  v_and_b32 v63, 0xffff0000, v126
  v_mul_f32 v62, v62, v121
  v_mul_f32 v63, v63, v121
  v_cvt_pk_bf16_f32 v17, v62, v63
  v_sub_f32 v64, v64, v120
  v_sub_f32 v65, v65, v120
  v_cvt_pk_bf16_f32 v124, v64, v65
  v_lshlrev_b32 v64, 16, v124
  v_and_b32 v65, 0xffff0000, v124
  v_mul_f32 v64, v64, v121
  v_mul_f32 v65, v65, v121
  v_cvt_pk_bf16_f32 v18, v64, v65
  v_sub_f32 v66, v66, v120
  v_sub_f32 v67, v67, v120
  v_cvt_pk_bf16_f32 v126, v66, v67
  v_lshlrev_b32 v66, 16, v126
  v_and_b32 v67, 0xffff0000, v126
  v_mul_f32 v66, v66, v121
  v_mul_f32 v67, v67, v121
  v_cvt_pk_bf16_f32 v19, v66, v67
  s_add_u32 s22, s21, 2048
  buffer_store_dwordx4 v[16:19], v6, s[4:7], s22 offen sc1
  v_sub_f32 v68, v68, v120
  v_sub_f32 v69, v69, v120
  v_cvt_pk_bf16_f32 v124, v68, v69
  v_lshlrev_b32 v68, 16, v124
  v_and_b32 v69, 0xffff0000, v124
  v_mul_f32 v68, v68, v121
  v_mul_f32 v69, v69, v121
  v_cvt_pk_bf16_f32 v20, v68, v69
  v_sub_f32 v70, v70, v120
  v_sub_f32 v71, v71, v120
  v_cvt_pk_bf16_f32 v126, v70, v71
  v_lshlrev_b32 v70, 16, v126
  v_and_b32 v71, 0xffff0000, v126
  v_mul_f32 v70, v70, v121
  v_mul_f32 v71, v71, v121
  v_cvt_pk_bf16_f32 v21, v70, v71
  v_sub_f32 v72, v72, v120
  v_sub_f32 v73, v73, v120
  v_cvt_pk_bf16_f32 v124, v72, v73
  v_lshlrev_b32 v72, 16, v124
  v_and_b32 v73, 0xffff0000, v124
  v_mul_f32 v72, v72, v121
  v_mul_f32 v73, v73, v121
  v_cvt_pk_bf16_f32 v22, v72, v73
  v_sub_f32 v74, v74, v120
  v_sub_f32 v75, v75, v120
  v_cvt_pk_bf16_f32 v126, v74, v75
  v_lshlrev_b32 v74, 16, v126
  v_and_b32 v75, 0xffff0000, v126
  v_mul_f32 v74, v74, v121
  v_mul_f32 v75, v75, v121
  v_cvt_pk_bf16_f32 v23, v74, v75
  s_add_u32 s22, s21, 3072
  buffer_store_dwordx4 v[20:23], v6, s[4:7], s22 offen sc1
  v_sub_f32 v76, v76, v120
  v_sub_f32 v77, v77, v120
  v_cvt_pk_bf16_f32 v124, v76, v77
  v_lshlrev_b32 v76, 16, v124
  v_and_b32 v77, 0xffff0000, v124
  v_mul_f32 v76, v76, v121
  v_mul_f32 v77, v77, v121
  v_cvt_pk_bf16_f32 v24, v76, v77
  v_sub_f32 v78, v78, v120
  v_sub_f32 v79, v79, v120
  v_cvt_pk_bf16_f32 v126, v78, v79
  v_lshlrev_b32 v78, 16, v126
  v_and_b32 v79, 0xffff0000, v126
  v_mul_f32 v78, v78, v121
  v_mul_f32 v79, v79, v121
  v_cvt_pk_bf16_f32 v25, v78, v79
  v_sub_f32 v80, v80, v120
  v_sub_f32 v81, v81, v120
  v_cvt_pk_bf16_f32 v124, v80, v81
  v_lshlrev_b32 v80, 16, v124
  v_and_b32 v81, 0xffff0000, v124
  v_mul_f32 v80, v80, v121
  v_mul_f32 v81, v81, v121
  v_cvt_pk_bf16_f32 v26, v80, v81
  v_sub_f32 v82, v82, v120
  v_sub_f32 v83, v83, v120
  v_cvt_pk_bf16_f32 v126, v82, v83
  v_lshlrev_b32 v82, 16, v126
  v_and_b32 v83, 0xffff0000, v126
  v_mul_f32 v82, v82, v121
  v_mul_f32 v83, v83, v121
  v_cvt_pk_bf16_f32 v27, v82, v83
  s_add_u32 s22, s21, 4096
  buffer_store_dwordx4 v[24:27], v6, s[4:7], s22 offen sc1
  v_sub_f32 v84, v84, v120
  v_sub_f32 v85, v85, v120
  v_cvt_pk_bf16_f32 v124, v84, v85
  v_lshlrev_b32 v84, 16, v124
  v_and_b32 v85, 0xffff0000, v124
  v_mul_f32 v84, v84, v121
  v_mul_f32 v85, v85, v121
  v_cvt_pk_bf16_f32 v28, v84, v85
  v_sub_f32 v86, v86, v120
  v_sub_f32 v87, v87, v120
  v_cvt_pk_bf16_f32 v126, v86, v87
  v_lshlrev_b32 v86, 16, v126
  v_and_b32 v87, 0xffff0000, v126
  v_mul_f32 v86, v86, v121
  v_mul_f32 v87, v87, v121
  v_cvt_pk_bf16_f32 v29, v86, v87
  v_sub_f32 v88, v88, v120
  v_sub_f32 v89, v89, v120
  v_cvt_pk_bf16_f32 v124, v88, v89
  v_lshlrev_b32 v88, 16, v124
  v_and_b32 v89, 0xffff0000, v124
  v_mul_f32 v88, v88, v121
  v_mul_f32 v89, v89, v121
  v_cvt_pk_bf16_f32 v30, v88, v89
  v_sub_f32 v90, v90, v120
  v_sub_f32 v91, v91, v120
  v_cvt_pk_bf16_f32 v126, v90, v91
  v_lshlrev_b32 v90, 16, v126
  v_and_b32 v91, 0xffff0000, v126
  v_mul_f32 v90, v90, v121
  v_mul_f32 v91, v91, v121
  v_cvt_pk_bf16_f32 v31, v90, v91
  s_add_u32 s22, s21, 5120
  buffer_store_dwordx4 v[28:31], v6, s[4:7], s22 offen sc1
  v_sub_f32 v92, v92, v120
  v_sub_f32 v93, v93, v120
  v_cvt_pk_bf16_f32 v124, v92, v93
  v_lshlrev_b32 v92, 16, v124
  v_and_b32 v93, 0xffff0000, v124
  v_mul_f32 v92, v92, v121
  v_mul_f32 v93, v93, v121
  v_cvt_pk_bf16_f32 v32, v92, v93
  v_sub_f32 v94, v94, v120
  v_sub_f32 v95, v95, v120
  v_cvt_pk_bf16_f32 v126, v94, v95
  v_lshlrev_b32 v94, 16, v126
  v_and_b32 v95, 0xffff0000, v126
  v_mul_f32 v94, v94, v121
  v_mul_f32 v95, v95, v121
  v_cvt_pk_bf16_f32 v33, v94, v95
  v_sub_f32 v96, v96, v120
  v_sub_f32 v97, v97, v120
  v_cvt_pk_bf16_f32 v124, v96, v97
  v_lshlrev_b32 v96, 16, v124
  v_and_b32 v97, 0xffff0000, v124
  v_mul_f32 v96, v96, v121
  v_mul_f32 v97, v97, v121
  v_cvt_pk_bf16_f32 v34, v96, v97
  v_sub_f32 v98, v98, v120
  v_sub_f32 v99, v99, v120
  v_cvt_pk_bf16_f32 v126, v98, v99
  v_lshlrev_b32 v98, 16, v126
  v_and_b32 v99, 0xffff0000, v126
  v_mul_f32 v98, v98, v121
  v_mul_f32 v99, v99, v121
  v_cvt_pk_bf16_f32 v35, v98, v99
  s_add_u32 s22, s21, 6144
  buffer_store_dwordx4 v[32:35], v6, s[4:7], s22 offen sc1
  v_sub_f32 v100, v100, v120
  v_sub_f32 v101, v101, v120
  v_cvt_pk_bf16_f32 v124, v100, v101
  v_lshlrev_b32 v100, 16, v124
  v_and_b32 v101, 0xffff0000, v124
  v_mul_f32 v100, v100, v121
  v_mul_f32 v101, v101, v121
  v_cvt_pk_bf16_f32 v36, v100, v101
  v_sub_f32 v102, v102, v120
  v_sub_f32 v103, v103, v120
  v_cvt_pk_bf16_f32 v126, v102, v103
  v_lshlrev_b32 v102, 16, v126
  v_and_b32 v103, 0xffff0000, v126
  v_mul_f32 v102, v102, v121
  v_mul_f32 v103, v103, v121
  v_cvt_pk_bf16_f32 v37, v102, v103
  v_sub_f32 v104, v104, v120
  v_sub_f32 v105, v105, v120
  v_cvt_pk_bf16_f32 v124, v104, v105
  v_lshlrev_b32 v104, 16, v124
  v_and_b32 v105, 0xffff0000, v124
  v_mul_f32 v104, v104, v121
  v_mul_f32 v105, v105, v121
  v_cvt_pk_bf16_f32 v38, v104, v105
  v_sub_f32 v106, v106, v120
  v_sub_f32 v107, v107, v120
  v_cvt_pk_bf16_f32 v126, v106, v107
  v_lshlrev_b32 v106, 16, v126
  v_and_b32 v107, 0xffff0000, v126
  v_mul_f32 v106, v106, v121
  v_mul_f32 v107, v107, v121
  v_cvt_pk_bf16_f32 v39, v106, v107
  s_add_u32 s22, s21, 7168
  buffer_store_dwordx4 v[36:39], v6, s[4:7], s22 offen sc1
  v_sub_f32 v108, v108, v120
  v_sub_f32 v109, v109, v120
  v_cvt_pk_bf16_f32 v124, v108, v109
  v_lshlrev_b32 v108, 16, v124
  v_and_b32 v109, 0xffff0000, v124
  v_mul_f32 v108, v108, v121
  v_mul_f32 v109, v109, v121
  v_cvt_pk_bf16_f32 v40, v108, v109
  v_sub_f32 v110, v110, v120
  v_sub_f32 v111, v111, v120
  v_cvt_pk_bf16_f32 v126, v110, v111
  v_lshlrev_b32 v110, 16, v126
  v_and_b32 v111, 0xffff0000, v126
  v_mul_f32 v110, v110, v121
  v_mul_f32 v111, v111, v121
  v_cvt_pk_bf16_f32 v41, v110, v111
  v_sub_f32 v112, v112, v120
  v_sub_f32 v113, v113, v120
  v_cvt_pk_bf16_f32 v124, v112, v113
  v_lshlrev_b32 v112, 16, v124
  v_and_b32 v113, 0xffff0000, v124
  v_mul_f32 v112, v112, v121
  v_mul_f32 v113, v113, v121
  v_cvt_pk_bf16_f32 v42, v112, v113
  v_sub_f32 v114, v114, v120
  v_sub_f32 v115, v115, v120
  v_cvt_pk_bf16_f32 v126, v114, v115
  v_lshlrev_b32 v114, 16, v126
  v_and_b32 v115, 0xffff0000, v126
  v_mul_f32 v114, v114, v121
  v_mul_f32 v115, v115, v121
  v_cvt_pk_bf16_f32 v43, v114, v115
  s_add_u32 s22, s21, 8192
  buffer_store_dwordx4 v[40:43], v6, s[4:7], s22 offen sc1
  s_waitcnt vmcnt(0)
  s_cmp_lg_u32 s17, 0
  s_cbranch_scc1 L_zf_22
  s_lshl_b32 s92, s30, 10
  s_add_u32 s92, s92, 0
  v_mov_b32 v8, 0
  v_mov_b32 v9, 0
  v_mov_b32 v10, 0
  v_mov_b32 v11, 0
  buffer_store_dwordx4 v[8:11], v6, s[4:7], s92 offen sc1
  s_waitcnt vmcnt(0)
L_zf_22:
  s_barrier
  s_cmp_lg_u32 s17, 0
  s_cbranch_scc1 L_lna_23
  s_mov_b64 exec, 1
  v_mov_b32 v8, 1
  buffer_atomic_add v8, off, s[12:15], 0 offset:128 sc1
  s_mov_b64 exec, -1
L_lna_23:
  s_mov_b32 s30, 0
  s_cmp_lt_u32 s96, 32
  s_cbranch_scc1 L_r_fol
  s_sub_u32 s96, s96, 32
  s_lshr_b32 s30, s96, 4
  s_add_u32 s30, s30, 1
L_r_fol:
  s_and_b32 s18, s96, 15
  s_lshr_b32 s19, s96, 4
  s_cmp_eq_u32 s30, 0
  s_cselect_b32 s20, s19, 63
  s_cselect_b32 s19, s19, 1
  s_cselect_b32 s29, 0, 31
  v_and_b32 v5, 63, v0
  v_lshlrev_b32 v1, 4, v5
  s_load_dwordx2 s[8:9], s[0:1], 40
  s_waitcnt lgkmcnt(0)
  s_and_b32 s9, s9, 0xffff
  s_mov_b32 s10, 4718592
  s_mov_b32 s11, 0x00020000
  v_add_u32 v6, 0, v5
  v_mul_u32_u24 v7, 3641, v6
  v_lshrrev_b32 v7, 16, v7
  v_mul_u32_u24 v8, 18, v7
  v_sub_u32 v8, v6, v8
  v_mul_u32_u24 v7, 1152, v7
  v_lshl_add_u32 v10, v8, 4, v7
  v_add_u32 v6, 64, v5
  v_mul_u32_u24 v7, 3641, v6
  v_lshrrev_b32 v7, 16, v7
  v_mul_u32_u24 v8, 18, v7
  v_sub_u32 v8, v6, v8
  v_mul_u32_u24 v7, 1152, v7
  v_lshl_add_u32 v11, v8, 4, v7
  v_add_u32 v6, 128, v5
  v_mul_u32_u24 v7, 3641, v6
  v_lshrrev_b32 v7, 16, v7
  v_mul_u32_u24 v8, 18, v7
  v_sub_u32 v8, v6, v8
  v_mul_u32_u24 v7, 1152, v7
  v_lshl_add_u32 v12, v8, 4, v7
  v_add_u32 v6, 192, v5
  v_mul_u32_u24 v7, 3641, v6
  v_lshrrev_b32 v7, 16, v7
  v_mul_u32_u24 v8, 18, v7
  v_sub_u32 v8, v6, v8
  v_mul_u32_u24 v7, 1152, v7
  v_lshl_add_u32 v13, v8, 4, v7
  v_add_u32 v6, 256, v5
  v_mul_u32_u24 v7, 3641, v6
  v_lshrrev_b32 v7, 16, v7
  v_mul_u32_u24 v8, 18, v7
  v_sub_u32 v8, v6, v8
  v_mul_u32_u24 v7, 1152, v7
  v_lshl_add_u32 v14, v8, 4, v7
  v_add_u32 v6, 320, v5
  v_mul_u32_u24 v7, 3641, v6
  v_lshrrev_b32 v7, 16, v7
  v_mul_u32_u24 v8, 18, v7
  v_sub_u32 v8, v6, v8
  v_mul_u32_u24 v7, 1152, v7
  v_lshl_add_u32 v15, v8, 4, v7
  v_add_u32 v6, 384, v5
  v_mul_u32_u24 v7, 3641, v6
  v_lshrrev_b32 v7, 16, v7
  v_mul_u32_u24 v8, 18, v7
  v_sub_u32 v8, v6, v8
  v_mul_u32_u24 v7, 1152, v7
  v_lshl_add_u32 v16, v8, 4, v7
  v_add_u32 v6, 448, v5
  v_mul_u32_u24 v7, 3641, v6
  v_lshrrev_b32 v7, 16, v7
  v_mul_u32_u24 v8, 18, v7
  v_sub_u32 v8, v6, v8
  v_mul_u32_u24 v7, 1152, v7
  v_lshl_add_u32 v17, v8, 4, v7
  v_add_u32 v6, 512, v5
  v_mul_u32_u24 v7, 3641, v6
  v_lshrrev_b32 v7, 16, v7
  v_mul_u32_u24 v8, 18, v7
  v_sub_u32 v8, v6, v8
  v_mul_u32_u24 v7, 1152, v7
  v_lshl_add_u32 v18, v8, 4, v7
  s_mul_i32 s21, s18, 294912
  s_mul_i32 s22, s17, 288
  s_add_u32 s21, s21, s22
  s_mul_i32 s22, s17, 36864
  v_lshrrev_b32 v6, 4, v5
  v_lshlrev_b32 v6, 2, v6
  v_bfe_u32 v7, v5, 2, 2
  v_add_u32 v6, v6, v7
  v_mul_u32_u24 v6, 288, v6
  v_and_b32 v7, 3, v5
  v_lshl_add_u32 v6, v7, 3, v6
  v_add_u32 v6, s22, v6
  s_mul_i32 s23, s30, 96
  v_add_u32 v6, s23, v6
  s_add_u32 m0, s22, 0
  s_nop 0
  buffer_load_dwordx4 v10, s[8:11], s21 offen lds
  s_add_u32 m0, s22, 1024
  s_nop 0
  buffer_load_dwordx4 v11, s[8:11], s21 offen lds
  s_add_u32 m0, s22, 2048
  s_nop 0
  buffer_load_dwordx4 v12, s[8:11], s21 offen lds
  s_add_u32 m0, s22, 3072
  s_nop 0
  buffer_load_dwordx4 v13, s[8:11], s21 offen lds
  s_add_u32 m0, s22, 4096
  s_nop 0
  buffer_load_dwordx4 v14, s[8:11], s21 offen lds
  s_add_u32 m0, s22, 5120
  s_nop 0
  buffer_load_dwordx4 v15, s[8:11], s21 offen lds
  s_add_u32 m0, s22, 6144
  s_nop 0
  buffer_load_dwordx4 v16, s[8:11], s21 offen lds
  s_add_u32 m0, s22, 7168
  s_nop 0
  buffer_load_dwordx4 v17, s[8:11], s21 offen lds
  s_add_u32 m0, s22, 8192
  s_nop 0
  buffer_load_dwordx4 v18, s[8:11], s21 offen lds
  s_add_u32 s21, s21, 36864
  s_add_u32 m0, s22, 9216
  s_nop 0
  buffer_load_dwordx4 v10, s[8:11], s21 offen lds
  s_add_u32 m0, s22, 10240
  s_nop 0
  buffer_load_dwordx4 v11, s[8:11], s21 offen lds
  s_add_u32 m0, s22, 11264
  s_nop 0
  buffer_load_dwordx4 v12, s[8:11], s21 offen lds
  s_add_u32 m0, s22, 12288
  s_nop 0
  buffer_load_dwordx4 v13, s[8:11], s21 offen lds
  s_add_u32 m0, s22, 13312
  s_nop 0
  buffer_load_dwordx4 v14, s[8:11], s21 offen lds
  s_add_u32 m0, s22, 14336
  s_nop 0
  buffer_load_dwordx4 v15, s[8:11], s21 offen lds
  s_add_u32 m0, s22, 15360
  s_nop 0
  buffer_load_dwordx4 v16, s[8:11], s21 offen lds
  s_add_u32 m0, s22, 16384
  s_nop 0
  buffer_load_dwordx4 v17, s[8:11], s21 offen lds
  s_add_u32 m0, s22, 17408
  s_nop 0
  buffer_load_dwordx4 v18, s[8:11], s21 offen lds
  s_add_u32 s21, s21, 36864
  s_add_u32 m0, s22, 18432
  s_nop 0
  buffer_load_dwordx4 v10, s[8:11], s21 offen lds
  s_add_u32 m0, s22, 19456
  s_nop 0
  buffer_load_dwordx4 v11, s[8:11], s21 offen lds
  s_add_u32 m0, s22, 20480
  s_nop 0
  buffer_load_dwordx4 v12, s[8:11], s21 offen lds
  s_add_u32 m0, s22, 21504
  s_nop 0
  buffer_load_dwordx4 v13, s[8:11], s21 offen lds
  s_add_u32 m0, s22, 22528
  s_nop 0
  buffer_load_dwordx4 v14, s[8:11], s21 offen lds
  s_add_u32 m0, s22, 23552
  s_nop 0
  buffer_load_dwordx4 v15, s[8:11], s21 offen lds
  s_add_u32 m0, s22, 24576
  s_nop 0
  buffer_load_dwordx4 v16, s[8:11], s21 offen lds
  s_add_u32 m0, s22, 25600
  s_nop 0
  buffer_load_dwordx4 v17, s[8:11], s21 offen lds
  s_add_u32 m0, s22, 26624
  s_nop 0
  buffer_load_dwordx4 v18, s[8:11], s21 offen lds
  s_add_u32 s21, s21, 36864
  s_add_u32 m0, s22, 27648
  s_nop 0
  buffer_load_dwordx4 v10, s[8:11], s21 offen lds
  s_add_u32 m0, s22, 28672
  s_nop 0
  buffer_load_dwordx4 v11, s[8:11], s21 offen lds
  s_add_u32 m0, s22, 29696
  s_nop 0
  buffer_load_dwordx4 v12, s[8:11], s21 offen lds
  s_add_u32 m0, s22, 30720
  s_nop 0
  buffer_load_dwordx4 v13, s[8:11], s21 offen lds
  s_add_u32 m0, s22, 31744
  s_nop 0
  buffer_load_dwordx4 v14, s[8:11], s21 offen lds
  s_add_u32 m0, s22, 32768
  s_nop 0
  buffer_load_dwordx4 v15, s[8:11], s21 offen lds
  s_add_u32 m0, s22, 33792
  s_nop 0
  buffer_load_dwordx4 v16, s[8:11], s21 offen lds
  s_add_u32 m0, s22, 34816
  s_nop 0
  buffer_load_dwordx4 v17, s[8:11], s21 offen lds
  s_add_u32 m0, s22, 35840
  s_nop 0
  buffer_load_dwordx4 v18, s[8:11], s21 offen lds
  s_add_u32 s21, s21, 36864
  s_waitcnt vmcnt(27)
  ds_read_b64_tr_b16 a[0:1], v6 offset:0
  ds_read_b64_tr_b16 a[2:3], v6 offset:4608
  ds_read_b64_tr_b16 a[32:33], v6 offset:32
  ds_read_b64_tr_b16 a[34:35], v6 offset:4640
  ds_read_b64_tr_b16 a[64:65], v6 offset:64
  ds_read_b64_tr_b16 a[66:67], v6 offset:4672
  ds_read_b64_tr_b16 a[96:97], v6 offset:96
  ds_read_b64_tr_b16 a[98:99], v6 offset:4704
  ds_read_b64_tr_b16 a[128:129], v6 offset:128
  ds_read_b64_tr_b16 a[130:131], v6 offset:4736
  ds_read_b64_tr_b16 a[160:161], v6 offset:160
  ds_read_b64_tr_b16 a[162:163], v6 offset:4768
  ds_read_b64_tr_b16 a[192:193], v6 offset:192
  ds_read_b64_tr_b16 a[194:195], v6 offset:4800
  ds_read_b64_tr_b16 a[224:225], v6 offset:224
  ds_read_b64_tr_b16 a[226:227], v6 offset:4832
  ds_read_b64_tr_b16 v[224:225], v6 offset:256
  ds_read_b64_tr_b16 v[226:227], v6 offset:4864
  s_waitcnt lgkmcnt(0)
  s_waitcnt vmcnt(18)
  ds_read_b64_tr_b16 a[4:5], v6 offset:9216
  ds_read_b64_tr_b16 a[6:7], v6 offset:13824
  ds_read_b64_tr_b16 a[36:37], v6 offset:9248
  ds_read_b64_tr_b16 a[38:39], v6 offset:13856
  ds_read_b64_tr_b16 a[68:69], v6 offset:9280
  ds_read_b64_tr_b16 a[70:71], v6 offset:13888
  ds_read_b64_tr_b16 a[100:101], v6 offset:9312
  ds_read_b64_tr_b16 a[102:103], v6 offset:13920
  ds_read_b64_tr_b16 a[132:133], v6 offset:9344
  ds_read_b64_tr_b16 a[134:135], v6 offset:13952
  ds_read_b64_tr_b16 a[164:165], v6 offset:9376
  ds_read_b64_tr_b16 a[166:167], v6 offset:13984
  ds_read_b64_tr_b16 a[196:197], v6 offset:9408
  ds_read_b64_tr_b16 a[198:199], v6 offset:14016
  ds_read_b64_tr_b16 a[228:229], v6 offset:9440
  ds_read_b64_tr_b16 a[230:231], v6 offset:14048
  ds_read_b64_tr_b16 v[228:229], v6 offset:9472
  ds_read_b64_tr_b16 v[230:231], v6 offset:14080
  s_waitcnt lgkmcnt(0)
  s_waitcnt vmcnt(9)
  ds_read_b64_tr_b16 a[8:9], v6 offset:18432
  ds_read_b64_tr_b16 a[10:11], v6 offset:23040
  ds_read_b64_tr_b16 a[40:41], v6 offset:18464
  ds_read_b64_tr_b16 a[42:43], v6 offset:23072
  ds_read_b64_tr_b16 a[72:73], v6 offset:18496
  ds_read_b64_tr_b16 a[74:75], v6 offset:23104
  ds_read_b64_tr_b16 a[104:105], v6 offset:18528
  ds_read_b64_tr_b16 a[106:107], v6 offset:23136
  ds_read_b64_tr_b16 a[136:137], v6 offset:18560
  ds_read_b64_tr_b16 a[138:139], v6 offset:23168
  ds_read_b64_tr_b16 a[168:169], v6 offset:18592
  ds_read_b64_tr_b16 a[170:171], v6 offset:23200
  ds_read_b64_tr_b16 a[200:201], v6 offset:18624
  ds_read_b64_tr_b16 a[202:203], v6 offset:23232
  ds_read_b64_tr_b16 a[232:233], v6 offset:18656
  ds_read_b64_tr_b16 a[234:235], v6 offset:23264
  ds_read_b64_tr_b16 v[232:233], v6 offset:18688
  ds_read_b64_tr_b16 v[234:235], v6 offset:23296
  s_waitcnt lgkmcnt(0)
  s_waitcnt vmcnt(0)
  ds_read_b64_tr_b16 a[12:13], v6 offset:27648
  ds_read_b64_tr_b16 a[14:15], v6 offset:32256
  ds_read_b64_tr_b16 a[44:45], v6 offset:27680
  ds_read_b64_tr_b16 a[46:47], v6 offset:32288
  ds_read_b64_tr_b16 a[76:77], v6 offset:27712
  ds_read_b64_tr_b16 a[78:79], v6 offset:32320
  ds_read_b64_tr_b16 a[108:109], v6 offset:27744
  ds_read_b64_tr_b16 a[110:111], v6 offset:32352
  ds_read_b64_tr_b16 a[140:141], v6 offset:27776
  ds_read_b64_tr_b16 a[142:143], v6 offset:32384
  ds_read_b64_tr_b16 a[172:173], v6 offset:27808
  ds_read_b64_tr_b16 a[174:175], v6 offset:32416
  ds_read_b64_tr_b16 a[204:205], v6 offset:27840
  ds_read_b64_tr_b16 a[206:207], v6 offset:32448
  ds_read_b64_tr_b16 a[236:237], v6 offset:27872
  ds_read_b64_tr_b16 a[238:239], v6 offset:32480
  ds_read_b64_tr_b16 v[236:237], v6 offset:27904
  ds_read_b64_tr_b16 v[238:239], v6 offset:32512
  s_waitcnt lgkmcnt(0)
  s_add_u32 m0, s22, 0
  s_nop 0
  buffer_load_dwordx4 v10, s[8:11], s21 offen lds
  s_add_u32 m0, s22, 1024
  s_nop 0
  buffer_load_dwordx4 v11, s[8:11], s21 offen lds
  s_add_u32 m0, s22, 2048
  s_nop 0
  buffer_load_dwordx4 v12, s[8:11], s21 offen lds
  s_add_u32 m0, s22, 3072
  s_nop 0
  buffer_load_dwordx4 v13, s[8:11], s21 offen lds
  s_add_u32 m0, s22, 4096
  s_nop 0
  buffer_load_dwordx4 v14, s[8:11], s21 offen lds
  s_add_u32 m0, s22, 5120
  s_nop 0
  buffer_load_dwordx4 v15, s[8:11], s21 offen lds
  s_add_u32 m0, s22, 6144
  s_nop 0
  buffer_load_dwordx4 v16, s[8:11], s21 offen lds
  s_add_u32 m0, s22, 7168
  s_nop 0
  buffer_load_dwordx4 v17, s[8:11], s21 offen lds
  s_add_u32 m0, s22, 8192
  s_nop 0
  buffer_load_dwordx4 v18, s[8:11], s21 offen lds
  s_add_u32 s21, s21, 36864
  s_add_u32 m0, s22, 9216
  s_nop 0
  buffer_load_dwordx4 v10, s[8:11], s21 offen lds
  s_add_u32 m0, s22, 10240
  s_nop 0
  buffer_load_dwordx4 v11, s[8:11], s21 offen lds
  s_add_u32 m0, s22, 11264
  s_nop 0
  buffer_load_dwordx4 v12, s[8:11], s21 offen lds
  s_add_u32 m0, s22, 12288
  s_nop 0
  buffer_load_dwordx4 v13, s[8:11], s21 offen lds
  s_add_u32 m0, s22, 13312
  s_nop 0
  buffer_load_dwordx4 v14, s[8:11], s21 offen lds
  s_add_u32 m0, s22, 14336
  s_nop 0
  buffer_load_dwordx4 v15, s[8:11], s21 offen lds
  s_add_u32 m0, s22, 15360
  s_nop 0
  buffer_load_dwordx4 v16, s[8:11], s21 offen lds
  s_add_u32 m0, s22, 16384
  s_nop 0
  buffer_load_dwordx4 v17, s[8:11], s21 offen lds
  s_add_u32 m0, s22, 17408
  s_nop 0
  buffer_load_dwordx4 v18, s[8:11], s21 offen lds
  s_add_u32 s21, s21, 36864
  s_add_u32 m0, s22, 18432
  s_nop 0
  buffer_load_dwordx4 v10, s[8:11], s21 offen lds
  s_add_u32 m0, s22, 19456
  s_nop 0
  buffer_load_dwordx4 v11, s[8:11], s21 offen lds
  s_add_u32 m0, s22, 20480
  s_nop 0
  buffer_load_dwordx4 v12, s[8:11], s21 offen lds
  s_add_u32 m0, s22, 21504
  s_nop 0
  buffer_load_dwordx4 v13, s[8:11], s21 offen lds
  s_add_u32 m0, s22, 22528
  s_nop 0
  buffer_load_dwordx4 v14, s[8:11], s21 offen lds
  s_add_u32 m0, s22, 23552
  s_nop 0
  buffer_load_dwordx4 v15, s[8:11], s21 offen lds
  s_add_u32 m0, s22, 24576
  s_nop 0
  buffer_load_dwordx4 v16, s[8:11], s21 offen lds
  s_add_u32 m0, s22, 25600
  s_nop 0
  buffer_load_dwordx4 v17, s[8:11], s21 offen lds
  s_add_u32 m0, s22, 26624
  s_nop 0
  buffer_load_dwordx4 v18, s[8:11], s21 offen lds
  s_add_u32 s21, s21, 36864
  s_add_u32 m0, s22, 27648
  s_nop 0
  buffer_load_dwordx4 v10, s[8:11], s21 offen lds
  s_add_u32 m0, s22, 28672
  s_nop 0
  buffer_load_dwordx4 v11, s[8:11], s21 offen lds
  s_add_u32 m0, s22, 29696
  s_nop 0
  buffer_load_dwordx4 v12, s[8:11], s21 offen lds
  s_add_u32 m0, s22, 30720
  s_nop 0
  buffer_load_dwordx4 v13, s[8:11], s21 offen lds
  s_add_u32 m0, s22, 31744
  s_nop 0
  buffer_load_dwordx4 v14, s[8:11], s21 offen lds
  s_add_u32 m0, s22, 32768
  s_nop 0
  buffer_load_dwordx4 v15, s[8:11], s21 offen lds
  s_add_u32 m0, s22, 33792
  s_nop 0
  buffer_load_dwordx4 v16, s[8:11], s21 offen lds
  s_add_u32 m0, s22, 34816
  s_nop 0
  buffer_load_dwordx4 v17, s[8:11], s21 offen lds
  s_add_u32 m0, s22, 35840
  s_nop 0
  buffer_load_dwordx4 v18, s[8:11], s21 offen lds
  s_add_u32 s21, s21, 36864
  s_waitcnt vmcnt(27)
  ds_read_b64_tr_b16 a[16:17], v6 offset:0
  ds_read_b64_tr_b16 a[18:19], v6 offset:4608
  ds_read_b64_tr_b16 a[48:49], v6 offset:32
  ds_read_b64_tr_b16 a[50:51], v6 offset:4640
  ds_read_b64_tr_b16 a[80:81], v6 offset:64
  ds_read_b64_tr_b16 a[82:83], v6 offset:4672
  ds_read_b64_tr_b16 a[112:113], v6 offset:96
  ds_read_b64_tr_b16 a[114:115], v6 offset:4704
  ds_read_b64_tr_b16 a[144:145], v6 offset:128
  ds_read_b64_tr_b16 a[146:147], v6 offset:4736
  ds_read_b64_tr_b16 a[176:177], v6 offset:160
  ds_read_b64_tr_b16 a[178:179], v6 offset:4768
  ds_read_b64_tr_b16 a[208:209], v6 offset:192
  ds_read_b64_tr_b16 a[210:211], v6 offset:4800
  ds_read_b64_tr_b16 a[240:241], v6 offset:224
  ds_read_b64_tr_b16 a[242:243], v6 offset:4832
  ds_read_b64_tr_b16 v[240:241], v6 offset:256
  ds_read_b64_tr_b16 v[242:243], v6 offset:4864
  s_waitcnt lgkmcnt(0)
  s_waitcnt vmcnt(18)
  ds_read_b64_tr_b16 a[20:21], v6 offset:9216
  ds_read_b64_tr_b16 a[22:23], v6 offset:13824
  ds_read_b64_tr_b16 a[52:53], v6 offset:9248
  ds_read_b64_tr_b16 a[54:55], v6 offset:13856
  ds_read_b64_tr_b16 a[84:85], v6 offset:9280
  ds_read_b64_tr_b16 a[86:87], v6 offset:13888
  ds_read_b64_tr_b16 a[116:117], v6 offset:9312
  ds_read_b64_tr_b16 a[118:119], v6 offset:13920
  ds_read_b64_tr_b16 a[148:149], v6 offset:9344
  ds_read_b64_tr_b16 a[150:151], v6 offset:13952
  ds_read_b64_tr_b16 a[180:181], v6 offset:9376
  ds_read_b64_tr_b16 a[182:183], v6 offset:13984
  ds_read_b64_tr_b16 a[212:213], v6 offset:9408
  ds_read_b64_tr_b16 a[214:215], v6 offset:14016
  ds_read_b64_tr_b16 a[244:245], v6 offset:9440
  ds_read_b64_tr_b16 a[246:247], v6 offset:14048
  ds_read_b64_tr_b16 v[244:245], v6 offset:9472
  ds_read_b64_tr_b16 v[246:247], v6 offset:14080
  s_waitcnt lgkmcnt(0)
  s_waitcnt vmcnt(9)
  ds_read_b64_tr_b16 a[24:25], v6 offset:18432
  ds_read_b64_tr_b16 a[26:27], v6 offset:23040
  ds_read_b64_tr_b16 a[56:57], v6 offset:18464
  ds_read_b64_tr_b16 a[58:59], v6 offset:23072
  ds_read_b64_tr_b16 a[88:89], v6 offset:18496
  ds_read_b64_tr_b16 a[90:91], v6 offset:23104
  ds_read_b64_tr_b16 a[120:121], v6 offset:18528
  ds_read_b64_tr_b16 a[122:123], v6 offset:23136
  ds_read_b64_tr_b16 a[152:153], v6 offset:18560
  ds_read_b64_tr_b16 a[154:155], v6 offset:23168
  ds_read_b64_tr_b16 a[184:185], v6 offset:18592
  ds_read_b64_tr_b16 a[186:187], v6 offset:23200
  ds_read_b64_tr_b16 a[216:217], v6 offset:18624
  ds_read_b64_tr_b16 a[218:219], v6 offset:23232
  ds_read_b64_tr_b16 a[248:249], v6 offset:18656
  ds_read_b64_tr_b16 a[250:251], v6 offset:23264
  ds_read_b64_tr_b16 v[248:249], v6 offset:18688
  ds_read_b64_tr_b16 v[250:251], v6 offset:23296
  s_waitcnt lgkmcnt(0)
  s_waitcnt vmcnt(0)
  ds_read_b64_tr_b16 a[28:29], v6 offset:27648
  ds_read_b64_tr_b16 a[30:31], v6 offset:32256
  ds_read_b64_tr_b16 a[60:61], v6 offset:27680
  ds_read_b64_tr_b16 a[62:63], v6 offset:32288
  ds_read_b64_tr_b16 a[92:93], v6 offset:27712
  ds_read_b64_tr_b16 a[94:95], v6 offset:32320
  ds_read_b64_tr_b16 a[124:125], v6 offset:27744
  ds_read_b64_tr_b16 a[126:127], v6 offset:32352
  ds_read_b64_tr_b16 a[156:157], v6 offset:27776
  ds_read_b64_tr_b16 a[158:159], v6 offset:32384
  ds_read_b64_tr_b16 a[188:189], v6 offset:27808
  ds_read_b64_tr_b16 a[190:191], v6 offset:32416
  ds_read_b64_tr_b16 a[220:221], v6 offset:27840
  ds_read_b64_tr_b16 a[222:223], v6 offset:32448
  ds_read_b64_tr_b16 a[252:253], v6 offset:27872
  ds_read_b64_tr_b16 a[254:255], v6 offset:32480
  ds_read_b64_tr_b16 v[252:253], v6 offset:27904
  ds_read_b64_tr_b16 v[254:255], v6 offset:32512
  s_waitcnt lgkmcnt(0)
  s_and_b32 s27, s17, 1
  s_lshr_b32 s21, s17, 1
  s_lshl_b32 s22, s18, 1
  s_add_u32 s22, s22, s21
  s_lshl_b32 s23, s20, 5
  s_add_u32 s23, s23, s22
  s_lshl_b32 s24, s23, 13
  s_lshl_b32 s25, s23, 12
  s_lshl_b32 s23, s20, 4
  s_add_u32 s23, s23, s18
  s_mul_i32 s23, s23, 36864
  s_mul_i32 s22, s17, 9216
  s_add_u32 s23, s23, s22
  s_mul_i32 s22, s30, 3072
  s_add_u32 s23, s23, s22
  s_add_u32 s26, s23, 71303168
  s_lshl_b32 s23, s17, 12
  v_add_u32 v2, s23, v1
  s_mov_b32 s28, 0x3e0293ee
  v_and_b32 v6, 15, v5
  v_lshrrev_b32 v7, 4, v5
  v_lshlrev_b32 v7, 2, v7
  v_add_u32 v8, 0, v7
  v_cmp_le_u32 s[40:41], v8, v6
  v_add_u32 v8, 1, v7
  v_cmp_le_u32 s[42:43], v8, v6
  v_add_u32 v8, 2, v7
  v_cmp_le_u32 s[44:45], v8, v6
  v_add_u32 v8, 3, v7
  v_cmp_le_u32 s[46:47], v8, v6
  s_cmp_eq_u32 s27, 0
  s_cselect_b64 s[48:49], 0, s[40:41]
  s_cselect_b64 s[40:41], s[40:41], -1
  s_cselect_b64 s[50:51], 0, s[42:43]
  s_cselect_b64 s[42:43], s[42:43], -1
  s_cselect_b64 s[52:53], 0, s[44:45]
  s_cselect_b64 s[44:45], s[44:45], -1
  s_cselect_b64 s[54:55], 0, s[46:47]
  s_cselect_b64 s[46:47], s[46:47], -1
  v_mov_b32 v30, 0x3f803f80
  v_mov_b32 v31, 0x3f803f80
  v_mov_b32 v32, 0x3f803f80
  v_mov_b32 v33, 0x3f803f80
  v_mov_b32 v34, 0x3f803f80
  v_mov_b32 v35, 0
  s_barrier
  s_add_u32 s95, s96, 128
  s_lshl_b32 s95, s95, 8
  s_add_u32 s95, s95, 0
  s_mul_i32 s92, s19, 48
  s_add_u32 s92, s92, s18
  s_add_u32 s92, s92, 32
  s_lshl_b32 s92, s92, 8
  s_add_u32 s92, s92, 0
  v_and_b32 v38, 63, v0
  v_cmp_gt_u32 vcc, 3, v38
  s_nop 1
  v_cndmask_b32 v38, 0, v38, vcc
  v_lshlrev_b32 v38, 12, v38
  v_add_u32 v5, s92, v38
  s_lshl_b32 s92, s18, 1
  s_lshr_b32 s93, s17, 1
  s_add_u32 s92, s92, s93
  s_add_u32 s92, s92, 0
  s_lshl_b32 s92, s92, 8
  s_add_u32 s92, s92, 0
  v_mov_b32 v6, s92
  s_mov_b32 s90, 0
  s_mov_b32 s91, 0
  s_cmp_lg_u32 s17, 0
  s_cbranch_scc1 L_wl_25
  s_mov_b32 s94, 0
L_wl_24:
  buffer_load_dword v38, off, s[12:15], 0 offset:128 sc1
  s_waitcnt vmcnt(0)
  v_readfirstlane_b32 s92, v38
  s_cmp_ge_u32 s92, 64
  s_cbranch_scc1 L_wl_25
  s_add_u32 s94, s94, 1
  s_cmp_lt_u32 s94, 400000
  s_cbranch_scc1 L_wl_24
  s_branch L_fail
L_wl_25:
  s_barrier
  s_cmp_eq_u32 s30, 0
  s_cselect_b32 s93, 1, 32
  s_cmp_ge_u32 s90, s93
  s_cbranch_scc1 L_wt_27
  s_mov_b32 s94, 0
L_wt_26:
  buffer_load_dword v38, v5, s[4:7], 0 offen sc1
  s_waitcnt vmcnt(0)
  v_readlane_b32 s90, v38, 0
  v_readlane_b32 s92, v38, 1
  s_min_u32 s90, s90, s92
  v_readlane_b32 s92, v38, 2
  s_min_u32 s90, s90, s92
  s_cmp_ge_u32 s90, s93
  s_cbranch_scc1 L_wt_27
  s_add_u32 s94, s94, 1
  s_cmp_lt_u32 s94, 400000
  s_cbranch_scc1 L_wt_26
  s_branch L_fail
L_wt_27:
  s_add_u32 s21, s24, 4194304
  s_add_u32 s22, s24, 37748736
  s_lshl_b32 s23, s27, 10
  s_add_u32 s22, s22, s23
  buffer_load_dwordx4 v[72:75], v1, s[4:7], s22 offen
  buffer_load_dwordx4 v[88:91], v1, s[4:7], s21 offen
  buffer_load_dwordx4 v[92:95], v1, s[4:7], s21 offen offset:1024
  s_add_u32 s21, s21, 2048
  s_add_u32 s22, s22, 2048
  buffer_load_dwordx4 v[76:79], v1, s[4:7], s22 offen
  buffer_load_dwordx4 v[96:99], v1, s[4:7], s21 offen
  buffer_load_dwordx4 v[100:103], v1, s[4:7], s21 offen offset:1024
  s_add_u32 s21, s21, 2048
  s_add_u32 s22, s22, 2048
  buffer_load_dwordx4 v[80:83], v1, s[4:7], s22 offen
  buffer_load_dwordx4 v[104:107], v1, s[4:7], s21 offen
  buffer_load_dwordx4 v[108:111], v1, s[4:7], s21 offen offset:1024
  s_add_u32 s21, s21, 2048
  s_add_u32 s22, s22, 2048
  buffer_load_dwordx4 v[84:87], v1, s[4:7], s22 offen
  buffer_load_dwordx4 v[112:115], v1, s[4:7], s21 offen
  buffer_load_dwordx4 v[116:119], v1, s[4:7], s21 offen offset:1024
  s_add_u32 s21, s24, 20971520
  buffer_load_dwordx4 v[120:123], v1, s[4:7], s21 offen
  buffer_load_dwordx4 v[124:127], v1, s[4:7], s21 offen offset:1024
  s_add_u32 s21, s21, 2048
  buffer_load_dwordx4 v[128:131], v1, s[4:7], s21 offen
  buffer_load_dwordx4 v[132:135], v1, s[4:7], s21 offen offset:1024
  s_add_u32 s21, s21, 2048
  buffer_load_dwordx4 v[136:139], v1, s[4:7], s21 offen
  buffer_load_dwordx4 v[140:143], v1, s[4:7], s21 offen offset:1024
  s_add_u32 s21, s21, 2048
  buffer_load_dwordx4 v[144:147], v1, s[4:7], s21 offen
  buffer_load_dwordx4 v[148:151], v1, s[4:7], s21 offen offset:1024
  s_add_u32 s24, s24, 524288
  s_cmp_lg_u32 s30, 0
  s_cbranch_scc1 L_fol_last
  s_waitcnt vmcnt(0)
L_fol_loop:
  s_cmp_gt_u32 s91, s20
  s_cbranch_scc1 L_wm_29
  s_mov_b32 s94, 0
L_wm_28:
  buffer_load_dword v38, v6, s[4:7], 0 offen sc1
  s_waitcnt vmcnt(0)
  v_readfirstlane_b32 s91, v38
  s_cmp_gt_u32 s91, s20
  s_cbranch_scc1 L_wm_29
  s_add_u32 s94, s94, 1
  s_cmp_lt_u32 s94, 400000
  s_cbranch_scc1 L_wm_28
  s_branch L_fail
L_wm_29:
  s_add_u32 s21, s25, 54525952
  s_add_u32 s22, s25, 62914560
  buffer_load_dwordx4 v[40:43], v1, s[4:7], s21 offen offset:0
  buffer_load_dwordx4 v[44:47], v1, s[4:7], s21 offen offset:1024
  buffer_load_dwordx4 v[48:51], v1, s[4:7], s21 offen offset:2048
  buffer_load_dwordx4 v[52:55], v1, s[4:7], s21 offen offset:3072
  buffer_load_dwordx4 v[56:59], v1, s[4:7], s22 offen offset:0
  buffer_load_dwordx4 v[60:63], v1, s[4:7], s22 offen offset:1024
  buffer_load_dwordx4 v[64:67], v1, s[4:7], s22 offen offset:2048
  buffer_load_dwordx4 v[68:71], v1, s[4:7], s22 offen offset:3072
  s_add_u32 s25, s25, 262144
  s_waitcnt vmcnt(17)
  v_mfma_f32_16x16x32_bf16 v[12:15], v[88:91], v[72:75], 0
  v_mfma_f32_16x16x32_bf16 v[16:19], v[92:95], v[72:75], 0
  v_mfma_f32_16x16x32_bf16 v[12:15], v[96:99], v[76:79], v[12:15]
  v_mfma_f32_16x16x32_bf16 v[16:19], v[100:103], v[76:79], v[16:19]
  v_mfma_f32_16x16x32_bf16 v[12:15], v[104:107], v[80:83], v[12:15]
  v_mfma_f32_16x16x32_bf16 v[16:19], v[108:111], v[80:83], v[16:19]
  v_mfma_f32_16x16x32_bf16 v[12:15], v[112:115], v[84:87], v[12:15]
  v_mfma_f32_16x16x32_bf16 v[16:19], v[116:119], v[84:87], v[16:19]
  s_waitcnt vmcnt(4)
  v_mfma_f32_16x16x32_bf16 v[8:11], v[40:43], v[72:75], 0
  v_mfma_f32_16x16x32_bf16 v[8:11], v[44:47], v[76:79], v[8:11]
  v_mfma_f32_16x16x32_bf16 v[8:11], v[48:51], v[80:83], v[8:11]
  v_mfma_f32_16x16x32_bf16 v[8:11], v[52:55], v[84:87], v[8:11]
  v_mov_b32 v37, 0xce6e6b28
  v_cndmask_b32 v12, v37, v12, s[40:41]
  v_cndmask_b32 v13, v37, v13, s[42:43]
  v_cndmask_b32 v14, v37, v14, s[44:45]
  v_cndmask_b32 v15, v37, v15, s[46:47]
  v_cndmask_b32 v16, v37, v16, s[48:49]
  v_cndmask_b32 v17, v37, v17, s[50:51]
  v_cndmask_b32 v18, v37, v18, s[52:53]
  v_cndmask_b32 v19, v37, v19, s[54:55]
  v_max3_f32 v36, v12, v13, v14
  v_max3_f32 v37, v15, v16, v17
  v_max3_f32 v36, v36, v18, v19
  v_max3_f32 v37, v37, v8, v9
  v_max_f32 v36, v36, v37
  v_mov_b32 v37, v36
  s_nop 1
  v_permlane16_swap_b32 v36, v37
  v_max_f32 v36, v36, v37
  v_mov_b32 v37, v36
  s_nop 1
  v_permlane32_swap_b32 v36, v37
  v_max_f32 v36, v36, v37
  v_mul_f32 v36, s28, v36
  v_fma_f32 v8, v8, s28, -v36
  v_fma_f32 v9, v9, s28, -v36
  v_fma_f32 v12, v12, s28, -v36
  v_fma_f32 v13, v13, s28, -v36
  v_fma_f32 v14, v14, s28, -v36
  v_fma_f32 v15, v15, s28, -v36
  v_fma_f32 v16, v16, s28, -v36
  v_fma_f32 v17, v17, s28, -v36
  v_fma_f32 v18, v18, s28, -v36
  v_fma_f32 v19, v19, s28, -v36
  v_exp_f32 v8, v8
  v_exp_f32 v9, v9
  v_exp_f32 v12, v12
  v_exp_f32 v13, v13
  v_exp_f32 v14, v14
  v_exp_f32 v15, v15
  v_exp_f32 v16, v16
  v_exp_f32 v17, v17
  v_exp_f32 v18, v18
  v_exp_f32 v19, v19
  v_cvt_pk_bf16_f32 v20, v12, v13
  v_cvt_pk_bf16_f32 v21, v14, v15
  v_cvt_pk_bf16_f32 v22, v16, v17
  v_cvt_pk_bf16_f32 v23, v18, v19
  v_cvt_pk_bf16_f32 v24, v8, v9
  v_mov_b32 v25, v24
  v_mfma_f32_16x16x32_bf16 v[26:29], v[30:33], v[20:23], 0
  v_mfma_f32_16x16x32_bf16 v[152:155], v[120:123], v[20:23], 0
  v_mfma_f32_16x16x32_bf16 v[156:159], v[124:127], v[20:23], 0
  v_mfma_f32_16x16x32_bf16 v[160:163], v[128:131], v[20:23], 0
  v_mfma_f32_16x16x32_bf16 v[164:167], v[132:135], v[20:23], 0
  v_mfma_f32_16x16x32_bf16 v[168:171], v[136:139], v[20:23], 0
  v_mfma_f32_16x16x32_bf16 v[172:175], v[140:143], v[20:23], 0
  v_mfma_f32_16x16x32_bf16 v[176:179], v[144:147], v[20:23], 0
  v_mfma_f32_16x16x32_bf16 v[180:183], v[148:151], v[20:23], 0
  s_waitcnt vmcnt(0)
  v_mfma_f32_16x16x16_bf16 v[26:29], v[34:35], v[24:25], v[26:29]
  v_mfma_f32_16x16x16_bf16 v[152:155], v[56:57], v[24:25], v[152:155]
  v_mfma_f32_16x16x16_bf16 v[156:159], v[58:59], v[24:25], v[156:159]
  v_mfma_f32_16x16x16_bf16 v[160:163], v[60:61], v[24:25], v[160:163]
  v_mfma_f32_16x16x16_bf16 v[164:167], v[62:63], v[24:25], v[164:167]
  v_mfma_f32_16x16x16_bf16 v[168:171], v[64:65], v[24:25], v[168:171]
  v_mfma_f32_16x16x16_bf16 v[172:175], v[66:67], v[24:25], v[172:175]
  v_mfma_f32_16x16x16_bf16 v[176:179], v[68:69], v[24:25], v[176:179]
  v_mfma_f32_16x16x16_bf16 v[180:183], v[70:71], v[24:25], v[180:183]
  s_add_u32 s93, s29, 2
  s_cmp_ge_u32 s90, s93
  s_cbranch_scc1 L_wt_31
  s_mov_b32 s94, 0
L_wt_30:
  buffer_load_dword v38, v5, s[4:7], 0 offen sc1
  s_waitcnt vmcnt(0)
  v_readlane_b32 s90, v38, 0
  v_readlane_b32 s92, v38, 1
  s_min_u32 s90, s90, s92
  v_readlane_b32 s92, v38, 2
  s_min_u32 s90, s90, s92
  s_cmp_ge_u32 s90, s93
  s_cbranch_scc1 L_wt_31
  s_add_u32 s94, s94, 1
  s_cmp_lt_u32 s94, 400000
  s_cbranch_scc1 L_wt_30
  s_branch L_fail
L_wt_31:
  s_add_u32 s21, s24, 4194304
  s_add_u32 s22, s24, 37748736
  s_lshl_b32 s23, s27, 10
  s_add_u32 s22, s22, s23
  buffer_load_dwordx4 v[72:75], v1, s[4:7], s22 offen
  buffer_load_dwordx4 v[88:91], v1, s[4:7], s21 offen
  buffer_load_dwordx4 v[92:95], v1, s[4:7], s21 offen offset:1024
  s_add_u32 s21, s21, 2048
  s_add_u32 s22, s22, 2048
  buffer_load_dwordx4 v[76:79], v1, s[4:7], s22 offen
  buffer_load_dwordx4 v[96:99], v1, s[4:7], s21 offen
  buffer_load_dwordx4 v[100:103], v1, s[4:7], s21 offen offset:1024
  s_add_u32 s21, s21, 2048
  s_add_u32 s22, s22, 2048
  buffer_load_dwordx4 v[80:83], v1, s[4:7], s22 offen
  buffer_load_dwordx4 v[104:107], v1, s[4:7], s21 offen
  buffer_load_dwordx4 v[108:111], v1, s[4:7], s21 offen offset:1024
  s_add_u32 s21, s21, 2048
  s_add_u32 s22, s22, 2048
  buffer_load_dwordx4 v[84:87], v1, s[4:7], s22 offen
  buffer_load_dwordx4 v[112:115], v1, s[4:7], s21 offen
  buffer_load_dwordx4 v[116:119], v1, s[4:7], s21 offen offset:1024
  s_add_u32 s21, s24, 20971520
  buffer_load_dwordx4 v[120:123], v1, s[4:7], s21 offen
  buffer_load_dwordx4 v[124:127], v1, s[4:7], s21 offen offset:1024
  s_add_u32 s21, s21, 2048
  buffer_load_dwordx4 v[128:131], v1, s[4:7], s21 offen
  buffer_load_dwordx4 v[132:135], v1, s[4:7], s21 offen offset:1024
  s_add_u32 s21, s21, 2048
  buffer_load_dwordx4 v[136:139], v1, s[4:7], s21 offen
  buffer_load_dwordx4 v[140:143], v1, s[4:7], s21 offen offset:1024
  s_add_u32 s21, s21, 2048
  buffer_load_dwordx4 v[144:147], v1, s[4:7], s21 offen
  buffer_load_dwordx4 v[148:151], v1, s[4:7], s21 offen offset:1024
  s_add_u32 s24, s24, 524288
  v_rcp_f32 v36, v26
  s_nop 0
  v_mul_f32 v152, v152, v36
  v_mul_f32 v153, v153, v36
  v_mul_f32 v154, v154, v36
  v_mul_f32 v155, v155, v36
  v_cvt_pk_bf16_f32 v184, v152, v153
  v_cvt_pk_bf16_f32 v185, v154, v155
  v_mul_f32 v156, v156, v36
  v_mul_f32 v157, v157, v36
  v_mul_f32 v158, v158, v36
  v_mul_f32 v159, v159, v36
  v_cvt_pk_bf16_f32 v186, v156, v157
  v_cvt_pk_bf16_f32 v187, v158, v159
  ds_write_b128 v2, v[184:187] offset:0
  v_mul_f32 v160, v160, v36
  v_mul_f32 v161, v161, v36
  v_mul_f32 v162, v162, v36
  v_mul_f32 v163, v163, v36
  v_cvt_pk_bf16_f32 v188, v160, v161
  v_cvt_pk_bf16_f32 v189, v162, v163
  v_mul_f32 v164, v164, v36
  v_mul_f32 v165, v165, v36
  v_mul_f32 v166, v166, v36
  v_mul_f32 v167, v167, v36
  v_cvt_pk_bf16_f32 v190, v164, v165
  v_cvt_pk_bf16_f32 v191, v166, v167
  ds_write_b128 v2, v[188:191] offset:1024
  v_mul_f32 v168, v168, v36
  v_mul_f32 v169, v169, v36
  v_mul_f32 v170, v170, v36
  v_mul_f32 v171, v171, v36
  v_cvt_pk_bf16_f32 v192, v168, v169
  v_cvt_pk_bf16_f32 v193, v170, v171
  v_mul_f32 v172, v172, v36
  v_mul_f32 v173, v173, v36
  v_mul_f32 v174, v174, v36
  v_mul_f32 v175, v175, v36
  v_cvt_pk_bf16_f32 v194, v172, v173
  v_cvt_pk_bf16_f32 v195, v174, v175
  ds_write_b128 v2, v[192:195] offset:2048
  v_mul_f32 v176, v176, v36
  v_mul_f32 v177, v177, v36
  v_mul_f32 v178, v178, v36
  v_mul_f32 v179, v179, v36
  v_cvt_pk_bf16_f32 v196, v176, v177
  v_cvt_pk_bf16_f32 v197, v178, v179
  v_mul_f32 v180, v180, v36
  v_mul_f32 v181, v181, v36
  v_mul_f32 v182, v182, v36
  v_mul_f32 v183, v183, v36
  v_cvt_pk_bf16_f32 v198, v180, v181
  v_cvt_pk_bf16_f32 v199, v182, v183
  ds_write_b128 v2, v[196:199] offset:3072
  s_waitcnt lgkmcnt(0)
  s_barrier
  s_cmp_lg_u32 s17, 0
  s_cbranch_scc1 L_fs_32
  v_mov_b32 v38, s29
  s_mov_b64 exec, 1
  buffer_store_dword v38, off, s[4:7], s95 sc1
  s_mov_b64 exec, -1
L_fs_32:
  ds_read_b128 v[40:43], v1 offset:0
  ds_read_b128 v[44:47], v1 offset:4096
  ds_read_b128 v[48:51], v1 offset:1024
  s_waitcnt lgkmcnt(2)
  v_mfma_f32_16x16x32_bf16 v[152:155], a[0:3], v[40:43], 0
  ds_read_b128 v[52:55], v1 offset:5120
  v_mfma_f32_16x16x32_bf16 v[160:163], a[32:35], v[40:43], 0
  v_mfma_f32_16x16x32_bf16 v[168:171], a[64:67], v[40:43], 0
  v_mfma_f32_16x16x32_bf16 v[176:179], a[96:99], v[40:43], 0
  v_mfma_f32_16x16x32_bf16 v[184:187], a[128:131], v[40:43], 0
  v_mfma_f32_16x16x32_bf16 v[192:195], a[160:163], v[40:43], 0
  v_mfma_f32_16x16x32_bf16 v[200:203], a[192:195], v[40:43], 0
  v_mfma_f32_16x16x32_bf16 v[208:211], a[224:227], v[40:43], 0
  v_mfma_f32_16x16x32_bf16 v[216:219], v[224:227], v[40:43], 0
  s_waitcnt lgkmcnt(2)
  v_mfma_f32_16x16x32_bf16 v[156:159], a[0:3], v[44:47], 0
  ds_read_b128 v[40:43], v1 offset:2048
  v_mfma_f32_16x16x32_bf16 v[164:167], a[32:35], v[44:47], 0
  v_mfma_f32_16x16x32_bf16 v[172:175], a[64:67], v[44:47], 0
  v_mfma_f32_16x16x32_bf16 v[180:183], a[96:99], v[44:47], 0
  v_mfma_f32_16x16x32_bf16 v[188:191], a[128:131], v[44:47], 0
  v_mfma_f32_16x16x32_bf16 v[196:199], a[160:163], v[44:47], 0
  v_mfma_f32_16x16x32_bf16 v[204:207], a[192:195], v[44:47], 0
  v_mfma_f32_16x16x32_bf16 v[212:215], a[224:227], v[44:47], 0
  v_mfma_f32_16x16x32_bf16 v[220:223], v[224:227], v[44:47], 0
  s_waitcnt lgkmcnt(2)
  v_mfma_f32_16x16x32_bf16 v[152:155], a[4:7], v[48:51], v[152:155]
  ds_read_b128 v[44:47], v1 offset:6144
  v_mfma_f32_16x16x32_bf16 v[160:163], a[36:39], v[48:51], v[160:163]
  v_mfma_f32_16x16x32_bf16 v[168:171], a[68:71], v[48:51], v[168:171]
  v_mfma_f32_16x16x32_bf16 v[176:179], a[100:103], v[48:51], v[176:179]
  v_mfma_f32_16x16x32_bf16 v[184:187], a[132:135], v[48:51], v[184:187]
  v_mfma_f32_16x16x32_bf16 v[192:195], a[164:167], v[48:51], v[192:195]
  v_mfma_f32_16x16x32_bf16 v[200:203], a[196:199], v[48:51], v[200:203]
  v_mfma_f32_16x16x32_bf16 v[208:211], a[228:231], v[48:51], v[208:211]
  v_mfma_f32_16x16x32_bf16 v[216:219], v[228:231], v[48:51], v[216:219]
  s_waitcnt lgkmcnt(2)
  v_mfma_f32_16x16x32_bf16 v[156:159], a[4:7], v[52:55], v[156:159]
  ds_read_b128 v[48:51], v1 offset:3072
  v_mfma_f32_16x16x32_bf16 v[164:167], a[36:39], v[52:55], v[164:167]
  v_mfma_f32_16x16x32_bf16 v[172:175], a[68:71], v[52:55], v[172:175]
  v_mfma_f32_16x16x32_bf16 v[180:183], a[100:103], v[52:55], v[180:183]
  v_mfma_f32_16x16x32_bf16 v[188:191], a[132:135], v[52:55], v[188:191]
  v_mfma_f32_16x16x32_bf16 v[196:199], a[164:167], v[52:55], v[196:199]
  v_mfma_f32_16x16x32_bf16 v[204:207], a[196:199], v[52:55], v[204:207]
  v_mfma_f32_16x16x32_bf16 v[212:215], a[228:231], v[52:55], v[212:215]
  v_mfma_f32_16x16x32_bf16 v[220:223], v[228:231], v[52:55], v[220:223]
  s_waitcnt lgkmcnt(2)
  v_mfma_f32_16x16x32_bf16 v[152:155], a[8:11], v[40:43], v[152:155]
  ds_read_b128 v[52:55], v1 offset:7168
  v_mfma_f32_16x16x32_bf16 v[160:163], a[40:43], v[40:43], v[160:163]
  v_mfma_f32_16x16x32_bf16 v[168:171], a[72:75], v[40:43], v[168:171]
  v_mfma_f32_16x16x32_bf16 v[176:179], a[104:107], v[40:43], v[176:179]
  v_mfma_f32_16x16x32_bf16 v[184:187], a[136:139], v[40:43], v[184:187]
  v_mfma_f32_16x16x32_bf16 v[192:195], a[168:171], v[40:43], v[192:195]
  v_mfma_f32_16x16x32_bf16 v[200:203], a[200:203], v[40:43], v[200:203]
  v_mfma_f32_16x16x32_bf16 v[208:211], a[232:235], v[40:43], v[208:211]
  v_mfma_f32_16x16x32_bf16 v[216:219], v[232:235], v[40:43], v[216:219]
  s_waitcnt lgkmcnt(2)
  v_mfma_f32_16x16x32_bf16 v[156:159], a[8:11], v[44:47], v[156:159]
  ds_read_b128 v[40:43], v1 offset:8192
  v_mfma_f32_16x16x32_bf16 v[164:167], a[40:43], v[44:47], v[164:167]
  v_mfma_f32_16x16x32_bf16 v[172:175], a[72:75], v[44:47], v[172:175]
  v_mfma_f32_16x16x32_bf16 v[180:183], a[104:107], v[44:47], v[180:183]
  v_mfma_f32_16x16x32_bf16 v[188:191], a[136:139], v[44:47], v[188:191]
  v_mfma_f32_16x16x32_bf16 v[196:199], a[168:171], v[44:47], v[196:199]
  v_mfma_f32_16x16x32_bf16 v[204:207], a[200:203], v[44:47], v[204:207]
  v_mfma_f32_16x16x32_bf16 v[212:215], a[232:235], v[44:47], v[212:215]
  v_mfma_f32_16x16x32_bf16 v[220:223], v[232:235], v[44:47], v[220:223]
  s_waitcnt lgkmcnt(2)
  v_mfma_f32_16x16x32_bf16 v[152:155], a[12:15], v[48:51], v[152:155]
  ds_read_b128 v[44:47], v1 offset:12288
  v_mfma_f32_16x16x32_bf16 v[160:163], a[44:47], v[48:51], v[160:163]
  v_mfma_f32_16x16x32_bf16 v[168:171], a[76:79], v[48:51], v[168:171]
  v_mfma_f32_16x16x32_bf16 v[176:179], a[108:111], v[48:51], v[176:179]
  v_mfma_f32_16x16x32_bf16 v[184:187], a[140:143], v[48:51], v[184:187]
  v_mfma_f32_16x16x32_bf16 v[192:195], a[172:175], v[48:51], v[192:195]
  v_mfma_f32_16x16x32_bf16 v[200:203], a[204:207], v[48:51], v[200:203]
  v_mfma_f32_16x16x32_bf16 v[208:211], a[236:239], v[48:51], v[208:211]
  v_mfma_f32_16x16x32_bf16 v[216:219], v[236:239], v[48:51], v[216:219]
  s_waitcnt lgkmcnt(2)
  v_mfma_f32_16x16x32_bf16 v[156:159], a[12:15], v[52:55], v[156:159]
  ds_read_b128 v[48:51], v1 offset:9216
  v_mfma_f32_16x16x32_bf16 v[164:167], a[44:47], v[52:55], v[164:167]
  v_mfma_f32_16x16x32_bf16 v[172:175], a[76:79], v[52:55], v[172:175]
  v_mfma_f32_16x16x32_bf16 v[180:183], a[108:111], v[52:55], v[180:183]
  v_mfma_f32_16x16x32_bf16 v[188:191], a[140:143], v[52:55], v[188:191]
  v_mfma_f32_16x16x32_bf16 v[196:199], a[172:175], v[52:55], v[196:199]
  v_mfma_f32_16x16x32_bf16 v[204:207], a[204:207], v[52:55], v[204:207]
  v_mfma_f32_16x16x32_bf16 v[212:215], a[236:239], v[52:55], v[212:215]
  v_mfma_f32_16x16x32_bf16 v[220:223], v[236:239], v[52:55], v[220:223]
  s_waitcnt lgkmcnt(2)
  v_mfma_f32_16x16x32_bf16 v[152:155], a[16:19], v[40:43], v[152:155]
  ds_read_b128 v[52:55], v1 offset:13312
  v_mfma_f32_16x16x32_bf16 v[160:163], a[48:51], v[40:43], v[160:163]
  v_mfma_f32_16x16x32_bf16 v[168:171], a[80:83], v[40:43], v[168:171]
  v_mfma_f32_16x16x32_bf16 v[176:179], a[112:115], v[40:43], v[176:179]
  v_mfma_f32_16x16x32_bf16 v[184:187], a[144:147], v[40:43], v[184:187]
  v_mfma_f32_16x16x32_bf16 v[192:195], a[176:179], v[40:43], v[192:195]
  v_mfma_f32_16x16x32_bf16 v[200:203], a[208:211], v[40:43], v[200:203]
  v_mfma_f32_16x16x32_bf16 v[208:211], a[240:243], v[40:43], v[208:211]
  v_mfma_f32_16x16x32_bf16 v[216:219], v[240:243], v[40:43], v[216:219]
  s_waitcnt lgkmcnt(2)
  v_mfma_f32_16x16x32_bf16 v[156:159], a[16:19], v[44:47], v[156:159]
  ds_read_b128 v[40:43], v1 offset:10240
  v_mfma_f32_16x16x32_bf16 v[164:167], a[48:51], v[44:47], v[164:167]
  v_mfma_f32_16x16x32_bf16 v[172:175], a[80:83], v[44:47], v[172:175]
  v_mfma_f32_16x16x32_bf16 v[180:183], a[112:115], v[44:47], v[180:183]
  v_mfma_f32_16x16x32_bf16 v[188:191], a[144:147], v[44:47], v[188:191]
  v_mfma_f32_16x16x32_bf16 v[196:199], a[176:179], v[44:47], v[196:199]
  v_mfma_f32_16x16x32_bf16 v[204:207], a[208:211], v[44:47], v[204:207]
  v_mfma_f32_16x16x32_bf16 v[212:215], a[240:243], v[44:47], v[212:215]
  v_mfma_f32_16x16x32_bf16 v[220:223], v[240:243], v[44:47], v[220:223]
  s_waitcnt lgkmcnt(2)
  v_mfma_f32_16x16x32_bf16 v[152:155], a[20:23], v[48:51], v[152:155]
  ds_read_b128 v[44:47], v1 offset:14336
  v_mfma_f32_16x16x32_bf16 v[160:163], a[52:55], v[48:51], v[160:163]
  v_mfma_f32_16x16x32_bf16 v[168:171], a[84:87], v[48:51], v[168:171]
  v_mfma_f32_16x16x32_bf16 v[176:179], a[116:119], v[48:51], v[176:179]
  v_mfma_f32_16x16x32_bf16 v[184:187], a[148:151], v[48:51], v[184:187]
  v_mfma_f32_16x16x32_bf16 v[192:195], a[180:183], v[48:51], v[192:195]
  v_mfma_f32_16x16x32_bf16 v[200:203], a[212:215], v[48:51], v[200:203]
  v_mfma_f32_16x16x32_bf16 v[208:211], a[244:247], v[48:51], v[208:211]
  v_mfma_f32_16x16x32_bf16 v[216:219], v[244:247], v[48:51], v[216:219]
  s_waitcnt lgkmcnt(2)
  v_mfma_f32_16x16x32_bf16 v[156:159], a[20:23], v[52:55], v[156:159]
  ds_read_b128 v[48:51], v1 offset:11264
  v_mfma_f32_16x16x32_bf16 v[164:167], a[52:55], v[52:55], v[164:167]
  v_mfma_f32_16x16x32_bf16 v[172:175], a[84:87], v[52:55], v[172:175]
  v_mfma_f32_16x16x32_bf16 v[180:183], a[116:119], v[52:55], v[180:183]
  v_mfma_f32_16x16x32_bf16 v[188:191], a[148:151], v[52:55], v[188:191]
  v_mfma_f32_16x16x32_bf16 v[196:199], a[180:183], v[52:55], v[196:199]
  v_mfma_f32_16x16x32_bf16 v[204:207], a[212:215], v[52:55], v[204:207]
  v_mfma_f32_16x16x32_bf16 v[212:215], a[244:247], v[52:55], v[212:215]
  v_mfma_f32_16x16x32_bf16 v[220:223], v[244:247], v[52:55], v[220:223]
  s_waitcnt lgkmcnt(2)
  v_mfma_f32_16x16x32_bf16 v[152:155], a[24:27], v[40:43], v[152:155]
  ds_read_b128 v[52:55], v1 offset:15360
  v_mfma_f32_16x16x32_bf16 v[160:163], a[56:59], v[40:43], v[160:163]
  v_mfma_f32_16x16x32_bf16 v[168:171], a[88:91], v[40:43], v[168:171]
  v_mfma_f32_16x16x32_bf16 v[176:179], a[120:123], v[40:43], v[176:179]
  v_mfma_f32_16x16x32_bf16 v[184:187], a[152:155], v[40:43], v[184:187]
  v_mfma_f32_16x16x32_bf16 v[192:195], a[184:187], v[40:43], v[192:195]
  v_mfma_f32_16x16x32_bf16 v[200:203], a[216:219], v[40:43], v[200:203]
  v_mfma_f32_16x16x32_bf16 v[208:211], a[248:251], v[40:43], v[208:211]
  v_mfma_f32_16x16x32_bf16 v[216:219], v[248:251], v[40:43], v[216:219]
  s_waitcnt lgkmcnt(2)
  v_mfma_f32_16x16x32_bf16 v[156:159], a[24:27], v[44:47], v[156:159]
  v_mfma_f32_16x16x32_bf16 v[164:167], a[56:59], v[44:47], v[164:167]
  v_mfma_f32_16x16x32_bf16 v[172:175], a[88:91], v[44:47], v[172:175]
  v_mfma_f32_16x16x32_bf16 v[180:183], a[120:123], v[44:47], v[180:183]
  v_mfma_f32_16x16x32_bf16 v[188:191], a[152:155], v[44:47], v[188:191]
  v_mfma_f32_16x16x32_bf16 v[196:199], a[184:187], v[44:47], v[196:199]
  v_mfma_f32_16x16x32_bf16 v[204:207], a[216:219], v[44:47], v[204:207]
  v_mfma_f32_16x16x32_bf16 v[212:215], a[248:251], v[44:47], v[212:215]
  v_mfma_f32_16x16x32_bf16 v[220:223], v[248:251], v[44:47], v[220:223]
  s_waitcnt lgkmcnt(1)
  v_mfma_f32_16x16x32_bf16 v[152:155], a[28:31], v[48:51], v[152:155]
  v_mfma_f32_16x16x32_bf16 v[160:163], a[60:63], v[48:51], v[160:163]
  v_mfma_f32_16x16x32_bf16 v[168:171], a[92:95], v[48:51], v[168:171]
  v_mfma_f32_16x16x32_bf16 v[176:179], a[124:127], v[48:51], v[176:179]
  v_mfma_f32_16x16x32_bf16 v[184:187], a[156:159], v[48:51], v[184:187]
  v_mfma_f32_16x16x32_bf16 v[192:195], a[188:191], v[48:51], v[192:195]
  v_mfma_f32_16x16x32_bf16 v[200:203], a[220:223], v[48:51], v[200:203]
  v_mfma_f32_16x16x32_bf16 v[208:211], a[252:255], v[48:51], v[208:211]
  v_mfma_f32_16x16x32_bf16 v[216:219], v[252:255], v[48:51], v[216:219]
  s_waitcnt lgkmcnt(0)
  v_mfma_f32_16x16x32_bf16 v[156:159], a[28:31], v[52:55], v[156:159]
  v_mfma_f32_16x16x32_bf16 v[164:167], a[60:63], v[52:55], v[164:167]
  v_mfma_f32_16x16x32_bf16 v[172:175], a[92:95], v[52:55], v[172:175]
  v_mfma_f32_16x16x32_bf16 v[180:183], a[124:127], v[52:55], v[180:183]
  v_mfma_f32_16x16x32_bf16 v[188:191], a[156:159], v[52:55], v[188:191]
  v_mfma_f32_16x16x32_bf16 v[196:199], a[188:191], v[52:55], v[196:199]
  v_mfma_f32_16x16x32_bf16 v[204:207], a[220:223], v[52:55], v[204:207]
  v_mfma_f32_16x16x32_bf16 v[212:215], a[252:255], v[52:55], v[212:215]
  v_mfma_f32_16x16x32_bf16 v[220:223], v[252:255], v[52:55], v[220:223]
  v_cvt_pk_bf16_f32 v8, v152, v153
  v_cvt_pk_bf16_f32 v9, v154, v155
  v_cvt_pk_bf16_f32 v10, v156, v157
  v_cvt_pk_bf16_f32 v11, v158, v159
  s_add_u32 s21, s26, 0
  buffer_store_dwordx4 v[8:11], v1, s[4:7], s21 offen sc1
  v_cvt_pk_bf16_f32 v12, v160, v161
  v_cvt_pk_bf16_f32 v13, v162, v163
  v_cvt_pk_bf16_f32 v14, v164, v165
  v_cvt_pk_bf16_f32 v15, v166, v167
  s_add_u32 s21, s26, 1024
  buffer_store_dwordx4 v[12:15], v1, s[4:7], s21 offen sc1
  v_cvt_pk_bf16_f32 v16, v168, v169
  v_cvt_pk_bf16_f32 v17, v170, v171
  v_cvt_pk_bf16_f32 v18, v172, v173
  v_cvt_pk_bf16_f32 v19, v174, v175
  s_add_u32 s21, s26, 2048
  buffer_store_dwordx4 v[16:19], v1, s[4:7], s21 offen sc1
  v_cvt_pk_bf16_f32 v20, v176, v177
  v_cvt_pk_bf16_f32 v21, v178, v179
  v_cvt_pk_bf16_f32 v22, v180, v181
  v_cvt_pk_bf16_f32 v23, v182, v183
  s_add_u32 s21, s26, 3072
  buffer_store_dwordx4 v[20:23], v1, s[4:7], s21 offen sc1
  v_cvt_pk_bf16_f32 v8, v184, v185
  v_cvt_pk_bf16_f32 v9, v186, v187
  v_cvt_pk_bf16_f32 v10, v188, v189
  v_cvt_pk_bf16_f32 v11, v190, v191
  s_add_u32 s21, s26, 4096
  buffer_store_dwordx4 v[8:11], v1, s[4:7], s21 offen sc1
  v_cvt_pk_bf16_f32 v12, v192, v193
  v_cvt_pk_bf16_f32 v13, v194, v195
  v_cvt_pk_bf16_f32 v14, v196, v197
  v_cvt_pk_bf16_f32 v15, v198, v199
  s_add_u32 s21, s26, 5120
  buffer_store_dwordx4 v[12:15], v1, s[4:7], s21 offen sc1
  v_cvt_pk_bf16_f32 v16, v200, v201
  v_cvt_pk_bf16_f32 v17, v202, v203
  v_cvt_pk_bf16_f32 v18, v204, v205
  v_cvt_pk_bf16_f32 v19, v206, v207
  s_add_u32 s21, s26, 6144
  buffer_store_dwordx4 v[16:19], v1, s[4:7], s21 offen sc1
  v_cvt_pk_bf16_f32 v20, v208, v209
  v_cvt_pk_bf16_f32 v21, v210, v211
  v_cvt_pk_bf16_f32 v22, v212, v213
  v_cvt_pk_bf16_f32 v23, v214, v215
  s_add_u32 s21, s26, 7168
  buffer_store_dwordx4 v[20:23], v1, s[4:7], s21 offen sc1
  v_cvt_pk_bf16_f32 v8, v216, v217
  v_cvt_pk_bf16_f32 v9, v218, v219
  v_cvt_pk_bf16_f32 v10, v220, v221
  v_cvt_pk_bf16_f32 v11, v222, v223
  s_add_u32 s21, s26, 8192
  buffer_store_dwordx4 v[8:11], v1, s[4:7], s21 offen sc1
  s_add_u32 s26, s26, 1179648
  s_add_u32 s29, s29, 1
  s_add_u32 s20, s20, 2
  s_cmp_eq_u32 s29, 29
  s_cbranch_scc1 L_fol_end3
  s_cmp_gt_u32 s91, s20
  s_cbranch_scc1 L_wm_34
  s_mov_b32 s94, 0
L_wm_33:
  buffer_load_dword v38, v6, s[4:7], 0 offen sc1
  s_waitcnt vmcnt(0)
  v_readfirstlane_b32 s91, v38
  s_cmp_gt_u32 s91, s20
  s_cbranch_scc1 L_wm_34
  s_add_u32 s94, s94, 1
  s_cmp_lt_u32 s94, 400000
  s_cbranch_scc1 L_wm_33
  s_branch L_fail
L_wm_34:
  s_add_u32 s21, s25, 54525952
  s_add_u32 s22, s25, 62914560
  buffer_load_dwordx4 v[40:43], v1, s[4:7], s21 offen offset:0
  buffer_load_dwordx4 v[44:47], v1, s[4:7], s21 offen offset:1024
  buffer_load_dwordx4 v[48:51], v1, s[4:7], s21 offen offset:2048
  buffer_load_dwordx4 v[52:55], v1, s[4:7], s21 offen offset:3072
  buffer_load_dwordx4 v[56:59], v1, s[4:7], s22 offen offset:0
  buffer_load_dwordx4 v[60:63], v1, s[4:7], s22 offen offset:1024
  buffer_load_dwordx4 v[64:67], v1, s[4:7], s22 offen offset:2048
  buffer_load_dwordx4 v[68:71], v1, s[4:7], s22 offen offset:3072
  s_add_u32 s25, s25, 262144
  s_waitcnt vmcnt(17)
  v_mfma_f32_16x16x32_bf16 v[12:15], v[88:91], v[72:75], 0
  v_mfma_f32_16x16x32_bf16 v[16:19], v[92:95], v[72:75], 0
  v_mfma_f32_16x16x32_bf16 v[12:15], v[96:99], v[76:79], v[12:15]
  v_mfma_f32_16x16x32_bf16 v[16:19], v[100:103], v[76:79], v[16:19]
  v_mfma_f32_16x16x32_bf16 v[12:15], v[104:107], v[80:83], v[12:15]
  v_mfma_f32_16x16x32_bf16 v[16:19], v[108:111], v[80:83], v[16:19]
  v_mfma_f32_16x16x32_bf16 v[12:15], v[112:115], v[84:87], v[12:15]
  v_mfma_f32_16x16x32_bf16 v[16:19], v[116:119], v[84:87], v[16:19]
  s_waitcnt vmcnt(4)
  v_mfma_f32_16x16x32_bf16 v[8:11], v[40:43], v[72:75], 0
  v_mfma_f32_16x16x32_bf16 v[8:11], v[44:47], v[76:79], v[8:11]
  v_mfma_f32_16x16x32_bf16 v[8:11], v[48:51], v[80:83], v[8:11]
  v_mfma_f32_16x16x32_bf16 v[8:11], v[52:55], v[84:87], v[8:11]
  v_mov_b32 v37, 0xce6e6b28
  v_cndmask_b32 v12, v37, v12, s[40:41]
  v_cndmask_b32 v13, v37, v13, s[42:43]
  v_cndmask_b32 v14, v37, v14, s[44:45]
  v_cndmask_b32 v15, v37, v15, s[46:47]
  v_cndmask_b32 v16, v37, v16, s[48:49]
  v_cndmask_b32 v17, v37, v17, s[50:51]
  v_cndmask_b32 v18, v37, v18, s[52:53]
  v_cndmask_b32 v19, v37, v19, s[54:55]
  v_max3_f32 v36, v12, v13, v14
  v_max3_f32 v37, v15, v16, v17
  v_max3_f32 v36, v36, v18, v19
  v_max3_f32 v37, v37, v8, v9
  v_max_f32 v36, v36, v37
  v_mov_b32 v37, v36
  s_nop 1
  v_permlane16_swap_b32 v36, v37
  v_max_f32 v36, v36, v37
  v_mov_b32 v37, v36
  s_nop 1
  v_permlane32_swap_b32 v36, v37
  v_max_f32 v36, v36, v37
  v_mul_f32 v36, s28, v36
  v_fma_f32 v8, v8, s28, -v36
  v_fma_f32 v9, v9, s28, -v36
  v_fma_f32 v12, v12, s28, -v36
  v_fma_f32 v13, v13, s28, -v36
  v_fma_f32 v14, v14, s28, -v36
  v_fma_f32 v15, v15, s28, -v36
  v_fma_f32 v16, v16, s28, -v36
  v_fma_f32 v17, v17, s28, -v36
  v_fma_f32 v18, v18, s28, -v36
  v_fma_f32 v19, v19, s28, -v36
  v_exp_f32 v8, v8
  v_exp_f32 v9, v9
  v_exp_f32 v12, v12
  v_exp_f32 v13, v13
  v_exp_f32 v14, v14
  v_exp_f32 v15, v15
  v_exp_f32 v16, v16
  v_exp_f32 v17, v17
  v_exp_f32 v18, v18
  v_exp_f32 v19, v19
  v_cvt_pk_bf16_f32 v20, v12, v13
  v_cvt_pk_bf16_f32 v21, v14, v15
  v_cvt_pk_bf16_f32 v22, v16, v17
  v_cvt_pk_bf16_f32 v23, v18, v19
  v_cvt_pk_bf16_f32 v24, v8, v9
  v_mov_b32 v25, v24
  v_mfma_f32_16x16x32_bf16 v[26:29], v[30:33], v[20:23], 0
  v_mfma_f32_16x16x32_bf16 v[152:155], v[120:123], v[20:23], 0
  v_mfma_f32_16x16x32_bf16 v[156:159], v[124:127], v[20:23], 0
  v_mfma_f32_16x16x32_bf16 v[160:163], v[128:131], v[20:23], 0
  v_mfma_f32_16x16x32_bf16 v[164:167], v[132:135], v[20:23], 0
  v_mfma_f32_16x16x32_bf16 v[168:171], v[136:139], v[20:23], 0
  v_mfma_f32_16x16x32_bf16 v[172:175], v[140:143], v[20:23], 0
  v_mfma_f32_16x16x32_bf16 v[176:179], v[144:147], v[20:23], 0
  v_mfma_f32_16x16x32_bf16 v[180:183], v[148:151], v[20:23], 0
  s_waitcnt vmcnt(0)
  v_mfma_f32_16x16x16_bf16 v[26:29], v[34:35], v[24:25], v[26:29]
  v_mfma_f32_16x16x16_bf16 v[152:155], v[56:57], v[24:25], v[152:155]
  v_mfma_f32_16x16x16_bf16 v[156:159], v[58:59], v[24:25], v[156:159]
  v_mfma_f32_16x16x16_bf16 v[160:163], v[60:61], v[24:25], v[160:163]
  v_mfma_f32_16x16x16_bf16 v[164:167], v[62:63], v[24:25], v[164:167]
  v_mfma_f32_16x16x16_bf16 v[168:171], v[64:65], v[24:25], v[168:171]
  v_mfma_f32_16x16x16_bf16 v[172:175], v[66:67], v[24:25], v[172:175]
  v_mfma_f32_16x16x16_bf16 v[176:179], v[68:69], v[24:25], v[176:179]
  v_mfma_f32_16x16x16_bf16 v[180:183], v[70:71], v[24:25], v[180:183]
  s_add_u32 s93, s29, 2
  s_cmp_ge_u32 s90, s93
  s_cbranch_scc1 L_wt_36
  s_mov_b32 s94, 0
L_wt_35:
  buffer_load_dword v38, v5, s[4:7], 0 offen sc1
  s_waitcnt vmcnt(0)
  v_readlane_b32 s90, v38, 0
  v_readlane_b32 s92, v38, 1
  s_min_u32 s90, s90, s92
  v_readlane_b32 s92, v38, 2
  s_min_u32 s90, s90, s92
  s_cmp_ge_u32 s90, s93
  s_cbranch_scc1 L_wt_36
  s_add_u32 s94, s94, 1
  s_cmp_lt_u32 s94, 400000
  s_cbranch_scc1 L_wt_35
  s_branch L_fail
L_wt_36:
  s_add_u32 s21, s24, 4194304
  s_add_u32 s22, s24, 37748736
  s_lshl_b32 s23, s27, 10
  s_add_u32 s22, s22, s23
  buffer_load_dwordx4 v[72:75], v1, s[4:7], s22 offen
  buffer_load_dwordx4 v[88:91], v1, s[4:7], s21 offen
  buffer_load_dwordx4 v[92:95], v1, s[4:7], s21 offen offset:1024
  s_add_u32 s21, s21, 2048
  s_add_u32 s22, s22, 2048
  buffer_load_dwordx4 v[76:79], v1, s[4:7], s22 offen
  buffer_load_dwordx4 v[96:99], v1, s[4:7], s21 offen
  buffer_load_dwordx4 v[100:103], v1, s[4:7], s21 offen offset:1024
  s_add_u32 s21, s21, 2048
  s_add_u32 s22, s22, 2048
  buffer_load_dwordx4 v[80:83], v1, s[4:7], s22 offen
  buffer_load_dwordx4 v[104:107], v1, s[4:7], s21 offen
  buffer_load_dwordx4 v[108:111], v1, s[4:7], s21 offen offset:1024
  s_add_u32 s21, s21, 2048
  s_add_u32 s22, s22, 2048
  buffer_load_dwordx4 v[84:87], v1, s[4:7], s22 offen
  buffer_load_dwordx4 v[112:115], v1, s[4:7], s21 offen
  buffer_load_dwordx4 v[116:119], v1, s[4:7], s21 offen offset:1024
  s_add_u32 s21, s24, 20971520
  buffer_load_dwordx4 v[120:123], v1, s[4:7], s21 offen
  buffer_load_dwordx4 v[124:127], v1, s[4:7], s21 offen offset:1024
  s_add_u32 s21, s21, 2048
  buffer_load_dwordx4 v[128:131], v1, s[4:7], s21 offen
  buffer_load_dwordx4 v[132:135], v1, s[4:7], s21 offen offset:1024
  s_add_u32 s21, s21, 2048
  buffer_load_dwordx4 v[136:139], v1, s[4:7], s21 offen
  buffer_load_dwordx4 v[140:143], v1, s[4:7], s21 offen offset:1024
  s_add_u32 s21, s21, 2048
  buffer_load_dwordx4 v[144:147], v1, s[4:7], s21 offen
  buffer_load_dwordx4 v[148:151], v1, s[4:7], s21 offen offset:1024
  s_add_u32 s24, s24, 524288
  v_rcp_f32 v36, v26
  s_nop 0
  v_mul_f32 v152, v152, v36
  v_mul_f32 v153, v153, v36
  v_mul_f32 v154, v154, v36
  v_mul_f32 v155, v155, v36
  v_cvt_pk_bf16_f32 v184, v152, v153
  v_cvt_pk_bf16_f32 v185, v154, v155
  v_mul_f32 v156, v156, v36
  v_mul_f32 v157, v157, v36
  v_mul_f32 v158, v158, v36
  v_mul_f32 v159, v159, v36
  v_cvt_pk_bf16_f32 v186, v156, v157
  v_cvt_pk_bf16_f32 v187, v158, v159
  ds_write_b128 v2, v[184:187] offset:16384
  v_mul_f32 v160, v160, v36
  v_mul_f32 v161, v161, v36
  v_mul_f32 v162, v162, v36
  v_mul_f32 v163, v163, v36
  v_cvt_pk_bf16_f32 v188, v160, v161
  v_cvt_pk_bf16_f32 v189, v162, v163
  v_mul_f32 v164, v164, v36
  v_mul_f32 v165, v165, v36
  v_mul_f32 v166, v166, v36
  v_mul_f32 v167, v167, v36
  v_cvt_pk_bf16_f32 v190, v164, v165
  v_cvt_pk_bf16_f32 v191, v166, v167
  ds_write_b128 v2, v[188:191] offset:17408
  v_mul_f32 v168, v168, v36
  v_mul_f32 v169, v169, v36
  v_mul_f32 v170, v170, v36
  v_mul_f32 v171, v171, v36
  v_cvt_pk_bf16_f32 v192, v168, v169
  v_cvt_pk_bf16_f32 v193, v170, v171
  v_mul_f32 v172, v172, v36
  v_mul_f32 v173, v173, v36
  v_mul_f32 v174, v174, v36
  v_mul_f32 v175, v175, v36
  v_cvt_pk_bf16_f32 v194, v172, v173
  v_cvt_pk_bf16_f32 v195, v174, v175
  ds_write_b128 v2, v[192:195] offset:18432
  v_mul_f32 v176, v176, v36
  v_mul_f32 v177, v177, v36
  v_mul_f32 v178, v178, v36
  v_mul_f32 v179, v179, v36
  v_cvt_pk_bf16_f32 v196, v176, v177
  v_cvt_pk_bf16_f32 v197, v178, v179
  v_mul_f32 v180, v180, v36
  v_mul_f32 v181, v181, v36
  v_mul_f32 v182, v182, v36
  v_mul_f32 v183, v183, v36
  v_cvt_pk_bf16_f32 v198, v180, v181
  v_cvt_pk_bf16_f32 v199, v182, v183
  ds_write_b128 v2, v[196:199] offset:19456
  s_waitcnt lgkmcnt(0)
  s_barrier
  s_cmp_lg_u32 s17, 0
  s_cbranch_scc1 L_fs_37
  v_mov_b32 v38, s29
  s_mov_b64 exec, 1
  buffer_store_dword v38, off, s[4:7], s95 sc1
  s_mov_b64 exec, -1
L_fs_37:
  ds_read_b128 v[40:43], v1 offset:16384
  ds_read_b128 v[44:47], v1 offset:20480
  ds_read_b128 v[48:51], v1 offset:17408
  s_waitcnt lgkmcnt(2)
  v_mfma_f32_16x16x32_bf16 v[152:155], a[0:3], v[40:43], 0
  ds_read_b128 v[52:55], v1 offset:21504
  v_mfma_f32_16x16x32_bf16 v[160:163], a[32:35], v[40:43], 0
  v_mfma_f32_16x16x32_bf16 v[168:171], a[64:67], v[40:43], 0
  v_mfma_f32_16x16x32_bf16 v[176:179], a[96:99], v[40:43], 0
  v_mfma_f32_16x16x32_bf16 v[184:187], a[128:131], v[40:43], 0
  v_mfma_f32_16x16x32_bf16 v[192:195], a[160:163], v[40:43], 0
  v_mfma_f32_16x16x32_bf16 v[200:203], a[192:195], v[40:43], 0
  v_mfma_f32_16x16x32_bf16 v[208:211], a[224:227], v[40:43], 0
  v_mfma_f32_16x16x32_bf16 v[216:219], v[224:227], v[40:43], 0
  s_waitcnt lgkmcnt(2)
  v_mfma_f32_16x16x32_bf16 v[156:159], a[0:3], v[44:47], 0
  ds_read_b128 v[40:43], v1 offset:18432
  v_mfma_f32_16x16x32_bf16 v[164:167], a[32:35], v[44:47], 0
  v_mfma_f32_16x16x32_bf16 v[172:175], a[64:67], v[44:47], 0
  v_mfma_f32_16x16x32_bf16 v[180:183], a[96:99], v[44:47], 0
  v_mfma_f32_16x16x32_bf16 v[188:191], a[128:131], v[44:47], 0
  v_mfma_f32_16x16x32_bf16 v[196:199], a[160:163], v[44:47], 0
  v_mfma_f32_16x16x32_bf16 v[204:207], a[192:195], v[44:47], 0
  v_mfma_f32_16x16x32_bf16 v[212:215], a[224:227], v[44:47], 0
  v_mfma_f32_16x16x32_bf16 v[220:223], v[224:227], v[44:47], 0
  s_waitcnt lgkmcnt(2)
  v_mfma_f32_16x16x32_bf16 v[152:155], a[4:7], v[48:51], v[152:155]
  ds_read_b128 v[44:47], v1 offset:22528
  v_mfma_f32_16x16x32_bf16 v[160:163], a[36:39], v[48:51], v[160:163]
  v_mfma_f32_16x16x32_bf16 v[168:171], a[68:71], v[48:51], v[168:171]
  v_mfma_f32_16x16x32_bf16 v[176:179], a[100:103], v[48:51], v[176:179]
  v_mfma_f32_16x16x32_bf16 v[184:187], a[132:135], v[48:51], v[184:187]
  v_mfma_f32_16x16x32_bf16 v[192:195], a[164:167], v[48:51], v[192:195]
  v_mfma_f32_16x16x32_bf16 v[200:203], a[196:199], v[48:51], v[200:203]
  v_mfma_f32_16x16x32_bf16 v[208:211], a[228:231], v[48:51], v[208:211]
  v_mfma_f32_16x16x32_bf16 v[216:219], v[228:231], v[48:51], v[216:219]
  s_waitcnt lgkmcnt(2)
  v_mfma_f32_16x16x32_bf16 v[156:159], a[4:7], v[52:55], v[156:159]
  ds_read_b128 v[48:51], v1 offset:19456
  v_mfma_f32_16x16x32_bf16 v[164:167], a[36:39], v[52:55], v[164:167]
  v_mfma_f32_16x16x32_bf16 v[172:175], a[68:71], v[52:55], v[172:175]
  v_mfma_f32_16x16x32_bf16 v[180:183], a[100:103], v[52:55], v[180:183]
  v_mfma_f32_16x16x32_bf16 v[188:191], a[132:135], v[52:55], v[188:191]
  v_mfma_f32_16x16x32_bf16 v[196:199], a[164:167], v[52:55], v[196:199]
  v_mfma_f32_16x16x32_bf16 v[204:207], a[196:199], v[52:55], v[204:207]
  v_mfma_f32_16x16x32_bf16 v[212:215], a[228:231], v[52:55], v[212:215]
  v_mfma_f32_16x16x32_bf16 v[220:223], v[228:231], v[52:55], v[220:223]
  s_waitcnt lgkmcnt(2)
  v_mfma_f32_16x16x32_bf16 v[152:155], a[8:11], v[40:43], v[152:155]
  ds_read_b128 v[52:55], v1 offset:23552
  v_mfma_f32_16x16x32_bf16 v[160:163], a[40:43], v[40:43], v[160:163]
  v_mfma_f32_16x16x32_bf16 v[168:171], a[72:75], v[40:43], v[168:171]
  v_mfma_f32_16x16x32_bf16 v[176:179], a[104:107], v[40:43], v[176:179]
  v_mfma_f32_16x16x32_bf16 v[184:187], a[136:139], v[40:43], v[184:187]
  v_mfma_f32_16x16x32_bf16 v[192:195], a[168:171], v[40:43], v[192:195]
  v_mfma_f32_16x16x32_bf16 v[200:203], a[200:203], v[40:43], v[200:203]
  v_mfma_f32_16x16x32_bf16 v[208:211], a[232:235], v[40:43], v[208:211]
  v_mfma_f32_16x16x32_bf16 v[216:219], v[232:235], v[40:43], v[216:219]
  s_waitcnt lgkmcnt(2)
  v_mfma_f32_16x16x32_bf16 v[156:159], a[8:11], v[44:47], v[156:159]
  ds_read_b128 v[40:43], v1 offset:24576
  v_mfma_f32_16x16x32_bf16 v[164:167], a[40:43], v[44:47], v[164:167]
  v_mfma_f32_16x16x32_bf16 v[172:175], a[72:75], v[44:47], v[172:175]
  v_mfma_f32_16x16x32_bf16 v[180:183], a[104:107], v[44:47], v[180:183]
  v_mfma_f32_16x16x32_bf16 v[188:191], a[136:139], v[44:47], v[188:191]
  v_mfma_f32_16x16x32_bf16 v[196:199], a[168:171], v[44:47], v[196:199]
  v_mfma_f32_16x16x32_bf16 v[204:207], a[200:203], v[44:47], v[204:207]
  v_mfma_f32_16x16x32_bf16 v[212:215], a[232:235], v[44:47], v[212:215]
  v_mfma_f32_16x16x32_bf16 v[220:223], v[232:235], v[44:47], v[220:223]
  s_waitcnt lgkmcnt(2)
  v_mfma_f32_16x16x32_bf16 v[152:155], a[12:15], v[48:51], v[152:155]
  ds_read_b128 v[44:47], v1 offset:28672
  v_mfma_f32_16x16x32_bf16 v[160:163], a[44:47], v[48:51], v[160:163]
  v_mfma_f32_16x16x32_bf16 v[168:171], a[76:79], v[48:51], v[168:171]
  v_mfma_f32_16x16x32_bf16 v[176:179], a[108:111], v[48:51], v[176:179]
  v_mfma_f32_16x16x32_bf16 v[184:187], a[140:143], v[48:51], v[184:187]
  v_mfma_f32_16x16x32_bf16 v[192:195], a[172:175], v[48:51], v[192:195]
  v_mfma_f32_16x16x32_bf16 v[200:203], a[204:207], v[48:51], v[200:203]
  v_mfma_f32_16x16x32_bf16 v[208:211], a[236:239], v[48:51], v[208:211]
  v_mfma_f32_16x16x32_bf16 v[216:219], v[236:239], v[48:51], v[216:219]
  s_waitcnt lgkmcnt(2)
  v_mfma_f32_16x16x32_bf16 v[156:159], a[12:15], v[52:55], v[156:159]
  ds_read_b128 v[48:51], v1 offset:25600
  v_mfma_f32_16x16x32_bf16 v[164:167], a[44:47], v[52:55], v[164:167]
  v_mfma_f32_16x16x32_bf16 v[172:175], a[76:79], v[52:55], v[172:175]
  v_mfma_f32_16x16x32_bf16 v[180:183], a[108:111], v[52:55], v[180:183]
  v_mfma_f32_16x16x32_bf16 v[188:191], a[140:143], v[52:55], v[188:191]
  v_mfma_f32_16x16x32_bf16 v[196:199], a[172:175], v[52:55], v[196:199]
  v_mfma_f32_16x16x32_bf16 v[204:207], a[204:207], v[52:55], v[204:207]
  v_mfma_f32_16x16x32_bf16 v[212:215], a[236:239], v[52:55], v[212:215]
  v_mfma_f32_16x16x32_bf16 v[220:223], v[236:239], v[52:55], v[220:223]
  s_waitcnt lgkmcnt(2)
  v_mfma_f32_16x16x32_bf16 v[152:155], a[16:19], v[40:43], v[152:155]
  ds_read_b128 v[52:55], v1 offset:29696
  v_mfma_f32_16x16x32_bf16 v[160:163], a[48:51], v[40:43], v[160:163]
  v_mfma_f32_16x16x32_bf16 v[168:171], a[80:83], v[40:43], v[168:171]
  v_mfma_f32_16x16x32_bf16 v[176:179], a[112:115], v[40:43], v[176:179]
  v_mfma_f32_16x16x32_bf16 v[184:187], a[144:147], v[40:43], v[184:187]
  v_mfma_f32_16x16x32_bf16 v[192:195], a[176:179], v[40:43], v[192:195]
  v_mfma_f32_16x16x32_bf16 v[200:203], a[208:211], v[40:43], v[200:203]
  v_mfma_f32_16x16x32_bf16 v[208:211], a[240:243], v[40:43], v[208:211]
  v_mfma_f32_16x16x32_bf16 v[216:219], v[240:243], v[40:43], v[216:219]
  s_waitcnt lgkmcnt(2)
  v_mfma_f32_16x16x32_bf16 v[156:159], a[16:19], v[44:47], v[156:159]
  ds_read_b128 v[40:43], v1 offset:26624
  v_mfma_f32_16x16x32_bf16 v[164:167], a[48:51], v[44:47], v[164:167]
  v_mfma_f32_16x16x32_bf16 v[172:175], a[80:83], v[44:47], v[172:175]
  v_mfma_f32_16x16x32_bf16 v[180:183], a[112:115], v[44:47], v[180:183]
  v_mfma_f32_16x16x32_bf16 v[188:191], a[144:147], v[44:47], v[188:191]
  v_mfma_f32_16x16x32_bf16 v[196:199], a[176:179], v[44:47], v[196:199]
  v_mfma_f32_16x16x32_bf16 v[204:207], a[208:211], v[44:47], v[204:207]
  v_mfma_f32_16x16x32_bf16 v[212:215], a[240:243], v[44:47], v[212:215]
  v_mfma_f32_16x16x32_bf16 v[220:223], v[240:243], v[44:47], v[220:223]
  s_waitcnt lgkmcnt(2)
  v_mfma_f32_16x16x32_bf16 v[152:155], a[20:23], v[48:51], v[152:155]
  ds_read_b128 v[44:47], v1 offset:30720
  v_mfma_f32_16x16x32_bf16 v[160:163], a[52:55], v[48:51], v[160:163]
  v_mfma_f32_16x16x32_bf16 v[168:171], a[84:87], v[48:51], v[168:171]
  v_mfma_f32_16x16x32_bf16 v[176:179], a[116:119], v[48:51], v[176:179]
  v_mfma_f32_16x16x32_bf16 v[184:187], a[148:151], v[48:51], v[184:187]
  v_mfma_f32_16x16x32_bf16 v[192:195], a[180:183], v[48:51], v[192:195]
  v_mfma_f32_16x16x32_bf16 v[200:203], a[212:215], v[48:51], v[200:203]
  v_mfma_f32_16x16x32_bf16 v[208:211], a[244:247], v[48:51], v[208:211]
  v_mfma_f32_16x16x32_bf16 v[216:219], v[244:247], v[48:51], v[216:219]
  s_waitcnt lgkmcnt(2)
  v_mfma_f32_16x16x32_bf16 v[156:159], a[20:23], v[52:55], v[156:159]
  ds_read_b128 v[48:51], v1 offset:27648
  v_mfma_f32_16x16x32_bf16 v[164:167], a[52:55], v[52:55], v[164:167]
  v_mfma_f32_16x16x32_bf16 v[172:175], a[84:87], v[52:55], v[172:175]
  v_mfma_f32_16x16x32_bf16 v[180:183], a[116:119], v[52:55], v[180:183]
  v_mfma_f32_16x16x32_bf16 v[188:191], a[148:151], v[52:55], v[188:191]
  v_mfma_f32_16x16x32_bf16 v[196:199], a[180:183], v[52:55], v[196:199]
  v_mfma_f32_16x16x32_bf16 v[204:207], a[212:215], v[52:55], v[204:207]
  v_mfma_f32_16x16x32_bf16 v[212:215], a[244:247], v[52:55], v[212:215]
  v_mfma_f32_16x16x32_bf16 v[220:223], v[244:247], v[52:55], v[220:223]
  s_waitcnt lgkmcnt(2)
  v_mfma_f32_16x16x32_bf16 v[152:155], a[24:27], v[40:43], v[152:155]
  ds_read_b128 v[52:55], v1 offset:31744
  v_mfma_f32_16x16x32_bf16 v[160:163], a[56:59], v[40:43], v[160:163]
  v_mfma_f32_16x16x32_bf16 v[168:171], a[88:91], v[40:43], v[168:171]
  v_mfma_f32_16x16x32_bf16 v[176:179], a[120:123], v[40:43], v[176:179]
  v_mfma_f32_16x16x32_bf16 v[184:187], a[152:155], v[40:43], v[184:187]
  v_mfma_f32_16x16x32_bf16 v[192:195], a[184:187], v[40:43], v[192:195]
  v_mfma_f32_16x16x32_bf16 v[200:203], a[216:219], v[40:43], v[200:203]
  v_mfma_f32_16x16x32_bf16 v[208:211], a[248:251], v[40:43], v[208:211]
  v_mfma_f32_16x16x32_bf16 v[216:219], v[248:251], v[40:43], v[216:219]
  s_waitcnt lgkmcnt(2)
  v_mfma_f32_16x16x32_bf16 v[156:159], a[24:27], v[44:47], v[156:159]
  v_mfma_f32_16x16x32_bf16 v[164:167], a[56:59], v[44:47], v[164:167]
  v_mfma_f32_16x16x32_bf16 v[172:175], a[88:91], v[44:47], v[172:175]
  v_mfma_f32_16x16x32_bf16 v[180:183], a[120:123], v[44:47], v[180:183]
  v_mfma_f32_16x16x32_bf16 v[188:191], a[152:155], v[44:47], v[188:191]
  v_mfma_f32_16x16x32_bf16 v[196:199], a[184:187], v[44:47], v[196:199]
  v_mfma_f32_16x16x32_bf16 v[204:207], a[216:219], v[44:47], v[204:207]
  v_mfma_f32_16x16x32_bf16 v[212:215], a[248:251], v[44:47], v[212:215]
  v_mfma_f32_16x16x32_bf16 v[220:223], v[248:251], v[44:47], v[220:223]
  s_waitcnt lgkmcnt(1)
  v_mfma_f32_16x16x32_bf16 v[152:155], a[28:31], v[48:51], v[152:155]
  v_mfma_f32_16x16x32_bf16 v[160:163], a[60:63], v[48:51], v[160:163]
  v_mfma_f32_16x16x32_bf16 v[168:171], a[92:95], v[48:51], v[168:171]
  v_mfma_f32_16x16x32_bf16 v[176:179], a[124:127], v[48:51], v[176:179]
  v_mfma_f32_16x16x32_bf16 v[184:187], a[156:159], v[48:51], v[184:187]
  v_mfma_f32_16x16x32_bf16 v[192:195], a[188:191], v[48:51], v[192:195]
  v_mfma_f32_16x16x32_bf16 v[200:203], a[220:223], v[48:51], v[200:203]
  v_mfma_f32_16x16x32_bf16 v[208:211], a[252:255], v[48:51], v[208:211]
  v_mfma_f32_16x16x32_bf16 v[216:219], v[252:255], v[48:51], v[216:219]
  s_waitcnt lgkmcnt(0)
  v_mfma_f32_16x16x32_bf16 v[156:159], a[28:31], v[52:55], v[156:159]
  v_mfma_f32_16x16x32_bf16 v[164:167], a[60:63], v[52:55], v[164:167]
  v_mfma_f32_16x16x32_bf16 v[172:175], a[92:95], v[52:55], v[172:175]
  v_mfma_f32_16x16x32_bf16 v[180:183], a[124:127], v[52:55], v[180:183]
  v_mfma_f32_16x16x32_bf16 v[188:191], a[156:159], v[52:55], v[188:191]
  v_mfma_f32_16x16x32_bf16 v[196:199], a[188:191], v[52:55], v[196:199]
  v_mfma_f32_16x16x32_bf16 v[204:207], a[220:223], v[52:55], v[204:207]
  v_mfma_f32_16x16x32_bf16 v[212:215], a[252:255], v[52:55], v[212:215]
  v_mfma_f32_16x16x32_bf16 v[220:223], v[252:255], v[52:55], v[220:223]
  v_cvt_pk_bf16_f32 v8, v152, v153
  v_cvt_pk_bf16_f32 v9, v154, v155
  v_cvt_pk_bf16_f32 v10, v156, v157
  v_cvt_pk_bf16_f32 v11, v158, v159
  s_add_u32 s21, s26, 0
  buffer_store_dwordx4 v[8:11], v1, s[4:7], s21 offen sc1
  v_cvt_pk_bf16_f32 v12, v160, v161
  v_cvt_pk_bf16_f32 v13, v162, v163
  v_cvt_pk_bf16_f32 v14, v164, v165
  v_cvt_pk_bf16_f32 v15, v166, v167
  s_add_u32 s21, s26, 1024
  buffer_store_dwordx4 v[12:15], v1, s[4:7], s21 offen sc1
  v_cvt_pk_bf16_f32 v16, v168, v169
  v_cvt_pk_bf16_f32 v17, v170, v171
  v_cvt_pk_bf16_f32 v18, v172, v173
  v_cvt_pk_bf16_f32 v19, v174, v175
  s_add_u32 s21, s26, 2048
  buffer_store_dwordx4 v[16:19], v1, s[4:7], s21 offen sc1
  v_cvt_pk_bf16_f32 v20, v176, v177
  v_cvt_pk_bf16_f32 v21, v178, v179
  v_cvt_pk_bf16_f32 v22, v180, v181
  v_cvt_pk_bf16_f32 v23, v182, v183
  s_add_u32 s21, s26, 3072
  buffer_store_dwordx4 v[20:23], v1, s[4:7], s21 offen sc1
  v_cvt_pk_bf16_f32 v8, v184, v185
  v_cvt_pk_bf16_f32 v9, v186, v187
  v_cvt_pk_bf16_f32 v10, v188, v189
  v_cvt_pk_bf16_f32 v11, v190, v191
  s_add_u32 s21, s26, 4096
  buffer_store_dwordx4 v[8:11], v1, s[4:7], s21 offen sc1
  v_cvt_pk_bf16_f32 v12, v192, v193
  v_cvt_pk_bf16_f32 v13, v194, v195
  v_cvt_pk_bf16_f32 v14, v196, v197
  v_cvt_pk_bf16_f32 v15, v198, v199
  s_add_u32 s21, s26, 5120
  buffer_store_dwordx4 v[12:15], v1, s[4:7], s21 offen sc1
  v_cvt_pk_bf16_f32 v16, v200, v201
  v_cvt_pk_bf16_f32 v17, v202, v203
  v_cvt_pk_bf16_f32 v18, v204, v205
  v_cvt_pk_bf16_f32 v19, v206, v207
  s_add_u32 s21, s26, 6144
  buffer_store_dwordx4 v[16:19], v1, s[4:7], s21 offen sc1
  v_cvt_pk_bf16_f32 v20, v208, v209
  v_cvt_pk_bf16_f32 v21, v210, v211
  v_cvt_pk_bf16_f32 v22, v212, v213
  v_cvt_pk_bf16_f32 v23, v214, v215
  s_add_u32 s21, s26, 7168
  buffer_store_dwordx4 v[20:23], v1, s[4:7], s21 offen sc1
  v_cvt_pk_bf16_f32 v8, v216, v217
  v_cvt_pk_bf16_f32 v9, v218, v219
  v_cvt_pk_bf16_f32 v10, v220, v221
  v_cvt_pk_bf16_f32 v11, v222, v223
  s_add_u32 s21, s26, 8192
  buffer_store_dwordx4 v[8:11], v1, s[4:7], s21 offen sc1
  s_add_u32 s26, s26, 1179648
  s_add_u32 s29, s29, 1
  s_add_u32 s20, s20, 2
  s_branch L_fol_loop
L_fol_end3:
  s_waitcnt vmcnt(9)
  v_mfma_f32_16x16x32_bf16 v[12:15], v[88:91], v[72:75], 0
  v_mfma_f32_16x16x32_bf16 v[16:19], v[92:95], v[72:75], 0
  v_mfma_f32_16x16x32_bf16 v[12:15], v[96:99], v[76:79], v[12:15]
  v_mfma_f32_16x16x32_bf16 v[16:19], v[100:103], v[76:79], v[16:19]
  v_mfma_f32_16x16x32_bf16 v[12:15], v[104:107], v[80:83], v[12:15]
  v_mfma_f32_16x16x32_bf16 v[16:19], v[108:111], v[80:83], v[16:19]
  v_mfma_f32_16x16x32_bf16 v[12:15], v[112:115], v[84:87], v[12:15]
  v_mfma_f32_16x16x32_bf16 v[16:19], v[116:119], v[84:87], v[16:19]
  s_mov_b32 s94, 0
  s_cmp_ge_u32 s91, s20
  s_cbranch_scc1 L_gm_39
L_gm_38:
  buffer_load_dword v38, v6, s[4:7], 0 offen sc1
  s_waitcnt vmcnt(0)
  v_readfirstlane_b32 s91, v38
  s_cmp_ge_u32 s91, s20
  s_cbranch_scc1 L_gm_39
  s_add_u32 s94, s94, 1
  s_cmp_lt_u32 s94, 400000
  s_cbranch_scc1 L_gm_38
  s_branch L_fail
L_gm_39:
L_md_40:
  s_add_u32 s21, s25, 54525952
  s_add_u32 s22, s25, 62914560
  buffer_load_dwordx4 v[40:43], v1, s[4:7], s21 offen offset:0 sc1
  buffer_load_dwordx4 v[44:47], v1, s[4:7], s21 offen offset:1024 sc1
  buffer_load_dwordx4 v[48:51], v1, s[4:7], s21 offen offset:2048 sc1
  buffer_load_dwordx4 v[52:55], v1, s[4:7], s21 offen offset:3072 sc1
  buffer_load_dwordx4 v[56:59], v1, s[4:7], s22 offen offset:0 sc1
  buffer_load_dwordx4 v[60:63], v1, s[4:7], s22 offen offset:1024 sc1
  buffer_load_dwordx4 v[64:67], v1, s[4:7], s22 offen offset:2048 sc1
  buffer_load_dwordx4 v[68:71], v1, s[4:7], s22 offen offset:3072 sc1
  s_waitcnt vmcnt(4)
  v_max3_u32 v36, v40, v41, v42
  v_max3_u32 v37, v43, v44, v45
  v_max3_u32 v36, v36, v46, v47
  v_max3_u32 v37, v37, v48, v49
  v_max3_u32 v36, v36, v50, v51
  v_max3_u32 v37, v37, v52, v53
  v_max3_u32 v36, v36, v54, v55
  v_max_u32 v36, v36, v37
  v_cmp_eq_u32 vcc, -1, v36
  s_cbranch_vccz L_md_41
  s_add_u32 s94, s94, 1
  s_cmp_lt_u32 s94, 400000
  s_cbranch_scc1 L_md_40
  s_branch L_fail
L_md_41:
  v_mfma_f32_16x16x32_bf16 v[8:11], v[40:43], v[72:75], 0
  v_mfma_f32_16x16x32_bf16 v[8:11], v[44:47], v[76:79], v[8:11]
  v_mfma_f32_16x16x32_bf16 v[8:11], v[48:51], v[80:83], v[8:11]
  v_mfma_f32_16x16x32_bf16 v[8:11], v[52:55], v[84:87], v[8:11]
  v_mov_b32 v37, 0xce6e6b28
  v_cndmask_b32 v12, v37, v12, s[40:41]
  v_cndmask_b32 v13, v37, v13, s[42:43]
  v_cndmask_b32 v14, v37, v14, s[44:45]
  v_cndmask_b32 v15, v37, v15, s[46:47]
  v_cndmask_b32 v16, v37, v16, s[48:49]
  v_cndmask_b32 v17, v37, v17, s[50:51]
  v_cndmask_b32 v18, v37, v18, s[52:53]
  v_cndmask_b32 v19, v37, v19, s[54:55]
  v_max3_f32 v36, v12, v13, v14
  v_max3_f32 v37, v15, v16, v17
  v_max3_f32 v36, v36, v18, v19
  v_max3_f32 v37, v37, v8, v9
  v_max_f32 v36, v36, v37
  v_mov_b32 v37, v36
  s_nop 1
  v_permlane16_swap_b32 v36, v37
  v_max_f32 v36, v36, v37
  v_mov_b32 v37, v36
  s_nop 1
  v_permlane32_swap_b32 v36, v37
  v_max_f32 v36, v36, v37
  v_mul_f32 v36, s28, v36
  v_fma_f32 v8, v8, s28, -v36
  v_fma_f32 v9, v9, s28, -v36
  v_fma_f32 v12, v12, s28, -v36
  v_fma_f32 v13, v13, s28, -v36
  v_fma_f32 v14, v14, s28, -v36
  v_fma_f32 v15, v15, s28, -v36
  v_fma_f32 v16, v16, s28, -v36
  v_fma_f32 v17, v17, s28, -v36
  v_fma_f32 v18, v18, s28, -v36
  v_fma_f32 v19, v19, s28, -v36
  v_exp_f32 v8, v8
  v_exp_f32 v9, v9
  v_exp_f32 v12, v12
  v_exp_f32 v13, v13
  v_exp_f32 v14, v14
  v_exp_f32 v15, v15
  v_exp_f32 v16, v16
  v_exp_f32 v17, v17
  v_exp_f32 v18, v18
  v_exp_f32 v19, v19
  v_cvt_pk_bf16_f32 v20, v12, v13
  v_cvt_pk_bf16_f32 v21, v14, v15
  v_cvt_pk_bf16_f32 v22, v16, v17
  v_cvt_pk_bf16_f32 v23, v18, v19
  v_cvt_pk_bf16_f32 v24, v8, v9
  v_mov_b32 v25, v24
  v_mfma_f32_16x16x32_bf16 v[26:29], v[30:33], v[20:23], 0
  v_mfma_f32_16x16x32_bf16 v[152:155], v[120:123], v[20:23], 0
  v_mfma_f32_16x16x32_bf16 v[156:159], v[124:127], v[20:23], 0
  v_mfma_f32_16x16x32_bf16 v[160:163], v[128:131], v[20:23], 0
  v_mfma_f32_16x16x32_bf16 v[164:167], v[132:135], v[20:23], 0
  v_mfma_f32_16x16x32_bf16 v[168:171], v[136:139], v[20:23], 0
  v_mfma_f32_16x16x32_bf16 v[172:175], v[140:143], v[20:23], 0
  v_mfma_f32_16x16x32_bf16 v[176:179], v[144:147], v[20:23], 0
  v_mfma_f32_16x16x32_bf16 v[180:183], v[148:151], v[20:23], 0
L_mv_42:
  s_waitcnt vmcnt(0)
  v_max3_u32 v36, v56, v57, v58
  v_max3_u32 v37, v59, v60, v61
  v_max3_u32 v36, v36, v62, v63
  v_max3_u32 v37, v37, v64, v65
  v_max3_u32 v36, v36, v66, v67
  v_max3_u32 v37, v37, v68, v69
  v_max3_u32 v36, v36, v70, v71
  v_max_u32 v36, v36, v37
  v_cmp_eq_u32 vcc, -1, v36
  s_cbranch_vccz L_mv_43
  s_add_u32 s22, s25, 62914560
  buffer_load_dwordx4 v[56:59], v1, s[4:7], s22 offen offset:0 sc1
  buffer_load_dwordx4 v[60:63], v1, s[4:7], s22 offen offset:1024 sc1
  buffer_load_dwordx4 v[64:67], v1, s[4:7], s22 offen offset:2048 sc1
  buffer_load_dwordx4 v[68:71], v1, s[4:7], s22 offen offset:3072 sc1
  s_add_u32 s94, s94, 1
  s_cmp_lt_u32 s94, 400000
  s_cbranch_scc1 L_mv_42
  s_branch L_fail
L_mv_43:
  s_add_u32 s25, s25, 262144
  v_mfma_f32_16x16x16_bf16 v[26:29], v[34:35], v[24:25], v[26:29]
  v_mfma_f32_16x16x16_bf16 v[152:155], v[56:57], v[24:25], v[152:155]
  v_mfma_f32_16x16x16_bf16 v[156:159], v[58:59], v[24:25], v[156:159]
  v_mfma_f32_16x16x16_bf16 v[160:163], v[60:61], v[24:25], v[160:163]
  v_mfma_f32_16x16x16_bf16 v[164:167], v[62:63], v[24:25], v[164:167]
  v_mfma_f32_16x16x16_bf16 v[168:171], v[64:65], v[24:25], v[168:171]
  v_mfma_f32_16x16x16_bf16 v[172:175], v[66:67], v[24:25], v[172:175]
  v_mfma_f32_16x16x16_bf16 v[176:179], v[68:69], v[24:25], v[176:179]
  v_mfma_f32_16x16x16_bf16 v[180:183], v[70:71], v[24:25], v[180:183]
  s_add_u32 s93, s29, 2
  s_cmp_ge_u32 s90, s93
  s_cbranch_scc1 L_wt_45
  s_mov_b32 s94, 0
L_wt_44:
  buffer_load_dword v38, v5, s[4:7], 0 offen sc1
  s_waitcnt vmcnt(0)
  v_readlane_b32 s90, v38, 0
  v_readlane_b32 s92, v38, 1
  s_min_u32 s90, s90, s92
  v_readlane_b32 s92, v38, 2
  s_min_u32 s90, s90, s92
  s_cmp_ge_u32 s90, s93
  s_cbranch_scc1 L_wt_45
  s_add_u32 s94, s94, 1
  s_cmp_lt_u32 s94, 400000
  s_cbranch_scc1 L_wt_44
  s_branch L_fail
L_wt_45:
  s_add_u32 s21, s24, 4194304
  s_add_u32 s22, s24, 37748736
  s_lshl_b32 s23, s27, 10
  s_add_u32 s22, s22, s23
  buffer_load_dwordx4 v[72:75], v1, s[4:7], s22 offen
  buffer_load_dwordx4 v[88:91], v1, s[4:7], s21 offen
  buffer_load_dwordx4 v[92:95], v1, s[4:7], s21 offen offset:1024
  s_add_u32 s21, s21, 2048
  s_add_u32 s22, s22, 2048
  buffer_load_dwordx4 v[76:79], v1, s[4:7], s22 offen
  buffer_load_dwordx4 v[96:99], v1, s[4:7], s21 offen
  buffer_load_dwordx4 v[100:103], v1, s[4:7], s21 offen offset:1024
  s_add_u32 s21, s21, 2048
  s_add_u32 s22, s22, 2048
  buffer_load_dwordx4 v[80:83], v1, s[4:7], s22 offen
  buffer_load_dwordx4 v[104:107], v1, s[4:7], s21 offen
  buffer_load_dwordx4 v[108:111], v1, s[4:7], s21 offen offset:1024
  s_add_u32 s21, s21, 2048
  s_add_u32 s22, s22, 2048
  buffer_load_dwordx4 v[84:87], v1, s[4:7], s22 offen
  buffer_load_dwordx4 v[112:115], v1, s[4:7], s21 offen
  buffer_load_dwordx4 v[116:119], v1, s[4:7], s21 offen offset:1024
  s_add_u32 s21, s24, 20971520
  buffer_load_dwordx4 v[120:123], v1, s[4:7], s21 offen
  buffer_load_dwordx4 v[124:127], v1, s[4:7], s21 offen offset:1024
  s_add_u32 s21, s21, 2048
  buffer_load_dwordx4 v[128:131], v1, s[4:7], s21 offen
  buffer_load_dwordx4 v[132:135], v1, s[4:7], s21 offen offset:1024
  s_add_u32 s21, s21, 2048
  buffer_load_dwordx4 v[136:139], v1, s[4:7], s21 offen
  buffer_load_dwordx4 v[140:143], v1, s[4:7], s21 offen offset:1024
  s_add_u32 s21, s21, 2048
  buffer_load_dwordx4 v[144:147], v1, s[4:7], s21 offen
  buffer_load_dwordx4 v[148:151], v1, s[4:7], s21 offen offset:1024
  s_add_u32 s24, s24, 524288
  v_rcp_f32 v36, v26
  s_nop 0
  v_mul_f32 v152, v152, v36
  v_mul_f32 v153, v153, v36
  v_mul_f32 v154, v154, v36
  v_mul_f32 v155, v155, v36
  v_cvt_pk_bf16_f32 v184, v152, v153
  v_cvt_pk_bf16_f32 v185, v154, v155
  v_mul_f32 v156, v156, v36
  v_mul_f32 v157, v157, v36
  v_mul_f32 v158, v158, v36
  v_mul_f32 v159, v159, v36
  v_cvt_pk_bf16_f32 v186, v156, v157
  v_cvt_pk_bf16_f32 v187, v158, v159
  ds_write_b128 v2, v[184:187] offset:16384
  v_mul_f32 v160, v160, v36
  v_mul_f32 v161, v161, v36
  v_mul_f32 v162, v162, v36
  v_mul_f32 v163, v163, v36
  v_cvt_pk_bf16_f32 v188, v160, v161
  v_cvt_pk_bf16_f32 v189, v162, v163
  v_mul_f32 v164, v164, v36
  v_mul_f32 v165, v165, v36
  v_mul_f32 v166, v166, v36
  v_mul_f32 v167, v167, v36
  v_cvt_pk_bf16_f32 v190, v164, v165
  v_cvt_pk_bf16_f32 v191, v166, v167
  ds_write_b128 v2, v[188:191] offset:17408
  v_mul_f32 v168, v168, v36
  v_mul_f32 v169, v169, v36
  v_mul_f32 v170, v170, v36
  v_mul_f32 v171, v171, v36
  v_cvt_pk_bf16_f32 v192, v168, v169
  v_cvt_pk_bf16_f32 v193, v170, v171
  v_mul_f32 v172, v172, v36
  v_mul_f32 v173, v173, v36
  v_mul_f32 v174, v174, v36
  v_mul_f32 v175, v175, v36
  v_cvt_pk_bf16_f32 v194, v172, v173
  v_cvt_pk_bf16_f32 v195, v174, v175
  ds_write_b128 v2, v[192:195] offset:18432
  v_mul_f32 v176, v176, v36
  v_mul_f32 v177, v177, v36
  v_mul_f32 v178, v178, v36
  v_mul_f32 v179, v179, v36
  v_cvt_pk_bf16_f32 v196, v176, v177
  v_cvt_pk_bf16_f32 v197, v178, v179
  v_mul_f32 v180, v180, v36
  v_mul_f32 v181, v181, v36
  v_mul_f32 v182, v182, v36
  v_mul_f32 v183, v183, v36
  v_cvt_pk_bf16_f32 v198, v180, v181
  v_cvt_pk_bf16_f32 v199, v182, v183
  ds_write_b128 v2, v[196:199] offset:19456
  s_waitcnt lgkmcnt(0)
  s_barrier
  s_cmp_lg_u32 s17, 0
  s_cbranch_scc1 L_fs_46
  v_mov_b32 v38, s29
  s_mov_b64 exec, 1
  buffer_store_dword v38, off, s[4:7], s95 sc1
  s_mov_b64 exec, -1
L_fs_46:
  ds_read_b128 v[40:43], v1 offset:16384
  ds_read_b128 v[44:47], v1 offset:20480
  ds_read_b128 v[48:51], v1 offset:17408
  s_waitcnt lgkmcnt(2)
  v_mfma_f32_16x16x32_bf16 v[152:155], a[0:3], v[40:43], 0
  ds_read_b128 v[52:55], v1 offset:21504
  v_mfma_f32_16x16x32_bf16 v[160:163], a[32:35], v[40:43], 0
  v_mfma_f32_16x16x32_bf16 v[168:171], a[64:67], v[40:43], 0
  v_mfma_f32_16x16x32_bf16 v[176:179], a[96:99], v[40:43], 0
  v_mfma_f32_16x16x32_bf16 v[184:187], a[128:131], v[40:43], 0
  v_mfma_f32_16x16x32_bf16 v[192:195], a[160:163], v[40:43], 0
  v_mfma_f32_16x16x32_bf16 v[200:203], a[192:195], v[40:43], 0
  v_mfma_f32_16x16x32_bf16 v[208:211], a[224:227], v[40:43], 0
  v_mfma_f32_16x16x32_bf16 v[216:219], v[224:227], v[40:43], 0
  s_waitcnt lgkmcnt(2)
  v_mfma_f32_16x16x32_bf16 v[156:159], a[0:3], v[44:47], 0
  ds_read_b128 v[40:43], v1 offset:18432
  v_mfma_f32_16x16x32_bf16 v[164:167], a[32:35], v[44:47], 0
  v_mfma_f32_16x16x32_bf16 v[172:175], a[64:67], v[44:47], 0
  v_mfma_f32_16x16x32_bf16 v[180:183], a[96:99], v[44:47], 0
  v_mfma_f32_16x16x32_bf16 v[188:191], a[128:131], v[44:47], 0
  v_mfma_f32_16x16x32_bf16 v[196:199], a[160:163], v[44:47], 0
  v_mfma_f32_16x16x32_bf16 v[204:207], a[192:195], v[44:47], 0
  v_mfma_f32_16x16x32_bf16 v[212:215], a[224:227], v[44:47], 0
  v_mfma_f32_16x16x32_bf16 v[220:223], v[224:227], v[44:47], 0
  s_waitcnt lgkmcnt(2)
  v_mfma_f32_16x16x32_bf16 v[152:155], a[4:7], v[48:51], v[152:155]
  ds_read_b128 v[44:47], v1 offset:22528
  v_mfma_f32_16x16x32_bf16 v[160:163], a[36:39], v[48:51], v[160:163]
  v_mfma_f32_16x16x32_bf16 v[168:171], a[68:71], v[48:51], v[168:171]
  v_mfma_f32_16x16x32_bf16 v[176:179], a[100:103], v[48:51], v[176:179]
  v_mfma_f32_16x16x32_bf16 v[184:187], a[132:135], v[48:51], v[184:187]
  v_mfma_f32_16x16x32_bf16 v[192:195], a[164:167], v[48:51], v[192:195]
  v_mfma_f32_16x16x32_bf16 v[200:203], a[196:199], v[48:51], v[200:203]
  v_mfma_f32_16x16x32_bf16 v[208:211], a[228:231], v[48:51], v[208:211]
  v_mfma_f32_16x16x32_bf16 v[216:219], v[228:231], v[48:51], v[216:219]
  s_waitcnt lgkmcnt(2)
  v_mfma_f32_16x16x32_bf16 v[156:159], a[4:7], v[52:55], v[156:159]
  ds_read_b128 v[48:51], v1 offset:19456
  v_mfma_f32_16x16x32_bf16 v[164:167], a[36:39], v[52:55], v[164:167]
  v_mfma_f32_16x16x32_bf16 v[172:175], a[68:71], v[52:55], v[172:175]
  v_mfma_f32_16x16x32_bf16 v[180:183], a[100:103], v[52:55], v[180:183]
  v_mfma_f32_16x16x32_bf16 v[188:191], a[132:135], v[52:55], v[188:191]
  v_mfma_f32_16x16x32_bf16 v[196:199], a[164:167], v[52:55], v[196:199]
  v_mfma_f32_16x16x32_bf16 v[204:207], a[196:199], v[52:55], v[204:207]
  v_mfma_f32_16x16x32_bf16 v[212:215], a[228:231], v[52:55], v[212:215]
  v_mfma_f32_16x16x32_bf16 v[220:223], v[228:231], v[52:55], v[220:223]
  s_waitcnt lgkmcnt(2)
  v_mfma_f32_16x16x32_bf16 v[152:155], a[8:11], v[40:43], v[152:155]
  ds_read_b128 v[52:55], v1 offset:23552
  v_mfma_f32_16x16x32_bf16 v[160:163], a[40:43], v[40:43], v[160:163]
  v_mfma_f32_16x16x32_bf16 v[168:171], a[72:75], v[40:43], v[168:171]
  v_mfma_f32_16x16x32_bf16 v[176:179], a[104:107], v[40:43], v[176:179]
  v_mfma_f32_16x16x32_bf16 v[184:187], a[136:139], v[40:43], v[184:187]
  v_mfma_f32_16x16x32_bf16 v[192:195], a[168:171], v[40:43], v[192:195]
  v_mfma_f32_16x16x32_bf16 v[200:203], a[200:203], v[40:43], v[200:203]
  v_mfma_f32_16x16x32_bf16 v[208:211], a[232:235], v[40:43], v[208:211]
  v_mfma_f32_16x16x32_bf16 v[216:219], v[232:235], v[40:43], v[216:219]
  s_waitcnt lgkmcnt(2)
  v_mfma_f32_16x16x32_bf16 v[156:159], a[8:11], v[44:47], v[156:159]
  ds_read_b128 v[40:43], v1 offset:24576
  v_mfma_f32_16x16x32_bf16 v[164:167], a[40:43], v[44:47], v[164:167]
  v_mfma_f32_16x16x32_bf16 v[172:175], a[72:75], v[44:47], v[172:175]
  v_mfma_f32_16x16x32_bf16 v[180:183], a[104:107], v[44:47], v[180:183]
  v_mfma_f32_16x16x32_bf16 v[188:191], a[136:139], v[44:47], v[188:191]
  v_mfma_f32_16x16x32_bf16 v[196:199], a[168:171], v[44:47], v[196:199]
  v_mfma_f32_16x16x32_bf16 v[204:207], a[200:203], v[44:47], v[204:207]
  v_mfma_f32_16x16x32_bf16 v[212:215], a[232:235], v[44:47], v[212:215]
  v_mfma_f32_16x16x32_bf16 v[220:223], v[232:235], v[44:47], v[220:223]
  s_waitcnt lgkmcnt(2)
  v_mfma_f32_16x16x32_bf16 v[152:155], a[12:15], v[48:51], v[152:155]
  ds_read_b128 v[44:47], v1 offset:28672
  v_mfma_f32_16x16x32_bf16 v[160:163], a[44:47], v[48:51], v[160:163]
  v_mfma_f32_16x16x32_bf16 v[168:171], a[76:79], v[48:51], v[168:171]
  v_mfma_f32_16x16x32_bf16 v[176:179], a[108:111], v[48:51], v[176:179]
  v_mfma_f32_16x16x32_bf16 v[184:187], a[140:143], v[48:51], v[184:187]
  v_mfma_f32_16x16x32_bf16 v[192:195], a[172:175], v[48:51], v[192:195]
  v_mfma_f32_16x16x32_bf16 v[200:203], a[204:207], v[48:51], v[200:203]
  v_mfma_f32_16x16x32_bf16 v[208:211], a[236:239], v[48:51], v[208:211]
  v_mfma_f32_16x16x32_bf16 v[216:219], v[236:239], v[48:51], v[216:219]
  s_waitcnt lgkmcnt(2)
  v_mfma_f32_16x16x32_bf16 v[156:159], a[12:15], v[52:55], v[156:159]
  ds_read_b128 v[48:51], v1 offset:25600
  v_mfma_f32_16x16x32_bf16 v[164:167], a[44:47], v[52:55], v[164:167]
  v_mfma_f32_16x16x32_bf16 v[172:175], a[76:79], v[52:55], v[172:175]
  v_mfma_f32_16x16x32_bf16 v[180:183], a[108:111], v[52:55], v[180:183]
  v_mfma_f32_16x16x32_bf16 v[188:191], a[140:143], v[52:55], v[188:191]
  v_mfma_f32_16x16x32_bf16 v[196:199], a[172:175], v[52:55], v[196:199]
  v_mfma_f32_16x16x32_bf16 v[204:207], a[204:207], v[52:55], v[204:207]
  v_mfma_f32_16x16x32_bf16 v[212:215], a[236:239], v[52:55], v[212:215]
  v_mfma_f32_16x16x32_bf16 v[220:223], v[236:239], v[52:55], v[220:223]
  s_waitcnt lgkmcnt(2)
  v_mfma_f32_16x16x32_bf16 v[152:155], a[16:19], v[40:43], v[152:155]
  ds_read_b128 v[52:55], v1 offset:29696
  v_mfma_f32_16x16x32_bf16 v[160:163], a[48:51], v[40:43], v[160:163]
  v_mfma_f32_16x16x32_bf16 v[168:171], a[80:83], v[40:43], v[168:171]
  v_mfma_f32_16x16x32_bf16 v[176:179], a[112:115], v[40:43], v[176:179]
  v_mfma_f32_16x16x32_bf16 v[184:187], a[144:147], v[40:43], v[184:187]
  v_mfma_f32_16x16x32_bf16 v[192:195], a[176:179], v[40:43], v[192:195]
  v_mfma_f32_16x16x32_bf16 v[200:203], a[208:211], v[40:43], v[200:203]
  v_mfma_f32_16x16x32_bf16 v[208:211], a[240:243], v[40:43], v[208:211]
  v_mfma_f32_16x16x32_bf16 v[216:219], v[240:243], v[40:43], v[216:219]
  s_waitcnt lgkmcnt(2)
  v_mfma_f32_16x16x32_bf16 v[156:159], a[16:19], v[44:47], v[156:159]
  ds_read_b128 v[40:43], v1 offset:26624
  v_mfma_f32_16x16x32_bf16 v[164:167], a[48:51], v[44:47], v[164:167]
  v_mfma_f32_16x16x32_bf16 v[172:175], a[80:83], v[44:47], v[172:175]
  v_mfma_f32_16x16x32_bf16 v[180:183], a[112:115], v[44:47], v[180:183]
  v_mfma_f32_16x16x32_bf16 v[188:191], a[144:147], v[44:47], v[188:191]
  v_mfma_f32_16x16x32_bf16 v[196:199], a[176:179], v[44:47], v[196:199]
  v_mfma_f32_16x16x32_bf16 v[204:207], a[208:211], v[44:47], v[204:207]
  v_mfma_f32_16x16x32_bf16 v[212:215], a[240:243], v[44:47], v[212:215]
  v_mfma_f32_16x16x32_bf16 v[220:223], v[240:243], v[44:47], v[220:223]
  s_waitcnt lgkmcnt(2)
  v_mfma_f32_16x16x32_bf16 v[152:155], a[20:23], v[48:51], v[152:155]
  ds_read_b128 v[44:47], v1 offset:30720
  v_mfma_f32_16x16x32_bf16 v[160:163], a[52:55], v[48:51], v[160:163]
  v_mfma_f32_16x16x32_bf16 v[168:171], a[84:87], v[48:51], v[168:171]
  v_mfma_f32_16x16x32_bf16 v[176:179], a[116:119], v[48:51], v[176:179]
  v_mfma_f32_16x16x32_bf16 v[184:187], a[148:151], v[48:51], v[184:187]
  v_mfma_f32_16x16x32_bf16 v[192:195], a[180:183], v[48:51], v[192:195]
  v_mfma_f32_16x16x32_bf16 v[200:203], a[212:215], v[48:51], v[200:203]
  v_mfma_f32_16x16x32_bf16 v[208:211], a[244:247], v[48:51], v[208:211]
  v_mfma_f32_16x16x32_bf16 v[216:219], v[244:247], v[48:51], v[216:219]
  s_waitcnt lgkmcnt(2)
  v_mfma_f32_16x16x32_bf16 v[156:159], a[20:23], v[52:55], v[156:159]
  ds_read_b128 v[48:51], v1 offset:27648
  v_mfma_f32_16x16x32_bf16 v[164:167], a[52:55], v[52:55], v[164:167]
  v_mfma_f32_16x16x32_bf16 v[172:175], a[84:87], v[52:55], v[172:175]
  v_mfma_f32_16x16x32_bf16 v[180:183], a[116:119], v[52:55], v[180:183]
  v_mfma_f32_16x16x32_bf16 v[188:191], a[148:151], v[52:55], v[188:191]
  v_mfma_f32_16x16x32_bf16 v[196:199], a[180:183], v[52:55], v[196:199]
  v_mfma_f32_16x16x32_bf16 v[204:207], a[212:215], v[52:55], v[204:207]
  v_mfma_f32_16x16x32_bf16 v[212:215], a[244:247], v[52:55], v[212:215]
  v_mfma_f32_16x16x32_bf16 v[220:223], v[244:247], v[52:55], v[220:223]
  s_waitcnt lgkmcnt(2)
  v_mfma_f32_16x16x32_bf16 v[152:155], a[24:27], v[40:43], v[152:155]
  ds_read_b128 v[52:55], v1 offset:31744
  v_mfma_f32_16x16x32_bf16 v[160:163], a[56:59], v[40:43], v[160:163]
  v_mfma_f32_16x16x32_bf16 v[168:171], a[88:91], v[40:43], v[168:171]
  v_mfma_f32_16x16x32_bf16 v[176:179], a[120:123], v[40:43], v[176:179]
  v_mfma_f32_16x16x32_bf16 v[184:187], a[152:155], v[40:43], v[184:187]
  v_mfma_f32_16x16x32_bf16 v[192:195], a[184:187], v[40:43], v[192:195]
  v_mfma_f32_16x16x32_bf16 v[200:203], a[216:219], v[40:43], v[200:203]
  v_mfma_f32_16x16x32_bf16 v[208:211], a[248:251], v[40:43], v[208:211]
  v_mfma_f32_16x16x32_bf16 v[216:219], v[248:251], v[40:43], v[216:219]
  s_waitcnt lgkmcnt(2)
  v_mfma_f32_16x16x32_bf16 v[156:159], a[24:27], v[44:47], v[156:159]
  v_mfma_f32_16x16x32_bf16 v[164:167], a[56:59], v[44:47], v[164:167]
  v_mfma_f32_16x16x32_bf16 v[172:175], a[88:91], v[44:47], v[172:175]
  v_mfma_f32_16x16x32_bf16 v[180:183], a[120:123], v[44:47], v[180:183]
  v_mfma_f32_16x16x32_bf16 v[188:191], a[152:155], v[44:47], v[188:191]
  v_mfma_f32_16x16x32_bf16 v[196:199], a[184:187], v[44:47], v[196:199]
  v_mfma_f32_16x16x32_bf16 v[204:207], a[216:219], v[44:47], v[204:207]
  v_mfma_f32_16x16x32_bf16 v[212:215], a[248:251], v[44:47], v[212:215]
  v_mfma_f32_16x16x32_bf16 v[220:223], v[248:251], v[44:47], v[220:223]
  s_waitcnt lgkmcnt(1)
  v_mfma_f32_16x16x32_bf16 v[152:155], a[28:31], v[48:51], v[152:155]
  v_mfma_f32_16x16x32_bf16 v[160:163], a[60:63], v[48:51], v[160:163]
  v_mfma_f32_16x16x32_bf16 v[168:171], a[92:95], v[48:51], v[168:171]
  v_mfma_f32_16x16x32_bf16 v[176:179], a[124:127], v[48:51], v[176:179]
  v_mfma_f32_16x16x32_bf16 v[184:187], a[156:159], v[48:51], v[184:187]
  v_mfma_f32_16x16x32_bf16 v[192:195], a[188:191], v[48:51], v[192:195]
  v_mfma_f32_16x16x32_bf16 v[200:203], a[220:223], v[48:51], v[200:203]
  v_mfma_f32_16x16x32_bf16 v[208:211], a[252:255], v[48:51], v[208:211]
  v_mfma_f32_16x16x32_bf16 v[216:219], v[252:255], v[48:51], v[216:219]
  s_waitcnt lgkmcnt(0)
  v_mfma_f32_16x16x32_bf16 v[156:159], a[28:31], v[52:55], v[156:159]
  v_mfma_f32_16x16x32_bf16 v[164:167], a[60:63], v[52:55], v[164:167]
  v_mfma_f32_16x16x32_bf16 v[172:175], a[92:95], v[52:55], v[172:175]
  v_mfma_f32_16x16x32_bf16 v[180:183], a[124:127], v[52:55], v[180:183]
  v_mfma_f32_16x16x32_bf16 v[188:191], a[156:159], v[52:55], v[188:191]
  v_mfma_f32_16x16x32_bf16 v[196:199], a[188:191], v[52:55], v[196:199]
  v_mfma_f32_16x16x32_bf16 v[204:207], a[220:223], v[52:55], v[204:207]
  v_mfma_f32_16x16x32_bf16 v[212:215], a[252:255], v[52:55], v[212:215]
  v_mfma_f32_16x16x32_bf16 v[220:223], v[252:255], v[52:55], v[220:223]
  v_cvt_pk_bf16_f32 v8, v152, v153
  v_cvt_pk_bf16_f32 v9, v154, v155
  v_cvt_pk_bf16_f32 v10, v156, v157
  v_cvt_pk_bf16_f32 v11, v158, v159
  s_add_u32 s21, s26, 0
  buffer_store_dwordx4 v[8:11], v1, s[4:7], s21 offen sc1
  v_cvt_pk_bf16_f32 v12, v160, v161
  v_cvt_pk_bf16_f32 v13, v162, v163
  v_cvt_pk_bf16_f32 v14, v164, v165
  v_cvt_pk_bf16_f32 v15, v166, v167
  s_add_u32 s21, s26, 1024
  buffer_store_dwordx4 v[12:15], v1, s[4:7], s21 offen sc1
  v_cvt_pk_bf16_f32 v16, v168, v169
  v_cvt_pk_bf16_f32 v17, v170, v171
  v_cvt_pk_bf16_f32 v18, v172, v173
  v_cvt_pk_bf16_f32 v19, v174, v175
  s_add_u32 s21, s26, 2048
  buffer_store_dwordx4 v[16:19], v1, s[4:7], s21 offen sc1
  v_cvt_pk_bf16_f32 v20, v176, v177
  v_cvt_pk_bf16_f32 v21, v178, v179
  v_cvt_pk_bf16_f32 v22, v180, v181
  v_cvt_pk_bf16_f32 v23, v182, v183
  s_add_u32 s21, s26, 3072
  buffer_store_dwordx4 v[20:23], v1, s[4:7], s21 offen sc1
  v_cvt_pk_bf16_f32 v8, v184, v185
  v_cvt_pk_bf16_f32 v9, v186, v187
  v_cvt_pk_bf16_f32 v10, v188, v189
  v_cvt_pk_bf16_f32 v11, v190, v191
  s_add_u32 s21, s26, 4096
  buffer_store_dwordx4 v[8:11], v1, s[4:7], s21 offen sc1
  v_cvt_pk_bf16_f32 v12, v192, v193
  v_cvt_pk_bf16_f32 v13, v194, v195
  v_cvt_pk_bf16_f32 v14, v196, v197
  v_cvt_pk_bf16_f32 v15, v198, v199
  s_add_u32 s21, s26, 5120
  buffer_store_dwordx4 v[12:15], v1, s[4:7], s21 offen sc1
  v_cvt_pk_bf16_f32 v16, v200, v201
  v_cvt_pk_bf16_f32 v17, v202, v203
  v_cvt_pk_bf16_f32 v18, v204, v205
  v_cvt_pk_bf16_f32 v19, v206, v207
  s_add_u32 s21, s26, 6144
  buffer_store_dwordx4 v[16:19], v1, s[4:7], s21 offen sc1
  v_cvt_pk_bf16_f32 v20, v208, v209
  v_cvt_pk_bf16_f32 v21, v210, v211
  v_cvt_pk_bf16_f32 v22, v212, v213
  v_cvt_pk_bf16_f32 v23, v214, v215
  s_add_u32 s21, s26, 7168
  buffer_store_dwordx4 v[20:23], v1, s[4:7], s21 offen sc1
  v_cvt_pk_bf16_f32 v8, v216, v217
  v_cvt_pk_bf16_f32 v9, v218, v219
  v_cvt_pk_bf16_f32 v10, v220, v221
  v_cvt_pk_bf16_f32 v11, v222, v223
  s_add_u32 s21, s26, 8192
  buffer_store_dwordx4 v[8:11], v1, s[4:7], s21 offen sc1
  s_add_u32 s26, s26, 1179648
  s_add_u32 s29, s29, 1
  s_add_u32 s20, s20, 2
  s_waitcnt vmcnt(9)
  v_mfma_f32_16x16x32_bf16 v[12:15], v[88:91], v[72:75], 0
  v_mfma_f32_16x16x32_bf16 v[16:19], v[92:95], v[72:75], 0
  v_mfma_f32_16x16x32_bf16 v[12:15], v[96:99], v[76:79], v[12:15]
  v_mfma_f32_16x16x32_bf16 v[16:19], v[100:103], v[76:79], v[16:19]
  v_mfma_f32_16x16x32_bf16 v[12:15], v[104:107], v[80:83], v[12:15]
  v_mfma_f32_16x16x32_bf16 v[16:19], v[108:111], v[80:83], v[16:19]
  v_mfma_f32_16x16x32_bf16 v[12:15], v[112:115], v[84:87], v[12:15]
  v_mfma_f32_16x16x32_bf16 v[16:19], v[116:119], v[84:87], v[16:19]
  s_mov_b32 s94, 0
  s_cmp_ge_u32 s91, s20
  s_cbranch_scc1 L_gm_48
L_gm_47:
  buffer_load_dword v38, v6, s[4:7], 0 offen sc1
  s_waitcnt vmcnt(0)
  v_readfirstlane_b32 s91, v38
  s_cmp_ge_u32 s91, s20
  s_cbranch_scc1 L_gm_48
  s_add_u32 s94, s94, 1
  s_cmp_lt_u32 s94, 400000
  s_cbranch_scc1 L_gm_47
  s_branch L_fail
L_gm_48:
L_md_49:
  s_add_u32 s21, s25, 54525952
  s_add_u32 s22, s25, 62914560
  buffer_load_dwordx4 v[40:43], v1, s[4:7], s21 offen offset:0 sc1
  buffer_load_dwordx4 v[44:47], v1, s[4:7], s21 offen offset:1024 sc1
  buffer_load_dwordx4 v[48:51], v1, s[4:7], s21 offen offset:2048 sc1
  buffer_load_dwordx4 v[52:55], v1, s[4:7], s21 offen offset:3072 sc1
  buffer_load_dwordx4 v[56:59], v1, s[4:7], s22 offen offset:0 sc1
  buffer_load_dwordx4 v[60:63], v1, s[4:7], s22 offen offset:1024 sc1
  buffer_load_dwordx4 v[64:67], v1, s[4:7], s22 offen offset:2048 sc1
  buffer_load_dwordx4 v[68:71], v1, s[4:7], s22 offen offset:3072 sc1
  s_waitcnt vmcnt(4)
  v_max3_u32 v36, v40, v41, v42
  v_max3_u32 v37, v43, v44, v45
  v_max3_u32 v36, v36, v46, v47
  v_max3_u32 v37, v37, v48, v49
  v_max3_u32 v36, v36, v50, v51
  v_max3_u32 v37, v37, v52, v53
  v_max3_u32 v36, v36, v54, v55
  v_max_u32 v36, v36, v37
  v_cmp_eq_u32 vcc, -1, v36
  s_cbranch_vccz L_md_50
  s_add_u32 s94, s94, 1
  s_cmp_lt_u32 s94, 400000
  s_cbranch_scc1 L_md_49
  s_branch L_fail
L_md_50:
  v_mfma_f32_16x16x32_bf16 v[8:11], v[40:43], v[72:75], 0
  v_mfma_f32_16x16x32_bf16 v[8:11], v[44:47], v[76:79], v[8:11]
  v_mfma_f32_16x16x32_bf16 v[8:11], v[48:51], v[80:83], v[8:11]
  v_mfma_f32_16x16x32_bf16 v[8:11], v[52:55], v[84:87], v[8:11]
  v_mov_b32 v37, 0xce6e6b28
  v_cndmask_b32 v12, v37, v12, s[40:41]
  v_cndmask_b32 v13, v37, v13, s[42:43]
  v_cndmask_b32 v14, v37, v14, s[44:45]
  v_cndmask_b32 v15, v37, v15, s[46:47]
  v_cndmask_b32 v16, v37, v16, s[48:49]
  v_cndmask_b32 v17, v37, v17, s[50:51]
  v_cndmask_b32 v18, v37, v18, s[52:53]
  v_cndmask_b32 v19, v37, v19, s[54:55]
  v_max3_f32 v36, v12, v13, v14
  v_max3_f32 v37, v15, v16, v17
  v_max3_f32 v36, v36, v18, v19
  v_max3_f32 v37, v37, v8, v9
  v_max_f32 v36, v36, v37
  v_mov_b32 v37, v36
  s_nop 1
  v_permlane16_swap_b32 v36, v37
  v_max_f32 v36, v36, v37
  v_mov_b32 v37, v36
  s_nop 1
  v_permlane32_swap_b32 v36, v37
  v_max_f32 v36, v36, v37
  v_mul_f32 v36, s28, v36
  v_fma_f32 v8, v8, s28, -v36
  v_fma_f32 v9, v9, s28, -v36
  v_fma_f32 v12, v12, s28, -v36
  v_fma_f32 v13, v13, s28, -v36
  v_fma_f32 v14, v14, s28, -v36
  v_fma_f32 v15, v15, s28, -v36
  v_fma_f32 v16, v16, s28, -v36
  v_fma_f32 v17, v17, s28, -v36
  v_fma_f32 v18, v18, s28, -v36
  v_fma_f32 v19, v19, s28, -v36
  v_exp_f32 v8, v8
  v_exp_f32 v9, v9
  v_exp_f32 v12, v12
  v_exp_f32 v13, v13
  v_exp_f32 v14, v14
  v_exp_f32 v15, v15
  v_exp_f32 v16, v16
  v_exp_f32 v17, v17
  v_exp_f32 v18, v18
  v_exp_f32 v19, v19
  v_cvt_pk_bf16_f32 v20, v12, v13
  v_cvt_pk_bf16_f32 v21, v14, v15
  v_cvt_pk_bf16_f32 v22, v16, v17
  v_cvt_pk_bf16_f32 v23, v18, v19
  v_cvt_pk_bf16_f32 v24, v8, v9
  v_mov_b32 v25, v24
  v_mfma_f32_16x16x32_bf16 v[26:29], v[30:33], v[20:23], 0
  v_mfma_f32_16x16x32_bf16 v[152:155], v[120:123], v[20:23], 0
  v_mfma_f32_16x16x32_bf16 v[156:159], v[124:127], v[20:23], 0
  v_mfma_f32_16x16x32_bf16 v[160:163], v[128:131], v[20:23], 0
  v_mfma_f32_16x16x32_bf16 v[164:167], v[132:135], v[20:23], 0
  v_mfma_f32_16x16x32_bf16 v[168:171], v[136:139], v[20:23], 0
  v_mfma_f32_16x16x32_bf16 v[172:175], v[140:143], v[20:23], 0
  v_mfma_f32_16x16x32_bf16 v[176:179], v[144:147], v[20:23], 0
  v_mfma_f32_16x16x32_bf16 v[180:183], v[148:151], v[20:23], 0
L_mv_51:
  s_waitcnt vmcnt(0)
  v_max3_u32 v36, v56, v57, v58
  v_max3_u32 v37, v59, v60, v61
  v_max3_u32 v36, v36, v62, v63
  v_max3_u32 v37, v37, v64, v65
  v_max3_u32 v36, v36, v66, v67
  v_max3_u32 v37, v37, v68, v69
  v_max3_u32 v36, v36, v70, v71
  v_max_u32 v36, v36, v37
  v_cmp_eq_u32 vcc, -1, v36
  s_cbranch_vccz L_mv_52
  s_add_u32 s22, s25, 62914560
  buffer_load_dwordx4 v[56:59], v1, s[4:7], s22 offen offset:0 sc1
  buffer_load_dwordx4 v[60:63], v1, s[4:7], s22 offen offset:1024 sc1
  buffer_load_dwordx4 v[64:67], v1, s[4:7], s22 offen offset:2048 sc1
  buffer_load_dwordx4 v[68:71], v1, s[4:7], s22 offen offset:3072 sc1
  s_add_u32 s94, s94, 1
  s_cmp_lt_u32 s94, 400000
  s_cbranch_scc1 L_mv_51
  s_branch L_fail
L_mv_52:
  s_add_u32 s25, s25, 262144
  v_mfma_f32_16x16x16_bf16 v[26:29], v[34:35], v[24:25], v[26:29]
  v_mfma_f32_16x16x16_bf16 v[152:155], v[56:57], v[24:25], v[152:155]
  v_mfma_f32_16x16x16_bf16 v[156:159], v[58:59], v[24:25], v[156:159]
  v_mfma_f32_16x16x16_bf16 v[160:163], v[60:61], v[24:25], v[160:163]
  v_mfma_f32_16x16x16_bf16 v[164:167], v[62:63], v[24:25], v[164:167]
  v_mfma_f32_16x16x16_bf16 v[168:171], v[64:65], v[24:25], v[168:171]
  v_mfma_f32_16x16x16_bf16 v[172:175], v[66:67], v[24:25], v[172:175]
  v_mfma_f32_16x16x16_bf16 v[176:179], v[68:69], v[24:25], v[176:179]
  v_mfma_f32_16x16x16_bf16 v[180:183], v[70:71], v[24:25], v[180:183]
  s_add_u32 s93, s29, 2
  s_cmp_ge_u32 s90, s93
  s_cbranch_scc1 L_wt_54
  s_mov_b32 s94, 0
L_wt_53:
  buffer_load_dword v38, v5, s[4:7], 0 offen sc1
  s_waitcnt vmcnt(0)
  v_readlane_b32 s90, v38, 0
  v_readlane_b32 s92, v38, 1
  s_min_u32 s90, s90, s92
  v_readlane_b32 s92, v38, 2
  s_min_u32 s90, s90, s92
  s_cmp_ge_u32 s90, s93
  s_cbranch_scc1 L_wt_54
  s_add_u32 s94, s94, 1
  s_cmp_lt_u32 s94, 400000
  s_cbranch_scc1 L_wt_53
  s_branch L_fail
L_wt_54:
  s_add_u32 s21, s24, 4194304
  s_add_u32 s22, s24, 37748736
  s_lshl_b32 s23, s27, 10
  s_add_u32 s22, s22, s23
  buffer_load_dwordx4 v[72:75], v1, s[4:7], s22 offen
  buffer_load_dwordx4 v[88:91], v1, s[4:7], s21 offen
  buffer_load_dwordx4 v[92:95], v1, s[4:7], s21 offen offset:1024
  s_add_u32 s21, s21, 2048
  s_add_u32 s22, s22, 2048
  buffer_load_dwordx4 v[76:79], v1, s[4:7], s22 offen
  buffer_load_dwordx4 v[96:99], v1, s[4:7], s21 offen
  buffer_load_dwordx4 v[100:103], v1, s[4:7], s21 offen offset:1024
  s_add_u32 s21, s21, 2048
  s_add_u32 s22, s22, 2048
  buffer_load_dwordx4 v[80:83], v1, s[4:7], s22 offen
  buffer_load_dwordx4 v[104:107], v1, s[4:7], s21 offen
  buffer_load_dwordx4 v[108:111], v1, s[4:7], s21 offen offset:1024
  s_add_u32 s21, s21, 2048
  s_add_u32 s22, s22, 2048
  buffer_load_dwordx4 v[84:87], v1, s[4:7], s22 offen
  buffer_load_dwordx4 v[112:115], v1, s[4:7], s21 offen
  buffer_load_dwordx4 v[116:119], v1, s[4:7], s21 offen offset:1024
  s_add_u32 s21, s24, 20971520
  buffer_load_dwordx4 v[120:123], v1, s[4:7], s21 offen
  buffer_load_dwordx4 v[124:127], v1, s[4:7], s21 offen offset:1024
  s_add_u32 s21, s21, 2048
  buffer_load_dwordx4 v[128:131], v1, s[4:7], s21 offen
  buffer_load_dwordx4 v[132:135], v1, s[4:7], s21 offen offset:1024
  s_add_u32 s21, s21, 2048
  buffer_load_dwordx4 v[136:139], v1, s[4:7], s21 offen
  buffer_load_dwordx4 v[140:143], v1, s[4:7], s21 offen offset:1024
  s_add_u32 s21, s21, 2048
  buffer_load_dwordx4 v[144:147], v1, s[4:7], s21 offen
  buffer_load_dwordx4 v[148:151], v1, s[4:7], s21 offen offset:1024
  s_add_u32 s24, s24, 524288
  v_rcp_f32 v36, v26
  s_nop 0
  v_mul_f32 v152, v152, v36
  v_mul_f32 v153, v153, v36
  v_mul_f32 v154, v154, v36
  v_mul_f32 v155, v155, v36
  v_cvt_pk_bf16_f32 v184, v152, v153
  v_cvt_pk_bf16_f32 v185, v154, v155
  v_mul_f32 v156, v156, v36
  v_mul_f32 v157, v157, v36
  v_mul_f32 v158, v158, v36
  v_mul_f32 v159, v159, v36
  v_cvt_pk_bf16_f32 v186, v156, v157
  v_cvt_pk_bf16_f32 v187, v158, v159
  ds_write_b128 v2, v[184:187] offset:0
  v_mul_f32 v160, v160, v36
  v_mul_f32 v161, v161, v36
  v_mul_f32 v162, v162, v36
  v_mul_f32 v163, v163, v36
  v_cvt_pk_bf16_f32 v188, v160, v161
  v_cvt_pk_bf16_f32 v189, v162, v163
  v_mul_f32 v164, v164, v36
  v_mul_f32 v165, v165, v36
  v_mul_f32 v166, v166, v36
  v_mul_f32 v167, v167, v36
  v_cvt_pk_bf16_f32 v190, v164, v165
  v_cvt_pk_bf16_f32 v191, v166, v167
  ds_write_b128 v2, v[188:191] offset:1024
  v_mul_f32 v168, v168, v36
  v_mul_f32 v169, v169, v36
  v_mul_f32 v170, v170, v36
  v_mul_f32 v171, v171, v36
  v_cvt_pk_bf16_f32 v192, v168, v169
  v_cvt_pk_bf16_f32 v193, v170, v171
  v_mul_f32 v172, v172, v36
  v_mul_f32 v173, v173, v36
  v_mul_f32 v174, v174, v36
  v_mul_f32 v175, v175, v36
  v_cvt_pk_bf16_f32 v194, v172, v173
  v_cvt_pk_bf16_f32 v195, v174, v175
  ds_write_b128 v2, v[192:195] offset:2048
  v_mul_f32 v176, v176, v36
  v_mul_f32 v177, v177, v36
  v_mul_f32 v178, v178, v36
  v_mul_f32 v179, v179, v36
  v_cvt_pk_bf16_f32 v196, v176, v177
  v_cvt_pk_bf16_f32 v197, v178, v179
  v_mul_f32 v180, v180, v36
  v_mul_f32 v181, v181, v36
  v_mul_f32 v182, v182, v36
  v_mul_f32 v183, v183, v36
  v_cvt_pk_bf16_f32 v198, v180, v181
  v_cvt_pk_bf16_f32 v199, v182, v183
  ds_write_b128 v2, v[196:199] offset:3072
  s_waitcnt lgkmcnt(0)
  s_barrier
  s_cmp_lg_u32 s17, 0
  s_cbranch_scc1 L_fs_55
  v_mov_b32 v38, s29
  s_mov_b64 exec, 1
  buffer_store_dword v38, off, s[4:7], s95 sc1
  s_mov_b64 exec, -1
L_fs_55:
  ds_read_b128 v[40:43], v1 offset:0
  ds_read_b128 v[44:47], v1 offset:4096
  ds_read_b128 v[48:51], v1 offset:1024
  s_waitcnt lgkmcnt(2)
  v_mfma_f32_16x16x32_bf16 v[152:155], a[0:3], v[40:43], 0
  ds_read_b128 v[52:55], v1 offset:5120
  v_mfma_f32_16x16x32_bf16 v[160:163], a[32:35], v[40:43], 0
  v_mfma_f32_16x16x32_bf16 v[168:171], a[64:67], v[40:43], 0
  v_mfma_f32_16x16x32_bf16 v[176:179], a[96:99], v[40:43], 0
  v_mfma_f32_16x16x32_bf16 v[184:187], a[128:131], v[40:43], 0
  v_mfma_f32_16x16x32_bf16 v[192:195], a[160:163], v[40:43], 0
  v_mfma_f32_16x16x32_bf16 v[200:203], a[192:195], v[40:43], 0
  v_mfma_f32_16x16x32_bf16 v[208:211], a[224:227], v[40:43], 0
  v_mfma_f32_16x16x32_bf16 v[216:219], v[224:227], v[40:43], 0
  s_waitcnt lgkmcnt(2)
  v_mfma_f32_16x16x32_bf16 v[156:159], a[0:3], v[44:47], 0
  ds_read_b128 v[40:43], v1 offset:2048
  v_mfma_f32_16x16x32_bf16 v[164:167], a[32:35], v[44:47], 0
  v_mfma_f32_16x16x32_bf16 v[172:175], a[64:67], v[44:47], 0
  v_mfma_f32_16x16x32_bf16 v[180:183], a[96:99], v[44:47], 0
  v_mfma_f32_16x16x32_bf16 v[188:191], a[128:131], v[44:47], 0
  v_mfma_f32_16x16x32_bf16 v[196:199], a[160:163], v[44:47], 0
  v_mfma_f32_16x16x32_bf16 v[204:207], a[192:195], v[44:47], 0
  v_mfma_f32_16x16x32_bf16 v[212:215], a[224:227], v[44:47], 0
  v_mfma_f32_16x16x32_bf16 v[220:223], v[224:227], v[44:47], 0
  s_waitcnt lgkmcnt(2)
  v_mfma_f32_16x16x32_bf16 v[152:155], a[4:7], v[48:51], v[152:155]
  ds_read_b128 v[44:47], v1 offset:6144
  v_mfma_f32_16x16x32_bf16 v[160:163], a[36:39], v[48:51], v[160:163]
  v_mfma_f32_16x16x32_bf16 v[168:171], a[68:71], v[48:51], v[168:171]
  v_mfma_f32_16x16x32_bf16 v[176:179], a[100:103], v[48:51], v[176:179]
  v_mfma_f32_16x16x32_bf16 v[184:187], a[132:135], v[48:51], v[184:187]
  v_mfma_f32_16x16x32_bf16 v[192:195], a[164:167], v[48:51], v[192:195]
  v_mfma_f32_16x16x32_bf16 v[200:203], a[196:199], v[48:51], v[200:203]
  v_mfma_f32_16x16x32_bf16 v[208:211], a[228:231], v[48:51], v[208:211]
  v_mfma_f32_16x16x32_bf16 v[216:219], v[228:231], v[48:51], v[216:219]
  s_waitcnt lgkmcnt(2)
  v_mfma_f32_16x16x32_bf16 v[156:159], a[4:7], v[52:55], v[156:159]
  ds_read_b128 v[48:51], v1 offset:3072
  v_mfma_f32_16x16x32_bf16 v[164:167], a[36:39], v[52:55], v[164:167]
  v_mfma_f32_16x16x32_bf16 v[172:175], a[68:71], v[52:55], v[172:175]
  v_mfma_f32_16x16x32_bf16 v[180:183], a[100:103], v[52:55], v[180:183]
  v_mfma_f32_16x16x32_bf16 v[188:191], a[132:135], v[52:55], v[188:191]
  v_mfma_f32_16x16x32_bf16 v[196:199], a[164:167], v[52:55], v[196:199]
  v_mfma_f32_16x16x32_bf16 v[204:207], a[196:199], v[52:55], v[204:207]
  v_mfma_f32_16x16x32_bf16 v[212:215], a[228:231], v[52:55], v[212:215]
  v_mfma_f32_16x16x32_bf16 v[220:223], v[228:231], v[52:55], v[220:223]
  s_waitcnt lgkmcnt(2)
  v_mfma_f32_16x16x32_bf16 v[152:155], a[8:11], v[40:43], v[152:155]
  ds_read_b128 v[52:55], v1 offset:7168
  v_mfma_f32_16x16x32_bf16 v[160:163], a[40:43], v[40:43], v[160:163]
  v_mfma_f32_16x16x32_bf16 v[168:171], a[72:75], v[40:43], v[168:171]
  v_mfma_f32_16x16x32_bf16 v[176:179], a[104:107], v[40:43], v[176:179]
  v_mfma_f32_16x16x32_bf16 v[184:187], a[136:139], v[40:43], v[184:187]
  v_mfma_f32_16x16x32_bf16 v[192:195], a[168:171], v[40:43], v[192:195]
  v_mfma_f32_16x16x32_bf16 v[200:203], a[200:203], v[40:43], v[200:203]
  v_mfma_f32_16x16x32_bf16 v[208:211], a[232:235], v[40:43], v[208:211]
  v_mfma_f32_16x16x32_bf16 v[216:219], v[232:235], v[40:43], v[216:219]
  s_waitcnt lgkmcnt(2)
  v_mfma_f32_16x16x32_bf16 v[156:159], a[8:11], v[44:47], v[156:159]
  ds_read_b128 v[40:43], v1 offset:8192
  v_mfma_f32_16x16x32_bf16 v[164:167], a[40:43], v[44:47], v[164:167]
  v_mfma_f32_16x16x32_bf16 v[172:175], a[72:75], v[44:47], v[172:175]
  v_mfma_f32_16x16x32_bf16 v[180:183], a[104:107], v[44:47], v[180:183]
  v_mfma_f32_16x16x32_bf16 v[188:191], a[136:139], v[44:47], v[188:191]
  v_mfma_f32_16x16x32_bf16 v[196:199], a[168:171], v[44:47], v[196:199]
  v_mfma_f32_16x16x32_bf16 v[204:207], a[200:203], v[44:47], v[204:207]
  v_mfma_f32_16x16x32_bf16 v[212:215], a[232:235], v[44:47], v[212:215]
  v_mfma_f32_16x16x32_bf16 v[220:223], v[232:235], v[44:47], v[220:223]
  s_waitcnt lgkmcnt(2)
  v_mfma_f32_16x16x32_bf16 v[152:155], a[12:15], v[48:51], v[152:155]
  ds_read_b128 v[44:47], v1 offset:12288
  v_mfma_f32_16x16x32_bf16 v[160:163], a[44:47], v[48:51], v[160:163]
  v_mfma_f32_16x16x32_bf16 v[168:171], a[76:79], v[48:51], v[168:171]
  v_mfma_f32_16x16x32_bf16 v[176:179], a[108:111], v[48:51], v[176:179]
  v_mfma_f32_16x16x32_bf16 v[184:187], a[140:143], v[48:51], v[184:187]
  v_mfma_f32_16x16x32_bf16 v[192:195], a[172:175], v[48:51], v[192:195]
  v_mfma_f32_16x16x32_bf16 v[200:203], a[204:207], v[48:51], v[200:203]
  v_mfma_f32_16x16x32_bf16 v[208:211], a[236:239], v[48:51], v[208:211]
  v_mfma_f32_16x16x32_bf16 v[216:219], v[236:239], v[48:51], v[216:219]
  s_waitcnt lgkmcnt(2)
  v_mfma_f32_16x16x32_bf16 v[156:159], a[12:15], v[52:55], v[156:159]
  ds_read_b128 v[48:51], v1 offset:9216
  v_mfma_f32_16x16x32_bf16 v[164:167], a[44:47], v[52:55], v[164:167]
  v_mfma_f32_16x16x32_bf16 v[172:175], a[76:79], v[52:55], v[172:175]
  v_mfma_f32_16x16x32_bf16 v[180:183], a[108:111], v[52:55], v[180:183]
  v_mfma_f32_16x16x32_bf16 v[188:191], a[140:143], v[52:55], v[188:191]
  v_mfma_f32_16x16x32_bf16 v[196:199], a[172:175], v[52:55], v[196:199]
  v_mfma_f32_16x16x32_bf16 v[204:207], a[204:207], v[52:55], v[204:207]
  v_mfma_f32_16x16x32_bf16 v[212:215], a[236:239], v[52:55], v[212:215]
  v_mfma_f32_16x16x32_bf16 v[220:223], v[236:239], v[52:55], v[220:223]
  s_waitcnt lgkmcnt(2)
  v_mfma_f32_16x16x32_bf16 v[152:155], a[16:19], v[40:43], v[152:155]
  ds_read_b128 v[52:55], v1 offset:13312
  v_mfma_f32_16x16x32_bf16 v[160:163], a[48:51], v[40:43], v[160:163]
  v_mfma_f32_16x16x32_bf16 v[168:171], a[80:83], v[40:43], v[168:171]
  v_mfma_f32_16x16x32_bf16 v[176:179], a[112:115], v[40:43], v[176:179]
  v_mfma_f32_16x16x32_bf16 v[184:187], a[144:147], v[40:43], v[184:187]
  v_mfma_f32_16x16x32_bf16 v[192:195], a[176:179], v[40:43], v[192:195]
  v_mfma_f32_16x16x32_bf16 v[200:203], a[208:211], v[40:43], v[200:203]
  v_mfma_f32_16x16x32_bf16 v[208:211], a[240:243], v[40:43], v[208:211]
  v_mfma_f32_16x16x32_bf16 v[216:219], v[240:243], v[40:43], v[216:219]
  s_waitcnt lgkmcnt(2)
  v_mfma_f32_16x16x32_bf16 v[156:159], a[16:19], v[44:47], v[156:159]
  ds_read_b128 v[40:43], v1 offset:10240
  v_mfma_f32_16x16x32_bf16 v[164:167], a[48:51], v[44:47], v[164:167]
  v_mfma_f32_16x16x32_bf16 v[172:175], a[80:83], v[44:47], v[172:175]
  v_mfma_f32_16x16x32_bf16 v[180:183], a[112:115], v[44:47], v[180:183]
  v_mfma_f32_16x16x32_bf16 v[188:191], a[144:147], v[44:47], v[188:191]
  v_mfma_f32_16x16x32_bf16 v[196:199], a[176:179], v[44:47], v[196:199]
  v_mfma_f32_16x16x32_bf16 v[204:207], a[208:211], v[44:47], v[204:207]
  v_mfma_f32_16x16x32_bf16 v[212:215], a[240:243], v[44:47], v[212:215]
  v_mfma_f32_16x16x32_bf16 v[220:223], v[240:243], v[44:47], v[220:223]
  s_waitcnt lgkmcnt(2)
  v_mfma_f32_16x16x32_bf16 v[152:155], a[20:23], v[48:51], v[152:155]
  ds_read_b128 v[44:47], v1 offset:14336
  v_mfma_f32_16x16x32_bf16 v[160:163], a[52:55], v[48:51], v[160:163]
  v_mfma_f32_16x16x32_bf16 v[168:171], a[84:87], v[48:51], v[168:171]
  v_mfma_f32_16x16x32_bf16 v[176:179], a[116:119], v[48:51], v[176:179]
  v_mfma_f32_16x16x32_bf16 v[184:187], a[148:151], v[48:51], v[184:187]
  v_mfma_f32_16x16x32_bf16 v[192:195], a[180:183], v[48:51], v[192:195]
  v_mfma_f32_16x16x32_bf16 v[200:203], a[212:215], v[48:51], v[200:203]
  v_mfma_f32_16x16x32_bf16 v[208:211], a[244:247], v[48:51], v[208:211]
  v_mfma_f32_16x16x32_bf16 v[216:219], v[244:247], v[48:51], v[216:219]
  s_waitcnt lgkmcnt(2)
  v_mfma_f32_16x16x32_bf16 v[156:159], a[20:23], v[52:55], v[156:159]
  ds_read_b128 v[48:51], v1 offset:11264
  v_mfma_f32_16x16x32_bf16 v[164:167], a[52:55], v[52:55], v[164:167]
  v_mfma_f32_16x16x32_bf16 v[172:175], a[84:87], v[52:55], v[172:175]
  v_mfma_f32_16x16x32_bf16 v[180:183], a[116:119], v[52:55], v[180:183]
  v_mfma_f32_16x16x32_bf16 v[188:191], a[148:151], v[52:55], v[188:191]
  v_mfma_f32_16x16x32_bf16 v[196:199], a[180:183], v[52:55], v[196:199]
  v_mfma_f32_16x16x32_bf16 v[204:207], a[212:215], v[52:55], v[204:207]
  v_mfma_f32_16x16x32_bf16 v[212:215], a[244:247], v[52:55], v[212:215]
  v_mfma_f32_16x16x32_bf16 v[220:223], v[244:247], v[52:55], v[220:223]
  s_waitcnt lgkmcnt(2)
  v_mfma_f32_16x16x32_bf16 v[152:155], a[24:27], v[40:43], v[152:155]
  ds_read_b128 v[52:55], v1 offset:15360
  v_mfma_f32_16x16x32_bf16 v[160:163], a[56:59], v[40:43], v[160:163]
  v_mfma_f32_16x16x32_bf16 v[168:171], a[88:91], v[40:43], v[168:171]
  v_mfma_f32_16x16x32_bf16 v[176:179], a[120:123], v[40:43], v[176:179]
  v_mfma_f32_16x16x32_bf16 v[184:187], a[152:155], v[40:43], v[184:187]
  v_mfma_f32_16x16x32_bf16 v[192:195], a[184:187], v[40:43], v[192:195]
  v_mfma_f32_16x16x32_bf16 v[200:203], a[216:219], v[40:43], v[200:203]
  v_mfma_f32_16x16x32_bf16 v[208:211], a[248:251], v[40:43], v[208:211]
  v_mfma_f32_16x16x32_bf16 v[216:219], v[248:251], v[40:43], v[216:219]
  s_waitcnt lgkmcnt(2)
  v_mfma_f32_16x16x32_bf16 v[156:159], a[24:27], v[44:47], v[156:159]
  v_mfma_f32_16x16x32_bf16 v[164:167], a[56:59], v[44:47], v[164:167]
  v_mfma_f32_16x16x32_bf16 v[172:175], a[88:91], v[44:47], v[172:175]
  v_mfma_f32_16x16x32_bf16 v[180:183], a[120:123], v[44:47], v[180:183]
  v_mfma_f32_16x16x32_bf16 v[188:191], a[152:155], v[44:47], v[188:191]
  v_mfma_f32_16x16x32_bf16 v[196:199], a[184:187], v[44:47], v[196:199]
  v_mfma_f32_16x16x32_bf16 v[204:207], a[216:219], v[44:47], v[204:207]
  v_mfma_f32_16x16x32_bf16 v[212:215], a[248:251], v[44:47], v[212:215]
  v_mfma_f32_16x16x32_bf16 v[220:223], v[248:251], v[44:47], v[220:223]
  s_waitcnt lgkmcnt(1)
  v_mfma_f32_16x16x32_bf16 v[152:155], a[28:31], v[48:51], v[152:155]
  v_mfma_f32_16x16x32_bf16 v[160:163], a[60:63], v[48:51], v[160:163]
  v_mfma_f32_16x16x32_bf16 v[168:171], a[92:95], v[48:51], v[168:171]
  v_mfma_f32_16x16x32_bf16 v[176:179], a[124:127], v[48:51], v[176:179]
  v_mfma_f32_16x16x32_bf16 v[184:187], a[156:159], v[48:51], v[184:187]
  v_mfma_f32_16x16x32_bf16 v[192:195], a[188:191], v[48:51], v[192:195]
  v_mfma_f32_16x16x32_bf16 v[200:203], a[220:223], v[48:51], v[200:203]
  v_mfma_f32_16x16x32_bf16 v[208:211], a[252:255], v[48:51], v[208:211]
  v_mfma_f32_16x16x32_bf16 v[216:219], v[252:255], v[48:51], v[216:219]
  s_waitcnt lgkmcnt(0)
  v_mfma_f32_16x16x32_bf16 v[156:159], a[28:31], v[52:55], v[156:159]
  v_mfma_f32_16x16x32_bf16 v[164:167], a[60:63], v[52:55], v[164:167]
  v_mfma_f32_16x16x32_bf16 v[172:175], a[92:95], v[52:55], v[172:175]
  v_mfma_f32_16x16x32_bf16 v[180:183], a[124:127], v[52:55], v[180:183]
  v_mfma_f32_16x16x32_bf16 v[188:191], a[156:159], v[52:55], v[188:191]
  v_mfma_f32_16x16x32_bf16 v[196:199], a[188:191], v[52:55], v[196:199]
  v_mfma_f32_16x16x32_bf16 v[204:207], a[220:223], v[52:55], v[204:207]
  v_mfma_f32_16x16x32_bf16 v[212:215], a[252:255], v[52:55], v[212:215]
  v_mfma_f32_16x16x32_bf16 v[220:223], v[252:255], v[52:55], v[220:223]
  v_cvt_pk_bf16_f32 v8, v152, v153
  v_cvt_pk_bf16_f32 v9, v154, v155
  v_cvt_pk_bf16_f32 v10, v156, v157
  v_cvt_pk_bf16_f32 v11, v158, v159
  s_add_u32 s21, s26, 0
  buffer_store_dwordx4 v[8:11], v1, s[4:7], s21 offen sc1
  v_cvt_pk_bf16_f32 v12, v160, v161
  v_cvt_pk_bf16_f32 v13, v162, v163
  v_cvt_pk_bf16_f32 v14, v164, v165
  v_cvt_pk_bf16_f32 v15, v166, v167
  s_add_u32 s21, s26, 1024
  buffer_store_dwordx4 v[12:15], v1, s[4:7], s21 offen sc1
  v_cvt_pk_bf16_f32 v16, v168, v169
  v_cvt_pk_bf16_f32 v17, v170, v171
  v_cvt_pk_bf16_f32 v18, v172, v173
  v_cvt_pk_bf16_f32 v19, v174, v175
  s_add_u32 s21, s26, 2048
  buffer_store_dwordx4 v[16:19], v1, s[4:7], s21 offen sc1
  v_cvt_pk_bf16_f32 v20, v176, v177
  v_cvt_pk_bf16_f32 v21, v178, v179
  v_cvt_pk_bf16_f32 v22, v180, v181
  v_cvt_pk_bf16_f32 v23, v182, v183
  s_add_u32 s21, s26, 3072
  buffer_store_dwordx4 v[20:23], v1, s[4:7], s21 offen sc1
  v_cvt_pk_bf16_f32 v8, v184, v185
  v_cvt_pk_bf16_f32 v9, v186, v187
  v_cvt_pk_bf16_f32 v10, v188, v189
  v_cvt_pk_bf16_f32 v11, v190, v191
  s_add_u32 s21, s26, 4096
  buffer_store_dwordx4 v[8:11], v1, s[4:7], s21 offen sc1
  v_cvt_pk_bf16_f32 v12, v192, v193
  v_cvt_pk_bf16_f32 v13, v194, v195
  v_cvt_pk_bf16_f32 v14, v196, v197
  v_cvt_pk_bf16_f32 v15, v198, v199
  s_add_u32 s21, s26, 5120
  buffer_store_dwordx4 v[12:15], v1, s[4:7], s21 offen sc1
  v_cvt_pk_bf16_f32 v16, v200, v201
  v_cvt_pk_bf16_f32 v17, v202, v203
  v_cvt_pk_bf16_f32 v18, v204, v205
  v_cvt_pk_bf16_f32 v19, v206, v207
  s_add_u32 s21, s26, 6144
  buffer_store_dwordx4 v[16:19], v1, s[4:7], s21 offen sc1
  v_cvt_pk_bf16_f32 v20, v208, v209
  v_cvt_pk_bf16_f32 v21, v210, v211
  v_cvt_pk_bf16_f32 v22, v212, v213
  v_cvt_pk_bf16_f32 v23, v214, v215
  s_add_u32 s21, s26, 7168
  buffer_store_dwordx4 v[20:23], v1, s[4:7], s21 offen sc1
  v_cvt_pk_bf16_f32 v8, v216, v217
  v_cvt_pk_bf16_f32 v9, v218, v219
  v_cvt_pk_bf16_f32 v10, v220, v221
  v_cvt_pk_bf16_f32 v11, v222, v223
  s_add_u32 s21, s26, 8192
  buffer_store_dwordx4 v[8:11], v1, s[4:7], s21 offen sc1
  s_add_u32 s26, s26, 1179648
  s_add_u32 s29, s29, 1
  s_add_u32 s20, s20, 2
L_fol_last:
  s_waitcnt vmcnt(0)
  s_barrier
  s_cmp_lg_u32 s30, 0
  s_cbranch_scc1 L_sm_56
  s_cmp_lg_u32 s17, 0
  s_cbranch_scc1 L_fs_57
  v_mov_b32 v38, s29
  s_mov_b64 exec, 1
  buffer_store_dword v38, off, s[4:7], s95 sc1
  s_mov_b64 exec, -1
L_fs_57:
L_sm_56:
  v_mfma_f32_16x16x32_bf16 v[12:15], v[88:91], v[72:75], 0
  v_mfma_f32_16x16x32_bf16 v[16:19], v[92:95], v[72:75], 0
  v_mfma_f32_16x16x32_bf16 v[12:15], v[96:99], v[76:79], v[12:15]
  v_mfma_f32_16x16x32_bf16 v[16:19], v[100:103], v[76:79], v[16:19]
  v_mfma_f32_16x16x32_bf16 v[12:15], v[104:107], v[80:83], v[12:15]
  v_mfma_f32_16x16x32_bf16 v[16:19], v[108:111], v[80:83], v[16:19]
  v_mfma_f32_16x16x32_bf16 v[12:15], v[112:115], v[84:87], v[12:15]
  v_mfma_f32_16x16x32_bf16 v[16:19], v[116:119], v[84:87], v[16:19]
  s_mov_b32 s94, 0
  s_cmp_ge_u32 s91, s20
  s_cbranch_scc1 L_gm_59
L_gm_58:
  buffer_load_dword v38, v6, s[4:7], 0 offen sc1
  s_waitcnt vmcnt(0)
  v_readfirstlane_b32 s91, v38
  s_cmp_ge_u32 s91, s20
  s_cbranch_scc1 L_gm_59
  s_add_u32 s94, s94, 1
  s_cmp_lt_u32 s94, 400000
  s_cbranch_scc1 L_gm_58
  s_branch L_fail
L_gm_59:
L_md_60:
  s_add_u32 s21, s25, 54525952
  s_add_u32 s22, s25, 62914560
  buffer_load_dwordx4 v[40:43], v1, s[4:7], s21 offen offset:0 sc1
  buffer_load_dwordx4 v[44:47], v1, s[4:7], s21 offen offset:1024 sc1
  buffer_load_dwordx4 v[48:51], v1, s[4:7], s21 offen offset:2048 sc1
  buffer_load_dwordx4 v[52:55], v1, s[4:7], s21 offen offset:3072 sc1
  buffer_load_dwordx4 v[56:59], v1, s[4:7], s22 offen offset:0 sc1
  buffer_load_dwordx4 v[60:63], v1, s[4:7], s22 offen offset:1024 sc1
  buffer_load_dwordx4 v[64:67], v1, s[4:7], s22 offen offset:2048 sc1
  buffer_load_dwordx4 v[68:71], v1, s[4:7], s22 offen offset:3072 sc1
  s_waitcnt vmcnt(4)
  v_max3_u32 v36, v40, v41, v42
  v_max3_u32 v37, v43, v44, v45
  v_max3_u32 v36, v36, v46, v47
  v_max3_u32 v37, v37, v48, v49
  v_max3_u32 v36, v36, v50, v51
  v_max3_u32 v37, v37, v52, v53
  v_max3_u32 v36, v36, v54, v55
  v_max_u32 v36, v36, v37
  v_cmp_eq_u32 vcc, -1, v36
  s_cbranch_vccz L_md_61
  s_add_u32 s94, s94, 1
  s_cmp_lt_u32 s94, 400000
  s_cbranch_scc1 L_md_60
  s_branch L_fail
L_md_61:
  v_mfma_f32_16x16x32_bf16 v[8:11], v[40:43], v[72:75], 0
  v_mfma_f32_16x16x32_bf16 v[8:11], v[44:47], v[76:79], v[8:11]
  v_mfma_f32_16x16x32_bf16 v[8:11], v[48:51], v[80:83], v[8:11]
  v_mfma_f32_16x16x32_bf16 v[8:11], v[52:55], v[84:87], v[8:11]
  v_mov_b32 v37, 0xce6e6b28
  v_cndmask_b32 v12, v37, v12, s[40:41]
  v_cndmask_b32 v13, v37, v13, s[42:43]
  v_cndmask_b32 v14, v37, v14, s[44:45]
  v_cndmask_b32 v15, v37, v15, s[46:47]
  v_cndmask_b32 v16, v37, v16, s[48:49]
  v_cndmask_b32 v17, v37, v17, s[50:51]
  v_cndmask_b32 v18, v37, v18, s[52:53]
  v_cndmask_b32 v19, v37, v19, s[54:55]
  v_max3_f32 v36, v12, v13, v14
  v_max3_f32 v37, v15, v16, v17
  v_max3_f32 v36, v36, v18, v19
  v_max3_f32 v37, v37, v8, v9
  v_max_f32 v36, v36, v37
  v_mov_b32 v37, v36
  s_nop 1
  v_permlane16_swap_b32 v36, v37
  v_max_f32 v36, v36, v37
  v_mov_b32 v37, v36
  s_nop 1
  v_permlane32_swap_b32 v36, v37
  v_max_f32 v36, v36, v37
  v_mul_f32 v36, s28, v36
  v_fma_f32 v8, v8, s28, -v36
  v_fma_f32 v9, v9, s28, -v36
  v_fma_f32 v12, v12, s28, -v36
  v_fma_f32 v13, v13, s28, -v36
  v_fma_f32 v14, v14, s28, -v36
  v_fma_f32 v15, v15, s28, -v36
  v_fma_f32 v16, v16, s28, -v36
  v_fma_f32 v17, v17, s28, -v36
  v_fma_f32 v18, v18, s28, -v36
  v_fma_f32 v19, v19, s28, -v36
  v_exp_f32 v8, v8
  v_exp_f32 v9, v9
  v_exp_f32 v12, v12
  v_exp_f32 v13, v13
  v_exp_f32 v14, v14
  v_exp_f32 v15, v15
  v_exp_f32 v16, v16
  v_exp_f32 v17, v17
  v_exp_f32 v18, v18
  v_exp_f32 v19, v19
  v_cvt_pk_bf16_f32 v20, v12, v13
  v_cvt_pk_bf16_f32 v21, v14, v15
  v_cvt_pk_bf16_f32 v22, v16, v17
  v_cvt_pk_bf16_f32 v23, v18, v19
  v_cvt_pk_bf16_f32 v24, v8, v9
  v_mov_b32 v25, v24
  v_mfma_f32_16x16x32_bf16 v[26:29], v[30:33], v[20:23], 0
  v_mfma_f32_16x16x32_bf16 v[152:155], v[120:123], v[20:23], 0
  v_mfma_f32_16x16x32_bf16 v[156:159], v[124:127], v[20:23], 0
  v_mfma_f32_16x16x32_bf16 v[160:163], v[128:131], v[20:23], 0
  v_mfma_f32_16x16x32_bf16 v[164:167], v[132:135], v[20:23], 0
  v_mfma_f32_16x16x32_bf16 v[168:171], v[136:139], v[20:23], 0
  v_mfma_f32_16x16x32_bf16 v[172:175], v[140:143], v[20:23], 0
  v_mfma_f32_16x16x32_bf16 v[176:179], v[144:147], v[20:23], 0
  v_mfma_f32_16x16x32_bf16 v[180:183], v[148:151], v[20:23], 0
L_mv_62:
  s_waitcnt vmcnt(0)
  v_max3_u32 v36, v56, v57, v58
  v_max3_u32 v37, v59, v60, v61
  v_max3_u32 v36, v36, v62, v63
  v_max3_u32 v37, v37, v64, v65
  v_max3_u32 v36, v36, v66, v67
  v_max3_u32 v37, v37, v68, v69
  v_max3_u32 v36, v36, v70, v71
  v_max_u32 v36, v36, v37
  v_cmp_eq_u32 vcc, -1, v36
  s_cbranch_vccz L_mv_63
  s_add_u32 s22, s25, 62914560
  buffer_load_dwordx4 v[56:59], v1, s[4:7], s22 offen offset:0 sc1
  buffer_load_dwordx4 v[60:63], v1, s[4:7], s22 offen offset:1024 sc1
  buffer_load_dwordx4 v[64:67], v1, s[4:7], s22 offen offset:2048 sc1
  buffer_load_dwordx4 v[68:71], v1, s[4:7], s22 offen offset:3072 sc1
  s_add_u32 s94, s94, 1
  s_cmp_lt_u32 s94, 400000
  s_cbranch_scc1 L_mv_62
  s_branch L_fail
L_mv_63:
  s_cmp_lg_u32 s30, 0
  s_cbranch_scc1 L_sm_64
  s_cmp_lg_u32 s17, 0
  s_cbranch_scc1 L_fs_65
  v_mov_b32 v38, 32
  s_mov_b64 exec, 1
  buffer_store_dword v38, off, s[4:7], s95 sc1
  s_mov_b64 exec, -1
L_fs_65:
L_sm_64:
  v_mfma_f32_16x16x16_bf16 v[26:29], v[34:35], v[24:25], v[26:29]
  v_mfma_f32_16x16x16_bf16 v[152:155], v[56:57], v[24:25], v[152:155]
  v_mfma_f32_16x16x16_bf16 v[156:159], v[58:59], v[24:25], v[156:159]
  v_mfma_f32_16x16x16_bf16 v[160:163], v[60:61], v[24:25], v[160:163]
  v_mfma_f32_16x16x16_bf16 v[164:167], v[62:63], v[24:25], v[164:167]
  v_mfma_f32_16x16x16_bf16 v[168:171], v[64:65], v[24:25], v[168:171]
  v_mfma_f32_16x16x16_bf16 v[172:175], v[66:67], v[24:25], v[172:175]
  v_mfma_f32_16x16x16_bf16 v[176:179], v[68:69], v[24:25], v[176:179]
  v_mfma_f32_16x16x16_bf16 v[180:183], v[70:71], v[24:25], v[180:183]
  v_rcp_f32 v36, v26
  s_nop 0
  v_mul_f32 v152, v152, v36
  v_mul_f32 v153, v153, v36
  v_mul_f32 v154, v154, v36
  v_mul_f32 v155, v155, v36
  v_cvt_pk_bf16_f32 v184, v152, v153
  v_cvt_pk_bf16_f32 v185, v154, v155
  v_mul_f32 v156, v156, v36
  v_mul_f32 v157, v157, v36
  v_mul_f32 v158, v158, v36
  v_mul_f32 v159, v159, v36
  v_cvt_pk_bf16_f32 v186, v156, v157
  v_cvt_pk_bf16_f32 v187, v158, v159
  ds_write_b128 v2, v[184:187] offset:16384
  v_mul_f32 v160, v160, v36
  v_mul_f32 v161, v161, v36
  v_mul_f32 v162, v162, v36
  v_mul_f32 v163, v163, v36
  v_cvt_pk_bf16_f32 v188, v160, v161
  v_cvt_pk_bf16_f32 v189, v162, v163
  v_mul_f32 v164, v164, v36
  v_mul_f32 v165, v165, v36
  v_mul_f32 v166, v166, v36
  v_mul_f32 v167, v167, v36
  v_cvt_pk_bf16_f32 v190, v164, v165
  v_cvt_pk_bf16_f32 v191, v166, v167
  ds_write_b128 v2, v[188:191] offset:17408
  v_mul_f32 v168, v168, v36
  v_mul_f32 v169, v169, v36
  v_mul_f32 v170, v170, v36
  v_mul_f32 v171, v171, v36
  v_cvt_pk_bf16_f32 v192, v168, v169
  v_cvt_pk_bf16_f32 v193, v170, v171
  v_mul_f32 v172, v172, v36
  v_mul_f32 v173, v173, v36
  v_mul_f32 v174, v174, v36
  v_mul_f32 v175, v175, v36
  v_cvt_pk_bf16_f32 v194, v172, v173
  v_cvt_pk_bf16_f32 v195, v174, v175
  ds_write_b128 v2, v[192:195] offset:18432
  v_mul_f32 v176, v176, v36
  v_mul_f32 v177, v177, v36
  v_mul_f32 v178, v178, v36
  v_mul_f32 v179, v179, v36
  v_cvt_pk_bf16_f32 v196, v176, v177
  v_cvt_pk_bf16_f32 v197, v178, v179
  v_mul_f32 v180, v180, v36
  v_mul_f32 v181, v181, v36
  v_mul_f32 v182, v182, v36
  v_mul_f32 v183, v183, v36
  v_cvt_pk_bf16_f32 v198, v180, v181
  v_cvt_pk_bf16_f32 v199, v182, v183
  ds_write_b128 v2, v[196:199] offset:19456
  s_waitcnt lgkmcnt(0)
  s_barrier
  s_cmp_eq_u32 s19, 0
  s_cbranch_scc1 L_fol_l62
  ds_read_b128 v[88:91], v1 offset:16384
  ds_read_b128 v[92:95], v1 offset:20480
  ds_read_b128 v[96:99], v1 offset:17408
  ds_read_b128 v[100:103], v1 offset:21504
  ds_read_b128 v[104:107], v1 offset:18432
  ds_read_b128 v[108:111], v1 offset:22528
  ds_read_b128 v[112:115], v1 offset:19456
  ds_read_b128 v[116:119], v1 offset:23552
  ds_read_b128 v[120:123], v1 offset:24576
  ds_read_b128 v[124:127], v1 offset:28672
  ds_read_b128 v[128:131], v1 offset:25600
  ds_read_b128 v[132:135], v1 offset:29696
  s_waitcnt lgkmcnt(11)
  v_mfma_f32_16x16x32_bf16 v[152:155], a[0:3], v[88:91], 0
  ds_read_b128 v[136:139], v1 offset:26624
  v_mfma_f32_16x16x32_bf16 v[160:163], a[32:35], v[88:91], 0
  v_mfma_f32_16x16x32_bf16 v[168:171], a[64:67], v[88:91], 0
  s_waitcnt lgkmcnt(11)
  v_mfma_f32_16x16x32_bf16 v[156:159], a[0:3], v[92:95], 0
  ds_read_b128 v[140:143], v1 offset:30720
  v_mfma_f32_16x16x32_bf16 v[164:167], a[32:35], v[92:95], 0
  v_mfma_f32_16x16x32_bf16 v[172:175], a[64:67], v[92:95], 0
  s_waitcnt lgkmcnt(11)
  v_mfma_f32_16x16x32_bf16 v[152:155], a[4:7], v[96:99], v[152:155]
  ds_read_b128 v[144:147], v1 offset:27648
  v_mfma_f32_16x16x32_bf16 v[160:163], a[36:39], v[96:99], v[160:163]
  v_mfma_f32_16x16x32_bf16 v[168:171], a[68:71], v[96:99], v[168:171]
  s_waitcnt lgkmcnt(11)
  v_mfma_f32_16x16x32_bf16 v[156:159], a[4:7], v[100:103], v[156:159]
  ds_read_b128 v[148:151], v1 offset:31744
  v_mfma_f32_16x16x32_bf16 v[164:167], a[36:39], v[100:103], v[164:167]
  v_mfma_f32_16x16x32_bf16 v[172:175], a[68:71], v[100:103], v[172:175]
  s_waitcnt lgkmcnt(11)
  v_mfma_f32_16x16x32_bf16 v[152:155], a[8:11], v[104:107], v[152:155]
  v_mfma_f32_16x16x32_bf16 v[160:163], a[40:43], v[104:107], v[160:163]
  v_mfma_f32_16x16x32_bf16 v[168:171], a[72:75], v[104:107], v[168:171]
  s_waitcnt lgkmcnt(10)
  v_mfma_f32_16x16x32_bf16 v[156:159], a[8:11], v[108:111], v[156:159]
  v_mfma_f32_16x16x32_bf16 v[164:167], a[40:43], v[108:111], v[164:167]
  v_mfma_f32_16x16x32_bf16 v[172:175], a[72:75], v[108:111], v[172:175]
  s_waitcnt lgkmcnt(9)
  v_mfma_f32_16x16x32_bf16 v[152:155], a[12:15], v[112:115], v[152:155]
  v_mfma_f32_16x16x32_bf16 v[160:163], a[44:47], v[112:115], v[160:163]
  v_mfma_f32_16x16x32_bf16 v[168:171], a[76:79], v[112:115], v[168:171]
  s_waitcnt lgkmcnt(8)
  v_mfma_f32_16x16x32_bf16 v[156:159], a[12:15], v[116:119], v[156:159]
  v_mfma_f32_16x16x32_bf16 v[164:167], a[44:47], v[116:119], v[164:167]
  v_mfma_f32_16x16x32_bf16 v[172:175], a[76:79], v[116:119], v[172:175]
  s_waitcnt lgkmcnt(7)
  v_mfma_f32_16x16x32_bf16 v[152:155], a[16:19], v[120:123], v[152:155]
  v_mfma_f32_16x16x32_bf16 v[160:163], a[48:51], v[120:123], v[160:163]
  v_mfma_f32_16x16x32_bf16 v[168:171], a[80:83], v[120:123], v[168:171]
  s_waitcnt lgkmcnt(6)
  v_mfma_f32_16x16x32_bf16 v[156:159], a[16:19], v[124:127], v[156:159]
  v_mfma_f32_16x16x32_bf16 v[164:167], a[48:51], v[124:127], v[164:167]
  v_mfma_f32_16x16x32_bf16 v[172:175], a[80:83], v[124:127], v[172:175]
  s_waitcnt lgkmcnt(5)
  v_mfma_f32_16x16x32_bf16 v[152:155], a[20:23], v[128:131], v[152:155]
  v_mfma_f32_16x16x32_bf16 v[160:163], a[52:55], v[128:131], v[160:163]
  v_mfma_f32_16x16x32_bf16 v[168:171], a[84:87], v[128:131], v[168:171]
  s_waitcnt lgkmcnt(4)
  v_mfma_f32_16x16x32_bf16 v[156:159], a[20:23], v[132:135], v[156:159]
  v_mfma_f32_16x16x32_bf16 v[164:167], a[52:55], v[132:135], v[164:167]
  v_mfma_f32_16x16x32_bf16 v[172:175], a[84:87], v[132:135], v[172:175]
  s_waitcnt lgkmcnt(3)
  v_mfma_f32_16x16x32_bf16 v[152:155], a[24:27], v[136:139], v[152:155]
  v_mfma_f32_16x16x32_bf16 v[160:163], a[56:59], v[136:139], v[160:163]
  v_mfma_f32_16x16x32_bf16 v[168:171], a[88:91], v[136:139], v[168:171]
  s_waitcnt lgkmcnt(2)
  v_mfma_f32_16x16x32_bf16 v[156:159], a[24:27], v[140:143], v[156:159]
  v_mfma_f32_16x16x32_bf16 v[164:167], a[56:59], v[140:143], v[164:167]
  v_mfma_f32_16x16x32_bf16 v[172:175], a[88:91], v[140:143], v[172:175]
  s_waitcnt lgkmcnt(1)
  v_mfma_f32_16x16x32_bf16 v[152:155], a[28:31], v[144:147], v[152:155]
  v_mfma_f32_16x16x32_bf16 v[160:163], a[60:63], v[144:147], v[160:163]
  v_mfma_f32_16x16x32_bf16 v[168:171], a[92:95], v[144:147], v[168:171]
  s_waitcnt lgkmcnt(0)
  v_mfma_f32_16x16x32_bf16 v[156:159], a[28:31], v[148:151], v[156:159]
  v_mfma_f32_16x16x32_bf16 v[164:167], a[60:63], v[148:151], v[164:167]
  v_mfma_f32_16x16x32_bf16 v[172:175], a[92:95], v[148:151], v[172:175]
  v_cvt_pk_bf16_f32 v8, v152, v153
  v_cvt_pk_bf16_f32 v9, v154, v155
  v_cvt_pk_bf16_f32 v10, v156, v157
  v_cvt_pk_bf16_f32 v11, v158, v159
  s_add_u32 s21, s26, 0
  buffer_store_dwordx4 v[8:11], v1, s[4:7], s21 offen sc1
  v_cvt_pk_bf16_f32 v12, v160, v161
  v_cvt_pk_bf16_f32 v13, v162, v163
  v_cvt_pk_bf16_f32 v14, v164, v165
  v_cvt_pk_bf16_f32 v15, v166, v167
  s_add_u32 s21, s26, 1024
  buffer_store_dwordx4 v[12:15], v1, s[4:7], s21 offen sc1
  v_cvt_pk_bf16_f32 v16, v168, v169
  v_cvt_pk_bf16_f32 v17, v170, v171
  v_cvt_pk_bf16_f32 v18, v172, v173
  v_cvt_pk_bf16_f32 v19, v174, v175
  s_add_u32 s21, s26, 2048
  buffer_store_dwordx4 v[16:19], v1, s[4:7], s21 offen sc1
  s_branch L_exit
L_fol_l62:
  ds_read_b128 v[40:43], v1 offset:16384
  ds_read_b128 v[44:47], v1 offset:20480
  ds_read_b128 v[48:51], v1 offset:17408
  s_waitcnt lgkmcnt(2)
  v_mfma_f32_16x16x32_bf16 v[152:155], a[0:3], v[40:43], 0
  ds_read_b128 v[52:55], v1 offset:21504
  v_mfma_f32_16x16x32_bf16 v[160:163], a[32:35], v[40:43], 0
  v_mfma_f32_16x16x32_bf16 v[168:171], a[64:67], v[40:43], 0
  v_mfma_f32_16x16x32_bf16 v[176:179], a[96:99], v[40:43], 0
  v_mfma_f32_16x16x32_bf16 v[184:187], a[128:131], v[40:43], 0
  v_mfma_f32_16x16x32_bf16 v[192:195], a[160:163], v[40:43], 0
  v_mfma_f32_16x16x32_bf16 v[200:203], a[192:195], v[40:43], 0
  v_mfma_f32_16x16x32_bf16 v[208:211], a[224:227], v[40:43], 0
  v_mfma_f32_16x16x32_bf16 v[216:219], v[224:227], v[40:43], 0
  s_waitcnt lgkmcnt(2)
  v_mfma_f32_16x16x32_bf16 v[156:159], a[0:3], v[44:47], 0
  ds_read_b128 v[40:43], v1 offset:18432
  v_mfma_f32_16x16x32_bf16 v[164:167], a[32:35], v[44:47], 0
  v_mfma_f32_16x16x32_bf16 v[172:175], a[64:67], v[44:47], 0
  v_mfma_f32_16x16x32_bf16 v[180:183], a[96:99], v[44:47], 0
  v_mfma_f32_16x16x32_bf16 v[188:191], a[128:131], v[44:47], 0
  v_mfma_f32_16x16x32_bf16 v[196:199], a[160:163], v[44:47], 0
  v_mfma_f32_16x16x32_bf16 v[204:207], a[192:195], v[44:47], 0
  v_mfma_f32_16x16x32_bf16 v[212:215], a[224:227], v[44:47], 0
  v_mfma_f32_16x16x32_bf16 v[220:223], v[224:227], v[44:47], 0
  s_waitcnt lgkmcnt(2)
  v_mfma_f32_16x16x32_bf16 v[152:155], a[4:7], v[48:51], v[152:155]
  ds_read_b128 v[44:47], v1 offset:22528
  v_mfma_f32_16x16x32_bf16 v[160:163], a[36:39], v[48:51], v[160:163]
  v_mfma_f32_16x16x32_bf16 v[168:171], a[68:71], v[48:51], v[168:171]
  v_mfma_f32_16x16x32_bf16 v[176:179], a[100:103], v[48:51], v[176:179]
  v_mfma_f32_16x16x32_bf16 v[184:187], a[132:135], v[48:51], v[184:187]
  v_mfma_f32_16x16x32_bf16 v[192:195], a[164:167], v[48:51], v[192:195]
  v_mfma_f32_16x16x32_bf16 v[200:203], a[196:199], v[48:51], v[200:203]
  v_mfma_f32_16x16x32_bf16 v[208:211], a[228:231], v[48:51], v[208:211]
  v_mfma_f32_16x16x32_bf16 v[216:219], v[228:231], v[48:51], v[216:219]
  s_waitcnt lgkmcnt(2)
  v_mfma_f32_16x16x32_bf16 v[156:159], a[4:7], v[52:55], v[156:159]
  ds_read_b128 v[48:51], v1 offset:19456
  v_mfma_f32_16x16x32_bf16 v[164:167], a[36:39], v[52:55], v[164:167]
  v_mfma_f32_16x16x32_bf16 v[172:175], a[68:71], v[52:55], v[172:175]
  v_mfma_f32_16x16x32_bf16 v[180:183], a[100:103], v[52:55], v[180:183]
  v_mfma_f32_16x16x32_bf16 v[188:191], a[132:135], v[52:55], v[188:191]
  v_mfma_f32_16x16x32_bf16 v[196:199], a[164:167], v[52:55], v[196:199]
  v_mfma_f32_16x16x32_bf16 v[204:207], a[196:199], v[52:55], v[204:207]
  v_mfma_f32_16x16x32_bf16 v[212:215], a[228:231], v[52:55], v[212:215]
  v_mfma_f32_16x16x32_bf16 v[220:223], v[228:231], v[52:55], v[220:223]
  s_waitcnt lgkmcnt(2)
  v_mfma_f32_16x16x32_bf16 v[152:155], a[8:11], v[40:43], v[152:155]
  ds_read_b128 v[52:55], v1 offset:23552
  v_mfma_f32_16x16x32_bf16 v[160:163], a[40:43], v[40:43], v[160:163]
  v_mfma_f32_16x16x32_bf16 v[168:171], a[72:75], v[40:43], v[168:171]
  v_mfma_f32_16x16x32_bf16 v[176:179], a[104:107], v[40:43], v[176:179]
  v_mfma_f32_16x16x32_bf16 v[184:187], a[136:139], v[40:43], v[184:187]
  v_mfma_f32_16x16x32_bf16 v[192:195], a[168:171], v[40:43], v[192:195]
  v_mfma_f32_16x16x32_bf16 v[200:203], a[200:203], v[40:43], v[200:203]
  v_mfma_f32_16x16x32_bf16 v[208:211], a[232:235], v[40:43], v[208:211]
  v_mfma_f32_16x16x32_bf16 v[216:219], v[232:235], v[40:43], v[216:219]
  s_waitcnt lgkmcnt(2)
  v_mfma_f32_16x16x32_bf16 v[156:159], a[8:11], v[44:47], v[156:159]
  ds_read_b128 v[40:43], v1 offset:24576
  v_mfma_f32_16x16x32_bf16 v[164:167], a[40:43], v[44:47], v[164:167]
  v_mfma_f32_16x16x32_bf16 v[172:175], a[72:75], v[44:47], v[172:175]
  v_mfma_f32_16x16x32_bf16 v[180:183], a[104:107], v[44:47], v[180:183]
  v_mfma_f32_16x16x32_bf16 v[188:191], a[136:139], v[44:47], v[188:191]
  v_mfma_f32_16x16x32_bf16 v[196:199], a[168:171], v[44:47], v[196:199]
  v_mfma_f32_16x16x32_bf16 v[204:207], a[200:203], v[44:47], v[204:207]
  v_mfma_f32_16x16x32_bf16 v[212:215], a[232:235], v[44:47], v[212:215]
  v_mfma_f32_16x16x32_bf16 v[220:223], v[232:235], v[44:47], v[220:223]
  s_waitcnt lgkmcnt(2)
  v_mfma_f32_16x16x32_bf16 v[152:155], a[12:15], v[48:51], v[152:155]
  ds_read_b128 v[44:47], v1 offset:28672
  v_mfma_f32_16x16x32_bf16 v[160:163], a[44:47], v[48:51], v[160:163]
  v_mfma_f32_16x16x32_bf16 v[168:171], a[76:79], v[48:51], v[168:171]
  v_mfma_f32_16x16x32_bf16 v[176:179], a[108:111], v[48:51], v[176:179]
  v_mfma_f32_16x16x32_bf16 v[184:187], a[140:143], v[48:51], v[184:187]
  v_mfma_f32_16x16x32_bf16 v[192:195], a[172:175], v[48:51], v[192:195]
  v_mfma_f32_16x16x32_bf16 v[200:203], a[204:207], v[48:51], v[200:203]
  v_mfma_f32_16x16x32_bf16 v[208:211], a[236:239], v[48:51], v[208:211]
  v_mfma_f32_16x16x32_bf16 v[216:219], v[236:239], v[48:51], v[216:219]
  s_waitcnt lgkmcnt(2)
  v_mfma_f32_16x16x32_bf16 v[156:159], a[12:15], v[52:55], v[156:159]
  ds_read_b128 v[48:51], v1 offset:25600
  v_mfma_f32_16x16x32_bf16 v[164:167], a[44:47], v[52:55], v[164:167]
  v_mfma_f32_16x16x32_bf16 v[172:175], a[76:79], v[52:55], v[172:175]
  v_mfma_f32_16x16x32_bf16 v[180:183], a[108:111], v[52:55], v[180:183]
  v_mfma_f32_16x16x32_bf16 v[188:191], a[140:143], v[52:55], v[188:191]
  v_mfma_f32_16x16x32_bf16 v[196:199], a[172:175], v[52:55], v[196:199]
  v_mfma_f32_16x16x32_bf16 v[204:207], a[204:207], v[52:55], v[204:207]
  v_mfma_f32_16x16x32_bf16 v[212:215], a[236:239], v[52:55], v[212:215]
  v_mfma_f32_16x16x32_bf16 v[220:223], v[236:239], v[52:55], v[220:223]
  s_waitcnt lgkmcnt(2)
  v_mfma_f32_16x16x32_bf16 v[152:155], a[16:19], v[40:43], v[152:155]
  ds_read_b128 v[52:55], v1 offset:29696
  v_mfma_f32_16x16x32_bf16 v[160:163], a[48:51], v[40:43], v[160:163]
  v_mfma_f32_16x16x32_bf16 v[168:171], a[80:83], v[40:43], v[168:171]
  v_mfma_f32_16x16x32_bf16 v[176:179], a[112:115], v[40:43], v[176:179]
  v_mfma_f32_16x16x32_bf16 v[184:187], a[144:147], v[40:43], v[184:187]
  v_mfma_f32_16x16x32_bf16 v[192:195], a[176:179], v[40:43], v[192:195]
  v_mfma_f32_16x16x32_bf16 v[200:203], a[208:211], v[40:43], v[200:203]
  v_mfma_f32_16x16x32_bf16 v[208:211], a[240:243], v[40:43], v[208:211]
  v_mfma_f32_16x16x32_bf16 v[216:219], v[240:243], v[40:43], v[216:219]
  s_waitcnt lgkmcnt(2)
  v_mfma_f32_16x16x32_bf16 v[156:159], a[16:19], v[44:47], v[156:159]
  ds_read_b128 v[40:43], v1 offset:26624
  v_mfma_f32_16x16x32_bf16 v[164:167], a[48:51], v[44:47], v[164:167]
  v_mfma_f32_16x16x32_bf16 v[172:175], a[80:83], v[44:47], v[172:175]
  v_mfma_f32_16x16x32_bf16 v[180:183], a[112:115], v[44:47], v[180:183]
  v_mfma_f32_16x16x32_bf16 v[188:191], a[144:147], v[44:47], v[188:191]
  v_mfma_f32_16x16x32_bf16 v[196:199], a[176:179], v[44:47], v[196:199]
  v_mfma_f32_16x16x32_bf16 v[204:207], a[208:211], v[44:47], v[204:207]
  v_mfma_f32_16x16x32_bf16 v[212:215], a[240:243], v[44:47], v[212:215]
  v_mfma_f32_16x16x32_bf16 v[220:223], v[240:243], v[44:47], v[220:223]
  s_waitcnt lgkmcnt(2)
  v_mfma_f32_16x16x32_bf16 v[152:155], a[20:23], v[48:51], v[152:155]
  ds_read_b128 v[44:47], v1 offset:30720
  v_mfma_f32_16x16x32_bf16 v[160:163], a[52:55], v[48:51], v[160:163]
  v_mfma_f32_16x16x32_bf16 v[168:171], a[84:87], v[48:51], v[168:171]
  v_mfma_f32_16x16x32_bf16 v[176:179], a[116:119], v[48:51], v[176:179]
  v_mfma_f32_16x16x32_bf16 v[184:187], a[148:151], v[48:51], v[184:187]
  v_mfma_f32_16x16x32_bf16 v[192:195], a[180:183], v[48:51], v[192:195]
  v_mfma_f32_16x16x32_bf16 v[200:203], a[212:215], v[48:51], v[200:203]
  v_mfma_f32_16x16x32_bf16 v[208:211], a[244:247], v[48:51], v[208:211]
  v_mfma_f32_16x16x32_bf16 v[216:219], v[244:247], v[48:51], v[216:219]
  s_waitcnt lgkmcnt(2)
  v_mfma_f32_16x16x32_bf16 v[156:159], a[20:23], v[52:55], v[156:159]
  ds_read_b128 v[48:51], v1 offset:27648
  v_mfma_f32_16x16x32_bf16 v[164:167], a[52:55], v[52:55], v[164:167]
  v_mfma_f32_16x16x32_bf16 v[172:175], a[84:87], v[52:55], v[172:175]
  v_mfma_f32_16x16x32_bf16 v[180:183], a[116:119], v[52:55], v[180:183]
  v_mfma_f32_16x16x32_bf16 v[188:191], a[148:151], v[52:55], v[188:191]
  v_mfma_f32_16x16x32_bf16 v[196:199], a[180:183], v[52:55], v[196:199]
  v_mfma_f32_16x16x32_bf16 v[204:207], a[212:215], v[52:55], v[204:207]
  v_mfma_f32_16x16x32_bf16 v[212:215], a[244:247], v[52:55], v[212:215]
  v_mfma_f32_16x16x32_bf16 v[220:223], v[244:247], v[52:55], v[220:223]
  s_waitcnt lgkmcnt(2)
  v_mfma_f32_16x16x32_bf16 v[152:155], a[24:27], v[40:43], v[152:155]
  ds_read_b128 v[52:55], v1 offset:31744
  v_mfma_f32_16x16x32_bf16 v[160:163], a[56:59], v[40:43], v[160:163]
  v_mfma_f32_16x16x32_bf16 v[168:171], a[88:91], v[40:43], v[168:171]
  v_mfma_f32_16x16x32_bf16 v[176:179], a[120:123], v[40:43], v[176:179]
  v_mfma_f32_16x16x32_bf16 v[184:187], a[152:155], v[40:43], v[184:187]
  v_mfma_f32_16x16x32_bf16 v[192:195], a[184:187], v[40:43], v[192:195]
  v_mfma_f32_16x16x32_bf16 v[200:203], a[216:219], v[40:43], v[200:203]
  v_mfma_f32_16x16x32_bf16 v[208:211], a[248:251], v[40:43], v[208:211]
  v_mfma_f32_16x16x32_bf16 v[216:219], v[248:251], v[40:43], v[216:219]
  s_waitcnt lgkmcnt(2)
  v_mfma_f32_16x16x32_bf16 v[156:159], a[24:27], v[44:47], v[156:159]
  v_mfma_f32_16x16x32_bf16 v[164:167], a[56:59], v[44:47], v[164:167]
  v_mfma_f32_16x16x32_bf16 v[172:175], a[88:91], v[44:47], v[172:175]
  v_mfma_f32_16x16x32_bf16 v[180:183], a[120:123], v[44:47], v[180:183]
  v_mfma_f32_16x16x32_bf16 v[188:191], a[152:155], v[44:47], v[188:191]
  v_mfma_f32_16x16x32_bf16 v[196:199], a[184:187], v[44:47], v[196:199]
  v_mfma_f32_16x16x32_bf16 v[204:207], a[216:219], v[44:47], v[204:207]
  v_mfma_f32_16x16x32_bf16 v[212:215], a[248:251], v[44:47], v[212:215]
  v_mfma_f32_16x16x32_bf16 v[220:223], v[248:251], v[44:47], v[220:223]
  s_waitcnt lgkmcnt(1)
  v_mfma_f32_16x16x32_bf16 v[152:155], a[28:31], v[48:51], v[152:155]
  v_mfma_f32_16x16x32_bf16 v[160:163], a[60:63], v[48:51], v[160:163]
  v_mfma_f32_16x16x32_bf16 v[168:171], a[92:95], v[48:51], v[168:171]
  v_mfma_f32_16x16x32_bf16 v[176:179], a[124:127], v[48:51], v[176:179]
  v_mfma_f32_16x16x32_bf16 v[184:187], a[156:159], v[48:51], v[184:187]
  v_mfma_f32_16x16x32_bf16 v[192:195], a[188:191], v[48:51], v[192:195]
  v_mfma_f32_16x16x32_bf16 v[200:203], a[220:223], v[48:51], v[200:203]
  v_mfma_f32_16x16x32_bf16 v[208:211], a[252:255], v[48:51], v[208:211]
  v_mfma_f32_16x16x32_bf16 v[216:219], v[252:255], v[48:51], v[216:219]
  s_waitcnt lgkmcnt(0)
  v_mfma_f32_16x16x32_bf16 v[156:159], a[28:31], v[52:55], v[156:159]
  v_mfma_f32_16x16x32_bf16 v[164:167], a[60:63], v[52:55], v[164:167]
  v_mfma_f32_16x16x32_bf16 v[172:175], a[92:95], v[52:55], v[172:175]
  v_mfma_f32_16x16x32_bf16 v[180:183], a[124:127], v[52:55], v[180:183]
  v_mfma_f32_16x16x32_bf16 v[188:191], a[156:159], v[52:55], v[188:191]
  v_mfma_f32_16x16x32_bf16 v[196:199], a[188:191], v[52:55], v[196:199]
  v_mfma_f32_16x16x32_bf16 v[204:207], a[220:223], v[52:55], v[204:207]
  v_mfma_f32_16x16x32_bf16 v[212:215], a[252:255], v[52:55], v[212:215]
  v_mfma_f32_16x16x32_bf16 v[220:223], v[252:255], v[52:55], v[220:223]
  v_cvt_pk_bf16_f32 v8, v152, v153
  v_cvt_pk_bf16_f32 v9, v154, v155
  v_cvt_pk_bf16_f32 v10, v156, v157
  v_cvt_pk_bf16_f32 v11, v158, v159
  s_add_u32 s21, s26, 0
  buffer_store_dwordx4 v[8:11], v1, s[4:7], s21 offen sc1
  v_cvt_pk_bf16_f32 v12, v160, v161
  v_cvt_pk_bf16_f32 v13, v162, v163
  v_cvt_pk_bf16_f32 v14, v164, v165
  v_cvt_pk_bf16_f32 v15, v166, v167
  s_add_u32 s21, s26, 1024
  buffer_store_dwordx4 v[12:15], v1, s[4:7], s21 offen sc1
  v_cvt_pk_bf16_f32 v16, v168, v169
  v_cvt_pk_bf16_f32 v17, v170, v171
  v_cvt_pk_bf16_f32 v18, v172, v173
  v_cvt_pk_bf16_f32 v19, v174, v175
  s_add_u32 s21, s26, 2048
  buffer_store_dwordx4 v[16:19], v1, s[4:7], s21 offen sc1
  v_cvt_pk_bf16_f32 v20, v176, v177
  v_cvt_pk_bf16_f32 v21, v178, v179
  v_cvt_pk_bf16_f32 v22, v180, v181
  v_cvt_pk_bf16_f32 v23, v182, v183
  s_add_u32 s21, s26, 3072
  buffer_store_dwordx4 v[20:23], v1, s[4:7], s21 offen sc1
  v_cvt_pk_bf16_f32 v8, v184, v185
  v_cvt_pk_bf16_f32 v9, v186, v187
  v_cvt_pk_bf16_f32 v10, v188, v189
  v_cvt_pk_bf16_f32 v11, v190, v191
  s_add_u32 s21, s26, 4096
  buffer_store_dwordx4 v[8:11], v1, s[4:7], s21 offen sc1
  v_cvt_pk_bf16_f32 v12, v192, v193
  v_cvt_pk_bf16_f32 v13, v194, v195
  v_cvt_pk_bf16_f32 v14, v196, v197
  v_cvt_pk_bf16_f32 v15, v198, v199
  s_add_u32 s21, s26, 5120
  buffer_store_dwordx4 v[12:15], v1, s[4:7], s21 offen sc1
  v_cvt_pk_bf16_f32 v16, v200, v201
  v_cvt_pk_bf16_f32 v17, v202, v203
  v_cvt_pk_bf16_f32 v18, v204, v205
  v_cvt_pk_bf16_f32 v19, v206, v207
  s_add_u32 s21, s26, 6144
  buffer_store_dwordx4 v[16:19], v1, s[4:7], s21 offen sc1
  v_cvt_pk_bf16_f32 v20, v208, v209
  v_cvt_pk_bf16_f32 v21, v210, v211
  v_cvt_pk_bf16_f32 v22, v212, v213
  v_cvt_pk_bf16_f32 v23, v214, v215
  s_add_u32 s21, s26, 7168
  buffer_store_dwordx4 v[20:23], v1, s[4:7], s21 offen sc1
  v_cvt_pk_bf16_f32 v8, v216, v217
  v_cvt_pk_bf16_f32 v9, v218, v219
  v_cvt_pk_bf16_f32 v10, v220, v221
  v_cvt_pk_bf16_f32 v11, v222, v223
  s_add_u32 s21, s26, 8192
  buffer_store_dwordx4 v[8:11], v1, s[4:7], s21 offen sc1
  s_branch L_exit
L_final:
  s_load_dwordx2 s[8:9], s[0:1], 0
  s_waitcnt lgkmcnt(0)
  s_and_b32 s9, s9, 0xffff
  s_mov_b32 s10, 2359296
  s_mov_b32 s11, 0x00020000
  s_load_dwordx2 s[32:33], s[0:1], 96
  s_waitcnt lgkmcnt(0)
  s_and_b32 s33, s33, 0xffff
  s_mov_b32 s34, 2359296
  s_mov_b32 s35, 0x00020000
  s_load_dwordx2 s[36:37], s[0:1], 88
  s_waitcnt lgkmcnt(0)
  s_and_b32 s37, s37, 0xffff
  s_mov_b32 s38, 1152
  s_mov_b32 s39, 0x00020000
  v_and_b32 v5, 63, v0
  v_lshlrev_b32 v1, 4, v5
  v_and_b32 v6, 15, v5
  v_lshrrev_b32 v7, 4, v5
  v_mul_u32_u24 v6, 1152, v6
  v_lshl_add_u32 v2, v7, 3, v6
  v_lshlrev_b32 v3, 3, v7
  s_lshl_b32 s30, s96, 2
  s_add_u32 s30, s30, s17
L_fin_loop:
  s_mul_i32 s92, s30, 1821
  s_lshr_b32 s92, s92, 16
  s_lshr_b32 s31, s92, 1
  s_add_u32 s31, s31, 1
  s_and_b32 s93, s92, 1
  s_lshl_b32 s93, s93, 4
  s_add_u32 s93, s93, 128
  s_and_b32 s92, s92, 0xfffffffc
  s_add_u32 s92, s92, 144
  v_and_b32 v126, 63, v0
  v_mov_b32 v124, s93
  v_mov_b32 v125, s92
  v_cmp_gt_u32 vcc, 16, v126
  s_nop 1
  v_cndmask_b32 v124, v125, v124, vcc
  v_mov_b32 v125, s31
  v_cndmask_b32 v125, 1, v125, vcc
  v_cmp_gt_u32 vcc, 20, v126
  s_nop 1
  v_cndmask_b32 v126, 0, v126, vcc
  v_add_u32 v124, v124, v126
  v_mov_b32 v126, s93
  v_cndmask_b32 v124, v126, v124, vcc
  v_mov_b32 v126, s31
  v_cndmask_b32 v125, v126, v125, vcc
  v_lshlrev_b32 v124, 8, v124
  v_add_u32 v124, 0, v124
  s_add_u32 s92, s92, 16
  s_lshl_b32 s92, s92, 8
  s_add_u32 s92, s92, 0
  s_mov_b32 s94, 0
  s_cmp_lg_u32 s17, 0
  s_cbranch_scc1 L_fin_bar
L_fin_p1:
  s_mov_b64 exec, 1
  buffer_load_dword v126, off, s[4:7], s92 sc1
  s_mov_b64 exec, -1
  s_waitcnt vmcnt(0)
  v_readfirstlane_b32 s93, v126
  s_cmp_ge_u32 s93, 1
  s_cbranch_scc1 L_fin_p1b
  s_add_u32 s94, s94, 1
  s_cmp_lt_u32 s94, 400000
  s_cbranch_scc1 L_fin_p1
  s_branch L_fail
L_fin_p1b:
  s_lshr_b32 s92, s30, 2
  s_and_b32 s92, s92, 15
  v_readfirstlane_b32 s93, v124
  s_lshl_b32 s92, s92, 8
  s_add_u32 s92, s92, s93
L_fin_p1c:
  s_mov_b64 exec, 1
  buffer_load_dword v126, off, s[4:7], s92 sc1
  s_mov_b64 exec, -1
  s_waitcnt vmcnt(0)
  v_readfirstlane_b32 s93, v126
  s_add_u32 s93, s93, 1
  s_cmp_ge_u32 s93, s31
  s_cbranch_scc1 L_fin_p2
  s_add_u32 s94, s94, 1
  s_cmp_lt_u32 s94, 400000
  s_cbranch_scc1 L_fin_p1c
  s_branch L_fail
L_fin_p2:
  buffer_load_dword v126, v124, s[4:7], 0 offen sc1
  s_waitcnt vmcnt(0)
  v_cmp_lt_u32 vcc, v126, v125
  s_cbranch_vccz L_fin_bar
  s_add_u32 s94, s94, 1
  s_cmp_lt_u32 s94, 400000
  s_cbranch_scc1 L_fin_p2
  s_branch L_fail
L_fin_bar:
  s_barrier
L_fin_go:
  s_mul_i32 s24, s30, 1821
  s_lshr_b32 s24, s24, 16
  s_mul_i32 s21, s24, 36
  s_sub_u32 s25, s30, s21
  s_mul_i32 s21, s24, 589824
  s_lshl_b32 s22, s25, 10
  s_add_u32 s21, s21, s22
  s_add_u32 s21, s21, 71303168
  buffer_load_dwordx4 v[8:11], v1, s[4:7], s21 offen
  s_add_u32 s21, s21, 36864
  buffer_load_dwordx4 v[12:15], v1, s[4:7], s21 offen
  s_add_u32 s21, s21, 36864
  buffer_load_dwordx4 v[16:19], v1, s[4:7], s21 offen
  s_add_u32 s21, s21, 36864
  buffer_load_dwordx4 v[20:23], v1, s[4:7], s21 offen
  s_add_u32 s21, s21, 36864
  buffer_load_dwordx4 v[24:27], v1, s[4:7], s21 offen
  s_add_u32 s21, s21, 36864
  buffer_load_dwordx4 v[28:31], v1, s[4:7], s21 offen
  s_add_u32 s21, s21, 36864
  buffer_load_dwordx4 v[32:35], v1, s[4:7], s21 offen
  s_add_u32 s21, s21, 36864
  buffer_load_dwordx4 v[36:39], v1, s[4:7], s21 offen
  s_add_u32 s21, s21, 36864
  buffer_load_dwordx4 v[40:43], v1, s[4:7], s21 offen
  s_add_u32 s21, s21, 36864
  buffer_load_dwordx4 v[44:47], v1, s[4:7], s21 offen
  s_add_u32 s21, s21, 36864
  buffer_load_dwordx4 v[48:51], v1, s[4:7], s21 offen
  s_add_u32 s21, s21, 36864
  buffer_load_dwordx4 v[52:55], v1, s[4:7], s21 offen
  s_add_u32 s21, s21, 36864
  buffer_load_dwordx4 v[56:59], v1, s[4:7], s21 offen
  s_add_u32 s21, s21, 36864
  buffer_load_dwordx4 v[60:63], v1, s[4:7], s21 offen
  s_add_u32 s21, s21, 36864
  buffer_load_dwordx4 v[64:67], v1, s[4:7], s21 offen
  s_add_u32 s21, s21, 36864
  buffer_load_dwordx4 v[68:71], v1, s[4:7], s21 offen
  s_mul_i32 s21, s24, 147456
  s_add_u32 s21, s21, s22
  s_add_u32 s21, s21, 109051904
  buffer_load_dwordx4 v[72:75], v1, s[4:7], s21 offen
  s_add_u32 s21, s21, 36864
  buffer_load_dwordx4 v[76:79], v1, s[4:7], s21 offen
  s_add_u32 s21, s21, 36864
  buffer_load_dwordx4 v[80:83], v1, s[4:7], s21 offen
  s_add_u32 s21, s21, 36864
  buffer_load_dwordx4 v[84:87], v1, s[4:7], s21 offen
  s_mul_i32 s21, s24, 36864
  s_lshl_b32 s22, s25, 5
  s_add_u32 s21, s21, s22
  s_add_u32 s23, s21, 18432
  buffer_load_dwordx2 v[88:89], v2, s[8:11], s21 offen
  buffer_load_dwordx2 v[90:91], v2, s[8:11], s23 offen
  buffer_load_dwordx2 v[92:93], v3, s[36:39], s22 offen
  s_waitcnt vmcnt(22)
  v_lshlrev_b32 v96, 16, v8
  v_and_b32 v97, 0xffff0000, v8
  v_lshlrev_b32 v98, 16, v9
  v_and_b32 v99, 0xffff0000, v9
  v_lshlrev_b32 v100, 16, v10
  v_and_b32 v101, 0xffff0000, v10
  v_lshlrev_b32 v102, 16, v11
  v_and_b32 v103, 0xffff0000, v11
  s_waitcnt vmcnt(21)
  v_lshlrev_b32 v112, 16, v12
  v_and_b32 v113, 0xffff0000, v12
  v_add_f32 v96, v96, v112
  v_add_f32 v97, v97, v113
  v_lshlrev_b32 v112, 16, v13
  v_and_b32 v113, 0xffff0000, v13
  v_add_f32 v98, v98, v112
  v_add_f32 v99, v99, v113
  v_lshlrev_b32 v112, 16, v14
  v_and_b32 v113, 0xffff0000, v14
  v_add_f32 v100, v100, v112
  v_add_f32 v101, v101, v113
  v_lshlrev_b32 v112, 16, v15
  v_and_b32 v113, 0xffff0000, v15
  v_add_f32 v102, v102, v112
  v_add_f32 v103, v103, v113
  s_waitcnt vmcnt(20)
  v_lshlrev_b32 v112, 16, v16
  v_and_b32 v113, 0xffff0000, v16
  v_add_f32 v96, v96, v112
  v_add_f32 v97, v97, v113
  v_lshlrev_b32 v112, 16, v17
  v_and_b32 v113, 0xffff0000, v17
  v_add_f32 v98, v98, v112
  v_add_f32 v99, v99, v113
  v_lshlrev_b32 v112, 16, v18
  v_and_b32 v113, 0xffff0000, v18
  v_add_f32 v100, v100, v112
  v_add_f32 v101, v101, v113
  v_lshlrev_b32 v112, 16, v19
  v_and_b32 v113, 0xffff0000, v19
  v_add_f32 v102, v102, v112
  v_add_f32 v103, v103, v113
  s_waitcnt vmcnt(19)
  v_lshlrev_b32 v112, 16, v20
  v_and_b32 v113, 0xffff0000, v20
  v_add_f32 v96, v96, v112
  v_add_f32 v97, v97, v113
  v_lshlrev_b32 v112, 16, v21
  v_and_b32 v113, 0xffff0000, v21
  v_add_f32 v98, v98, v112
  v_add_f32 v99, v99, v113
  v_lshlrev_b32 v112, 16, v22
  v_and_b32 v113, 0xffff0000, v22
  v_add_f32 v100, v100, v112
  v_add_f32 v101, v101, v113
  v_lshlrev_b32 v112, 16, v23
  v_and_b32 v113, 0xffff0000, v23
  v_add_f32 v102, v102, v112
  v_add_f32 v103, v103, v113
  s_waitcnt vmcnt(18)
  v_lshlrev_b32 v112, 16, v24
  v_and_b32 v113, 0xffff0000, v24
  v_add_f32 v96, v96, v112
  v_add_f32 v97, v97, v113
  v_lshlrev_b32 v112, 16, v25
  v_and_b32 v113, 0xffff0000, v25
  v_add_f32 v98, v98, v112
  v_add_f32 v99, v99, v113
  v_lshlrev_b32 v112, 16, v26
  v_and_b32 v113, 0xffff0000, v26
  v_add_f32 v100, v100, v112
  v_add_f32 v101, v101, v113
  v_lshlrev_b32 v112, 16, v27
  v_and_b32 v113, 0xffff0000, v27
  v_add_f32 v102, v102, v112
  v_add_f32 v103, v103, v113
  s_waitcnt vmcnt(17)
  v_lshlrev_b32 v112, 16, v28
  v_and_b32 v113, 0xffff0000, v28
  v_add_f32 v96, v96, v112
  v_add_f32 v97, v97, v113
  v_lshlrev_b32 v112, 16, v29
  v_and_b32 v113, 0xffff0000, v29
  v_add_f32 v98, v98, v112
  v_add_f32 v99, v99, v113
  v_lshlrev_b32 v112, 16, v30
  v_and_b32 v113, 0xffff0000, v30
  v_add_f32 v100, v100, v112
  v_add_f32 v101, v101, v113
  v_lshlrev_b32 v112, 16, v31
  v_and_b32 v113, 0xffff0000, v31
  v_add_f32 v102, v102, v112
  v_add_f32 v103, v103, v113
  s_waitcnt vmcnt(16)
  v_lshlrev_b32 v112, 16, v32
  v_and_b32 v113, 0xffff0000, v32
  v_add_f32 v96, v96, v112
  v_add_f32 v97, v97, v113
  v_lshlrev_b32 v112, 16, v33
  v_and_b32 v113, 0xffff0000, v33
  v_add_f32 v98, v98, v112
  v_add_f32 v99, v99, v113
  v_lshlrev_b32 v112, 16, v34
  v_and_b32 v113, 0xffff0000, v34
  v_add_f32 v100, v100, v112
  v_add_f32 v101, v101, v113
  v_lshlrev_b32 v112, 16, v35
  v_and_b32 v113, 0xffff0000, v35
  v_add_f32 v102, v102, v112
  v_add_f32 v103, v103, v113
  s_waitcnt vmcnt(15)
  v_lshlrev_b32 v112, 16, v36
  v_and_b32 v113, 0xffff0000, v36
  v_add_f32 v96, v96, v112
  v_add_f32 v97, v97, v113
  v_lshlrev_b32 v112, 16, v37
  v_and_b32 v113, 0xffff0000, v37
  v_add_f32 v98, v98, v112
  v_add_f32 v99, v99, v113
  v_lshlrev_b32 v112, 16, v38
  v_and_b32 v113, 0xffff0000, v38
  v_add_f32 v100, v100, v112
  v_add_f32 v101, v101, v113
  v_lshlrev_b32 v112, 16, v39
  v_and_b32 v113, 0xffff0000, v39
  v_add_f32 v102, v102, v112
  v_add_f32 v103, v103, v113
  s_waitcnt vmcnt(14)
  v_lshlrev_b32 v112, 16, v40
  v_and_b32 v113, 0xffff0000, v40
  v_add_f32 v96, v96, v112
  v_add_f32 v97, v97, v113
  v_lshlrev_b32 v112, 16, v41
  v_and_b32 v113, 0xffff0000, v41
  v_add_f32 v98, v98, v112
  v_add_f32 v99, v99, v113
  v_lshlrev_b32 v112, 16, v42
  v_and_b32 v113, 0xffff0000, v42
  v_add_f32 v100, v100, v112
  v_add_f32 v101, v101, v113
  v_lshlrev_b32 v112, 16, v43
  v_and_b32 v113, 0xffff0000, v43
  v_add_f32 v102, v102, v112
  v_add_f32 v103, v103, v113
  s_waitcnt vmcnt(13)
  v_lshlrev_b32 v112, 16, v44
  v_and_b32 v113, 0xffff0000, v44
  v_add_f32 v96, v96, v112
  v_add_f32 v97, v97, v113
  v_lshlrev_b32 v112, 16, v45
  v_and_b32 v113, 0xffff0000, v45
  v_add_f32 v98, v98, v112
  v_add_f32 v99, v99, v113
  v_lshlrev_b32 v112, 16, v46
  v_and_b32 v113, 0xffff0000, v46
  v_add_f32 v100, v100, v112
  v_add_f32 v101, v101, v113
  v_lshlrev_b32 v112, 16, v47
  v_and_b32 v113, 0xffff0000, v47
  v_add_f32 v102, v102, v112
  v_add_f32 v103, v103, v113
  s_waitcnt vmcnt(12)
  v_lshlrev_b32 v112, 16, v48
  v_and_b32 v113, 0xffff0000, v48
  v_add_f32 v96, v96, v112
  v_add_f32 v97, v97, v113
  v_lshlrev_b32 v112, 16, v49
  v_and_b32 v113, 0xffff0000, v49
  v_add_f32 v98, v98, v112
  v_add_f32 v99, v99, v113
  v_lshlrev_b32 v112, 16, v50
  v_and_b32 v113, 0xffff0000, v50
  v_add_f32 v100, v100, v112
  v_add_f32 v101, v101, v113
  v_lshlrev_b32 v112, 16, v51
  v_and_b32 v113, 0xffff0000, v51
  v_add_f32 v102, v102, v112
  v_add_f32 v103, v103, v113
  s_waitcnt vmcnt(11)
  v_lshlrev_b32 v112, 16, v52
  v_and_b32 v113, 0xffff0000, v52
  v_add_f32 v96, v96, v112
  v_add_f32 v97, v97, v113
  v_lshlrev_b32 v112, 16, v53
  v_and_b32 v113, 0xffff0000, v53
  v_add_f32 v98, v98, v112
  v_add_f32 v99, v99, v113
  v_lshlrev_b32 v112, 16, v54
  v_and_b32 v113, 0xffff0000, v54
  v_add_f32 v100, v100, v112
  v_add_f32 v101, v101, v113
  v_lshlrev_b32 v112, 16, v55
  v_and_b32 v113, 0xffff0000, v55
  v_add_f32 v102, v102, v112
  v_add_f32 v103, v103, v113
  s_waitcnt vmcnt(10)
  v_lshlrev_b32 v112, 16, v56
  v_and_b32 v113, 0xffff0000, v56
  v_add_f32 v96, v96, v112
  v_add_f32 v97, v97, v113
  v_lshlrev_b32 v112, 16, v57
  v_and_b32 v113, 0xffff0000, v57
  v_add_f32 v98, v98, v112
  v_add_f32 v99, v99, v113
  v_lshlrev_b32 v112, 16, v58
  v_and_b32 v113, 0xffff0000, v58
  v_add_f32 v100, v100, v112
  v_add_f32 v101, v101, v113
  v_lshlrev_b32 v112, 16, v59
  v_and_b32 v113, 0xffff0000, v59
  v_add_f32 v102, v102, v112
  v_add_f32 v103, v103, v113
  s_waitcnt vmcnt(9)
  v_lshlrev_b32 v112, 16, v60
  v_and_b32 v113, 0xffff0000, v60
  v_add_f32 v96, v96, v112
  v_add_f32 v97, v97, v113
  v_lshlrev_b32 v112, 16, v61
  v_and_b32 v113, 0xffff0000, v61
  v_add_f32 v98, v98, v112
  v_add_f32 v99, v99, v113
  v_lshlrev_b32 v112, 16, v62
  v_and_b32 v113, 0xffff0000, v62
  v_add_f32 v100, v100, v112
  v_add_f32 v101, v101, v113
  v_lshlrev_b32 v112, 16, v63
  v_and_b32 v113, 0xffff0000, v63
  v_add_f32 v102, v102, v112
  v_add_f32 v103, v103, v113
  s_waitcnt vmcnt(8)
  v_lshlrev_b32 v112, 16, v64
  v_and_b32 v113, 0xffff0000, v64
  v_add_f32 v96, v96, v112
  v_add_f32 v97, v97, v113
  v_lshlrev_b32 v112, 16, v65
  v_and_b32 v113, 0xffff0000, v65
  v_add_f32 v98, v98, v112
  v_add_f32 v99, v99, v113
  v_lshlrev_b32 v112, 16, v66
  v_and_b32 v113, 0xffff0000, v66
  v_add_f32 v100, v100, v112
  v_add_f32 v101, v101, v113
  v_lshlrev_b32 v112, 16, v67
  v_and_b32 v113, 0xffff0000, v67
  v_add_f32 v102, v102, v112
  v_add_f32 v103, v103, v113
  s_waitcnt vmcnt(7)
  v_lshlrev_b32 v112, 16, v68
  v_and_b32 v113, 0xffff0000, v68
  v_add_f32 v96, v96, v112
  v_add_f32 v97, v97, v113
  v_lshlrev_b32 v112, 16, v69
  v_and_b32 v113, 0xffff0000, v69
  v_add_f32 v98, v98, v112
  v_add_f32 v99, v99, v113
  v_lshlrev_b32 v112, 16, v70
  v_and_b32 v113, 0xffff0000, v70
  v_add_f32 v100, v100, v112
  v_add_f32 v101, v101, v113
  v_lshlrev_b32 v112, 16, v71
  v_and_b32 v113, 0xffff0000, v71
  v_add_f32 v102, v102, v112
  v_add_f32 v103, v103, v113
  s_waitcnt vmcnt(6)
  v_lshlrev_b32 v104, 16, v72
  v_and_b32 v105, 0xffff0000, v72
  v_lshlrev_b32 v106, 16, v73
  v_and_b32 v107, 0xffff0000, v73
  v_lshlrev_b32 v108, 16, v74
  v_and_b32 v109, 0xffff0000, v74
  v_lshlrev_b32 v110, 16, v75
  v_and_b32 v111, 0xffff0000, v75
  s_waitcnt vmcnt(5)
  v_lshlrev_b32 v112, 16, v76
  v_and_b32 v113, 0xffff0000, v76
  v_add_f32 v104, v104, v112
  v_add_f32 v105, v105, v113
  v_lshlrev_b32 v112, 16, v77
  v_and_b32 v113, 0xffff0000, v77
  v_add_f32 v106, v106, v112
  v_add_f32 v107, v107, v113
  v_lshlrev_b32 v112, 16, v78
  v_and_b32 v113, 0xffff0000, v78
  v_add_f32 v108, v108, v112
  v_add_f32 v109, v109, v113
  v_lshlrev_b32 v112, 16, v79
  v_and_b32 v113, 0xffff0000, v79
  v_add_f32 v110, v110, v112
  v_add_f32 v111, v111, v113
  s_waitcnt vmcnt(4)
  v_lshlrev_b32 v112, 16, v80
  v_and_b32 v113, 0xffff0000, v80
  v_add_f32 v104, v104, v112
  v_add_f32 v105, v105, v113
  v_lshlrev_b32 v112, 16, v81
  v_and_b32 v113, 0xffff0000, v81
  v_add_f32 v106, v106, v112
  v_add_f32 v107, v107, v113
  v_lshlrev_b32 v112, 16, v82
  v_and_b32 v113, 0xffff0000, v82
  v_add_f32 v108, v108, v112
  v_add_f32 v109, v109, v113
  v_lshlrev_b32 v112, 16, v83
  v_and_b32 v113, 0xffff0000, v83
  v_add_f32 v110, v110, v112
  v_add_f32 v111, v111, v113
  s_waitcnt vmcnt(3)
  v_lshlrev_b32 v112, 16, v84
  v_and_b32 v113, 0xffff0000, v84
  v_add_f32 v104, v104, v112
  v_add_f32 v105, v105, v113
  v_lshlrev_b32 v112, 16, v85
  v_and_b32 v113, 0xffff0000, v85
  v_add_f32 v106, v106, v112
  v_add_f32 v107, v107, v113
  v_lshlrev_b32 v112, 16, v86
  v_and_b32 v113, 0xffff0000, v86
  v_add_f32 v108, v108, v112
  v_add_f32 v109, v109, v113
  v_lshlrev_b32 v112, 16, v87
  v_and_b32 v113, 0xffff0000, v87
  v_add_f32 v110, v110, v112
  v_add_f32 v111, v111, v113
  s_waitcnt vmcnt(0)
  v_cvt_pk_bf16_f32 v112, v96, v97
  v_cvt_pk_bf16_f32 v113, v104, v105
  v_lshlrev_b32 v114, 16, v112
  v_and_b32 v115, 0xffff0000, v112
  v_lshlrev_b32 v116, 16, v88
  v_and_b32 v117, 0xffff0000, v88
  v_add_f32 v114, v114, v116
  v_add_f32 v115, v115, v117
  v_cvt_pk_bf16_f32 v112, v114, v115
  v_lshlrev_b32 v114, 16, v113
  v_and_b32 v115, 0xffff0000, v113
  v_lshlrev_b32 v116, 16, v92
  v_and_b32 v117, 0xffff0000, v92
  v_add_f32 v114, v114, v116
  v_add_f32 v115, v115, v117
  v_cvt_pk_bf16_f32 v113, v114, v115
  v_lshlrev_b32 v114, 16, v112
  v_and_b32 v115, 0xffff0000, v112
  v_lshlrev_b32 v116, 16, v113
  v_and_b32 v117, 0xffff0000, v113
  v_add_f32 v114, v114, v116
  v_add_f32 v115, v115, v117
  v_cvt_pk_bf16_f32 v120, v114, v115
  v_cvt_pk_bf16_f32 v112, v98, v99
  v_cvt_pk_bf16_f32 v113, v106, v107
  v_lshlrev_b32 v114, 16, v112
  v_and_b32 v115, 0xffff0000, v112
  v_lshlrev_b32 v116, 16, v89
  v_and_b32 v117, 0xffff0000, v89
  v_add_f32 v114, v114, v116
  v_add_f32 v115, v115, v117
  v_cvt_pk_bf16_f32 v112, v114, v115
  v_lshlrev_b32 v114, 16, v113
  v_and_b32 v115, 0xffff0000, v113
  v_lshlrev_b32 v116, 16, v93
  v_and_b32 v117, 0xffff0000, v93
  v_add_f32 v114, v114, v116
  v_add_f32 v115, v115, v117
  v_cvt_pk_bf16_f32 v113, v114, v115
  v_lshlrev_b32 v114, 16, v112
  v_and_b32 v115, 0xffff0000, v112
  v_lshlrev_b32 v116, 16, v113
  v_and_b32 v117, 0xffff0000, v113
  v_add_f32 v114, v114, v116
  v_add_f32 v115, v115, v117
  v_cvt_pk_bf16_f32 v121, v114, v115
  v_cvt_pk_bf16_f32 v112, v100, v101
  v_cvt_pk_bf16_f32 v113, v108, v109
  v_lshlrev_b32 v114, 16, v112
  v_and_b32 v115, 0xffff0000, v112
  v_lshlrev_b32 v116, 16, v90
  v_and_b32 v117, 0xffff0000, v90
  v_add_f32 v114, v114, v116
  v_add_f32 v115, v115, v117
  v_cvt_pk_bf16_f32 v112, v114, v115
  v_lshlrev_b32 v114, 16, v113
  v_and_b32 v115, 0xffff0000, v113
  v_lshlrev_b32 v116, 16, v92
  v_and_b32 v117, 0xffff0000, v92
  v_add_f32 v114, v114, v116
  v_add_f32 v115, v115, v117
  v_cvt_pk_bf16_f32 v113, v114, v115
  v_lshlrev_b32 v114, 16, v112
  v_and_b32 v115, 0xffff0000, v112
  v_lshlrev_b32 v116, 16, v113
  v_and_b32 v117, 0xffff0000, v113
  v_add_f32 v114, v114, v116
  v_add_f32 v115, v115, v117
  v_cvt_pk_bf16_f32 v122, v114, v115
  v_cvt_pk_bf16_f32 v112, v102, v103
  v_cvt_pk_bf16_f32 v113, v110, v111
  v_lshlrev_b32 v114, 16, v112
  v_and_b32 v115, 0xffff0000, v112
  v_lshlrev_b32 v116, 16, v91
  v_and_b32 v117, 0xffff0000, v91
  v_add_f32 v114, v114, v116
  v_add_f32 v115, v115, v117
  v_cvt_pk_bf16_f32 v112, v114, v115
  v_lshlrev_b32 v114, 16, v113
  v_and_b32 v115, 0xffff0000, v113
  v_lshlrev_b32 v116, 16, v93
  v_and_b32 v117, 0xffff0000, v93
  v_add_f32 v114, v114, v116
  v_add_f32 v115, v115, v117
  v_cvt_pk_bf16_f32 v113, v114, v115
  v_lshlrev_b32 v114, 16, v112
  v_and_b32 v115, 0xffff0000, v112
  v_lshlrev_b32 v116, 16, v113
  v_and_b32 v117, 0xffff0000, v113
  v_add_f32 v114, v114, v116
  v_add_f32 v115, v115, v117
  v_cvt_pk_bf16_f32 v123, v114, v115
  buffer_store_dwordx2 v[120:121], v2, s[32:35], s21 offen
  buffer_store_dwordx2 v[122:123], v2, s[32:35], s23 offen
  s_add_u32 s30, s30, 640
  s_cmp_lt_u32 s30, 2232
  s_cbranch_scc1 L_fin_loop
  s_cmp_lg_u32 s17, 0
  s_cbranch_scc1 L_exit
  s_cmp_lt_u32 s96, 88
  s_cbranch_scc1 L_exit
  s_sub_u32 s30, s96, 88
  s_cmp_ge_u32 s30, 36
  s_cselect_b32 s24, 1, 0
  s_mul_i32 s21, s24, 36
  s_sub_u32 s25, s30, s21
  v_and_b32 v5, 63, v0
  v_and_b32 v6, 1, v5
  v_cmp_eq_u32 vcc, 0, v6
  v_mov_b32 v7, 0x3f80
  v_mov_b32 v6, 0x3f800000
  v_cndmask_b32 v6, v6, v7, vcc
  v_and_b32 v7, 2, v5
  v_cmp_eq_u32 vcc, 0, v7
  s_nop 1
  v_cndmask_b32 v118, 0, v6, vcc
  v_cndmask_b32 v119, v6, 0, vcc
  v_and_b32 v7, 3, v5
  v_add_u32 v7, 220, v7
  v_lshlrev_b32 v7, 8, v7
  v_add_u32 v7, 0, v7
  s_mov_b32 s94, 0
L_lf_66:
  buffer_load_dword v112, v7, s[4:7], 0 offen sc1
  s_waitcnt vmcnt(0)
  v_cmp_eq_u32 vcc, 0, v112
  s_cbranch_vccz L_lf_67
  s_add_u32 s94, s94, 1
  s_cmp_lt_u32 s94, 400000
  s_cbranch_scc1 L_lf_66
  s_branch L_fail
L_lf_67:
  s_lshl_b32 s22, s25, 10
  s_mul_i32 s21, s24, 589824
  s_add_u32 s26, s22, s21
  s_add_u32 s26, s26, 107872256
  s_mul_i32 s21, s24, 147456
  s_add_u32 s21, s21, s22
  s_add_u32 s21, s21, 118194176
  buffer_load_dwordx4 v[72:75], v1, s[4:7], s21 offen
  s_add_u32 s21, s21, 36864
  buffer_load_dwordx4 v[76:79], v1, s[4:7], s21 offen
  s_add_u32 s21, s21, 36864
  buffer_load_dwordx4 v[80:83], v1, s[4:7], s21 offen
  s_add_u32 s21, s21, 36864
  buffer_load_dwordx4 v[84:87], v1, s[4:7], s21 offen
  s_lshl_b32 s22, s25, 5
  s_mul_i32 s27, s24, 36864
  s_add_u32 s27, s27, s22
  s_add_u32 s27, s27, 2285568
  s_add_u32 s23, s27, 18432
  buffer_load_dwordx2 v[88:89], v2, s[8:11], s27 offen
  buffer_load_dwordx2 v[90:91], v2, s[8:11], s23 offen
  buffer_load_dwordx2 v[92:93], v3, s[36:39], s22 offen
  s_and_b32 s21, s25, 15
  s_lshl_b32 s24, s24, 4
  s_add_u32 s21, s21, s24
  s_add_u32 s21, s21, 128
  s_lshl_b32 s21, s21, 8
  s_add_u32 s25, s21, 0
  s_waitcnt vmcnt(6)
  v_mfma_f32_4x4x4_16b_bf16 v[104:107], v[118:119], v[72:73], 0
  v_mfma_f32_4x4x4_16b_bf16 v[108:111], v[118:119], v[74:75], 0
  s_waitcnt vmcnt(5)
  v_mfma_f32_4x4x4_16b_bf16 v[104:107], v[118:119], v[76:77], v[104:107]
  v_mfma_f32_4x4x4_16b_bf16 v[108:111], v[118:119], v[78:79], v[108:111]
  s_waitcnt vmcnt(4)
  v_mfma_f32_4x4x4_16b_bf16 v[104:107], v[118:119], v[80:81], v[104:107]
  v_mfma_f32_4x4x4_16b_bf16 v[108:111], v[118:119], v[82:83], v[108:111]
  s_waitcnt vmcnt(3)
  v_mfma_f32_4x4x4_16b_bf16 v[104:107], v[118:119], v[84:85], v[104:107]
  v_mfma_f32_4x4x4_16b_bf16 v[108:111], v[118:119], v[86:87], v[108:111]
  s_waitcnt vmcnt(0)
  s_nop 1
  v_cvt_pk_bf16_f32 v113, v104, v105
  v_lshlrev_b32 v114, 16, v113
  v_and_b32 v115, 0xffff0000, v113
  v_lshlrev_b32 v116, 16, v92
  v_and_b32 v117, 0xffff0000, v92
  v_add_f32 v114, v114, v116
  v_add_f32 v115, v115, v117
  v_cvt_pk_bf16_f32 v113, v114, v115
  v_lshlrev_b32 v136, 16, v113
  v_and_b32 v137, 0xffff0000, v113
  v_lshlrev_b32 v128, 16, v88
  v_and_b32 v129, 0xffff0000, v88
  v_cvt_pk_bf16_f32 v113, v106, v107
  v_lshlrev_b32 v114, 16, v113
  v_and_b32 v115, 0xffff0000, v113
  v_lshlrev_b32 v116, 16, v93
  v_and_b32 v117, 0xffff0000, v93
  v_add_f32 v114, v114, v116
  v_add_f32 v115, v115, v117
  v_cvt_pk_bf16_f32 v113, v114, v115
  v_lshlrev_b32 v138, 16, v113
  v_and_b32 v139, 0xffff0000, v113
  v_lshlrev_b32 v130, 16, v89
  v_and_b32 v131, 0xffff0000, v89
  v_cvt_pk_bf16_f32 v113, v108, v109
  v_lshlrev_b32 v114, 16, v113
  v_and_b32 v115, 0xffff0000, v113
  v_lshlrev_b32 v116, 16, v92
  v_and_b32 v117, 0xffff0000, v92
  v_add_f32 v114, v114, v116
  v_add_f32 v115, v115, v117
  v_cvt_pk_bf16_f32 v113, v114, v115
  v_lshlrev_b32 v140, 16, v113
  v_and_b32 v141, 0xffff0000, v113
  v_lshlrev_b32 v132, 16, v90
  v_and_b32 v133, 0xffff0000, v90
  v_cvt_pk_bf16_f32 v113, v110, v111
  v_lshlrev_b32 v114, 16, v113
  v_and_b32 v115, 0xffff0000, v113
  v_lshlrev_b32 v116, 16, v93
  v_and_b32 v117, 0xffff0000, v93
  v_add_f32 v114, v114, v116
  v_add_f32 v115, v115, v117
  v_cvt_pk_bf16_f32 v113, v114, v115
  v_lshlrev_b32 v142, 16, v113
  v_and_b32 v143, 0xffff0000, v113
  v_lshlrev_b32 v134, 16, v91
  v_and_b32 v135, 0xffff0000, v91
  s_mov_b32 s94, 0
L_lg_68:
  s_mov_b64 exec, 1
  buffer_load_dword v112, off, s[4:7], s25 sc1
  s_mov_b64 exec, -1
  s_waitcnt vmcnt(0)
  v_readfirstlane_b32 s21, v112
  s_cmp_ge_u32 s21, 32
  s_nop 0
  s_cbranch_scc1 L_lg_69
  s_add_u32 s94, s94, 1
  s_cmp_lt_u32 s94, 400000
  s_cbranch_scc1 L_lg_68
  s_branch L_fail
L_lg_69:
  s_mov_b32 s94, 0
L_pd_70:
  s_mov_b32 s21, s26
  buffer_load_dwordx4 v[8:11], v1, s[4:7], s21 offen sc1
  s_add_u32 s21, s21, 36864
  buffer_load_dwordx4 v[12:15], v1, s[4:7], s21 offen sc1
  s_add_u32 s21, s21, 36864
  buffer_load_dwordx4 v[16:19], v1, s[4:7], s21 offen sc1
  s_add_u32 s21, s21, 36864
  buffer_load_dwordx4 v[20:23], v1, s[4:7], s21 offen sc1
  s_add_u32 s21, s21, 36864
  buffer_load_dwordx4 v[24:27], v1, s[4:7], s21 offen sc1
  s_add_u32 s21, s21, 36864
  buffer_load_dwordx4 v[28:31], v1, s[4:7], s21 offen sc1
  s_add_u32 s21, s21, 36864
  buffer_load_dwordx4 v[32:35], v1, s[4:7], s21 offen sc1
  s_add_u32 s21, s21, 36864
  buffer_load_dwordx4 v[36:39], v1, s[4:7], s21 offen sc1
  s_add_u32 s21, s21, 36864
  buffer_load_dwordx4 v[40:43], v1, s[4:7], s21 offen sc1
  s_add_u32 s21, s21, 36864
  buffer_load_dwordx4 v[44:47], v1, s[4:7], s21 offen sc1
  s_add_u32 s21, s21, 36864
  buffer_load_dwordx4 v[48:51], v1, s[4:7], s21 offen sc1
  s_add_u32 s21, s21, 36864
  buffer_load_dwordx4 v[52:55], v1, s[4:7], s21 offen sc1
  s_add_u32 s21, s21, 36864
  buffer_load_dwordx4 v[56:59], v1, s[4:7], s21 offen sc1
  s_add_u32 s21, s21, 36864
  buffer_load_dwordx4 v[60:63], v1, s[4:7], s21 offen sc1
  s_add_u32 s21, s21, 36864
  buffer_load_dwordx4 v[64:67], v1, s[4:7], s21 offen sc1
  s_add_u32 s21, s21, 36864
  buffer_load_dwordx4 v[68:71], v1, s[4:7], s21 offen sc1
  s_waitcnt vmcnt(15)
  v_mfma_f32_4x4x4_16b_bf16 v[96:99], v[118:119], v[8:9], 0
  v_mfma_f32_4x4x4_16b_bf16 v[100:103], v[118:119], v[10:11], 0
  v_max3_u32 v112, v8, v9, v10
  v_mov_b32 v113, v11
  s_waitcnt vmcnt(14)
  v_mfma_f32_4x4x4_16b_bf16 v[96:99], v[118:119], v[12:13], v[96:99]
  v_mfma_f32_4x4x4_16b_bf16 v[100:103], v[118:119], v[14:15], v[100:103]
  v_max3_u32 v112, v112, v12, v13
  v_max3_u32 v113, v113, v14, v15
  s_waitcnt vmcnt(13)
  v_mfma_f32_4x4x4_16b_bf16 v[96:99], v[118:119], v[16:17], v[96:99]
  v_mfma_f32_4x4x4_16b_bf16 v[100:103], v[118:119], v[18:19], v[100:103]
  v_max3_u32 v112, v112, v16, v17
  v_max3_u32 v113, v113, v18, v19
  s_waitcnt vmcnt(12)
  v_mfma_f32_4x4x4_16b_bf16 v[96:99], v[118:119], v[20:21], v[96:99]
  v_mfma_f32_4x4x4_16b_bf16 v[100:103], v[118:119], v[22:23], v[100:103]
  v_max3_u32 v112, v112, v20, v21
  v_max3_u32 v113, v113, v22, v23
  s_waitcnt vmcnt(11)
  v_mfma_f32_4x4x4_16b_bf16 v[96:99], v[118:119], v[24:25], v[96:99]
  v_mfma_f32_4x4x4_16b_bf16 v[100:103], v[118:119], v[26:27], v[100:103]
  v_max3_u32 v112, v112, v24, v25
  v_max3_u32 v113, v113, v26, v27
  s_waitcnt vmcnt(10)
  v_mfma_f32_4x4x4_16b_bf16 v[96:99], v[118:119], v[28:29], v[96:99]
  v_mfma_f32_4x4x4_16b_bf16 v[100:103], v[118:119], v[30:31], v[100:103]
  v_max3_u32 v112, v112, v28, v29
  v_max3_u32 v113, v113, v30, v31
  s_waitcnt vmcnt(9)
  v_mfma_f32_4x4x4_16b_bf16 v[96:99], v[118:119], v[32:33], v[96:99]
  v_mfma_f32_4x4x4_16b_bf16 v[100:103], v[118:119], v[34:35], v[100:103]
  v_max3_u32 v112, v112, v32, v33
  v_max3_u32 v113, v113, v34, v35
  s_waitcnt vmcnt(8)
  v_mfma_f32_4x4x4_16b_bf16 v[96:99], v[118:119], v[36:37], v[96:99]
  v_mfma_f32_4x4x4_16b_bf16 v[100:103], v[118:119], v[38:39], v[100:103]
  v_max3_u32 v112, v112, v36, v37
  v_max3_u32 v113, v113, v38, v39
  s_waitcnt vmcnt(7)
  v_mfma_f32_4x4x4_16b_bf16 v[96:99], v[118:119], v[40:41], v[96:99]
  v_mfma_f32_4x4x4_16b_bf16 v[100:103], v[118:119], v[42:43], v[100:103]
  v_max3_u32 v112, v112, v40, v41
  v_max3_u32 v113, v113, v42, v43
  s_waitcnt vmcnt(6)
  v_mfma_f32_4x4x4_16b_bf16 v[96:99], v[118:119], v[44:45], v[96:99]
  v_mfma_f32_4x4x4_16b_bf16 v[100:103], v[118:119], v[46:47], v[100:103]
  v_max3_u32 v112, v112, v44, v45
  v_max3_u32 v113, v113, v46, v47
  s_waitcnt vmcnt(5)
  v_mfma_f32_4x4x4_16b_bf16 v[96:99], v[118:119], v[48:49], v[96:99]
  v_mfma_f32_4x4x4_16b_bf16 v[100:103], v[118:119], v[50:51], v[100:103]
  v_max3_u32 v112, v112, v48, v49
  v_max3_u32 v113, v113, v50, v51
  s_waitcnt vmcnt(4)
  v_mfma_f32_4x4x4_16b_bf16 v[96:99], v[118:119], v[52:53], v[96:99]
  v_mfma_f32_4x4x4_16b_bf16 v[100:103], v[118:119], v[54:55], v[100:103]
  v_max3_u32 v112, v112, v52, v53
  v_max3_u32 v113, v113, v54, v55
  s_waitcnt vmcnt(3)
  v_mfma_f32_4x4x4_16b_bf16 v[96:99], v[118:119], v[56:57], v[96:99]
  v_mfma_f32_4x4x4_16b_bf16 v[100:103], v[118:119], v[58:59], v[100:103]
  v_max3_u32 v112, v112, v56, v57
  v_max3_u32 v113, v113, v58, v59
  s_waitcnt vmcnt(2)
  v_mfma_f32_4x4x4_16b_bf16 v[96:99], v[118:119], v[60:61], v[96:99]
  v_mfma_f32_4x4x4_16b_bf16 v[100:103], v[118:119], v[62:63], v[100:103]
  v_max3_u32 v112, v112, v60, v61
  v_max3_u32 v113, v113, v62, v63
  s_waitcnt vmcnt(1)
  v_mfma_f32_4x4x4_16b_bf16 v[96:99], v[118:119], v[64:65], v[96:99]
  v_mfma_f32_4x4x4_16b_bf16 v[100:103], v[118:119], v[66:67], v[100:103]
  v_max3_u32 v112, v112, v64, v65
  v_max3_u32 v113, v113, v66, v67
  s_waitcnt vmcnt(0)
  v_mfma_f32_4x4x4_16b_bf16 v[96:99], v[118:119], v[68:69], v[96:99]
  v_mfma_f32_4x4x4_16b_bf16 v[100:103], v[118:119], v[70:71], v[100:103]
  v_max3_u32 v112, v112, v68, v69
  v_max3_u32 v113, v113, v70, v71
  v_max_u32 v112, v112, v113
  v_cmp_eq_u32 vcc, -1, v112
  s_cbranch_vccz L_pd_71
  s_add_u32 s94, s94, 1
  s_cmp_lt_u32 s94, 400000
  s_cbranch_scc1 L_pd_70
  s_branch L_fail
L_pd_71:
  v_cvt_pk_bf16_f32 v112, v96, v97
  v_lshlrev_b32 v114, 16, v112
  v_and_b32 v115, 0xffff0000, v112
  v_pk_add_f32 v[114:115], v[114:115], v[128:129]
  v_cvt_pk_bf16_f32 v112, v114, v115
  v_lshlrev_b32 v114, 16, v112
  v_and_b32 v115, 0xffff0000, v112
  v_pk_add_f32 v[114:115], v[114:115], v[136:137]
  v_cvt_pk_bf16_f32 v120, v114, v115
  v_cvt_pk_bf16_f32 v112, v98, v99
  v_lshlrev_b32 v114, 16, v112
  v_and_b32 v115, 0xffff0000, v112
  v_pk_add_f32 v[114:115], v[114:115], v[130:131]
  v_cvt_pk_bf16_f32 v112, v114, v115
  v_lshlrev_b32 v114, 16, v112
  v_and_b32 v115, 0xffff0000, v112
  v_pk_add_f32 v[114:115], v[114:115], v[138:139]
  v_cvt_pk_bf16_f32 v121, v114, v115
  buffer_store_dwordx2 v[120:121], v2, s[32:35], s27 offen
  v_cvt_pk_bf16_f32 v112, v100, v101
  v_lshlrev_b32 v114, 16, v112
  v_and_b32 v115, 0xffff0000, v112
  v_pk_add_f32 v[114:115], v[114:115], v[132:133]
  v_cvt_pk_bf16_f32 v112, v114, v115
  v_lshlrev_b32 v114, 16, v112
  v_and_b32 v115, 0xffff0000, v112
  v_pk_add_f32 v[114:115], v[114:115], v[140:141]
  v_cvt_pk_bf16_f32 v122, v114, v115
  v_cvt_pk_bf16_f32 v112, v102, v103
  v_lshlrev_b32 v114, 16, v112
  v_and_b32 v115, 0xffff0000, v112
  v_pk_add_f32 v[114:115], v[114:115], v[134:135]
  v_cvt_pk_bf16_f32 v112, v114, v115
  v_lshlrev_b32 v114, 16, v112
  v_and_b32 v115, 0xffff0000, v112
  v_pk_add_f32 v[114:115], v[114:115], v[142:143]
  v_cvt_pk_bf16_f32 v123, v114, v115
  buffer_store_dwordx2 v[122:123], v2, s[32:35], s23 offen
  s_branch L_exit
L_chain:
  s_mov_b32 s16, s97
  s_mov_b64 s[94:95], 0
  s_mov_b64 s[100:101], -1
  v_and_b32 v14, 63, v0
  s_and_b32 s9, s9, 0xffff
  s_mov_b32 s10, 4718592
  s_mov_b32 s11, 0x00020000
  s_mul_i32 s43, s16, 147456
  s_mul_i32 s44, s17, 288
  s_add_u32 s43, s43, s44
  s_mul_i32 s84, s17, 36864
  s_add_u32 s84, s84, 16384
  v_add_u32 v28, 0, v14
  v_mul_u32_u24 v29, 3641, v28
  v_lshrrev_b32 v29, 16, v29
  v_mul_u32_u24 v39, 18, v29
  v_sub_u32 v39, v28, v39
  v_mul_u32_u24 v29, 1152, v29
  v_lshl_add_u32 v30, v39, 4, v29
  s_add_u32 m0, s84, 0
  s_nop 0
  buffer_load_dwordx4 v30, s[8:11], s43 offen lds
  v_add_u32 v28, 64, v14
  v_mul_u32_u24 v29, 3641, v28
  v_lshrrev_b32 v29, 16, v29
  v_mul_u32_u24 v39, 18, v29
  v_sub_u32 v39, v28, v39
  v_mul_u32_u24 v29, 1152, v29
  v_lshl_add_u32 v31, v39, 4, v29
  s_add_u32 m0, s84, 1024
  s_nop 0
  buffer_load_dwordx4 v31, s[8:11], s43 offen lds
  v_add_u32 v28, 128, v14
  v_mul_u32_u24 v29, 3641, v28
  v_lshrrev_b32 v29, 16, v29
  v_mul_u32_u24 v39, 18, v29
  v_sub_u32 v39, v28, v39
  v_mul_u32_u24 v29, 1152, v29
  v_lshl_add_u32 v32, v39, 4, v29
  s_add_u32 m0, s84, 2048
  s_nop 0
  buffer_load_dwordx4 v32, s[8:11], s43 offen lds
  v_add_u32 v28, 192, v14
  v_mul_u32_u24 v29, 3641, v28
  v_lshrrev_b32 v29, 16, v29
  v_mul_u32_u24 v39, 18, v29
  v_sub_u32 v39, v28, v39
  v_mul_u32_u24 v29, 1152, v29
  v_lshl_add_u32 v33, v39, 4, v29
  s_add_u32 m0, s84, 3072
  s_nop 0
  buffer_load_dwordx4 v33, s[8:11], s43 offen lds
  v_add_u32 v28, 256, v14
  v_mul_u32_u24 v29, 3641, v28
  v_lshrrev_b32 v29, 16, v29
  v_mul_u32_u24 v39, 18, v29
  v_sub_u32 v39, v28, v39
  v_mul_u32_u24 v29, 1152, v29
  v_lshl_add_u32 v34, v39, 4, v29
  s_add_u32 m0, s84, 4096
  s_nop 0
  buffer_load_dwordx4 v34, s[8:11], s43 offen lds
  v_add_u32 v28, 320, v14
  v_mul_u32_u24 v29, 3641, v28
  v_lshrrev_b32 v29, 16, v29
  v_mul_u32_u24 v39, 18, v29
  v_sub_u32 v39, v28, v39
  v_mul_u32_u24 v29, 1152, v29
  v_lshl_add_u32 v35, v39, 4, v29
  s_add_u32 m0, s84, 5120
  s_nop 0
  buffer_load_dwordx4 v35, s[8:11], s43 offen lds
  v_add_u32 v28, 384, v14
  v_mul_u32_u24 v29, 3641, v28
  v_lshrrev_b32 v29, 16, v29
  v_mul_u32_u24 v39, 18, v29
  v_sub_u32 v39, v28, v39
  v_mul_u32_u24 v29, 1152, v29
  v_lshl_add_u32 v36, v39, 4, v29
  s_add_u32 m0, s84, 6144
  s_nop 0
  buffer_load_dwordx4 v36, s[8:11], s43 offen lds
  v_add_u32 v28, 448, v14
  v_mul_u32_u24 v29, 3641, v28
  v_lshrrev_b32 v29, 16, v29
  v_mul_u32_u24 v39, 18, v29
  v_sub_u32 v39, v28, v39
  v_mul_u32_u24 v29, 1152, v29
  v_lshl_add_u32 v37, v39, 4, v29
  s_add_u32 m0, s84, 7168
  s_nop 0
  buffer_load_dwordx4 v37, s[8:11], s43 offen lds
  v_add_u32 v28, 512, v14
  v_mul_u32_u24 v29, 3641, v28
  v_lshrrev_b32 v29, 16, v29
  v_mul_u32_u24 v39, 18, v29
  v_sub_u32 v39, v28, v39
  v_mul_u32_u24 v29, 1152, v29
  v_lshl_add_u32 v38, v39, 4, v29
  s_add_u32 m0, s84, 8192
  s_nop 0
  buffer_load_dwordx4 v38, s[8:11], s43 offen lds
  s_add_u32 s43, s43, 36864
  s_add_u32 m0, s84, 9216
  s_nop 0
  buffer_load_dwordx4 v30, s[8:11], s43 offen lds
  s_add_u32 m0, s84, 10240
  s_nop 0
  buffer_load_dwordx4 v31, s[8:11], s43 offen lds
  s_add_u32 m0, s84, 11264
  s_nop 0
  buffer_load_dwordx4 v32, s[8:11], s43 offen lds
  s_add_u32 m0, s84, 12288
  s_nop 0
  buffer_load_dwordx4 v33, s[8:11], s43 offen lds
  s_add_u32 m0, s84, 13312
  s_nop 0
  buffer_load_dwordx4 v34, s[8:11], s43 offen lds
  s_add_u32 m0, s84, 14336
  s_nop 0
  buffer_load_dwordx4 v35, s[8:11], s43 offen lds
  s_add_u32 m0, s84, 15360
  s_nop 0
  buffer_load_dwordx4 v36, s[8:11], s43 offen lds
  s_add_u32 m0, s84, 16384
  s_nop 0
  buffer_load_dwordx4 v37, s[8:11], s43 offen lds
  s_add_u32 m0, s84, 17408
  s_nop 0
  buffer_load_dwordx4 v38, s[8:11], s43 offen lds
  s_add_u32 s43, s43, 36864
  s_add_u32 m0, s84, 18432
  s_nop 0
  buffer_load_dwordx4 v30, s[8:11], s43 offen lds
  s_add_u32 m0, s84, 19456
  s_nop 0
  buffer_load_dwordx4 v31, s[8:11], s43 offen lds
  s_add_u32 m0, s84, 20480
  s_nop 0
  buffer_load_dwordx4 v32, s[8:11], s43 offen lds
  s_add_u32 m0, s84, 21504
  s_nop 0
  buffer_load_dwordx4 v33, s[8:11], s43 offen lds
  s_add_u32 m0, s84, 22528
  s_nop 0
  buffer_load_dwordx4 v34, s[8:11], s43 offen lds
  s_add_u32 m0, s84, 23552
  s_nop 0
  buffer_load_dwordx4 v35, s[8:11], s43 offen lds
  s_add_u32 m0, s84, 24576
  s_nop 0
  buffer_load_dwordx4 v36, s[8:11], s43 offen lds
  s_add_u32 m0, s84, 25600
  s_nop 0
  buffer_load_dwordx4 v37, s[8:11], s43 offen lds
  s_add_u32 m0, s84, 26624
  s_nop 0
  buffer_load_dwordx4 v38, s[8:11], s43 offen lds
  s_add_u32 s43, s43, 36864
  s_add_u32 m0, s84, 27648
  s_nop 0
  buffer_load_dwordx4 v30, s[8:11], s43 offen lds
  s_add_u32 m0, s84, 28672
  s_nop 0
  buffer_load_dwordx4 v31, s[8:11], s43 offen lds
  s_add_u32 m0, s84, 29696
  s_nop 0
  buffer_load_dwordx4 v32, s[8:11], s43 offen lds
  s_add_u32 m0, s84, 30720
  s_nop 0
  buffer_load_dwordx4 v33, s[8:11], s43 offen lds
  s_add_u32 m0, s84, 31744
  s_nop 0
  buffer_load_dwordx4 v34, s[8:11], s43 offen lds
  s_add_u32 m0, s84, 32768
  s_nop 0
  buffer_load_dwordx4 v35, s[8:11], s43 offen lds
  s_add_u32 m0, s84, 33792
  s_nop 0
  buffer_load_dwordx4 v36, s[8:11], s43 offen lds
  s_add_u32 m0, s84, 34816
  s_nop 0
  buffer_load_dwordx4 v37, s[8:11], s43 offen lds
  s_add_u32 m0, s84, 35840
  s_nop 0
  buffer_load_dwordx4 v38, s[8:11], s43 offen lds
  s_load_dwordx2 s[8:9], s[0:1], 8
  s_waitcnt lgkmcnt(0)
  s_and_b32 s9, s9, 0xffff
  s_mov_b32 s10, 9216
  s_mov_b32 s11, 0x00020000
  v_lshlrev_b32 v0, 4, v14
  s_lshl_b32 s43, s17, 10
  v_add_u32 v1, s43, v0
  s_mul_i32 s43, s17, 36864
  s_add_u32 s43, s43, 16384
  v_add_u32 v2, s43, v0
  v_and_b32 v15, 15, v14
  v_lshrrev_b32 v16, 4, v14
  v_lshrrev_b32 v17, 2, v15
  v_and_b32 v18, 1, v15
  v_bfe_u32 v19, v15, 1, 1
  v_lshl_add_u32 v20, v17, 1, v18
  v_lshl_add_u32 v21, v16, 3, v20
  v_lshlrev_b32 v21, 5, v21
  s_lshl_b32 s43, s17, 3
  s_add_u32 s43, s43, 13312
  v_add_u32 v3, s43, v21
  v_and_b32 v21, 13, v15
  v_lshl_add_u32 v21, v16, 4, v21
  s_and_b32 s43, s17, 1
  s_lshl_b32 s43, s43, 1
  v_add_u32 v21, s43, v21
  v_lshlrev_b32 v21, 4, v21
  s_lshr_b32 s43, s17, 1
  s_lshl_b32 s43, s43, 10
  s_add_u32 s43, s43, 14336
  v_add_u32 v21, s43, v21
  v_add_u32 v22, 8192, v0
  v_cmp_eq_u32 s[52:53], 1, v19
  s_nop 1
  v_cndmask_b32 v4, v21, v22, s[52:53]
  v_lshlrev_b32 v5, 2, v14
  v_lshl_add_u32 v21, v16, 1, v19
  v_mul_u32_u24 v21, 9344, v21
  v_lshl_add_u32 v6, v20, 4, v21
  v_lshl_add_u32 v21, v16, 1, v18
  v_lshlrev_b32 v21, 4, v21
  v_lshl_add_u32 v7, v17, 2, v21
  s_lshr_b32 s43, s16, 3
  s_add_u32 s44, s43, 5
  s_cmp_lt_u32 s16, 8
  s_cselect_b32 s45, 4, s44
  v_mov_b32 v21, s43
  v_mov_b32 v22, s44
  v_cmp_eq_u32 vcc, 1, v16
  s_nop 1
  v_cndmask_b32 v21, v21, v22, vcc
  v_mov_b32 v22, s45
  v_cmp_eq_u32 vcc, 2, v16
  s_nop 1
  v_cndmask_b32 v21, v21, v22, vcc
  v_lshlrev_b32 v21, 10, v21
  v_lshl_add_u32 v21, v15, 3, v21
  s_lshr_b32 s43, s16, 1
  s_and_b32 s43, s43, 3
  s_lshl_b32 s43, s43, 8
  s_and_b32 s44, s16, 1
  s_lshl_b32 s44, s44, 7
  s_add_u32 s43, s43, s44
  v_add_u32 v21, s43, v21
  s_cmp_eq_u32 s17, 3
  s_cselect_b64 vcc, -1, 0
  v_cndmask_b32 v7, v7, v21, vcc
  v_mov_b32 v21, 0x4444
  v_mov_b32 v22, 0xeeee
  v_cndmask_b32 v8, v21, v22, s[52:53]
  v_mov_b32 v22, 0x3f80
  v_mov_b32 v23, 0x3f800000
  v_cmp_eq_u32 vcc, 1, v18
  s_nop 1
  v_cndmask_b32 v9, v22, v23, vcc
  v_cmp_eq_u32 s[54:55], 0, v17
  v_cmp_eq_u32 s[56:57], 1, v17
  v_cmp_eq_u32 s[58:59], 2, v17
  v_cmp_eq_u32 s[60:61], 3, v17
  v_cmp_eq_u32 vcc, v17, v16
  s_nop 1
  v_cndmask_b32 v74, 0, v9, vcc
  v_cndmask_b32 v75, 0, v9, vcc
  v_lshlrev_b32 v21, 7, v15
  v_and_b32 v22, 1, v16
  v_mul_u32_u24 v22, 4096, v22
  v_lshlrev_b32 v22, 12, v22
  v_add_u32 v10, v21, v22
  v_lshlrev_b32 v10, 5, v14
  s_mov_b32 s46, 0x3e0293ee
  s_mov_b32 s47, 0x3e0293ee
  s_mov_b32 s48, 0x3f803f80
  s_mov_b32 s49, 0x3f803f80
  s_mov_b32 s50, 0x3f803f80
  s_mov_b32 s51, 0
  s_lshl_b32 s43, s17, 10
  s_add_u32 s63, s43, 65536
  s_mul_i32 s43, s16, 9344
  s_mul_i32 s44, s17, 2304
  s_add_u32 s43, s43, s44
  s_add_u32 s33, s43, 655360
  s_lshr_b32 s43, s16, 3
  s_add_u32 s44, s43, 5
  s_cmp_eq_u32 s17, 1
  s_cselect_b32 s43, s44, s43
  s_cmp_lt_u32 s16, 8
  s_cselect_b32 s44, 4, 9
  s_cmp_eq_u32 s17, 2
  s_cselect_b32 s43, s44, s43
  s_cmp_eq_u32 s17, 3
  s_cselect_b32 s43, 9, s43
  s_mov_b32 s20, s4
  s_mov_b32 s21, s5
  s_cmp_lt_u32 s43, 9
  s_cselect_b32 s22, 268435456, 0
  s_mov_b32 s23, 0x00020000
  s_min_u32 s43, s43, 8
  s_lshr_b32 s44, s16, 1
  s_and_b32 s44, s44, 3
  s_and_b32 s45, s16, 1
  s_lshl_b32 s45, s45, 7
  s_lshl_b32 s62, s43, 10
  s_lshl_b32 s34, s44, 8
  s_add_u32 s62, s62, s34
  s_add_u32 s62, s62, s45
  s_add_u32 s62, s62, 65536
  s_lshl_b32 s34, s43, 8
  s_mul_i32 s44, s44, 2304
  s_add_u32 s34, s34, s44
  s_add_u32 s34, s34, s45
  s_add_u32 s34, s34, 655360
  s_add_u32 s35, s34, 74752
  s_add_u32 s36, s34, 149504
  s_add_u32 s37, s34, 224256
  s_lshl_b32 s43, s16, 2
  s_add_u32 s43, s43, s17
  s_lshl_b32 s44, s43, 11
  s_add_u32 s38, s44, 4194304
  s_add_u32 s39, s44, 20971520
  s_lshl_b32 s44, s43, 10
  s_add_u32 s40, s44, 54525952
  s_add_u32 s41, s44, 62914560
  s_lshl_b32 s43, s16, 8
  s_add_u32 s43, s43, 0
  s_add_u32 s24, s4, s43
  s_addc_u32 s25, s5, 0
  s_cmp_eq_u32 s17, 0
  s_cselect_b32 s26, 4, 0
  s_mov_b32 s27, 0x00020000
  s_mov_b32 s18, 0
  s_mov_b32 s32, s62
  v_mov_b64 v[24:25], s[100:101]
  v_mov_b64 v[26:27], s[100:101]
  s_xor_b32 s43, s34, 0
  buffer_store_dwordx4 v[24:27], v6, s[20:23], s43 offen sc1
  s_xor_b32 s43, s35, 0
  buffer_store_dwordx4 v[24:27], v6, s[20:23], s43 offen sc1
  s_xor_b32 s43, s36, 0
  buffer_store_dwordx4 v[24:27], v6, s[20:23], s43 offen sc1
  s_xor_b32 s43, s37, 0
  buffer_store_dwordx4 v[24:27], v6, s[20:23], s43 offen sc1
  s_xor_b32 s43, s34, 524288
  buffer_store_dwordx4 v[24:27], v6, s[20:23], s43 offen sc1
  s_xor_b32 s43, s35, 524288
  buffer_store_dwordx4 v[24:27], v6, s[20:23], s43 offen sc1
  s_xor_b32 s43, s36, 524288
  buffer_store_dwordx4 v[24:27], v6, s[20:23], s43 offen sc1
  s_xor_b32 s43, s37, 524288
  buffer_store_dwordx4 v[24:27], v6, s[20:23], s43 offen sc1
  s_add_u32 s43, s62, 0
  buffer_store_dword v24, v7, s[20:23], s43 offen sc1
  s_add_u32 s43, s62, 16384
  buffer_store_dword v24, v7, s[20:23], s43 offen sc1
  s_add_u32 s43, s62, 32768
  buffer_store_dword v24, v7, s[20:23], s43 offen sc1
  s_add_u32 s43, s62, 49152
  buffer_store_dword v24, v7, s[20:23], s43 offen sc1
  v_bfe_u32 v28, v14, 4, 1
  v_lshlrev_b32 v29, 3, v28
  v_lshlrev_b32 v28, 2, v28
  v_and_b32 v39, 7, v14
  v_xor_b32 v39, v39, v28
  v_bfe_u32 v28, v14, 3, 1
  v_lshl_add_u32 v29, v28, 2, v29
  v_bfe_u32 v28, v14, 5, 1
  v_add_u32 v29, v29, v28
  v_lshlrev_b32 v29, 13, v29
  v_lshl_add_u32 v11, v39, 4, v29
  v_lshrrev_b32 v28, 2, v15
  v_lshlrev_b32 v29, 7, v28
  v_lshl_add_u32 v29, v16, 10, v29
  v_lshrrev_b32 v28, 1, v28
  s_and_b32 s43, s17, 1
  v_xor_b32 v28, s43, v28
  v_lshl_add_u32 v29, v28, 6, v29
  v_and_b32 v28, 3, v15
  v_lshl_add_u32 v29, v28, 3, v29
  v_add_u32 v12, s84, v29
  s_xor_b32 s43, s17, 1
  s_mul_i32 s43, s43, 36864
  s_add_u32 s43, s43, 16384
  v_add_u32 v13, s43, v29
  s_lshr_b32 s43, s17, 1
  s_lshl_b32 s43, s43, 13
  s_sub_u32 s85, s43, s84
  v_lshrrev_b32 v28, 2, v15
  v_lshrrev_b32 v29, 1, v28
  v_lshlrev_b32 v29, 5, v29
  v_and_b32 v28, 1, v28
  v_add_u32 v29, v29, v28
  v_and_b32 v28, 1, v16
  v_lshl_add_u32 v29, v28, 4, v29
  v_lshrrev_b32 v28, 1, v16
  v_lshl_add_u32 v29, v28, 2, v29
  v_mul_u32_u24 v29, 288, v29
  v_and_b32 v28, 3, v15
  v_lshl_add_u32 v29, v28, 3, v29
  v_add_u32 v62, s84, v29
  s_load_dwordx2 s[64:65], s[0:1], 16
  s_waitcnt lgkmcnt(0)
  s_and_b32 s65, s65, 0xffff
  s_mov_b32 s66, 4718592
  s_mov_b32 s67, 0x00020000
  s_load_dwordx2 s[68:69], s[0:1], 24
  s_waitcnt lgkmcnt(0)
  s_and_b32 s69, s69, 0xffff
  s_mov_b32 s70, 4718592
  s_mov_b32 s71, 0x00020000
  s_load_dwordx2 s[72:73], s[0:1], 32
  s_waitcnt lgkmcnt(0)
  s_and_b32 s73, s73, 0xffff
  s_mov_b32 s74, 4718592
  s_mov_b32 s75, 0x00020000
  s_lshl_b32 s43, s16, 8
  s_lshr_b32 s44, s17, 1
  s_lshl_b32 s44, s44, 7
  s_add_u32 s43, s43, s44
  s_xor_b32 s44, s17, 0
  s_lshl_b32 s44, s44, 17
  s_add_u32 s76, s43, s44
  s_xor_b32 s44, s17, 2
  s_lshl_b32 s44, s44, 17
  s_add_u32 s80, s43, s44
  s_xor_b32 s44, s17, 0
  s_add_u32 s44, s44, 4
  s_lshl_b32 s44, s44, 17
  s_add_u32 s77, s43, s44
  s_xor_b32 s44, s17, 2
  s_add_u32 s44, s44, 4
  s_lshl_b32 s44, s44, 17
  s_add_u32 s83, s43, s44
  s_and_b32 s44, s17, 1
  s_mul_i32 s44, s44, 2359296
  s_add_u32 s44, s44, 1048576
  s_add_u32 s78, s43, s44
  s_lshl_b32 s79, s17, 12
  s_add_u32 s43, s78, 0
  s_add_u32 m0, s79, 0
  s_nop 0
  buffer_load_dwordx4 v11, s[64:67], s43 offen lds
  s_add_u32 s43, s78, 16384
  s_add_u32 m0, s79, 1024
  s_nop 0
  buffer_load_dwordx4 v11, s[64:67], s43 offen lds
  s_add_u32 s43, s78, 1179648
  s_add_u32 m0, s79, 2048
  s_nop 0
  buffer_load_dwordx4 v11, s[64:67], s43 offen lds
  s_add_u32 s43, s78, 1196032
  s_add_u32 m0, s79, 3072
  s_nop 0
  buffer_load_dwordx4 v11, s[64:67], s43 offen lds
  s_waitcnt vmcnt(34)
  ds_read_b64_tr_b16 v[14:15], v62 offset:0
  ds_read_b64_tr_b16 v[16:17], v62 offset:576
  ds_read_b64_tr_b16 v[18:19], v62 offset:2304
  ds_read_b64_tr_b16 v[20:21], v62 offset:2880
  ds_read_b64_tr_b16 a[160:161], v62 offset:32
  ds_read_b64_tr_b16 a[162:163], v62 offset:608
  ds_read_b64_tr_b16 a[164:165], v62 offset:2336
  ds_read_b64_tr_b16 a[166:167], v62 offset:2912
  ds_read_b64_tr_b16 a[176:177], v62 offset:64
  ds_read_b64_tr_b16 a[178:179], v62 offset:640
  ds_read_b64_tr_b16 a[180:181], v62 offset:2368
  ds_read_b64_tr_b16 a[182:183], v62 offset:2944
  ds_read_b64_tr_b16 a[192:193], v62 offset:96
  ds_read_b64_tr_b16 a[194:195], v62 offset:672
  ds_read_b64_tr_b16 a[196:197], v62 offset:2400
  ds_read_b64_tr_b16 a[198:199], v62 offset:2976
  ds_read_b64_tr_b16 v[30:31], v62 offset:128
  ds_read_b64_tr_b16 v[32:33], v62 offset:704
  ds_read_b64_tr_b16 v[34:35], v62 offset:2432
  ds_read_b64_tr_b16 v[36:37], v62 offset:3008
  ds_read_b64_tr_b16 a[208:209], v62 offset:160
  ds_read_b64_tr_b16 a[210:211], v62 offset:736
  ds_read_b64_tr_b16 a[212:213], v62 offset:2464
  ds_read_b64_tr_b16 a[214:215], v62 offset:3040
  ds_read_b64_tr_b16 a[224:225], v62 offset:192
  ds_read_b64_tr_b16 a[226:227], v62 offset:768
  ds_read_b64_tr_b16 a[228:229], v62 offset:2496
  ds_read_b64_tr_b16 a[230:231], v62 offset:3072
  ds_read_b64_tr_b16 a[240:241], v62 offset:224
  ds_read_b64_tr_b16 a[242:243], v62 offset:800
  ds_read_b64_tr_b16 a[244:245], v62 offset:2528
  ds_read_b64_tr_b16 a[246:247], v62 offset:3104
  ds_read_b64_tr_b16 v[46:47], v62 offset:256
  ds_read_b64_tr_b16 v[48:49], v62 offset:832
  ds_read_b64_tr_b16 v[50:51], v62 offset:2560
  ds_read_b64_tr_b16 v[52:53], v62 offset:3136
  s_waitcnt lgkmcnt(0)
  s_add_u32 s43, s80, 0
  s_add_u32 m0, s84, 0
  s_nop 0
  buffer_load_dwordx4 v11, s[64:67], s43 offen lds
  s_add_u32 s43, s80, 16384
  s_add_u32 m0, s84, 1024
  s_nop 0
  buffer_load_dwordx4 v11, s[64:67], s43 offen lds
  s_add_u32 s43, s80, 1179648
  s_add_u32 m0, s84, 2048
  s_nop 0
  buffer_load_dwordx4 v11, s[64:67], s43 offen lds
  s_add_u32 s43, s80, 1196032
  s_add_u32 m0, s84, 3072
  s_nop 0
  buffer_load_dwordx4 v11, s[64:67], s43 offen lds
  s_add_u32 s43, s80, 2359296
  s_add_u32 m0, s84, 4096
  s_nop 0
  buffer_load_dwordx4 v11, s[64:67], s43 offen lds
  s_add_u32 s43, s80, 2375680
  s_add_u32 m0, s84, 5120
  s_nop 0
  buffer_load_dwordx4 v11, s[64:67], s43 offen lds
  s_add_u32 s43, s80, 3538944
  s_add_u32 m0, s84, 6144
  s_nop 0
  buffer_load_dwordx4 v11, s[64:67], s43 offen lds
  s_add_u32 s43, s80, 3555328
  s_add_u32 m0, s84, 7168
  s_nop 0
  buffer_load_dwordx4 v11, s[64:67], s43 offen lds
  s_add_u32 s43, s77, 0
  s_add_u32 m0, s84, 8192
  s_nop 0
  buffer_load_dwordx4 v11, s[64:67], s43 offen lds
  s_add_u32 s43, s77, 16384
  s_add_u32 m0, s84, 9216
  s_nop 0
  buffer_load_dwordx4 v11, s[64:67], s43 offen lds
  s_add_u32 s43, s77, 1179648
  s_add_u32 m0, s84, 10240
  s_nop 0
  buffer_load_dwordx4 v11, s[64:67], s43 offen lds
  s_add_u32 s43, s77, 1196032
  s_add_u32 m0, s84, 11264
  s_nop 0
  buffer_load_dwordx4 v11, s[64:67], s43 offen lds
  s_add_u32 s43, s77, 2359296
  s_add_u32 m0, s84, 12288
  s_nop 0
  buffer_load_dwordx4 v11, s[64:67], s43 offen lds
  s_add_u32 s43, s77, 2375680
  s_add_u32 m0, s84, 13312
  s_nop 0
  buffer_load_dwordx4 v11, s[64:67], s43 offen lds
  s_add_u32 s43, s77, 3538944
  s_add_u32 m0, s84, 14336
  s_nop 0
  buffer_load_dwordx4 v11, s[64:67], s43 offen lds
  s_add_u32 s43, s77, 3555328
  s_add_u32 m0, s84, 15360
  s_nop 0
  buffer_load_dwordx4 v11, s[64:67], s43 offen lds
  s_waitcnt vmcnt(32)
  ds_read_b64_tr_b16 v[22:23], v62 offset:18432
  ds_read_b64_tr_b16 v[24:25], v62 offset:19008
  ds_read_b64_tr_b16 v[26:27], v62 offset:20736
  ds_read_b64_tr_b16 v[28:29], v62 offset:21312
  ds_read_b64_tr_b16 a[168:169], v62 offset:18464
  ds_read_b64_tr_b16 a[170:171], v62 offset:19040
  ds_read_b64_tr_b16 a[172:173], v62 offset:20768
  ds_read_b64_tr_b16 a[174:175], v62 offset:21344
  ds_read_b64_tr_b16 a[184:185], v62 offset:18496
  ds_read_b64_tr_b16 a[186:187], v62 offset:19072
  ds_read_b64_tr_b16 a[188:189], v62 offset:20800
  ds_read_b64_tr_b16 a[190:191], v62 offset:21376
  ds_read_b64_tr_b16 a[200:201], v62 offset:18528
  ds_read_b64_tr_b16 a[202:203], v62 offset:19104
  ds_read_b64_tr_b16 a[204:205], v62 offset:20832
  ds_read_b64_tr_b16 a[206:207], v62 offset:21408
  ds_read_b64_tr_b16 v[38:39], v62 offset:18560
  ds_read_b64_tr_b16 v[40:41], v62 offset:19136
  ds_read_b64_tr_b16 v[42:43], v62 offset:20864
  ds_read_b64_tr_b16 v[44:45], v62 offset:21440
  ds_read_b64_tr_b16 a[216:217], v62 offset:18592
  ds_read_b64_tr_b16 a[218:219], v62 offset:19168
  ds_read_b64_tr_b16 a[220:221], v62 offset:20896
  ds_read_b64_tr_b16 a[222:223], v62 offset:21472
  ds_read_b64_tr_b16 a[232:233], v62 offset:18624
  ds_read_b64_tr_b16 a[234:235], v62 offset:19200
  ds_read_b64_tr_b16 a[236:237], v62 offset:20928
  ds_read_b64_tr_b16 a[238:239], v62 offset:21504
  ds_read_b64_tr_b16 a[248:249], v62 offset:18656
  ds_read_b64_tr_b16 a[250:251], v62 offset:19232
  ds_read_b64_tr_b16 a[252:253], v62 offset:20960
  ds_read_b64_tr_b16 a[254:255], v62 offset:21536
  ds_read_b64_tr_b16 v[54:55], v62 offset:18688
  ds_read_b64_tr_b16 v[56:57], v62 offset:19264
  ds_read_b64_tr_b16 v[58:59], v62 offset:20992
  ds_read_b64_tr_b16 v[60:61], v62 offset:21568
  s_waitcnt lgkmcnt(0)
  s_add_u32 s43, s76, 0
  s_add_u32 m0, s84, 16384
  s_nop 0
  buffer_load_dwordx4 v11, s[68:71], s43 offen lds
  s_add_u32 s43, s76, 16384
  s_add_u32 m0, s84, 17408
  s_nop 0
  buffer_load_dwordx4 v11, s[68:71], s43 offen lds
  s_add_u32 s43, s76, 1179648
  s_add_u32 m0, s84, 18432
  s_nop 0
  buffer_load_dwordx4 v11, s[68:71], s43 offen lds
  s_add_u32 s43, s76, 1196032
  s_add_u32 m0, s84, 19456
  s_nop 0
  buffer_load_dwordx4 v11, s[68:71], s43 offen lds
  s_add_u32 s43, s76, 2359296
  s_add_u32 m0, s84, 20480
  s_nop 0
  buffer_load_dwordx4 v11, s[68:71], s43 offen lds
  s_add_u32 s43, s76, 2375680
  s_add_u32 m0, s84, 21504
  s_nop 0
  buffer_load_dwordx4 v11, s[68:71], s43 offen lds
  s_add_u32 s43, s76, 3538944
  s_add_u32 m0, s84, 22528
  s_nop 0
  buffer_load_dwordx4 v11, s[68:71], s43 offen lds
  s_add_u32 s43, s76, 3555328
  s_add_u32 m0, s84, 23552
  s_nop 0
  buffer_load_dwordx4 v11, s[68:71], s43 offen lds
  s_add_u32 s43, s76, 0
  s_add_u32 m0, s84, 24576
  s_nop 0
  buffer_load_dwordx4 v11, s[72:75], s43 offen lds
  s_add_u32 s43, s76, 16384
  s_add_u32 m0, s84, 25600
  s_nop 0
  buffer_load_dwordx4 v11, s[72:75], s43 offen lds
  s_add_u32 s43, s76, 1179648
  s_add_u32 m0, s84, 26624
  s_nop 0
  buffer_load_dwordx4 v11, s[72:75], s43 offen lds
  s_add_u32 s43, s76, 1196032
  s_add_u32 m0, s84, 27648
  s_nop 0
  buffer_load_dwordx4 v11, s[72:75], s43 offen lds
  s_add_u32 s43, s76, 2359296
  s_add_u32 m0, s84, 28672
  s_nop 0
  buffer_load_dwordx4 v11, s[72:75], s43 offen lds
  s_add_u32 s43, s76, 2375680
  s_add_u32 m0, s84, 29696
  s_nop 0
  buffer_load_dwordx4 v11, s[72:75], s43 offen lds
  s_add_u32 s43, s76, 3538944
  s_add_u32 m0, s84, 30720
  s_nop 0
  buffer_load_dwordx4 v11, s[72:75], s43 offen lds
  s_add_u32 s43, s76, 3555328
  s_add_u32 m0, s84, 31744
  s_nop 0
  buffer_load_dwordx4 v11, s[72:75], s43 offen lds
  s_waitcnt vmcnt(24)
  s_barrier
  s_cmp_lg_u32 s17, 0
  s_cbranch_scc1 L_cb_arr
  s_mov_b64 exec, 1
  v_mov_b32 v76, 1
  buffer_atomic_add v76, off, s[12:15], 0 offset:12 sc1
  s_mov_b64 exec, -1
L_cb_arr:
  ds_read_b64_tr_b16 v[128:129], v12 offset:0
  ds_read_b64_tr_b16 v[130:131], v12 offset:512
  ds_read_b64_tr_b16 v[132:133], v12 offset:4096
  ds_read_b64_tr_b16 v[134:135], v12 offset:4608
  ds_read_b64_tr_b16 v[136:137], v12 offset:32
  ds_read_b64_tr_b16 v[138:139], v12 offset:544
  ds_read_b64_tr_b16 v[140:141], v12 offset:4128
  ds_read_b64_tr_b16 v[142:143], v12 offset:4640
  ds_read_b64_tr_b16 v[144:145], v13 offset:0
  ds_read_b64_tr_b16 v[146:147], v13 offset:512
  ds_read_b64_tr_b16 v[148:149], v13 offset:4096
  ds_read_b64_tr_b16 v[150:151], v13 offset:4608
  ds_read_b64_tr_b16 v[152:153], v13 offset:32
  ds_read_b64_tr_b16 v[154:155], v13 offset:544
  ds_read_b64_tr_b16 v[156:157], v13 offset:4128
  ds_read_b64_tr_b16 v[158:159], v13 offset:4640
  s_waitcnt lgkmcnt(0)
  s_barrier
  s_add_u32 s43, s80, 0
  s_add_u32 m0, s84, 0
  s_nop 0
  buffer_load_dwordx4 v11, s[72:75], s43 offen lds
  s_add_u32 s43, s80, 16384
  s_add_u32 m0, s84, 1024
  s_nop 0
  buffer_load_dwordx4 v11, s[72:75], s43 offen lds
  s_add_u32 s43, s80, 1179648
  s_add_u32 m0, s84, 2048
  s_nop 0
  buffer_load_dwordx4 v11, s[72:75], s43 offen lds
  s_add_u32 s43, s80, 1196032
  s_add_u32 m0, s84, 3072
  s_nop 0
  buffer_load_dwordx4 v11, s[72:75], s43 offen lds
  s_add_u32 s43, s80, 2359296
  s_add_u32 m0, s84, 4096
  s_nop 0
  buffer_load_dwordx4 v11, s[72:75], s43 offen lds
  s_add_u32 s43, s80, 2375680
  s_add_u32 m0, s84, 5120
  s_nop 0
  buffer_load_dwordx4 v11, s[72:75], s43 offen lds
  s_add_u32 s43, s80, 3538944
  s_add_u32 m0, s84, 6144
  s_nop 0
  buffer_load_dwordx4 v11, s[72:75], s43 offen lds
  s_add_u32 s43, s80, 3555328
  s_add_u32 m0, s84, 7168
  s_nop 0
  buffer_load_dwordx4 v11, s[72:75], s43 offen lds
  s_waitcnt vmcnt(24)
  s_barrier
  ds_read_b64_tr_b16 v[80:81], v12 offset:8192
  ds_read_b64_tr_b16 v[82:83], v12 offset:8704
  ds_read_b64_tr_b16 v[84:85], v12 offset:12288
  ds_read_b64_tr_b16 v[86:87], v12 offset:12800
  ds_read_b64_tr_b16 v[88:89], v12 offset:8224
  ds_read_b64_tr_b16 v[90:91], v12 offset:8736
  ds_read_b64_tr_b16 v[92:93], v12 offset:12320
  ds_read_b64_tr_b16 v[94:95], v12 offset:12832
  ds_read_b64_tr_b16 v[160:161], v13 offset:8192
  ds_read_b64_tr_b16 v[162:163], v13 offset:8704
  ds_read_b64_tr_b16 v[164:165], v13 offset:12288
  ds_read_b64_tr_b16 v[166:167], v13 offset:12800
  ds_read_b64_tr_b16 v[168:169], v13 offset:8224
  ds_read_b64_tr_b16 v[170:171], v13 offset:8736
  ds_read_b64_tr_b16 v[172:173], v13 offset:12320
  ds_read_b64_tr_b16 v[174:175], v13 offset:12832
  v_add_u32 v76, s85, v12
  ds_read_b64_tr_b16 v[96:97], v76 offset:0
  ds_read_b64_tr_b16 v[98:99], v76 offset:512
  ds_read_b64_tr_b16 v[100:101], v76 offset:4096
  ds_read_b64_tr_b16 v[102:103], v76 offset:4608
  ds_read_b64_tr_b16 v[104:105], v76 offset:32
  ds_read_b64_tr_b16 v[106:107], v76 offset:544
  ds_read_b64_tr_b16 v[108:109], v76 offset:4128
  ds_read_b64_tr_b16 v[110:111], v76 offset:4640
  s_waitcnt lgkmcnt(0)
  s_barrier
  s_add_u32 s43, s77, 0
  s_add_u32 m0, s84, 8192
  s_nop 0
  buffer_load_dwordx4 v11, s[72:75], s43 offen lds
  s_add_u32 s43, s77, 16384
  s_add_u32 m0, s84, 9216
  s_nop 0
  buffer_load_dwordx4 v11, s[72:75], s43 offen lds
  s_add_u32 s43, s77, 1179648
  s_add_u32 m0, s84, 10240
  s_nop 0
  buffer_load_dwordx4 v11, s[72:75], s43 offen lds
  s_add_u32 s43, s77, 1196032
  s_add_u32 m0, s84, 11264
  s_nop 0
  buffer_load_dwordx4 v11, s[72:75], s43 offen lds
  s_add_u32 s43, s77, 2359296
  s_add_u32 m0, s84, 12288
  s_nop 0
  buffer_load_dwordx4 v11, s[72:75], s43 offen lds
  s_add_u32 s43, s77, 2375680
  s_add_u32 m0, s84, 13312
  s_nop 0
  buffer_load_dwordx4 v11, s[72:75], s43 offen lds
  s_add_u32 s43, s77, 3538944
  s_add_u32 m0, s84, 14336
  s_nop 0
  buffer_load_dwordx4 v11, s[72:75], s43 offen lds
  s_add_u32 s43, s77, 3555328
  s_add_u32 m0, s84, 15360
  s_nop 0
  buffer_load_dwordx4 v11, s[72:75], s43 offen lds
  s_add_u32 s43, s78, 0
  s_add_u32 m0, s79, 0
  s_nop 0
  buffer_load_dwordx4 v11, s[68:71], s43 offen lds
  s_add_u32 s43, s78, 16384
  s_add_u32 m0, s79, 1024
  s_nop 0
  buffer_load_dwordx4 v11, s[68:71], s43 offen lds
  s_add_u32 s43, s78, 1179648
  s_add_u32 m0, s79, 2048
  s_nop 0
  buffer_load_dwordx4 v11, s[68:71], s43 offen lds
  s_add_u32 s43, s78, 1196032
  s_add_u32 m0, s79, 3072
  s_nop 0
  buffer_load_dwordx4 v11, s[68:71], s43 offen lds
  s_waitcnt vmcnt(28)
  s_barrier
  ds_read_b64_tr_b16 v[192:193], v12 offset:16384
  ds_read_b64_tr_b16 v[194:195], v12 offset:16896
  ds_read_b64_tr_b16 v[196:197], v12 offset:20480
  ds_read_b64_tr_b16 v[198:199], v12 offset:20992
  ds_read_b64_tr_b16 v[200:201], v12 offset:16416
  ds_read_b64_tr_b16 v[202:203], v12 offset:16928
  ds_read_b64_tr_b16 v[204:205], v12 offset:20512
  ds_read_b64_tr_b16 v[206:207], v12 offset:21024
  ds_read_b64_tr_b16 v[224:225], v13 offset:16384
  ds_read_b64_tr_b16 v[226:227], v13 offset:16896
  ds_read_b64_tr_b16 v[228:229], v13 offset:20480
  ds_read_b64_tr_b16 v[230:231], v13 offset:20992
  ds_read_b64_tr_b16 v[232:233], v13 offset:16416
  ds_read_b64_tr_b16 v[234:235], v13 offset:16928
  ds_read_b64_tr_b16 v[236:237], v13 offset:20512
  ds_read_b64_tr_b16 v[238:239], v13 offset:21024
  s_waitcnt lgkmcnt(0)
  s_barrier
  s_add_u32 s43, s83, 0
  s_add_u32 m0, s84, 16384
  s_nop 0
  buffer_load_dwordx4 v11, s[72:75], s43 offen lds
  s_add_u32 s43, s83, 16384
  s_add_u32 m0, s84, 17408
  s_nop 0
  buffer_load_dwordx4 v11, s[72:75], s43 offen lds
  s_add_u32 s43, s83, 1179648
  s_add_u32 m0, s84, 18432
  s_nop 0
  buffer_load_dwordx4 v11, s[72:75], s43 offen lds
  s_add_u32 s43, s83, 1196032
  s_add_u32 m0, s84, 19456
  s_nop 0
  buffer_load_dwordx4 v11, s[72:75], s43 offen lds
  s_add_u32 s43, s83, 2359296
  s_add_u32 m0, s84, 20480
  s_nop 0
  buffer_load_dwordx4 v11, s[72:75], s43 offen lds
  s_add_u32 s43, s83, 2375680
  s_add_u32 m0, s84, 21504
  s_nop 0
  buffer_load_dwordx4 v11, s[72:75], s43 offen lds
  s_add_u32 s43, s83, 3538944
  s_add_u32 m0, s84, 22528
  s_nop 0
  buffer_load_dwordx4 v11, s[72:75], s43 offen lds
  s_add_u32 s43, s83, 3555328
  s_add_u32 m0, s84, 23552
  s_nop 0
  buffer_load_dwordx4 v11, s[72:75], s43 offen lds
  s_waitcnt vmcnt(28)
  s_barrier
  ds_read_b64_tr_b16 a[32:33], v12 offset:24576
  ds_read_b64_tr_b16 a[34:35], v12 offset:25088
  ds_read_b64_tr_b16 a[36:37], v12 offset:28672
  ds_read_b64_tr_b16 a[38:39], v12 offset:29184
  ds_read_b64_tr_b16 a[40:41], v12 offset:24608
  ds_read_b64_tr_b16 a[42:43], v12 offset:25120
  ds_read_b64_tr_b16 a[44:45], v12 offset:28704
  ds_read_b64_tr_b16 a[46:47], v12 offset:29216
  ds_read_b64_tr_b16 a[64:65], v13 offset:24576
  ds_read_b64_tr_b16 a[66:67], v13 offset:25088
  ds_read_b64_tr_b16 a[68:69], v13 offset:28672
  ds_read_b64_tr_b16 a[70:71], v13 offset:29184
  ds_read_b64_tr_b16 a[72:73], v13 offset:24608
  ds_read_b64_tr_b16 a[74:75], v13 offset:25120
  ds_read_b64_tr_b16 a[76:77], v13 offset:28704
  ds_read_b64_tr_b16 a[78:79], v13 offset:29216
  s_waitcnt lgkmcnt(0)
  s_barrier
  s_add_u32 s43, s76, 0
  s_add_u32 m0, s84, 24576
  s_nop 0
  buffer_load_dwordx4 v11, s[64:67], s43 offen lds
  s_add_u32 s43, s76, 16384
  s_add_u32 m0, s84, 25600
  s_nop 0
  buffer_load_dwordx4 v11, s[64:67], s43 offen lds
  s_add_u32 s43, s76, 1179648
  s_add_u32 m0, s84, 26624
  s_nop 0
  buffer_load_dwordx4 v11, s[64:67], s43 offen lds
  s_add_u32 s43, s76, 1196032
  s_add_u32 m0, s84, 27648
  s_nop 0
  buffer_load_dwordx4 v11, s[64:67], s43 offen lds
  s_add_u32 s43, s76, 2359296
  s_add_u32 m0, s84, 28672
  s_nop 0
  buffer_load_dwordx4 v11, s[64:67], s43 offen lds
  s_add_u32 s43, s76, 2375680
  s_add_u32 m0, s84, 29696
  s_nop 0
  buffer_load_dwordx4 v11, s[64:67], s43 offen lds
  s_add_u32 s43, s76, 3538944
  s_add_u32 m0, s84, 30720
  s_nop 0
  buffer_load_dwordx4 v11, s[64:67], s43 offen lds
  s_add_u32 s43, s76, 3555328
  s_add_u32 m0, s84, 31744
  s_nop 0
  buffer_load_dwordx4 v11, s[64:67], s43 offen lds
  s_waitcnt vmcnt(28)
  s_barrier
  ds_read_b64_tr_b16 a[80:81], v12 offset:0
  ds_read_b64_tr_b16 a[82:83], v12 offset:512
  ds_read_b64_tr_b16 a[84:85], v12 offset:4096
  ds_read_b64_tr_b16 a[86:87], v12 offset:4608
  ds_read_b64_tr_b16 a[88:89], v12 offset:32
  ds_read_b64_tr_b16 a[90:91], v12 offset:544
  ds_read_b64_tr_b16 a[92:93], v12 offset:4128
  ds_read_b64_tr_b16 a[94:95], v12 offset:4640
  ds_read_b64_tr_b16 a[96:97], v13 offset:0
  ds_read_b64_tr_b16 a[98:99], v13 offset:512
  ds_read_b64_tr_b16 a[100:101], v13 offset:4096
  ds_read_b64_tr_b16 a[102:103], v13 offset:4608
  ds_read_b64_tr_b16 a[104:105], v13 offset:32
  ds_read_b64_tr_b16 a[106:107], v13 offset:544
  ds_read_b64_tr_b16 a[108:109], v13 offset:4128
  ds_read_b64_tr_b16 a[110:111], v13 offset:4640
  s_waitcnt lgkmcnt(0)
  s_barrier
  s_add_u32 s43, s77, 0
  s_add_u32 m0, s84, 0
  s_nop 0
  buffer_load_dwordx4 v11, s[68:71], s43 offen lds
  s_add_u32 s43, s77, 16384
  s_add_u32 m0, s84, 1024
  s_nop 0
  buffer_load_dwordx4 v11, s[68:71], s43 offen lds
  s_add_u32 s43, s77, 1179648
  s_add_u32 m0, s84, 2048
  s_nop 0
  buffer_load_dwordx4 v11, s[68:71], s43 offen lds
  s_add_u32 s43, s77, 1196032
  s_add_u32 m0, s84, 3072
  s_nop 0
  buffer_load_dwordx4 v11, s[68:71], s43 offen lds
  s_add_u32 s43, s77, 2359296
  s_add_u32 m0, s84, 4096
  s_nop 0
  buffer_load_dwordx4 v11, s[68:71], s43 offen lds
  s_add_u32 s43, s77, 2375680
  s_add_u32 m0, s84, 5120
  s_nop 0
  buffer_load_dwordx4 v11, s[68:71], s43 offen lds
  s_add_u32 s43, s77, 3538944
  s_add_u32 m0, s84, 6144
  s_nop 0
  buffer_load_dwordx4 v11, s[68:71], s43 offen lds
  s_add_u32 s43, s77, 3555328
  s_add_u32 m0, s84, 7168
  s_nop 0
  buffer_load_dwordx4 v11, s[68:71], s43 offen lds
  s_waitcnt vmcnt(28)
  s_waitcnt vmcnt(24)
  s_barrier
  ds_read_b64_tr_b16 a[48:49], v12 offset:8192
  ds_read_b64_tr_b16 a[50:51], v12 offset:8704
  ds_read_b64_tr_b16 a[52:53], v12 offset:12288
  ds_read_b64_tr_b16 a[54:55], v12 offset:12800
  ds_read_b64_tr_b16 a[56:57], v12 offset:8224
  ds_read_b64_tr_b16 a[58:59], v12 offset:8736
  ds_read_b64_tr_b16 a[60:61], v12 offset:12320
  ds_read_b64_tr_b16 a[62:63], v12 offset:12832
  ds_read_b64_tr_b16 a[112:113], v13 offset:8192
  ds_read_b64_tr_b16 a[114:115], v13 offset:8704
  ds_read_b64_tr_b16 a[116:117], v13 offset:12288
  ds_read_b64_tr_b16 a[118:119], v13 offset:12800
  ds_read_b64_tr_b16 a[120:121], v13 offset:8224
  ds_read_b64_tr_b16 a[122:123], v13 offset:8736
  ds_read_b64_tr_b16 a[124:125], v13 offset:12320
  ds_read_b64_tr_b16 a[126:127], v13 offset:12832
  v_add_u32 v76, s85, v12
  ds_read_b64_tr_b16 v[208:209], v76 offset:0
  ds_read_b64_tr_b16 v[210:211], v76 offset:512
  ds_read_b64_tr_b16 v[212:213], v76 offset:4096
  ds_read_b64_tr_b16 v[214:215], v76 offset:4608
  ds_read_b64_tr_b16 v[216:217], v76 offset:32
  ds_read_b64_tr_b16 v[218:219], v76 offset:544
  ds_read_b64_tr_b16 v[220:221], v76 offset:4128
  ds_read_b64_tr_b16 v[222:223], v76 offset:4640
  s_waitcnt lgkmcnt(0)
  s_barrier
  s_add_u32 s43, s80, 0
  s_add_u32 m0, s84, 8192
  s_nop 0
  buffer_load_dwordx4 v11, s[68:71], s43 offen lds
  s_add_u32 s43, s80, 16384
  s_add_u32 m0, s84, 9216
  s_nop 0
  buffer_load_dwordx4 v11, s[68:71], s43 offen lds
  s_add_u32 s43, s80, 1179648
  s_add_u32 m0, s84, 10240
  s_nop 0
  buffer_load_dwordx4 v11, s[68:71], s43 offen lds
  s_add_u32 s43, s80, 1196032
  s_add_u32 m0, s84, 11264
  s_nop 0
  buffer_load_dwordx4 v11, s[68:71], s43 offen lds
  s_add_u32 s43, s80, 2359296
  s_add_u32 m0, s84, 12288
  s_nop 0
  buffer_load_dwordx4 v11, s[68:71], s43 offen lds
  s_add_u32 s43, s80, 2375680
  s_add_u32 m0, s84, 13312
  s_nop 0
  buffer_load_dwordx4 v11, s[68:71], s43 offen lds
  s_add_u32 s43, s80, 3538944
  s_add_u32 m0, s84, 14336
  s_nop 0
  buffer_load_dwordx4 v11, s[68:71], s43 offen lds
  s_add_u32 s43, s80, 3555328
  s_add_u32 m0, s84, 15360
  s_nop 0
  buffer_load_dwordx4 v11, s[68:71], s43 offen lds
  s_add_u32 s43, s78, 0
  s_add_u32 m0, s79, 0
  s_nop 0
  buffer_load_dwordx4 v11, s[72:75], s43 offen lds
  s_add_u32 s43, s78, 16384
  s_add_u32 m0, s79, 1024
  s_nop 0
  buffer_load_dwordx4 v11, s[72:75], s43 offen lds
  s_add_u32 s43, s78, 1179648
  s_add_u32 m0, s79, 2048
  s_nop 0
  buffer_load_dwordx4 v11, s[72:75], s43 offen lds
  s_add_u32 s43, s78, 1196032
  s_add_u32 m0, s79, 3072
  s_nop 0
  buffer_load_dwordx4 v11, s[72:75], s43 offen lds
  s_waitcnt vmcnt(28)
  s_barrier
  ds_read_b64_tr_b16 a[128:129], v12 offset:16384
  ds_read_b64_tr_b16 a[130:131], v12 offset:16896
  ds_read_b64_tr_b16 a[132:133], v12 offset:20480
  ds_read_b64_tr_b16 a[134:135], v12 offset:20992
  ds_read_b64_tr_b16 a[136:137], v12 offset:16416
  ds_read_b64_tr_b16 a[138:139], v12 offset:16928
  ds_read_b64_tr_b16 a[140:141], v12 offset:20512
  ds_read_b64_tr_b16 a[142:143], v12 offset:21024
  ds_read_b64_tr_b16 a[144:145], v13 offset:16384
  ds_read_b64_tr_b16 a[146:147], v13 offset:16896
  ds_read_b64_tr_b16 a[148:149], v13 offset:20480
  ds_read_b64_tr_b16 a[150:151], v13 offset:20992
  ds_read_b64_tr_b16 a[152:153], v13 offset:16416
  ds_read_b64_tr_b16 a[154:155], v13 offset:16928
  ds_read_b64_tr_b16 a[156:157], v13 offset:20512
  ds_read_b64_tr_b16 a[158:159], v13 offset:21024
  s_waitcnt lgkmcnt(0)
  s_barrier
  s_add_u32 s43, s83, 0
  s_add_u32 m0, s84, 16384
  s_nop 0
  buffer_load_dwordx4 v11, s[64:67], s43 offen lds
  s_add_u32 s43, s83, 16384
  s_add_u32 m0, s84, 17408
  s_nop 0
  buffer_load_dwordx4 v11, s[64:67], s43 offen lds
  s_add_u32 s43, s83, 1179648
  s_add_u32 m0, s84, 18432
  s_nop 0
  buffer_load_dwordx4 v11, s[64:67], s43 offen lds
  s_add_u32 s43, s83, 1196032
  s_add_u32 m0, s84, 19456
  s_nop 0
  buffer_load_dwordx4 v11, s[64:67], s43 offen lds
  s_add_u32 s43, s83, 2359296
  s_add_u32 m0, s84, 20480
  s_nop 0
  buffer_load_dwordx4 v11, s[64:67], s43 offen lds
  s_add_u32 s43, s83, 2375680
  s_add_u32 m0, s84, 21504
  s_nop 0
  buffer_load_dwordx4 v11, s[64:67], s43 offen lds
  s_add_u32 s43, s83, 3538944
  s_add_u32 m0, s84, 22528
  s_nop 0
  buffer_load_dwordx4 v11, s[64:67], s43 offen lds
  s_add_u32 s43, s83, 3555328
  s_add_u32 m0, s84, 23552
  s_nop 0
  buffer_load_dwordx4 v11, s[64:67], s43 offen lds
  s_waitcnt vmcnt(28)
  s_barrier
  ds_read_b64_tr_b16 v[62:63], v12 offset:24576
  ds_read_b64_tr_b16 v[64:65], v12 offset:25088
  ds_read_b64_tr_b16 v[66:67], v12 offset:28672
  ds_read_b64_tr_b16 v[68:69], v12 offset:29184
  ds_read_b64_tr_b16 v[70:71], v12 offset:24608
  ds_read_b64_tr_b16 v[72:73], v12 offset:25120
  ds_read_b64_tr_b16 v[76:77], v12 offset:28704
  ds_read_b64_tr_b16 v[78:79], v12 offset:29216
  ds_read_b64_tr_b16 v[112:113], v13 offset:24576
  ds_read_b64_tr_b16 v[114:115], v13 offset:25088
  ds_read_b64_tr_b16 v[116:117], v13 offset:28672
  ds_read_b64_tr_b16 v[118:119], v13 offset:29184
  ds_read_b64_tr_b16 v[120:121], v13 offset:24608
  ds_read_b64_tr_b16 v[122:123], v13 offset:25120
  ds_read_b64_tr_b16 v[124:125], v13 offset:28704
  ds_read_b64_tr_b16 v[126:127], v13 offset:29216
  s_waitcnt lgkmcnt(0)
  s_barrier
  s_mul_i32 s44, s17, 3072
  s_add_u32 s43, s44, 0
  s_add_u32 m0, s84, 24576
  s_nop 0
  buffer_load_dwordx4 v0, s[8:11], s43 offen lds
  s_add_u32 s43, s44, 1024
  s_add_u32 m0, s84, 25600
  s_nop 0
  buffer_load_dwordx4 v0, s[8:11], s43 offen lds
  s_add_u32 s43, s44, 2048
  s_add_u32 m0, s84, 26624
  s_nop 0
  buffer_load_dwordx4 v0, s[8:11], s43 offen lds
  s_add_u32 s43, s83, 0
  s_add_u32 m0, s84, 24576
  s_nop 0
  buffer_load_dwordx4 v11, s[68:71], s43 offen lds
  s_add_u32 s43, s83, 16384
  s_add_u32 m0, s84, 25600
  s_nop 0
  buffer_load_dwordx4 v11, s[68:71], s43 offen lds
  s_add_u32 s43, s83, 1179648
  s_add_u32 m0, s84, 26624
  s_nop 0
  buffer_load_dwordx4 v11, s[68:71], s43 offen lds
  s_add_u32 s43, s83, 1196032
  s_add_u32 m0, s84, 27648
  s_nop 0
  buffer_load_dwordx4 v11, s[68:71], s43 offen lds
  s_add_u32 s43, s83, 2359296
  s_add_u32 m0, s84, 28672
  s_nop 0
  buffer_load_dwordx4 v11, s[68:71], s43 offen lds
  s_add_u32 s43, s83, 2375680
  s_add_u32 m0, s84, 29696
  s_nop 0
  buffer_load_dwordx4 v11, s[68:71], s43 offen lds
  s_add_u32 s43, s83, 3538944
  s_add_u32 m0, s84, 30720
  s_nop 0
  buffer_load_dwordx4 v11, s[68:71], s43 offen lds
  s_add_u32 s43, s83, 3555328
  s_add_u32 m0, s84, 31744
  s_nop 0
  buffer_load_dwordx4 v11, s[68:71], s43 offen lds
  s_waitcnt vmcnt(31)
  s_barrier
  ds_write_b128 v2, v[62:65] offset:32768
  ds_write_b128 v2, v[66:69] offset:33792
  ds_write_b128 v2, v[70:73] offset:34816
  ds_write_b128 v2, v[76:79] offset:35840
  s_waitcnt lgkmcnt(0)
  ds_read_b64_tr_b16 v[62:63], v12 offset:0
  ds_read_b64_tr_b16 v[64:65], v12 offset:512
  ds_read_b64_tr_b16 v[66:67], v12 offset:4096
  ds_read_b64_tr_b16 v[68:69], v12 offset:4608
  ds_read_b64_tr_b16 v[70:71], v12 offset:32
  ds_read_b64_tr_b16 v[72:73], v12 offset:544
  ds_read_b64_tr_b16 v[76:77], v12 offset:4128
  ds_read_b64_tr_b16 v[78:79], v12 offset:4640
  ds_read_b64_tr_b16 a[0:1], v13 offset:0
  ds_read_b64_tr_b16 a[2:3], v13 offset:512
  ds_read_b64_tr_b16 a[4:5], v13 offset:4096
  ds_read_b64_tr_b16 a[6:7], v13 offset:4608
  ds_read_b64_tr_b16 a[8:9], v13 offset:32
  ds_read_b64_tr_b16 a[10:11], v13 offset:544
  ds_read_b64_tr_b16 a[12:13], v13 offset:4128
  ds_read_b64_tr_b16 a[14:15], v13 offset:4640
  s_waitcnt lgkmcnt(0)
  s_waitcnt vmcnt(23)
  s_barrier
  ds_write_b128 v2, v[62:65] offset:0
  ds_write_b128 v2, v[66:69] offset:1024
  ds_write_b128 v2, v[70:73] offset:2048
  ds_write_b128 v2, v[76:79] offset:3072
  s_waitcnt lgkmcnt(0)
  buffer_load_dword a16, off, s[12:15], 0 offset:128 sc1
  ds_read_b64_tr_b16 v[62:63], v12 offset:8192
  ds_read_b64_tr_b16 v[64:65], v12 offset:8704
  ds_read_b64_tr_b16 v[66:67], v12 offset:12288
  ds_read_b64_tr_b16 v[68:69], v12 offset:12800
  ds_read_b64_tr_b16 v[70:71], v12 offset:8224
  ds_read_b64_tr_b16 v[72:73], v12 offset:8736
  ds_read_b64_tr_b16 v[76:77], v12 offset:12320
  ds_read_b64_tr_b16 v[78:79], v12 offset:12832
  ds_read_b64_tr_b16 v[240:241], v13 offset:8192
  ds_read_b64_tr_b16 v[242:243], v13 offset:8704
  ds_read_b64_tr_b16 v[244:245], v13 offset:12288
  ds_read_b64_tr_b16 v[246:247], v13 offset:12800
  ds_read_b64_tr_b16 v[248:249], v13 offset:8224
  ds_read_b64_tr_b16 v[250:251], v13 offset:8736
  ds_read_b64_tr_b16 v[252:253], v13 offset:12320
  ds_read_b64_tr_b16 v[254:255], v13 offset:12832
  s_waitcnt lgkmcnt(0)
  s_waitcnt vmcnt(12)
  s_barrier
  ds_write_b128 v2, v[62:65] offset:4096
  ds_write_b128 v2, v[66:69] offset:5120
  ds_write_b128 v2, v[70:73] offset:6144
  ds_write_b128 v2, v[76:79] offset:7168
  s_waitcnt lgkmcnt(0)
  ds_read_b64_tr_b16 v[62:63], v12 offset:16384
  ds_read_b64_tr_b16 v[64:65], v12 offset:16896
  ds_read_b64_tr_b16 v[66:67], v12 offset:20480
  ds_read_b64_tr_b16 v[68:69], v12 offset:20992
  ds_read_b64_tr_b16 v[70:71], v12 offset:16416
  ds_read_b64_tr_b16 v[72:73], v12 offset:16928
  ds_read_b64_tr_b16 v[76:77], v12 offset:20512
  ds_read_b64_tr_b16 v[78:79], v12 offset:21024
  ds_read_b64_tr_b16 v[176:177], v13 offset:16384
  ds_read_b64_tr_b16 v[178:179], v13 offset:16896
  ds_read_b64_tr_b16 v[180:181], v13 offset:20480
  ds_read_b64_tr_b16 v[182:183], v13 offset:20992
  ds_read_b64_tr_b16 v[184:185], v13 offset:16416
  ds_read_b64_tr_b16 v[186:187], v13 offset:16928
  ds_read_b64_tr_b16 v[188:189], v13 offset:20512
  ds_read_b64_tr_b16 v[190:191], v13 offset:21024
  s_waitcnt lgkmcnt(0)
  s_waitcnt vmcnt(1)
  s_barrier
  ds_write_b128 v2, v[62:65] offset:8192
  ds_write_b128 v2, v[66:69] offset:9216
  ds_write_b128 v2, v[70:73] offset:10240
  ds_write_b128 v2, v[76:79] offset:11264
  s_waitcnt lgkmcnt(0)
  s_waitcnt vmcnt(0)
  v_accvgpr_read_b32 v76, a16
  s_nop 0
  v_readfirstlane_b32 s96, v76
  ds_read_b64_tr_b16 a[16:17], v12 offset:24576
  ds_read_b64_tr_b16 a[18:19], v12 offset:25088
  ds_read_b64_tr_b16 a[20:21], v12 offset:28672
  ds_read_b64_tr_b16 a[22:23], v12 offset:29184
  ds_read_b64_tr_b16 a[24:25], v12 offset:24608
  ds_read_b64_tr_b16 a[26:27], v12 offset:25120
  ds_read_b64_tr_b16 a[28:29], v12 offset:28704
  ds_read_b64_tr_b16 a[30:31], v12 offset:29216
  ds_read_b64_tr_b16 v[62:63], v13 offset:24576
  ds_read_b64_tr_b16 v[64:65], v13 offset:25088
  ds_read_b64_tr_b16 v[66:67], v13 offset:28672
  ds_read_b64_tr_b16 v[68:69], v13 offset:29184
  ds_read_b64_tr_b16 v[70:71], v13 offset:24608
  ds_read_b64_tr_b16 v[72:73], v13 offset:25120
  ds_read_b64_tr_b16 v[76:77], v13 offset:28704
  ds_read_b64_tr_b16 v[78:79], v13 offset:29216
  s_waitcnt lgkmcnt(0)
  s_barrier
  v_add_u32 v13, s85, v12
  ds_write_b128 v2, v[14:17] offset:20480
  ds_write_b128 v2, v[18:21] offset:21504
  ds_write_b128 v2, v[22:25] offset:22528
  ds_write_b128 v2, v[26:29] offset:23552
  ds_write_b128 v2, v[30:33] offset:24576
  ds_write_b128 v2, v[34:37] offset:25600
  ds_write_b128 v2, v[38:41] offset:26624
  ds_write_b128 v2, v[42:45] offset:27648
  ds_write_b128 v2, v[46:49] offset:28672
  ds_write_b128 v2, v[50:53] offset:29696
  ds_write_b128 v2, v[54:57] offset:30720
  ds_write_b128 v2, v[58:61] offset:31744
  ds_write_b128 v2, v[62:65] offset:12288
  ds_write_b128 v2, v[66:69] offset:13312
  ds_write_b128 v2, v[70:73] offset:14336
  ds_write_b128 v2, v[76:79] offset:15360
  s_waitcnt lgkmcnt(0)
  ds_read_b64_tr_b16 v[62:63], v13 offset:0
  ds_read_b64_tr_b16 v[64:65], v13 offset:512
  ds_read_b64_tr_b16 v[66:67], v13 offset:4096
  ds_read_b64_tr_b16 v[68:69], v13 offset:4608
  ds_read_b64_tr_b16 v[70:71], v13 offset:32
  ds_read_b64_tr_b16 v[72:73], v13 offset:544
  ds_read_b64_tr_b16 v[76:77], v13 offset:4128
  ds_read_b64_tr_b16 v[78:79], v13 offset:4640
  v_lshrrev_b32 v58, 4, v0
  v_and_b32 v59, 15, v58
  v_lshrrev_b32 v60, 4, v58
  v_lshrrev_b32 v61, 2, v59
  v_lshlrev_b32 v61, 1, v61
  v_and_b32 v57, 1, v59
  v_add_u32 v61, v61, v57
  v_mul_u32_u24 v61, 1152, v61
  v_mul_u32_u24 v60, 288, v60
  v_add_u32 v61, v61, v60
  v_bfe_u32 v57, v59, 1, 1
  v_lshl_add_u32 v61, v57, 4, v61
  s_lshl_b32 s43, s17, 5
  s_add_u32 s44, s43, 128
  s_movk_i32 s45, 256
  s_mov_b32 s86, 0x05040100
  s_mov_b32 s87, 0x07060302
  buffer_load_dwordx4 v[30:33], v61, s[8:11], s43 offen
  buffer_load_dwordx4 v[34:37], v61, s[8:11], s44 offen
  buffer_load_dwordx4 v[38:41], v61, s[8:11], s45 offen
  buffer_load_dwordx4 v[42:45], off, s[12:15], 0 sc1
  buffer_load_dword v46, off, s[12:15], 0 offset:128 sc1
  s_lshr_b32 s92, s16, 1
  s_add_u32 s92, s92, 32
  s_lshl_b32 s92, s92, 8
  s_add_u32 s92, s92, 0
  s_add_u32 s43, s92, 4096
  buffer_load_dword v47, off, s[4:7], s92 sc1
  buffer_load_dword v48, off, s[4:7], s43 sc1
  s_add_u32 s43, s92, 12288
  buffer_load_dword v49, off, s[4:7], s43 sc1
  s_add_u32 s43, s43, 4096
  buffer_load_dword v50, off, s[4:7], s43 sc1
  s_waitcnt lgkmcnt(0)
  s_barrier
  ds_write_b128 v2, v[62:65] offset:16384
  ds_write_b128 v2, v[66:69] offset:17408
  ds_write_b128 v2, v[70:73] offset:18432
  ds_write_b128 v2, v[76:79] offset:19456
  s_waitcnt lgkmcnt(0)
  ds_read_b128 v[58:61], v2 offset:32768
  ds_read_b128 v[62:65], v2 offset:33792
  ds_read_b128 v[66:69], v2 offset:34816
  ds_read_b128 v[70:73], v2 offset:35840
  s_mov_b32 s42, 0
L_cb_chk:
  s_waitcnt vmcnt(0)
  v_readfirstlane_b32 s43, v45
  v_readfirstlane_b32 s19, v44
  v_readfirstlane_b32 s45, v46
  v_min_u32 v47, v47, v48
  v_min_u32 v49, v49, v50
  s_cmp_lt_u32 s96, 64
  s_cselect_b32 s43, 0, s43
  s_mov_b32 s96, s45
  v_readfirstlane_b32 s90, v47
  v_readfirstlane_b32 s91, v49
  s_cmp_eq_u32 s90, 0
  s_cselect_b32 s43, 0, s43
  s_cmp_ge_u32 s43, 32
  s_cbranch_scc1 L_cb_ok
  s_add_u32 s42, s42, 1
  s_cmp_lt_u32 s42, 400000
  s_cbranch_scc0 L_fail_far
  buffer_load_dwordx4 v[42:45], off, s[12:15], 0 sc1
  buffer_load_dword v46, off, s[12:15], 0 offset:128 sc1
  s_lshr_b32 s92, s16, 1
  s_add_u32 s92, s92, 32
  s_lshl_b32 s92, s92, 8
  s_add_u32 s92, s92, 0
  s_add_u32 s43, s92, 4096
  buffer_load_dword v47, off, s[4:7], s92 sc1
  buffer_load_dword v48, off, s[4:7], s43 sc1
  s_add_u32 s43, s92, 12288
  buffer_load_dword v49, off, s[4:7], s43 sc1
  s_add_u32 s43, s43, 4096
  buffer_load_dword v50, off, s[4:7], s43 sc1
  s_branch L_cb_chk
L_fail_far:
  s_branch L_fail
L_cb_ok:
  v_perm_b32 v14, v32, v30, s86
  v_perm_b32 v15, v32, v30, s87
  v_perm_b32 v16, v33, v31, s86
  v_perm_b32 v17, v33, v31, s87
  v_perm_b32 v18, v36, v34, s86
  v_perm_b32 v19, v36, v34, s87
  v_perm_b32 v20, v37, v35, s86
  v_perm_b32 v21, v37, v35, s87
  v_perm_b32 v22, v40, v38, s86
  v_perm_b32 v23, v40, v38, s87
  v_perm_b32 v24, v41, v39, s86
  v_perm_b32 v25, v41, v39, s87
  v_mov_b64 v[34:35], s[94:95]
  v_mov_b64 v[36:37], s[94:95]
  v_mov_b64 v[38:39], s[94:95]
  v_mov_b64 v[40:41], s[94:95]
  v_mov_b64 v[42:43], s[94:95]
  v_mov_b64 v[44:45], s[94:95]
  v_mov_b64 v[46:47], s[94:95]
  v_mov_b64 v[48:49], s[94:95]
  v_mov_b64 v[50:51], s[94:95]
  v_mov_b64 v[52:53], s[94:95]
  v_mov_b64 v[54:55], s[94:95]
  v_mov_b64 v[56:57], s[94:95]
  v_mov_b64 v[76:77], s[100:101]
  v_mov_b64 v[78:79], s[100:101]
  v_xor_b32 v12, 1024, v1
  v_xor_b32 v13, 2048, v1
  v_xor_b32 v11, 3072, v1
  s_mov_b32 m0, 8192
  s_waitcnt lgkmcnt(0)
  s_cmp_lg_u32 s19, 0
  s_cbranch_scc1 L_got2_s
  s_branch L_got2_f
L_got_f:
  s_cbranch_scc1 L_last_f
L_got2_f:
  v_smfmac_f32_16x16x64_bf16 v[34:37], v[14:17], v[58:65], v8
  ds_write_b128 v1, v[14:17]
  s_add_u32 s43, s18, 1
  s_min_u32 s43, s43, 63
  s_lshr_b32 s93, s43, 1
  s_bitcmp1_b32 s43, 0
  s_cselect_b32 s44, s91, s90
  s_cmp_gt_u32 s44, s93
  s_cbranch_scc0 L_qr_72
L_qr_73:
  s_add_u32 s44, s38, 262144
  v_smfmac_f32_16x16x64_bf16 v[38:41], v[14:17], v[66:73], v8
  ds_write_b128 v1, v[18:21] offset:4096
  buffer_load_dword v10, s[4:7], s44 offen lds
  v_smfmac_f32_16x16x64_bf16 v[42:45], v[14:17], v[192:199], v8
  ds_read_b128 v[58:61], v2 offset:0
  s_bitcmp1_b32 s18, 0
  s_cselect_b32 s86, 12288, 0
  v_smfmac_f32_16x16x64_bf16 v[46:49], v[14:17], v[200:207], v8
  ds_read_b128 v[62:65], v2 offset:1024
  s_add_u32 s86, s86, s92
  s_add_u32 s87, s86, 3584
  v_smfmac_f32_16x16x64_bf16 v[50:53], v[14:17], a[32:39], v8
  ds_read_b128 v[66:69], v2 offset:2048
  s_sub_u32 s86, s86, 256
  v_smfmac_f32_16x16x64_bf16 v[54:57], v[14:17], a[40:47], v8
  ds_read_b128 v[70:73], v2 offset:3072
  buffer_load_dword off, s[4:7], s86 offset:256 sc1 lds
  v_smfmac_f32_16x16x64_bf16 v[34:37], v[18:21], v[80:87], v8
  buffer_load_dword off, s[4:7], s87 offset:512 sc1 lds
  v_smfmac_f32_16x16x64_bf16 v[38:41], v[18:21], v[88:95], v8
  s_waitcnt lgkmcnt(4)
  s_barrier
  ds_read_b128 v[26:29], v12 offset:0
  s_waitcnt lgkmcnt(3)
  v_smfmac_f32_16x16x64_bf16 v[42:45], v[18:21], v[58:65], v8
  ds_read_b128 v[30:33], v13 offset:0
  s_xor_b32 s34, s34, 524288
  s_xor_b32 s35, s35, 524288
  s_waitcnt lgkmcnt(2)
  v_smfmac_f32_16x16x64_bf16 v[46:49], v[18:21], v[66:73], v8
  ds_read_b128 v[58:61], v2 offset:16384
  s_xor_b32 s36, s36, 524288
  s_xor_b32 s37, s37, 524288
  v_smfmac_f32_16x16x64_bf16 v[50:53], v[18:21], a[48:55], v8
  ds_read_b128 v[62:65], v2 offset:17408
  s_xor_b32 s33, s33, 524288
  s_add_u32 s43, s18, 1
  v_smfmac_f32_16x16x64_bf16 v[54:57], v[18:21], a[56:63], v8
  ds_read_b128 v[66:69], v2 offset:18432
  s_and_b32 s43, s43, 3
  s_lshl_b32 s43, s43, 14
  v_smfmac_f32_16x16x64_bf16 v[34:37], v[22:25], v[96:103], v8
  ds_read_b128 v[70:73], v2 offset:19456
  s_add_u32 s31, s62, s43
  s_add_u32 s28, s63, s43
  v_smfmac_f32_16x16x64_bf16 v[38:41], v[22:25], v[104:111], v8
  ds_read_b128 v[14:17], v11 offset:0
  s_add_u32 s29, s28, 4096
  s_add_u32 s30, s43, 73728
  v_smfmac_f32_16x16x64_bf16 v[42:45], v[22:25], v[208:215], v8
  ds_read_b128 v[18:21], v12 offset:4096
  v_smfmac_f32_16x16x64_bf16 v[46:49], v[22:25], v[216:223], v8
  s_waitcnt lgkmcnt(4)
  v_smfmac_f32_16x16x64_bf16 v[50:53], v[22:25], v[58:65], v8
  s_waitcnt lgkmcnt(2)
  v_smfmac_f32_16x16x64_bf16 v[54:57], v[22:25], v[66:73], v8
  ds_read_b128 v[58:61], v2 offset:4096
  v_smfmac_f32_16x16x64_bf16 v[34:37], v[26:29], v[112:119], v8
  ds_read_b128 v[62:65], v2 offset:5120
  ds_read_b128 v[22:25], v13 offset:4096
  v_smfmac_f32_16x16x64_bf16 v[38:41], v[26:29], v[120:127], v8
  ds_read_b128 v[66:69], v2 offset:6144
  v_smfmac_f32_16x16x64_bf16 v[42:45], v[26:29], v[224:231], v8
  ds_read_b128 v[70:73], v2 offset:7168
  v_smfmac_f32_16x16x64_bf16 v[46:49], v[26:29], v[232:239], v8
  v_smfmac_f32_16x16x64_bf16 v[34:37], v[30:33], v[128:135], v8
  ds_read_b128 v[26:29], v11 offset:4096
  v_smfmac_f32_16x16x64_bf16 v[38:41], v[30:33], v[136:143], v8
  s_waitcnt lgkmcnt(4)
  v_smfmac_f32_16x16x64_bf16 v[42:45], v[30:33], v[58:65], v8
  s_waitcnt lgkmcnt(1)
  v_smfmac_f32_16x16x64_bf16 v[46:49], v[30:33], v[66:73], v8
  ds_read_b128 v[58:61], v2 offset:8192
  buffer_load_dwordx4 v[30:33], v0, s[4:7], s38 offen
  v_smfmac_f32_16x16x64_bf16 v[34:37], v[14:17], v[144:151], v8
  ds_read_b128 v[62:65], v2 offset:9216
  v_smfmac_f32_16x16x64_bf16 v[38:41], v[14:17], v[152:159], v8
  ds_read_b128 v[66:69], v2 offset:10240
  v_smfmac_f32_16x16x64_bf16 v[42:45], v[14:17], v[240:247], v8
  ds_read_b128 v[70:73], v2 offset:11264
  v_smfmac_f32_16x16x64_bf16 v[46:49], v[14:17], v[248:255], v8
  buffer_load_dwordx4 v[14:17], v0, s[4:7], s38 offen offset:1024
  v_smfmac_f32_16x16x64_bf16 v[34:37], v[18:21], v[160:167], v8
  v_smfmac_f32_16x16x64_bf16 v[38:41], v[18:21], v[168:175], v8
  s_waitcnt lgkmcnt(2)
  v_smfmac_f32_16x16x64_bf16 v[34:37], v[22:25], v[58:65], v8
  s_waitcnt lgkmcnt(0)
  v_smfmac_f32_16x16x64_bf16 v[38:41], v[22:25], v[66:73], v8
  ds_read_b128 v[58:61], v2 offset:12288
  v_smfmac_f32_16x16x64_bf16 v[34:37], v[26:29], v[176:183], v8
  ds_read_b128 v[62:65], v2 offset:13312
  v_smfmac_f32_16x16x64_bf16 v[38:41], v[26:29], v[184:191], v8
  ds_read_b128 v[66:69], v2 offset:14336
  v_smfmac_f32_16x16x64_bf16 v[42:45], v[18:21], a[0:7], v8
  ds_read_b128 v[70:73], v2 offset:15360
  v_smfmac_f32_16x16x64_bf16 v[46:49], v[18:21], a[8:15], v8
  v_cvt_pk_bf16_f32 v34, v34, v35
  v_smfmac_f32_16x16x64_bf16 v[42:45], v[22:25], a[16:23], v8
  v_cvt_pk_bf16_f32 v35, v36, v37
  v_smfmac_f32_16x16x64_bf16 v[46:49], v[22:25], a[24:31], v8
  v_cvt_pk_bf16_f32 v36, v38, v39
  s_waitcnt lgkmcnt(2)
  v_smfmac_f32_16x16x64_bf16 v[42:45], v[26:29], v[58:65], v8
  v_cvt_pk_bf16_f32 v37, v40, v41
  s_waitcnt lgkmcnt(0)
  v_smfmac_f32_16x16x64_bf16 v[46:49], v[26:29], v[66:73], v8
  v_mfma_f32_16x16x16_bf16 v[38:41], v[36:37], v[74:75], 0
  v_mfma_f32_16x16x16_bf16 v[34:37], v[34:35], v[74:75], 0
  v_smfmac_f32_16x16x64_bf16 v[50:53], v[18:21], a[112:119], v8
  v_cvt_pk_bf16_f32 v42, v42, v43
  v_cvt_pk_bf16_f32 v43, v44, v45
  v_smfmac_f32_16x16x64_bf16 v[54:57], v[18:21], a[120:127], v8
  ds_read_b128 v[18:21], v12 offset:0
  v_cvt_pk_bf16_f32 v44, v46, v47
  v_cvt_pk_bf16_f32 v45, v48, v49
  v_cvt_pk_bf16_f32 v41, v40, v41
  v_cvt_pk_bf16_f32 v40, v38, v39
  v_mfma_f32_16x16x16_bf16 v[46:49], v[44:45], v[74:75], 0
  v_mfma_f32_16x16x16_bf16 v[42:45], v[42:43], v[74:75], 0
  v_cvt_pk_bf16_f32 v38, v34, v35
  v_cvt_pk_bf16_f32 v39, v36, v37
  s_waitcnt vmcnt(0)
  s_nop 0
  v_mfma_f32_16x16x32_bf16 v[34:37], v[30:33], v[38:41], 0
  v_mfma_f32_16x16x32_bf16 v[58:61], v[14:17], v[38:41], 0
  v_cvt_pk_bf16_f32 v49, v48, v49
  v_cvt_pk_bf16_f32 v48, v46, v47
  v_cvt_pk_bf16_f32 v46, v42, v43
  v_cvt_pk_bf16_f32 v47, v44, v45
  buffer_load_dwordx4 v[42:45], v0, s[4:7], s39 offen offset:1024
  s_nop 0
  v_mfma_f32_16x16x32_bf16 v[62:65], v[46:49], v[38:41], 0
  v_smfmac_f32_16x16x64_bf16 v[50:53], v[22:25], a[128:135], v8
  v_cndmask_b32 v30, v34, v58, s[52:53]
  v_cndmask_b32 v31, v35, v59, s[52:53]
  v_cndmask_b32 v32, v36, v60, s[52:53]
  v_cndmask_b32 v33, v37, v61, s[52:53]
  ds_write_b128 v1, v[30:33] offset:9216
  buffer_load_dwordx4 v[34:37], v0, s[4:7], s39 offen
  ds_write_b64 v3, v[62:63]
  v_smfmac_f32_16x16x64_bf16 v[54:57], v[22:25], a[136:143], v8
  ds_read_b128 v[22:25], v13 offset:0
  buffer_store_dwordx4 v[46:49], v0, s[4:7], s40 offen sc1
  v_mov_b32 v76, s18
  v_smfmac_f32_16x16x64_bf16 v[50:53], v[26:29], a[144:151], v8
  buffer_store_dword v76, v0, s[24:27], 0 offen sc1
  v_and_b32 v38, -32, v3
  v_smfmac_f32_16x16x64_bf16 v[54:57], v[26:29], a[152:159], v8
  ds_read_b128 v[26:29], v11 offset:0
  s_waitcnt lgkmcnt(4)
  v_smfmac_f32_16x16x64_bf16 v[50:53], v[18:21], a[64:71], v8
  s_waitcnt lgkmcnt(2)
  s_barrier
  ds_read_b128 v[66:69], v12 offset:9216
  ds_read_b128 v[70:73], v13 offset:9216
  ds_read_b128 v[58:61], v11 offset:9216
  ds_read_b128 v[62:65], v38
  ds_read_b128 v[76:79], v38 offset:16
  v_smfmac_f32_16x16x64_bf16 v[54:57], v[18:21], a[72:79], v8
  s_add_u32 s44, s39, 262144
  buffer_load_dword v10, s[4:7], s44 offen lds
  s_waitcnt lgkmcnt(6)
  v_smfmac_f32_16x16x64_bf16 v[50:53], v[22:25], a[80:87], v8
  v_smfmac_f32_16x16x64_bf16 v[54:57], v[22:25], a[88:95], v8
  s_waitcnt lgkmcnt(5)
  v_smfmac_f32_16x16x64_bf16 v[50:53], v[26:29], a[96:103], v8
  v_smfmac_f32_16x16x64_bf16 v[54:57], v[26:29], a[104:111], v8
  v_mov_b64 v[14:15], s[48:49]
  v_mov_b64 v[16:17], s[48:49]
  v_mov_b64 v[46:47], s[50:51]
  s_waitcnt lgkmcnt(4)
  v_pk_add_f32 v[66:67], v[30:31], v[66:67]
  v_pk_add_f32 v[68:69], v[32:33], v[68:69]
  s_waitcnt lgkmcnt(2)
  v_pk_add_f32 v[70:71], v[70:71], v[58:59]
  v_pk_add_f32 v[72:73], v[72:73], v[60:61]
  s_waitcnt lgkmcnt(0)
  v_pk_add_f32 v[62:63], v[62:63], v[64:65]
  v_pk_add_f32 v[76:77], v[76:77], v[78:79]
  v_pk_add_f32 v[66:67], v[66:67], v[70:71]
  v_pk_add_f32 v[68:69], v[68:69], v[72:73]
  v_pk_add_f32 v[62:63], v[62:63], v[76:77]
  v_max3_f32 v12, v66, v67, v68
  v_max3_f32 v13, v69, v62, v63
  v_max_f32 v12, v12, v13
  s_nop 1
  v_max_f32_dpp v12, v12, v12 quad_perm:[2,3,0,1] row_mask:0xf bank_mask:0xf
  v_cvt_pk_bf16_f32 v50, v50, v51
  v_mov_b32 v13, v12
  v_cvt_pk_bf16_f32 v51, v52, v53
  v_cvt_pk_bf16_f32 v52, v54, v55
  v_permlane16_swap_b32 v12, v13
  v_cvt_pk_bf16_f32 v53, v56, v57
  v_max_f32 v12, v12, v13
  v_mov_b32 v13, v12
  buffer_store_dwordx4 v[50:53], v0, s[4:7], s41 offen sc1
  s_nop 0
  v_permlane32_swap_b32 v12, v13
  v_max_f32 v12, v12, v13
  v_mul_f32 v12, s46, v12
  v_pk_fma_f32 v[66:67], v[66:67], s[46:47], v[12:13] op_sel_hi:[1,1,0] neg_lo:[0,0,1] neg_hi:[0,0,1]
  v_pk_fma_f32 v[68:69], v[68:69], s[46:47], v[12:13] op_sel_hi:[1,1,0] neg_lo:[0,0,1] neg_hi:[0,0,1]
  v_pk_fma_f32 v[62:63], v[62:63], s[46:47], v[12:13] op_sel_hi:[1,1,0] neg_lo:[0,0,1] neg_hi:[0,0,1]
  v_exp_f32 v66, v66
  v_exp_f32 v67, v67
  v_exp_f32 v68, v68
  v_exp_f32 v69, v69
  v_exp_f32 v62, v62
  v_exp_f32 v63, v63
  v_cvt_pk_bf16_f32 v66, v66, v67
  v_cvt_pk_bf16_f32 v67, v68, v69
  v_cvt_pk_bf16_f32 v62, v62, v63
  v_mov_b32_dpp v68, v66 quad_perm:[2,3,0,1] row_mask:0xf bank_mask:0xf
  v_mov_b32_dpp v69, v67 quad_perm:[2,3,0,1] row_mask:0xf bank_mask:0xf
  v_mov_b32 v63, v62
  s_waitcnt vmcnt(4)
  v_mfma_f32_16x16x32_bf16 v[18:21], v[14:17], v[66:69], 0
  v_mfma_f32_16x16x32_bf16 v[22:25], v[34:37], v[66:69], 0
  v_mfma_f32_16x16x32_bf16 v[26:29], v[42:45], v[66:69], 0
  v_mfma_f32_16x16x16_bf16 v[18:21], v[46:47], v[62:63], v[18:21]
  v_mfma_f32_16x16x16_bf16 v[22:25], v[50:51], v[62:63], v[22:25]
  v_mfma_f32_16x16x16_bf16 v[26:29], v[52:53], v[62:63], v[26:29]
  v_rcp_f32 v12, v18
  s_nop 2
  v_pk_mul_f32 v[22:23], v[22:23], v[12:13] op_sel_hi:[1,0]
  v_pk_mul_f32 v[24:25], v[24:25], v[12:13] op_sel_hi:[1,0]
  s_nop 1
  v_pk_mul_f32 v[26:27], v[26:27], v[12:13] op_sel_hi:[1,0]
  v_pk_mul_f32 v[28:29], v[28:29], v[12:13] op_sel_hi:[1,0]
  v_cvt_pk_bf16_f32 v54, v22, v23
  v_cvt_pk_bf16_f32 v55, v24, v25
  v_cvt_pk_bf16_f32 v56, v26, v27
  v_cvt_pk_bf16_f32 v57, v28, v29
  s_andn2_b64 exec, exec, s[52:53]
  ds_write_b128 v4, v[54:57]
  s_mov_b64 exec, -1
  ds_read_b128 v[58:61], v2 offset:20480
  ds_read_b128 v[62:65], v2 offset:21504
  ds_read_b128 v[66:69], v2 offset:22528
  ds_read_b128 v[70:73], v2 offset:23552
  v_mov_b64 v[14:15], s[94:95]
  v_mov_b64 v[16:17], s[94:95]
  v_mov_b64 v[18:19], s[94:95]
  v_mov_b64 v[20:21], s[94:95]
  v_mov_b64 v[22:23], s[94:95]
  v_mov_b64 v[24:25], s[94:95]
  v_mov_b64 v[26:27], s[94:95]
  v_mov_b64 v[28:29], s[94:95]
  v_mov_b64 v[30:31], s[94:95]
  v_mov_b64 v[32:33], s[94:95]
  s_waitcnt lgkmcnt(4)
  s_barrier
  ds_read_b128 v[50:53], v0 offset:14336
  ds_read_b128 v[54:57], v0 offset:15360
  v_mov_b64 v[34:35], s[94:95]
  v_mov_b64 v[36:37], s[94:95]
  v_mov_b64 v[38:39], s[94:95]
  v_mov_b64 v[40:41], s[94:95]
  v_mov_b64 v[42:43], s[94:95]
  v_mov_b64 v[44:45], s[94:95]
  v_mov_b64 v[46:47], s[94:95]
  v_mov_b64 v[48:49], s[94:95]
  s_add_u32 s38, s38, 262144
  s_add_u32 s39, s39, 262144
  s_add_u32 s40, s40, 131072
  s_add_u32 s41, s41, 131072
  s_waitcnt lgkmcnt(1)
  v_smfmac_f32_16x16x64_bf16 v[14:17], v[50:53], v[58:65], v8
  s_waitcnt lgkmcnt(0)
  v_smfmac_f32_16x16x64_bf16 v[14:17], v[54:57], v[66:73], v8
  ds_read_b128 v[58:61], v2 offset:24576
  ds_read_b32 v76, v0 offset:8448
  v_smfmac_f32_16x16x64_bf16 v[18:21], v[50:53], a[160:167], v8
  ds_read_b128 v[62:65], v2 offset:25600
  ds_read_b128 v[66:69], v2 offset:26624
  ds_read_b32 v77, v0 offset:8704
  v_smfmac_f32_16x16x64_bf16 v[18:21], v[54:57], a[168:175], v8
  ds_read_b128 v[70:73], v2 offset:27648
  v_add_f32 v14, v14, v16
  v_add_f32 v15, v15, v17
  v_smfmac_f32_16x16x64_bf16 v[22:25], v[50:53], a[176:183], v8
  v_cvt_pk_bf16_f32 v14, v14, v15
  v_smfmac_f32_16x16x64_bf16 v[22:25], v[54:57], a[184:191], v8
  buffer_store_dword v14, v5, s[4:7], s33 offen offset:0
  v_add_f32 v18, v18, v20
  v_add_f32 v19, v19, v21
  v_smfmac_f32_16x16x64_bf16 v[26:29], v[50:53], a[192:199], v8
  v_cvt_pk_bf16_f32 v18, v18, v19
  v_smfmac_f32_16x16x64_bf16 v[26:29], v[54:57], a[200:207], v8
  buffer_store_dword v18, v5, s[4:7], s33 offen offset:256
  v_add_f32 v22, v22, v24
  v_add_f32 v23, v23, v25
  s_waitcnt lgkmcnt(3)
  v_smfmac_f32_16x16x64_bf16 v[30:33], v[50:53], v[58:65], v8
  v_cvt_pk_bf16_f32 v22, v22, v23
  s_waitcnt lgkmcnt(0)
  v_smfmac_f32_16x16x64_bf16 v[30:33], v[54:57], v[66:73], v8
  buffer_store_dword v22, v5, s[4:7], s33 offen offset:512
  ds_read_b128 v[58:61], v2 offset:28672
  v_add_f32 v26, v26, v28
  v_add_f32 v27, v27, v29
  v_min_u32 v76, v76, v77
  v_smfmac_f32_16x16x64_bf16 v[34:37], v[50:53], a[208:215], v8
  ds_read_b128 v[62:65], v2 offset:29696
  ds_read_b128 v[66:69], v2 offset:30720
  v_cvt_pk_bf16_f32 v26, v26, v27
  v_readfirstlane_b32 s86, v76
  v_smfmac_f32_16x16x64_bf16 v[34:37], v[54:57], a[216:223], v8
  buffer_store_dword v26, v5, s[4:7], s33 offen offset:768
  ds_read_b128 v[70:73], v2 offset:31744
  s_bitcmp1_b32 s18, 0
  v_add_f32 v30, v30, v32
  v_add_f32 v31, v31, v33
  v_smfmac_f32_16x16x64_bf16 v[38:41], v[50:53], a[224:231], v8
  s_cselect_b32 s91, s86, s91
  v_cvt_pk_bf16_f32 v30, v30, v31
  v_smfmac_f32_16x16x64_bf16 v[38:41], v[54:57], a[232:239], v8
  buffer_store_dword v30, v5, s[4:7], s33 offen offset:1024
  s_cselect_b32 s90, s90, s86
  v_add_f32 v34, v34, v36
  v_add_f32 v35, v35, v37
  v_smfmac_f32_16x16x64_bf16 v[42:45], v[50:53], a[240:247], v8
  v_cvt_pk_bf16_f32 v34, v34, v35
  v_smfmac_f32_16x16x64_bf16 v[42:45], v[54:57], a[248:255], v8
  buffer_store_dword v34, v5, s[4:7], s33 offen offset:1280
  v_add_f32 v38, v38, v40
  v_add_f32 v39, v39, v41
  s_waitcnt lgkmcnt(2)
  v_smfmac_f32_16x16x64_bf16 v[46:49], v[50:53], v[58:65], v8
  v_cvt_pk_bf16_f32 v38, v38, v39
  s_waitcnt lgkmcnt(0)
  v_smfmac_f32_16x16x64_bf16 v[46:49], v[54:57], v[66:73], v8
  buffer_store_dword v38, v5, s[4:7], s33 offen offset:1536
  v_add_f32 v42, v42, v44
  v_add_f32 v43, v43, v45
  v_cvt_pk_bf16_f32 v42, v42, v43
  s_nop 3
  v_add_f32 v46, v46, v48
  v_add_f32 v47, v47, v49
  buffer_store_dword v42, v5, s[4:7], s33 offen offset:1792
  v_cvt_pk_bf16_f32 v46, v46, v47
  buffer_store_dword v46, v5, s[4:7], s33 offen offset:2048
  s_add_u32 s18, s18, 1
  s_cmp_eq_u32 s22, 0
  s_cbranch_scc1 L_nu_f
  s_mov_b32 s42, 0
  v_cndmask_b32 v76, 0, v9, s[54:55]
  v_cndmask_b32 v77, 0, v9, s[56:57]
  v_cndmask_b32 v78, 0, v9, s[58:59]
  v_cndmask_b32 v79, 0, v9, s[60:61]
  buffer_load_dwordx4 v[14:17], v6, s[20:23], s34 offen sc1
  buffer_load_dwordx4 v[18:21], v6, s[20:23], s35 offen sc1
  buffer_load_dwordx4 v[22:25], v6, s[20:23], s36 offen sc1
  buffer_load_dwordx4 v[26:29], v6, s[20:23], s37 offen sc1
  v_mov_b64 v[34:35], s[94:95]
  v_mov_b64 v[36:37], s[94:95]
  v_mov_b64 v[38:39], s[94:95]
  v_mov_b64 v[40:41], s[94:95]
  v_mov_b64 v[42:43], s[94:95]
  v_mov_b64 v[44:45], s[94:95]
  v_mov_b64 v[46:47], s[94:95]
  v_mov_b64 v[48:49], s[94:95]
  buffer_load_dwordx4 v[14:17], v6, s[20:23], s34 offen sc1
  buffer_load_dwordx4 v[18:21], v6, s[20:23], s35 offen sc1
  buffer_load_dwordx4 v[22:25], v6, s[20:23], s36 offen sc1
  buffer_load_dwordx4 v[26:29], v6, s[20:23], s37 offen sc1
  s_waitcnt vmcnt(7)
  v_max3_u32 v12, v14, v15, v16
  v_max_u32 v12, v12, v17
  v_mfma_f32_16x16x32_bf16 v[30:33], v[14:17], v[76:79], 0
  s_waitcnt vmcnt(6)
  v_max3_u32 v12, v12, v18, v19
  v_max3_u32 v12, v12, v20, v21
  v_mfma_f32_16x16x32_bf16 v[30:33], v[18:21], v[76:79], v[30:33]
  s_waitcnt vmcnt(5)
  v_max3_u32 v12, v12, v22, v23
  v_max3_u32 v12, v12, v24, v25
  v_mfma_f32_16x16x32_bf16 v[30:33], v[22:25], v[76:79], v[30:33]
  s_waitcnt vmcnt(4)
  v_max3_u32 v12, v12, v26, v27
  v_max3_u32 v12, v12, v28, v29
  v_mfma_f32_16x16x32_bf16 v[30:33], v[26:29], v[76:79], v[30:33]
  v_cmp_eq_u32 vcc, -1, v12
  s_cbranch_vccnz L_rretry_f
L_rgot_f:
  s_nop 5
  v_add_f32 v30, v30, v32
  v_add_f32 v31, v31, v33
  v_xor_b32 v12, 1024, v1
  v_cvt_pk_bf16_f32 v30, v30, v31
  v_xor_b32 v13, 2048, v1
  s_mov_b32 s42, 0
  buffer_store_dword v30, v7, s[20:23], s31 offen
  ds_read_b128 v[58:61], v2 offset:32768
  ds_read_b128 v[62:65], v2 offset:33792
  ds_read_b128 v[66:69], v2 offset:34816
  ds_read_b128 v[70:73], v2 offset:35840
  v_mov_b64 v[50:51], s[94:95]
  v_mov_b64 v[52:53], s[94:95]
  v_mov_b64 v[54:55], s[94:95]
  v_mov_b64 v[56:57], s[94:95]
  v_xor_b32 v11, 3072, v1
L_gprep_f:
  s_barrier
  buffer_load_dwordx4 v[14:17], v0, s[4:7], s28 offen sc1
  buffer_load_dwordx4 v[18:21], v0, s[4:7], s29 offen sc1
  buffer_load_dwordx4 v[22:25], v0, s[4:7], s30 offen sc1
  s_cmp_eq_u32 s18, 63
  s_waitcnt vmcnt(0) lgkmcnt(0)
  v_max3_u32 v26, v14, v15, v16
  v_max3_u32 v27, v17, v18, v19
  v_max3_u32 v26, v26, v20, v21
  v_max3_u32 v27, v27, v22, v23
  v_max3_u32 v26, v26, v24, v25
  v_max_u32 v26, v26, v27
  v_cmp_eq_u32 vcc, -1, v26
  s_cbranch_vccz L_got_f
L_gretry_f:
  buffer_load_dwordx4 v[14:17], v0, s[4:7], s28 offen sc1
  buffer_load_dwordx4 v[18:21], v0, s[4:7], s29 offen sc1
  buffer_load_dwordx4 v[22:25], v0, s[4:7], s30 offen sc1
  s_add_u32 s42, s42, 1
  s_cmp_lt_u32 s42, 400000
  s_cbranch_scc0 L_fail
  s_cmp_eq_u32 s18, 63
  s_waitcnt vmcnt(0)
  v_max3_u32 v26, v14, v15, v16
  v_max3_u32 v27, v17, v18, v19
  v_max3_u32 v26, v26, v20, v21
  v_max3_u32 v27, v27, v22, v23
  v_max3_u32 v26, v26, v24, v25
  v_max_u32 v26, v26, v27
  v_cmp_eq_u32 vcc, -1, v26
  s_cbranch_vccz L_got_f
  s_branch L_gretry_f
L_nu_f:
  s_cmp_lg_u32 s17, 3
  s_cbranch_scc1 L_nr_75
  v_mov_b64 v[26:27], s[100:101]
  v_mov_b64 v[28:29], s[100:101]
  s_xor_b32 s43, s33, 524288
  s_sub_u32 s43, s43, 6912
  s_add_u32 s44, s18, 2
  s_and_b32 s44, s44, 3
  s_lshl_b32 s44, s44, 14
  s_add_u32 s44, s44, 65536
  buffer_store_dwordx4 v[26:29], v0, s[4:7], s43 offen offset:0
  buffer_store_dwordx4 v[26:29], v0, s[4:7], s43 offen offset:1024
  buffer_store_dwordx4 v[26:29], v0, s[4:7], s43 offen offset:2048
  buffer_store_dwordx4 v[26:29], v0, s[4:7], s43 offen offset:3072
  s_add_u32 s43, s43, 4096
  buffer_store_dwordx4 v[26:29], v0, s[4:7], s43 offen offset:0
  buffer_store_dwordx4 v[26:29], v0, s[4:7], s43 offen offset:1024
  buffer_store_dwordx4 v[26:29], v0, s[4:7], s43 offen offset:2048
  buffer_store_dwordx4 v[26:29], v0, s[4:7], s43 offen offset:3072
  s_add_u32 s43, s43, 4096
  buffer_store_dwordx4 v[26:29], v0, s[4:7], s43 offen offset:0
  buffer_store_dwordx2 v[26:27], v7, s[4:7], s44 offen
L_nr_75:
  v_xor_b32 v12, 1024, v1
  v_xor_b32 v13, 2048, v1
  v_xor_b32 v11, 3072, v1
  s_mov_b32 s42, 0
  ds_read_b128 v[58:61], v2 offset:32768
  ds_read_b128 v[62:65], v2 offset:33792
  ds_read_b128 v[66:69], v2 offset:34816
  ds_read_b128 v[70:73], v2 offset:35840
  v_mov_b64 v[34:35], s[94:95]
  v_mov_b64 v[36:37], s[94:95]
  v_mov_b64 v[38:39], s[94:95]
  v_mov_b64 v[40:41], s[94:95]
  v_mov_b64 v[42:43], s[94:95]
  v_mov_b64 v[44:45], s[94:95]
  v_mov_b64 v[46:47], s[94:95]
  v_mov_b64 v[48:49], s[94:95]
  v_mov_b64 v[50:51], s[94:95]
  v_mov_b64 v[52:53], s[94:95]
  v_mov_b64 v[54:55], s[94:95]
  v_mov_b64 v[56:57], s[94:95]
  s_branch L_gprep_f
L_rretry_f:
  buffer_load_dwordx4 v[14:17], v6, s[20:23], s34 offen sc1
  buffer_load_dwordx4 v[18:21], v6, s[20:23], s35 offen sc1
  buffer_load_dwordx4 v[22:25], v6, s[20:23], s36 offen sc1
  buffer_load_dwordx4 v[26:29], v6, s[20:23], s37 offen sc1
  s_add_u32 s42, s42, 1
  s_cmp_lt_u32 s42, 400000
  s_cbranch_scc0 L_fail
  s_waitcnt vmcnt(7)
  v_max3_u32 v12, v14, v15, v16
  v_max_u32 v12, v12, v17
  v_mfma_f32_16x16x32_bf16 v[30:33], v[14:17], v[76:79], 0
  s_waitcnt vmcnt(6)
  v_max3_u32 v12, v12, v18, v19
  v_max3_u32 v12, v12, v20, v21
  v_mfma_f32_16x16x32_bf16 v[30:33], v[18:21], v[76:79], v[30:33]
  s_waitcnt vmcnt(5)
  v_max3_u32 v12, v12, v22, v23
  v_max3_u32 v12, v12, v24, v25
  v_mfma_f32_16x16x32_bf16 v[30:33], v[22:25], v[76:79], v[30:33]
  s_waitcnt vmcnt(4)
  v_max3_u32 v12, v12, v26, v27
  v_max3_u32 v12, v12, v28, v29
  v_mfma_f32_16x16x32_bf16 v[30:33], v[26:29], v[76:79], v[30:33]
  v_cmp_eq_u32 vcc, -1, v12
  s_cbranch_vccz L_rgot_f
  s_branch L_rretry_f
L_qr_72:
  s_and_b32 s43, s43, 1
  s_mul_i32 s45, s43, 12288
  s_add_u32 s45, s45, s92
  s_mov_b32 s42, 0
L_qr_74:
  buffer_load_dword v77, off, s[4:7], s45 sc1
  s_add_u32 s44, s45, 4096
  buffer_load_dword v78, off, s[4:7], s44 sc1
  s_waitcnt vmcnt(0)
  v_min_u32 v77, v77, v78
  s_nop 0
  v_readfirstlane_b32 s44, v77
  s_cmp_eq_u32 s43, 0
  s_cselect_b32 s90, s44, s90
  s_cselect_b32 s91, s91, s44
  s_cmp_gt_u32 s44, s93
  s_cbranch_scc1 L_qr_73
  s_add_u32 s42, s42, 1
  s_cmp_lt_u32 s42, 400000
  s_cbranch_scc1 L_qr_74
  s_branch L_fail
L_last_f:
  v_mov_b32 v76, s18
  buffer_store_dword v76, v0, s[24:27], 0 offen sc1
  ds_write_b128 v1, v[14:17]
  ds_write_b128 v1, v[18:21] offset:4096
  ds_read_b128 v[58:61], v2 offset:0
  ds_read_b128 v[62:65], v2 offset:1024
  ds_read_b128 v[66:69], v2 offset:2048
  ds_read_b128 v[70:73], v2 offset:3072
  v_smfmac_f32_16x16x64_bf16 v[42:45], v[14:17], v[192:199], v8
  v_smfmac_f32_16x16x64_bf16 v[46:49], v[14:17], v[200:207], v8
  v_smfmac_f32_16x16x64_bf16 v[50:53], v[14:17], a[32:39], v8
  v_smfmac_f32_16x16x64_bf16 v[54:57], v[14:17], a[40:47], v8
  v_smfmac_f32_16x16x64_bf16 v[50:53], v[18:21], a[48:55], v8
  v_smfmac_f32_16x16x64_bf16 v[54:57], v[18:21], a[56:63], v8
  v_smfmac_f32_16x16x64_bf16 v[42:45], v[22:25], v[208:215], v8
  v_smfmac_f32_16x16x64_bf16 v[46:49], v[22:25], v[216:223], v8
  s_waitcnt lgkmcnt(4)
  s_barrier
  ds_read_b128 v[26:29], v12 offset:0
  ds_read_b128 v[30:33], v13 offset:0
  ds_read_b128 v[14:17], v11 offset:0
  s_waitcnt lgkmcnt(5)
  v_smfmac_f32_16x16x64_bf16 v[42:45], v[18:21], v[58:65], v8
  s_waitcnt lgkmcnt(3)
  v_smfmac_f32_16x16x64_bf16 v[46:49], v[18:21], v[66:73], v8
  ds_read_b128 v[58:61], v2 offset:16384
  ds_read_b128 v[62:65], v2 offset:17408
  ds_read_b128 v[66:69], v2 offset:18432
  ds_read_b128 v[70:73], v2 offset:19456
  ds_read_b128 v[18:21], v12 offset:4096
  s_waitcnt lgkmcnt(7)
  v_smfmac_f32_16x16x64_bf16 v[42:45], v[26:29], v[224:231], v8
  v_smfmac_f32_16x16x64_bf16 v[46:49], v[26:29], v[232:239], v8
  v_smfmac_f32_16x16x64_bf16 v[50:53], v[26:29], a[64:71], v8
  v_smfmac_f32_16x16x64_bf16 v[54:57], v[26:29], a[72:79], v8
  ds_read_b128 v[26:29], v11 offset:4096
  s_waitcnt lgkmcnt(4)
  v_smfmac_f32_16x16x64_bf16 v[50:53], v[22:25], v[58:65], v8
  s_waitcnt lgkmcnt(2)
  v_smfmac_f32_16x16x64_bf16 v[54:57], v[22:25], v[66:73], v8
  ds_read_b128 v[58:61], v2 offset:4096
  ds_read_b128 v[62:65], v2 offset:5120
  ds_read_b128 v[66:69], v2 offset:6144
  ds_read_b128 v[70:73], v2 offset:7168
  ds_read_b128 v[22:25], v13 offset:4096
  v_smfmac_f32_16x16x64_bf16 v[50:53], v[30:33], a[80:87], v8
  v_smfmac_f32_16x16x64_bf16 v[54:57], v[30:33], a[88:95], v8
  v_smfmac_f32_16x16x64_bf16 v[42:45], v[14:17], v[240:247], v8
  v_smfmac_f32_16x16x64_bf16 v[46:49], v[14:17], v[248:255], v8
  v_smfmac_f32_16x16x64_bf16 v[50:53], v[14:17], a[96:103], v8
  v_smfmac_f32_16x16x64_bf16 v[54:57], v[14:17], a[104:111], v8
  s_waitcnt lgkmcnt(3)
  v_smfmac_f32_16x16x64_bf16 v[42:45], v[30:33], v[58:65], v8
  s_waitcnt lgkmcnt(1)
  v_smfmac_f32_16x16x64_bf16 v[46:49], v[30:33], v[66:73], v8
  ds_read_b128 v[58:61], v2 offset:12288
  ds_read_b128 v[62:65], v2 offset:13312
  ds_read_b128 v[66:69], v2 offset:14336
  ds_read_b128 v[70:73], v2 offset:15360
  v_smfmac_f32_16x16x64_bf16 v[42:45], v[18:21], a[0:7], v8
  v_smfmac_f32_16x16x64_bf16 v[46:49], v[18:21], a[8:15], v8
  s_waitcnt lgkmcnt(4)
  v_smfmac_f32_16x16x64_bf16 v[42:45], v[22:25], a[16:23], v8
  v_smfmac_f32_16x16x64_bf16 v[46:49], v[22:25], a[24:31], v8
  v_smfmac_f32_16x16x64_bf16 v[50:53], v[18:21], a[112:119], v8
  v_smfmac_f32_16x16x64_bf16 v[54:57], v[18:21], a[120:127], v8
  s_waitcnt lgkmcnt(2)
  v_smfmac_f32_16x16x64_bf16 v[42:45], v[26:29], v[58:65], v8
  s_waitcnt lgkmcnt(0)
  v_smfmac_f32_16x16x64_bf16 v[46:49], v[26:29], v[66:73], v8
  v_smfmac_f32_16x16x64_bf16 v[50:53], v[22:25], a[128:135], v8
  v_smfmac_f32_16x16x64_bf16 v[54:57], v[22:25], a[136:143], v8
  v_cvt_pk_bf16_f32 v42, v42, v43
  v_cvt_pk_bf16_f32 v43, v44, v45
  v_cvt_pk_bf16_f32 v44, v46, v47
  v_cvt_pk_bf16_f32 v45, v48, v49
  s_nop 1
  v_mfma_f32_16x16x16_bf16 v[46:49], v[44:45], v[74:75], 0
  v_mfma_f32_16x16x16_bf16 v[42:45], v[42:43], v[74:75], 0
  v_smfmac_f32_16x16x64_bf16 v[50:53], v[26:29], a[144:151], v8
  v_smfmac_f32_16x16x64_bf16 v[54:57], v[26:29], a[152:159], v8
  v_cvt_pk_bf16_f32 v49, v48, v49
  v_cvt_pk_bf16_f32 v48, v46, v47
  v_cvt_pk_bf16_f32 v46, v42, v43
  v_cvt_pk_bf16_f32 v47, v44, v45
  buffer_store_dwordx4 v[46:49], v0, s[4:7], s40 offen sc1
  v_cvt_pk_bf16_f32 v50, v50, v51
  v_cvt_pk_bf16_f32 v51, v52, v53
  s_nop 0
  v_cvt_pk_bf16_f32 v52, v54, v55
  v_cvt_pk_bf16_f32 v53, v56, v57
  buffer_store_dwordx4 v[50:53], v0, s[4:7], s41 offen sc1
L_done_f:
  s_branch L_exit
L_got_s:
  s_cbranch_scc1 L_last_s
L_got2_s:
  v_smfmac_f32_16x16x64_bf16 v[34:37], v[14:17], v[58:65], v8
  ds_write_b128 v1, v[14:17]
  s_add_u32 s43, s18, 1
  s_min_u32 s43, s43, 63
  s_lshr_b32 s93, s43, 1
  s_bitcmp1_b32 s43, 0
  s_cselect_b32 s44, s91, s90
  s_cmp_gt_u32 s44, s93
  s_cbranch_scc0 L_qr_76
L_qr_77:
  s_add_u32 s44, s38, 262144
  v_smfmac_f32_16x16x64_bf16 v[38:41], v[14:17], v[66:73], v8
  ds_write_b128 v1, v[18:21] offset:4096
  buffer_load_dword v10, s[4:7], s44 offen lds
  v_smfmac_f32_16x16x64_bf16 v[42:45], v[14:17], v[192:199], v8
  ds_read_b128 v[58:61], v2 offset:0
  s_bitcmp1_b32 s18, 0
  s_cselect_b32 s86, 12288, 0
  v_smfmac_f32_16x16x64_bf16 v[46:49], v[14:17], v[200:207], v8
  ds_read_b128 v[62:65], v2 offset:1024
  s_add_u32 s86, s86, s92
  s_add_u32 s87, s86, 3584
  v_smfmac_f32_16x16x64_bf16 v[50:53], v[14:17], a[32:39], v8
  ds_read_b128 v[66:69], v2 offset:2048
  s_sub_u32 s86, s86, 256
  v_smfmac_f32_16x16x64_bf16 v[54:57], v[14:17], a[40:47], v8
  ds_read_b128 v[70:73], v2 offset:3072
  buffer_load_dword off, s[4:7], s86 offset:256 sc1 lds
  v_smfmac_f32_16x16x64_bf16 v[34:37], v[18:21], v[80:87], v8
  buffer_load_dword off, s[4:7], s87 offset:512 sc1 lds
  v_smfmac_f32_16x16x64_bf16 v[38:41], v[18:21], v[88:95], v8
  s_waitcnt lgkmcnt(4)
  s_barrier
  ds_read_b128 v[26:29], v12 offset:0
  s_waitcnt lgkmcnt(3)
  v_smfmac_f32_16x16x64_bf16 v[42:45], v[18:21], v[58:65], v8
  ds_read_b128 v[30:33], v13 offset:0
  s_xor_b32 s34, s34, 524288
  s_xor_b32 s35, s35, 524288
  s_waitcnt lgkmcnt(2)
  v_smfmac_f32_16x16x64_bf16 v[46:49], v[18:21], v[66:73], v8
  ds_read_b128 v[58:61], v2 offset:16384
  s_xor_b32 s36, s36, 524288
  s_xor_b32 s37, s37, 524288
  v_smfmac_f32_16x16x64_bf16 v[50:53], v[18:21], a[48:55], v8
  ds_read_b128 v[62:65], v2 offset:17408
  s_xor_b32 s33, s33, 524288
  s_add_u32 s43, s18, 1
  v_smfmac_f32_16x16x64_bf16 v[54:57], v[18:21], a[56:63], v8
  ds_read_b128 v[66:69], v2 offset:18432
  s_and_b32 s43, s43, 3
  s_lshl_b32 s43, s43, 14
  v_smfmac_f32_16x16x64_bf16 v[34:37], v[22:25], v[96:103], v8
  ds_read_b128 v[70:73], v2 offset:19456
  s_add_u32 s31, s62, s43
  s_add_u32 s28, s63, s43
  v_smfmac_f32_16x16x64_bf16 v[38:41], v[22:25], v[104:111], v8
  ds_read_b128 v[14:17], v11 offset:0
  s_add_u32 s29, s28, 4096
  s_add_u32 s30, s43, 73728
  v_smfmac_f32_16x16x64_bf16 v[42:45], v[22:25], v[208:215], v8
  ds_read_b128 v[18:21], v12 offset:4096
  v_smfmac_f32_16x16x64_bf16 v[46:49], v[22:25], v[216:223], v8
  s_waitcnt lgkmcnt(4)
  v_smfmac_f32_16x16x64_bf16 v[50:53], v[22:25], v[58:65], v8
  s_waitcnt lgkmcnt(2)
  v_smfmac_f32_16x16x64_bf16 v[54:57], v[22:25], v[66:73], v8
  ds_read_b128 v[58:61], v2 offset:4096
  v_smfmac_f32_16x16x64_bf16 v[34:37], v[26:29], v[112:119], v8
  ds_read_b128 v[62:65], v2 offset:5120
  ds_read_b128 v[22:25], v13 offset:4096
  v_smfmac_f32_16x16x64_bf16 v[38:41], v[26:29], v[120:127], v8
  ds_read_b128 v[66:69], v2 offset:6144
  v_smfmac_f32_16x16x64_bf16 v[42:45], v[26:29], v[224:231], v8
  ds_read_b128 v[70:73], v2 offset:7168
  v_smfmac_f32_16x16x64_bf16 v[46:49], v[26:29], v[232:239], v8
  v_smfmac_f32_16x16x64_bf16 v[34:37], v[30:33], v[128:135], v8
  ds_read_b128 v[26:29], v11 offset:4096
  v_smfmac_f32_16x16x64_bf16 v[38:41], v[30:33], v[136:143], v8
  s_waitcnt lgkmcnt(4)
  v_smfmac_f32_16x16x64_bf16 v[42:45], v[30:33], v[58:65], v8
  s_waitcnt lgkmcnt(1)
  v_smfmac_f32_16x16x64_bf16 v[46:49], v[30:33], v[66:73], v8
  ds_read_b128 v[58:61], v2 offset:8192
  buffer_load_dwordx4 v[30:33], v0, s[4:7], s38 offen
  v_smfmac_f32_16x16x64_bf16 v[34:37], v[14:17], v[144:151], v8
  ds_read_b128 v[62:65], v2 offset:9216
  v_smfmac_f32_16x16x64_bf16 v[38:41], v[14:17], v[152:159], v8
  ds_read_b128 v[66:69], v2 offset:10240
  v_smfmac_f32_16x16x64_bf16 v[42:45], v[14:17], v[240:247], v8
  ds_read_b128 v[70:73], v2 offset:11264
  v_smfmac_f32_16x16x64_bf16 v[46:49], v[14:17], v[248:255], v8
  buffer_load_dwordx4 v[14:17], v0, s[4:7], s38 offen offset:1024
  v_smfmac_f32_16x16x64_bf16 v[34:37], v[18:21], v[160:167], v8
  v_smfmac_f32_16x16x64_bf16 v[38:41], v[18:21], v[168:175], v8
  s_waitcnt lgkmcnt(2)
  v_smfmac_f32_16x16x64_bf16 v[34:37], v[22:25], v[58:65], v8
  s_waitcnt lgkmcnt(0)
  v_smfmac_f32_16x16x64_bf16 v[38:41], v[22:25], v[66:73], v8
  ds_read_b128 v[58:61], v2 offset:12288
  v_smfmac_f32_16x16x64_bf16 v[34:37], v[26:29], v[176:183], v8
  ds_read_b128 v[62:65], v2 offset:13312
  v_smfmac_f32_16x16x64_bf16 v[38:41], v[26:29], v[184:191], v8
  ds_read_b128 v[66:69], v2 offset:14336
  v_smfmac_f32_16x16x64_bf16 v[42:45], v[18:21], a[0:7], v8
  ds_read_b128 v[70:73], v2 offset:15360
  v_smfmac_f32_16x16x64_bf16 v[46:49], v[18:21], a[8:15], v8
  v_cvt_pk_bf16_f32 v34, v34, v35
  v_smfmac_f32_16x16x64_bf16 v[42:45], v[22:25], a[16:23], v8
  v_cvt_pk_bf16_f32 v35, v36, v37
  v_smfmac_f32_16x16x64_bf16 v[46:49], v[22:25], a[24:31], v8
  v_cvt_pk_bf16_f32 v36, v38, v39
  s_waitcnt lgkmcnt(2)
  v_smfmac_f32_16x16x64_bf16 v[42:45], v[26:29], v[58:65], v8
  v_cvt_pk_bf16_f32 v37, v40, v41
  s_waitcnt lgkmcnt(0)
  v_smfmac_f32_16x16x64_bf16 v[46:49], v[26:29], v[66:73], v8
  v_mfma_f32_16x16x16_bf16 v[38:41], v[36:37], v[74:75], 0
  v_mfma_f32_16x16x16_bf16 v[34:37], v[34:35], v[74:75], 0
  v_smfmac_f32_16x16x64_bf16 v[50:53], v[18:21], a[112:119], v8
  v_cvt_pk_bf16_f32 v42, v42, v43
  v_cvt_pk_bf16_f32 v43, v44, v45
  v_smfmac_f32_16x16x64_bf16 v[54:57], v[18:21], a[120:127], v8
  ds_read_b128 v[18:21], v12 offset:0
  v_cvt_pk_bf16_f32 v44, v46, v47
  v_cvt_pk_bf16_f32 v45, v48, v49
  v_cvt_pk_bf16_f32 v41, v40, v41
  v_cvt_pk_bf16_f32 v40, v38, v39
  v_mfma_f32_16x16x16_bf16 v[46:49], v[44:45], v[74:75], 0
  v_mfma_f32_16x16x16_bf16 v[42:45], v[42:43], v[74:75], 0
  v_cvt_pk_bf16_f32 v38, v34, v35
  v_cvt_pk_bf16_f32 v39, v36, v37
  s_waitcnt vmcnt(0)
  s_nop 0
  v_mfma_f32_16x16x32_bf16 v[34:37], v[30:33], v[38:41], 0
  v_mfma_f32_16x16x32_bf16 v[58:61], v[14:17], v[38:41], 0
  v_cvt_pk_bf16_f32 v49, v48, v49
  v_cvt_pk_bf16_f32 v48, v46, v47
  v_cvt_pk_bf16_f32 v46, v42, v43
  v_cvt_pk_bf16_f32 v47, v44, v45
  buffer_load_dwordx4 v[42:45], v0, s[4:7], s39 offen offset:1024
  s_nop 0
  v_mfma_f32_16x16x32_bf16 v[62:65], v[46:49], v[38:41], 0
  v_smfmac_f32_16x16x64_bf16 v[50:53], v[22:25], a[128:135], v8
  v_cndmask_b32 v30, v34, v58, s[52:53]
  v_cndmask_b32 v31, v35, v59, s[52:53]
  v_cndmask_b32 v32, v36, v60, s[52:53]
  v_cndmask_b32 v33, v37, v61, s[52:53]
  ds_write_b128 v1, v[30:33] offset:9216
  buffer_load_dwordx4 v[34:37], v0, s[4:7], s39 offen
  ds_write_b64 v3, v[62:63]
  v_smfmac_f32_16x16x64_bf16 v[54:57], v[22:25], a[136:143], v8
  ds_read_b128 v[22:25], v13 offset:0
  buffer_store_dwordx4 v[46:49], v0, s[4:7], s40 offen sc1
  v_mov_b32 v76, s18
  v_smfmac_f32_16x16x64_bf16 v[50:53], v[26:29], a[144:151], v8
  buffer_store_dword v76, v0, s[24:27], 0 offen sc1
  v_and_b32 v38, -32, v3
  v_smfmac_f32_16x16x64_bf16 v[54:57], v[26:29], a[152:159], v8
  ds_read_b128 v[26:29], v11 offset:0
  s_waitcnt lgkmcnt(4)
  v_smfmac_f32_16x16x64_bf16 v[50:53], v[18:21], a[64:71], v8
  s_waitcnt lgkmcnt(2)
  s_barrier
  ds_read_b128 v[66:69], v12 offset:9216
  ds_read_b128 v[70:73], v13 offset:9216
  ds_read_b128 v[58:61], v11 offset:9216
  ds_read_b128 v[62:65], v38
  ds_read_b128 v[76:79], v38 offset:16
  v_smfmac_f32_16x16x64_bf16 v[54:57], v[18:21], a[72:79], v8
  s_add_u32 s44, s39, 262144
  buffer_load_dword v10, s[4:7], s44 offen lds
  s_waitcnt lgkmcnt(6)
  v_smfmac_f32_16x16x64_bf16 v[50:53], v[22:25], a[80:87], v8
  v_smfmac_f32_16x16x64_bf16 v[54:57], v[22:25], a[88:95], v8
  s_waitcnt lgkmcnt(5)
  v_smfmac_f32_16x16x64_bf16 v[50:53], v[26:29], a[96:103], v8
  v_smfmac_f32_16x16x64_bf16 v[54:57], v[26:29], a[104:111], v8
  v_mov_b64 v[14:15], s[48:49]
  v_mov_b64 v[16:17], s[48:49]
  v_mov_b64 v[46:47], s[50:51]
  s_waitcnt lgkmcnt(4)
  v_pk_add_f32 v[66:67], v[30:31], v[66:67]
  v_pk_add_f32 v[68:69], v[32:33], v[68:69]
  s_waitcnt lgkmcnt(2)
  v_pk_add_f32 v[70:71], v[70:71], v[58:59]
  v_pk_add_f32 v[72:73], v[72:73], v[60:61]
  s_waitcnt lgkmcnt(0)
  v_pk_add_f32 v[62:63], v[62:63], v[64:65]
  v_pk_add_f32 v[76:77], v[76:77], v[78:79]
  v_pk_add_f32 v[66:67], v[66:67], v[70:71]
  v_pk_add_f32 v[68:69], v[68:69], v[72:73]
  v_pk_add_f32 v[62:63], v[62:63], v[76:77]
  v_max3_f32 v12, v66, v67, v68
  v_max3_f32 v13, v69, v62, v63
  v_max_f32 v12, v12, v13
  s_nop 1
  v_max_f32_dpp v12, v12, v12 quad_perm:[2,3,0,1] row_mask:0xf bank_mask:0xf
  v_cvt_pk_bf16_f32 v50, v50, v51
  v_mov_b32 v13, v12
  v_cvt_pk_bf16_f32 v51, v52, v53
  v_cvt_pk_bf16_f32 v52, v54, v55
  v_permlane16_swap_b32 v12, v13
  v_cvt_pk_bf16_f32 v53, v56, v57
  v_max_f32 v12, v12, v13
  v_mov_b32 v13, v12
  buffer_store_dwordx4 v[50:53], v0, s[4:7], s41 offen sc1
  s_nop 0
  v_permlane32_swap_b32 v12, v13
  v_max_f32 v12, v12, v13
  v_mul_f32 v12, s46, v12
  v_pk_fma_f32 v[66:67], v[66:67], s[46:47], v[12:13] op_sel_hi:[1,1,0] neg_lo:[0,0,1] neg_hi:[0,0,1]
  v_pk_fma_f32 v[68:69], v[68:69], s[46:47], v[12:13] op_sel_hi:[1,1,0] neg_lo:[0,0,1] neg_hi:[0,0,1]
  v_pk_fma_f32 v[62:63], v[62:63], s[46:47], v[12:13] op_sel_hi:[1,1,0] neg_lo:[0,0,1] neg_hi:[0,0,1]
  v_exp_f32 v66, v66
  v_exp_f32 v67, v67
  v_exp_f32 v68, v68
  v_exp_f32 v69, v69
  v_exp_f32 v62, v62
  v_exp_f32 v63, v63
  v_cvt_pk_bf16_f32 v66, v66, v67
  v_cvt_pk_bf16_f32 v67, v68, v69
  v_cvt_pk_bf16_f32 v62, v62, v63
  v_mov_b32_dpp v68, v66 quad_perm:[2,3,0,1] row_mask:0xf bank_mask:0xf
  v_mov_b32_dpp v69, v67 quad_perm:[2,3,0,1] row_mask:0xf bank_mask:0xf
  v_mov_b32 v63, v62
  s_waitcnt vmcnt(4)
  v_mfma_f32_16x16x32_bf16 v[18:21], v[14:17], v[66:69], 0
  v_mfma_f32_16x16x32_bf16 v[22:25], v[34:37], v[66:69], 0
  v_mfma_f32_16x16x32_bf16 v[26:29], v[42:45], v[66:69], 0
  v_mfma_f32_16x16x16_bf16 v[18:21], v[46:47], v[62:63], v[18:21]
  v_mfma_f32_16x16x16_bf16 v[22:25], v[50:51], v[62:63], v[22:25]
  v_mfma_f32_16x16x16_bf16 v[26:29], v[52:53], v[62:63], v[26:29]
  v_rcp_f32 v12, v18
  s_nop 2
  v_pk_mul_f32 v[22:23], v[22:23], v[12:13] op_sel_hi:[1,0]
  v_pk_mul_f32 v[24:25], v[24:25], v[12:13] op_sel_hi:[1,0]
  s_nop 1
  v_pk_mul_f32 v[26:27], v[26:27], v[12:13] op_sel_hi:[1,0]
  v_pk_mul_f32 v[28:29], v[28:29], v[12:13] op_sel_hi:[1,0]
  v_cvt_pk_bf16_f32 v54, v22, v23
  v_cvt_pk_bf16_f32 v55, v24, v25
  v_cvt_pk_bf16_f32 v56, v26, v27
  v_cvt_pk_bf16_f32 v57, v28, v29
  s_andn2_b64 exec, exec, s[52:53]
  ds_write_b128 v4, v[54:57]
  s_mov_b64 exec, -1
  ds_read_b128 v[58:61], v2 offset:20480
  ds_read_b128 v[62:65], v2 offset:21504
  ds_read_b128 v[66:69], v2 offset:22528
  ds_read_b128 v[70:73], v2 offset:23552
  v_mov_b64 v[14:15], s[94:95]
  v_mov_b64 v[16:17], s[94:95]
  v_mov_b64 v[18:19], s[94:95]
  v_mov_b64 v[20:21], s[94:95]
  v_mov_b64 v[22:23], s[94:95]
  v_mov_b64 v[24:25], s[94:95]
  v_mov_b64 v[26:27], s[94:95]
  v_mov_b64 v[28:29], s[94:95]
  v_mov_b64 v[30:31], s[94:95]
  v_mov_b64 v[32:33], s[94:95]
  s_waitcnt lgkmcnt(4)
  s_barrier
  ds_read_b128 v[50:53], v0 offset:14336
  ds_read_b128 v[54:57], v0 offset:15360
  v_mov_b64 v[34:35], s[94:95]
  v_mov_b64 v[36:37], s[94:95]
  v_mov_b64 v[38:39], s[94:95]
  v_mov_b64 v[40:41], s[94:95]
  v_mov_b64 v[42:43], s[94:95]
  v_mov_b64 v[44:45], s[94:95]
  v_mov_b64 v[46:47], s[94:95]
  v_mov_b64 v[48:49], s[94:95]
  s_add_u32 s38, s38, 262144
  s_add_u32 s39, s39, 262144
  s_add_u32 s40, s40, 131072
  s_add_u32 s41, s41, 131072
  s_waitcnt lgkmcnt(1)
  v_smfmac_f32_16x16x64_bf16 v[14:17], v[50:53], v[58:65], v8
  s_waitcnt lgkmcnt(0)
  v_smfmac_f32_16x16x64_bf16 v[14:17], v[54:57], v[66:73], v8
  ds_read_b128 v[58:61], v2 offset:24576
  ds_read_b32 v76, v0 offset:8448
  v_smfmac_f32_16x16x64_bf16 v[18:21], v[50:53], a[160:167], v8
  ds_read_b128 v[62:65], v2 offset:25600
  ds_read_b128 v[66:69], v2 offset:26624
  ds_read_b32 v77, v0 offset:8704
  v_smfmac_f32_16x16x64_bf16 v[18:21], v[54:57], a[168:175], v8
  ds_read_b128 v[70:73], v2 offset:27648
  v_add_f32 v14, v14, v16
  v_add_f32 v15, v15, v17
  v_smfmac_f32_16x16x64_bf16 v[22:25], v[50:53], a[176:183], v8
  v_cvt_pk_bf16_f32 v14, v14, v15
  v_smfmac_f32_16x16x64_bf16 v[22:25], v[54:57], a[184:191], v8
  buffer_store_dword v14, v5, s[4:7], s33 offen offset:0 sc1
  v_add_f32 v18, v18, v20
  v_add_f32 v19, v19, v21
  v_smfmac_f32_16x16x64_bf16 v[26:29], v[50:53], a[192:199], v8
  v_cvt_pk_bf16_f32 v18, v18, v19
  v_smfmac_f32_16x16x64_bf16 v[26:29], v[54:57], a[200:207], v8
  buffer_store_dword v18, v5, s[4:7], s33 offen offset:256 sc1
  v_add_f32 v22, v22, v24
  v_add_f32 v23, v23, v25
  s_waitcnt lgkmcnt(3)
  v_smfmac_f32_16x16x64_bf16 v[30:33], v[50:53], v[58:65], v8
  v_cvt_pk_bf16_f32 v22, v22, v23
  s_waitcnt lgkmcnt(0)
  v_smfmac_f32_16x16x64_bf16 v[30:33], v[54:57], v[66:73], v8
  buffer_store_dword v22, v5, s[4:7], s33 offen offset:512 sc1
  ds_read_b128 v[58:61], v2 offset:28672
  v_add_f32 v26, v26, v28
  v_add_f32 v27, v27, v29
  v_min_u32 v76, v76, v77
  v_smfmac_f32_16x16x64_bf16 v[34:37], v[50:53], a[208:215], v8
  ds_read_b128 v[62:65], v2 offset:29696
  ds_read_b128 v[66:69], v2 offset:30720
  v_cvt_pk_bf16_f32 v26, v26, v27
  v_readfirstlane_b32 s86, v76
  v_smfmac_f32_16x16x64_bf16 v[34:37], v[54:57], a[216:223], v8
  buffer_store_dword v26, v5, s[4:7], s33 offen offset:768 sc1
  ds_read_b128 v[70:73], v2 offset:31744
  s_bitcmp1_b32 s18, 0
  v_add_f32 v30, v30, v32
  v_add_f32 v31, v31, v33
  v_smfmac_f32_16x16x64_bf16 v[38:41], v[50:53], a[224:231], v8
  s_cselect_b32 s91, s86, s91
  v_cvt_pk_bf16_f32 v30, v30, v31
  v_smfmac_f32_16x16x64_bf16 v[38:41], v[54:57], a[232:239], v8
  buffer_store_dword v30, v5, s[4:7], s33 offen offset:1024 sc1
  s_cselect_b32 s90, s90, s86
  v_add_f32 v34, v34, v36
  v_add_f32 v35, v35, v37
  v_smfmac_f32_16x16x64_bf16 v[42:45], v[50:53], a[240:247], v8
  v_cvt_pk_bf16_f32 v34, v34, v35
  v_smfmac_f32_16x16x64_bf16 v[42:45], v[54:57], a[248:255], v8
  buffer_store_dword v34, v5, s[4:7], s33 offen offset:1280 sc1
  v_add_f32 v38, v38, v40
  v_add_f32 v39, v39, v41
  s_waitcnt lgkmcnt(2)
  v_smfmac_f32_16x16x64_bf16 v[46:49], v[50:53], v[58:65], v8
  v_cvt_pk_bf16_f32 v38, v38, v39
  s_waitcnt lgkmcnt(0)
  v_smfmac_f32_16x16x64_bf16 v[46:49], v[54:57], v[66:73], v8
  buffer_store_dword v38, v5, s[4:7], s33 offen offset:1536 sc1
  v_add_f32 v42, v42, v44
  v_add_f32 v43, v43, v45
  v_cvt_pk_bf16_f32 v42, v42, v43
  s_nop 3
  v_add_f32 v46, v46, v48
  v_add_f32 v47, v47, v49
  buffer_store_dword v42, v5, s[4:7], s33 offen offset:1792 sc1
  v_cvt_pk_bf16_f32 v46, v46, v47
  buffer_store_dword v46, v5, s[4:7], s33 offen offset:2048 sc1
  s_add_u32 s18, s18, 1
  s_cmp_eq_u32 s22, 0
  s_cbranch_scc1 L_nu_s
  s_mov_b32 s42, 0
  v_cndmask_b32 v76, 0, v9, s[54:55]
  v_cndmask_b32 v77, 0, v9, s[56:57]
  v_cndmask_b32 v78, 0, v9, s[58:59]
  v_cndmask_b32 v79, 0, v9, s[60:61]
  buffer_load_dwordx4 v[14:17], v6, s[20:23], s34 offen sc1
  buffer_load_dwordx4 v[18:21], v6, s[20:23], s35 offen sc1
  buffer_load_dwordx4 v[22:25], v6, s[20:23], s36 offen sc1
  buffer_load_dwordx4 v[26:29], v6, s[20:23], s37 offen sc1
  v_mov_b64 v[34:35], s[94:95]
  v_mov_b64 v[36:37], s[94:95]
  v_mov_b64 v[38:39], s[94:95]
  v_mov_b64 v[40:41], s[94:95]
  v_mov_b64 v[42:43], s[94:95]
  v_mov_b64 v[44:45], s[94:95]
  v_mov_b64 v[46:47], s[94:95]
  v_mov_b64 v[48:49], s[94:95]
  buffer_load_dwordx4 v[14:17], v6, s[20:23], s34 offen sc1
  buffer_load_dwordx4 v[18:21], v6, s[20:23], s35 offen sc1
  buffer_load_dwordx4 v[22:25], v6, s[20:23], s36 offen sc1
  buffer_load_dwordx4 v[26:29], v6, s[20:23], s37 offen sc1
  s_waitcnt vmcnt(7)
  v_max3_u32 v12, v14, v15, v16
  v_max_u32 v12, v12, v17
  v_mfma_f32_16x16x32_bf16 v[30:33], v[14:17], v[76:79], 0
  s_waitcnt vmcnt(6)
  v_max3_u32 v12, v12, v18, v19
  v_max3_u32 v12, v12, v20, v21
  v_mfma_f32_16x16x32_bf16 v[30:33], v[18:21], v[76:79], v[30:33]
  s_waitcnt vmcnt(5)
  v_max3_u32 v12, v12, v22, v23
  v_max3_u32 v12, v12, v24, v25
  v_mfma_f32_16x16x32_bf16 v[30:33], v[22:25], v[76:79], v[30:33]
  s_waitcnt vmcnt(4)
  v_max3_u32 v12, v12, v26, v27
  v_max3_u32 v12, v12, v28, v29
  v_mfma_f32_16x16x32_bf16 v[30:33], v[26:29], v[76:79], v[30:33]
  v_cmp_eq_u32 vcc, -1, v12
  s_cbranch_vccnz L_rretry_s
L_rgot_s:
  s_nop 5
  v_add_f32 v30, v30, v32
  v_add_f32 v31, v31, v33
  v_xor_b32 v12, 1024, v1
  v_cvt_pk_bf16_f32 v30, v30, v31
  v_xor_b32 v13, 2048, v1
  s_mov_b32 s42, 0
  buffer_store_dword v30, v7, s[20:23], s31 offen sc1
  ds_read_b128 v[58:61], v2 offset:32768
  ds_read_b128 v[62:65], v2 offset:33792
  ds_read_b128 v[66:69], v2 offset:34816
  ds_read_b128 v[70:73], v2 offset:35840
  v_mov_b64 v[50:51], s[94:95]
  v_mov_b64 v[52:53], s[94:95]
  v_mov_b64 v[54:55], s[94:95]
  v_mov_b64 v[56:57], s[94:95]
  v_xor_b32 v11, 3072, v1
L_gprep_s:
  s_barrier
  buffer_load_dwordx4 v[14:17], v0, s[4:7], s28 offen sc1
  buffer_load_dwordx4 v[18:21], v0, s[4:7], s29 offen sc1
  buffer_load_dwordx4 v[22:25], v0, s[4:7], s30 offen sc1
  s_cmp_eq_u32 s18, 63
  s_waitcnt vmcnt(0) lgkmcnt(0)
  v_max3_u32 v26, v14, v15, v16
  v_max3_u32 v27, v17, v18, v19
  v_max3_u32 v26, v26, v20, v21
  v_max3_u32 v27, v27, v22, v23
  v_max3_u32 v26, v26, v24, v25
  v_max_u32 v26, v26, v27
  v_cmp_eq_u32 vcc, -1, v26
  s_cbranch_vccz L_got_s
L_gretry_s:
  buffer_load_dwordx4 v[14:17], v0, s[4:7], s28 offen sc1
  buffer_load_dwordx4 v[18:21], v0, s[4:7], s29 offen sc1
  buffer_load_dwordx4 v[22:25], v0, s[4:7], s30 offen sc1
  s_add_u32 s42, s42, 1
  s_cmp_lt_u32 s42, 400000
  s_cbranch_scc0 L_fail
  s_cmp_eq_u32 s18, 63
  s_waitcnt vmcnt(0)
  v_max3_u32 v26, v14, v15, v16
  v_max3_u32 v27, v17, v18, v19
  v_max3_u32 v26, v26, v20, v21
  v_max3_u32 v27, v27, v22, v23
  v_max3_u32 v26, v26, v24, v25
  v_max_u32 v26, v26, v27
  v_cmp_eq_u32 vcc, -1, v26
  s_cbranch_vccz L_got_s
  s_branch L_gretry_s
L_nu_s:
  s_cmp_lg_u32 s17, 3
  s_cbranch_scc1 L_nr_79
  v_mov_b64 v[26:27], s[100:101]
  v_mov_b64 v[28:29], s[100:101]
  s_xor_b32 s43, s33, 524288
  s_sub_u32 s43, s43, 6912
  s_add_u32 s44, s18, 2
  s_and_b32 s44, s44, 3
  s_lshl_b32 s44, s44, 14
  s_add_u32 s44, s44, 65536
  buffer_store_dwordx4 v[26:29], v0, s[4:7], s43 offen offset:0 sc1
  buffer_store_dwordx4 v[26:29], v0, s[4:7], s43 offen offset:1024 sc1
  buffer_store_dwordx4 v[26:29], v0, s[4:7], s43 offen offset:2048 sc1
  buffer_store_dwordx4 v[26:29], v0, s[4:7], s43 offen offset:3072 sc1
  s_add_u32 s43, s43, 4096
  buffer_store_dwordx4 v[26:29], v0, s[4:7], s43 offen offset:0 sc1
  buffer_store_dwordx4 v[26:29], v0, s[4:7], s43 offen offset:1024 sc1
  buffer_store_dwordx4 v[26:29], v0, s[4:7], s43 offen offset:2048 sc1
  buffer_store_dwordx4 v[26:29], v0, s[4:7], s43 offen offset:3072 sc1
  s_add_u32 s43, s43, 4096
  buffer_store_dwordx4 v[26:29], v0, s[4:7], s43 offen offset:0 sc1
  buffer_store_dwordx2 v[26:27], v7, s[4:7], s44 offen sc1
L_nr_79:
  v_xor_b32 v12, 1024, v1
  v_xor_b32 v13, 2048, v1
  v_xor_b32 v11, 3072, v1
  s_mov_b32 s42, 0
  ds_read_b128 v[58:61], v2 offset:32768
  ds_read_b128 v[62:65], v2 offset:33792
  ds_read_b128 v[66:69], v2 offset:34816
  ds_read_b128 v[70:73], v2 offset:35840
  v_mov_b64 v[34:35], s[94:95]
  v_mov_b64 v[36:37], s[94:95]
  v_mov_b64 v[38:39], s[94:95]
  v_mov_b64 v[40:41], s[94:95]
  v_mov_b64 v[42:43], s[94:95]
  v_mov_b64 v[44:45], s[94:95]
  v_mov_b64 v[46:47], s[94:95]
  v_mov_b64 v[48:49], s[94:95]
  v_mov_b64 v[50:51], s[94:95]
  v_mov_b64 v[52:53], s[94:95]
  v_mov_b64 v[54:55], s[94:95]
  v_mov_b64 v[56:57], s[94:95]
  s_branch L_gprep_s
L_rretry_s:
  buffer_load_dwordx4 v[14:17], v6, s[20:23], s34 offen sc1
  buffer_load_dwordx4 v[18:21], v6, s[20:23], s35 offen sc1
  buffer_load_dwordx4 v[22:25], v6, s[20:23], s36 offen sc1
  buffer_load_dwordx4 v[26:29], v6, s[20:23], s37 offen sc1
  s_add_u32 s42, s42, 1
  s_cmp_lt_u32 s42, 400000
  s_cbranch_scc0 L_fail
  s_waitcnt vmcnt(7)
  v_max3_u32 v12, v14, v15, v16
  v_max_u32 v12, v12, v17
  v_mfma_f32_16x16x32_bf16 v[30:33], v[14:17], v[76:79], 0
  s_waitcnt vmcnt(6)
  v_max3_u32 v12, v12, v18, v19
  v_max3_u32 v12, v12, v20, v21
  v_mfma_f32_16x16x32_bf16 v[30:33], v[18:21], v[76:79], v[30:33]
  s_waitcnt vmcnt(5)
  v_max3_u32 v12, v12, v22, v23
  v_max3_u32 v12, v12, v24, v25
  v_mfma_f32_16x16x32_bf16 v[30:33], v[22:25], v[76:79], v[30:33]
  s_waitcnt vmcnt(4)
  v_max3_u32 v12, v12, v26, v27
  v_max3_u32 v12, v12, v28, v29
  v_mfma_f32_16x16x32_bf16 v[30:33], v[26:29], v[76:79], v[30:33]
  v_cmp_eq_u32 vcc, -1, v12
  s_cbranch_vccz L_rgot_s
  s_branch L_rretry_s
L_qr_76:
  s_and_b32 s43, s43, 1
  s_mul_i32 s45, s43, 12288
  s_add_u32 s45, s45, s92
  s_mov_b32 s42, 0
L_qr_78:
  buffer_load_dword v77, off, s[4:7], s45 sc1
  s_add_u32 s44, s45, 4096
  buffer_load_dword v78, off, s[4:7], s44 sc1
  s_waitcnt vmcnt(0)
  v_min_u32 v77, v77, v78
  s_nop 0
  v_readfirstlane_b32 s44, v77
  s_cmp_eq_u32 s43, 0
  s_cselect_b32 s90, s44, s90
  s_cselect_b32 s91, s91, s44
  s_cmp_gt_u32 s44, s93
  s_cbranch_scc1 L_qr_77
  s_add_u32 s42, s42, 1
  s_cmp_lt_u32 s42, 400000
  s_cbranch_scc1 L_qr_78
  s_branch L_fail
L_last_s:
  v_mov_b32 v76, s18
  buffer_store_dword v76, v0, s[24:27], 0 offen sc1
  ds_write_b128 v1, v[14:17]
  ds_write_b128 v1, v[18:21] offset:4096
  ds_read_b128 v[58:61], v2 offset:0
  ds_read_b128 v[62:65], v2 offset:1024
  ds_read_b128 v[66:69], v2 offset:2048
  ds_read_b128 v[70:73], v2 offset:3072
  v_smfmac_f32_16x16x64_bf16 v[42:45], v[14:17], v[192:199], v8
  v_smfmac_f32_16x16x64_bf16 v[46:49], v[14:17], v[200:207], v8
  v_smfmac_f32_16x16x64_bf16 v[50:53], v[14:17], a[32:39], v8
  v_smfmac_f32_16x16x64_bf16 v[54:57], v[14:17], a[40:47], v8
  v_smfmac_f32_16x16x64_bf16 v[50:53], v[18:21], a[48:55], v8
  v_smfmac_f32_16x16x64_bf16 v[54:57], v[18:21], a[56:63], v8
  v_smfmac_f32_16x16x64_bf16 v[42:45], v[22:25], v[208:215], v8
  v_smfmac_f32_16x16x64_bf16 v[46:49], v[22:25], v[216:223], v8
  s_waitcnt lgkmcnt(4)
  s_barrier
  ds_read_b128 v[26:29], v12 offset:0
  ds_read_b128 v[30:33], v13 offset:0
  ds_read_b128 v[14:17], v11 offset:0
  s_waitcnt lgkmcnt(5)
  v_smfmac_f32_16x16x64_bf16 v[42:45], v[18:21], v[58:65], v8
  s_waitcnt lgkmcnt(3)
  v_smfmac_f32_16x16x64_bf16 v[46:49], v[18:21], v[66:73], v8
  ds_read_b128 v[58:61], v2 offset:16384
  ds_read_b128 v[62:65], v2 offset:17408
  ds_read_b128 v[66:69], v2 offset:18432
  ds_read_b128 v[70:73], v2 offset:19456
  ds_read_b128 v[18:21], v12 offset:4096
  s_waitcnt lgkmcnt(7)
  v_smfmac_f32_16x16x64_bf16 v[42:45], v[26:29], v[224:231], v8
  v_smfmac_f32_16x16x64_bf16 v[46:49], v[26:29], v[232:239], v8
  v_smfmac_f32_16x16x64_bf16 v[50:53], v[26:29], a[64:71], v8
  v_smfmac_f32_16x16x64_bf16 v[54:57], v[26:29], a[72:79], v8
  ds_read_b128 v[26:29], v11 offset:4096
  s_waitcnt lgkmcnt(4)
  v_smfmac_f32_16x16x64_bf16 v[50:53], v[22:25], v[58:65], v8
  s_waitcnt lgkmcnt(2)
  v_smfmac_f32_16x16x64_bf16 v[54:57], v[22:25], v[66:73], v8
  ds_read_b128 v[58:61], v2 offset:4096
  ds_read_b128 v[62:65], v2 offset:5120
  ds_read_b128 v[66:69], v2 offset:6144
  ds_read_b128 v[70:73], v2 offset:7168
  ds_read_b128 v[22:25], v13 offset:4096
  v_smfmac_f32_16x16x64_bf16 v[50:53], v[30:33], a[80:87], v8
  v_smfmac_f32_16x16x64_bf16 v[54:57], v[30:33], a[88:95], v8
  v_smfmac_f32_16x16x64_bf16 v[42:45], v[14:17], v[240:247], v8
  v_smfmac_f32_16x16x64_bf16 v[46:49], v[14:17], v[248:255], v8
  v_smfmac_f32_16x16x64_bf16 v[50:53], v[14:17], a[96:103], v8
  v_smfmac_f32_16x16x64_bf16 v[54:57], v[14:17], a[104:111], v8
  s_waitcnt lgkmcnt(3)
  v_smfmac_f32_16x16x64_bf16 v[42:45], v[30:33], v[58:65], v8
  s_waitcnt lgkmcnt(1)
  v_smfmac_f32_16x16x64_bf16 v[46:49], v[30:33], v[66:73], v8
  ds_read_b128 v[58:61], v2 offset:12288
  ds_read_b128 v[62:65], v2 offset:13312
  ds_read_b128 v[66:69], v2 offset:14336
  ds_read_b128 v[70:73], v2 offset:15360
  v_smfmac_f32_16x16x64_bf16 v[42:45], v[18:21], a[0:7], v8
  v_smfmac_f32_16x16x64_bf16 v[46:49], v[18:21], a[8:15], v8
  s_waitcnt lgkmcnt(4)
  v_smfmac_f32_16x16x64_bf16 v[42:45], v[22:25], a[16:23], v8
  v_smfmac_f32_16x16x64_bf16 v[46:49], v[22:25], a[24:31], v8
  v_smfmac_f32_16x16x64_bf16 v[50:53], v[18:21], a[112:119], v8
  v_smfmac_f32_16x16x64_bf16 v[54:57], v[18:21], a[120:127], v8
  s_waitcnt lgkmcnt(2)
  v_smfmac_f32_16x16x64_bf16 v[42:45], v[26:29], v[58:65], v8
  s_waitcnt lgkmcnt(0)
  v_smfmac_f32_16x16x64_bf16 v[46:49], v[26:29], v[66:73], v8
  v_smfmac_f32_16x16x64_bf16 v[50:53], v[22:25], a[128:135], v8
  v_smfmac_f32_16x16x64_bf16 v[54:57], v[22:25], a[136:143], v8
  v_cvt_pk_bf16_f32 v42, v42, v43
  v_cvt_pk_bf16_f32 v43, v44, v45
  v_cvt_pk_bf16_f32 v44, v46, v47
  v_cvt_pk_bf16_f32 v45, v48, v49
  s_nop 1
  v_mfma_f32_16x16x16_bf16 v[46:49], v[44:45], v[74:75], 0
  v_mfma_f32_16x16x16_bf16 v[42:45], v[42:43], v[74:75], 0
  v_smfmac_f32_16x16x64_bf16 v[50:53], v[26:29], a[144:151], v8
  v_smfmac_f32_16x16x64_bf16 v[54:57], v[26:29], a[152:159], v8
  v_cvt_pk_bf16_f32 v49, v48, v49
  v_cvt_pk_bf16_f32 v48, v46, v47
  v_cvt_pk_bf16_f32 v46, v42, v43
  v_cvt_pk_bf16_f32 v47, v44, v45
  buffer_store_dwordx4 v[46:49], v0, s[4:7], s40 offen sc1
  v_cvt_pk_bf16_f32 v50, v50, v51
  v_cvt_pk_bf16_f32 v51, v52, v53
  s_nop 0
  v_cvt_pk_bf16_f32 v52, v54, v55
  v_cvt_pk_bf16_f32 v53, v56, v57
  buffer_store_dwordx4 v[50:53], v0, s[4:7], s41 offen sc1
L_done_s:
  s_branch L_exit
L_fail:
  s_mov_b64 exec, 1
  v_mov_b32 v78, 1
  buffer_atomic_add v78, off, s[12:15], 0 offset:32 sc1
  s_waitcnt vmcnt(0)
L_exit:
  s_endpgm
.section .rodata,"a"
.p2align 6
.amdhsa_kernel parallel_sum__memory_aug_recurrent_mem_tr__dense_activation_gelu__prompt_kernel
  .amdhsa_next_free_vgpr 512
  .amdhsa_next_free_sgpr 102
  .amdhsa_accum_offset 256
  .amdhsa_group_segment_fixed_size 0
  .amdhsa_kernarg_size 120
  .amdhsa_user_sgpr_count 2
  .amdhsa_user_sgpr_kernarg_segment_ptr 1
  .amdhsa_system_sgpr_workgroup_id_x 1
.end_amdhsa_kernel
```
